```python
import torch

def _softmax(x, axis=-1):
    return torch.softmax(x, dim=axis)

def _gelu(x):
    return torch.nn.functional.gelu(x, approximate='tanh')

def _silu(x):
    return torch.nn.functional.silu(x)

def _sigmoid(x):
    return torch.sigmoid(x)

def _layernorm(x, axis=-1, eps=1e-05):
    m = x.mean(dim=axis, keepdim=True)
    v = x.var(dim=axis, keepdim=True, unbiased=False)
    return (x - m) / torch.sqrt(v + eps)

def _scatter_add(tgt, idx, src, axis=0):
    return tgt.clone().index_add_(axis, idx, src)

def _segment_sum(src, seg, n):
    out = torch.zeros((n,) + src.shape[1:], dtype=src.dtype)
    return out.index_add_(0, seg, src)

def _pad(x, pw):
    flat = tuple((v for pair in reversed(pw) for v in pair))
    return torch.nn.functional.pad(x, flat)
kernel_name = 'gated_mix__memory_aug_recurrent_mem_tr__ssm_conv_h3__prompt'

def setup_inputs():

    _w = lambda a: (lambda t: t.to(torch.bfloat16) if t.is_floating_point() else t)(torch.as_tensor(a))

    def _A_setup():
        B, S, Dm = (1, 2048, 512)
        H, Dh = (32, 128)
        M, seg = (8, 32)
        seg = min(seg, S)
        S = S // seg * seg
        return {'x': _w((lambda *s: torch.randn(*s, dtype=torch.bfloat16) * 0.05)(B, S, Dm)), 'mem0': _w((lambda *s: torch.randn(*s, dtype=torch.bfloat16) * 0.4)(B, M, Dm)), 'Wq': _w((lambda *s: torch.randn(*s, dtype=torch.bfloat16) * 6.4)(Dm, H, Dh) * Dm ** (-0.5)), 'Wk': _w((lambda *s: torch.randn(*s, dtype=torch.bfloat16) * 6.4)(Dm, H, Dh) * Dm ** (-0.5)), 'Wv': _w((lambda *s: torch.randn(*s, dtype=torch.bfloat16) * 0.4)(Dm, H, Dh) * Dm ** (-0.5)), 'Wo': _w((lambda *s: torch.randn(*s, dtype=torch.bfloat16) * 0.4)(H, Dh, Dm) * (H * Dh) ** (-0.5)), 'seg_len': seg}
    _A_in = _A_setup()

    def _B_setup():
        B, S, D = (1, 2048, 512)
        ks = 4
        return {'q': _w((lambda *s: torch.randn(*s, dtype=torch.bfloat16) * 0.05)(B, S, D)), 'k': _w((lambda *s: torch.randn(*s, dtype=torch.bfloat16) * 0.4)(B, S, D)), 'v': _w((lambda *s: torch.randn(*s, dtype=torch.bfloat16) * 0.4)(B, S, D)), 'shift_k': _w((lambda *s: torch.randn(*s, dtype=torch.bfloat16) * 0.4)(D, ks) * 0.5), 'ssm_k': _w((lambda *s: torch.randn(*s, dtype=torch.bfloat16) * 0.4)(D, S) * (1.0 / S ** 0.5)), 'ssm_D': _w((lambda *s: torch.randn(*s, dtype=torch.bfloat16) * 0.4)(D))}
    _B_in = _B_setup()
    return {'A_x': _A_in['x'], 'A_mem0': _A_in['mem0'], 'A_Wq': _A_in['Wq'], 'A_Wk': _A_in['Wk'], 'A_Wv': _A_in['Wv'], 'A_Wo': _A_in['Wo'], 'A_seg_len': _A_in['seg_len'], 'B_q': _B_in['q'], 'B_k': _B_in['k'], 'B_v': _B_in['v'], 'B_shift_k': _B_in['shift_k'], 'B_ssm_k': _B_in['ssm_k'], 'B_ssm_D': _B_in['ssm_D'], 'gate_w': _w((lambda *s: torch.randn(*s, dtype=torch.bfloat16) * 0.05)(512) * 16.0)}

def reference(A_x, A_mem0, A_Wq, A_Wk, A_Wv, A_Wo, A_seg_len, B_q, B_k, B_v, B_shift_k, B_ssm_k, B_ssm_D, gate_w):

    def _A_ref(x, mem0, Wq, Wk, Wv, Wo, seg_len):
        B, S, Dm = x.shape
        H, Dh = (Wq.shape[1], Wq.shape[2])
        M = mem0.shape[1]
        scale = Dh ** (-0.5)
        n_seg = S // seg_len
        L = M + seg_len
        idx = torch.arange(L)
        mask = (idx[:, None] < M) | (idx[:, None] >= idx[None, :])
        mem = mem0
        outs = []
        for s in range(n_seg):
            xs = x[:, s * seg_len:(s + 1) * seg_len, :].clone()
            h = torch.concatenate([mem, xs], axis=1)
            q = torch.einsum('btd,dhe->bhte', h, Wq)
            k = torch.einsum('btd,dhe->bhte', h, Wk)
            v = torch.einsum('btd,dhe->bhte', h, Wv)
            scores = torch.einsum('bhqe,bhke->bhqk', q, k) * scale
            scores = torch.where(mask[None, None], scores, -1000000000.0)
            p = _softmax(scores, axis=-1)
            o = torch.einsum('bhqk,bhke->bhqe', p, v)
            o = torch.einsum('bhte,hed->btd', o, Wo)
            mem = o[:, :M, :].clone()
            outs.append(o[:, M:, :])
        return torch.concatenate(outs, axis=1)

    def _B_ref(q, k, v, shift_k, ssm_k, ssm_D):
        B, S, D = q.shape
        ks = shift_k.shape[-1]
        k_pad = _pad(k, ((0, 0), (ks - 1, 0), (0, 0)))
        k_shift = torch.zeros_like(k)
        for t in range(ks):
            k_shift = k_shift + k_pad[:, t:t + S, :] * shift_k[:, ks - 1 - t][None, None, :]
        kv = k_shift * v
        L = 2 * S
        kv_pad = _pad(kv, ((0, 0), (0, S), (0, 0)))
        kf_pad = _pad(ssm_k, ((0, 0), (0, S)))
        kv_f = (lambda x, axes=(-2, -1): torch.fft.rfft2(x.float(), dim=axes))(kv_pad[:, None, :, :], axes=(1, 2))
        kf_f = (lambda x, axes=(-2, -1): torch.fft.rfft2(x.float(), dim=axes))(kf_pad[:, None, :], axes=(1, 2))
        kf_f = (lambda x, *d: x.permute(*d))(kf_f, 1, 2, 0)
        y_f = kv_f * kf_f[None, :, :, :]
        y = (lambda x, s, axes=(-2, -1): torch.fft.irfft2(x, s=s, dim=axes).to(torch.bfloat16))(y_f, (1, L), axes=(1, 2))[:, 0, :S, :]
        y = y + kv * ssm_D[None, None, :]
        return q * y
    x = A_x
    g = _sigmoid((x * gate_w).sum(-1, keepdims=True))
    a = _A_ref(x, A_mem0, A_Wq, A_Wk, A_Wv, A_Wo, A_seg_len)
    b = _B_ref(x, B_k, B_v, B_shift_k, B_ssm_k, B_ssm_D)
    return g * a + (1 - g) * b
```

```asm
; @launch grid=(256,1,1) block=(256,1,1) lds=163840
.amdgcn_target "amdgcn-amd-amdhsa--gfx950"
.text
.globl gated_mix__memory_aug_recurrent_mem_tr__ssm_conv_h3__prompt_kernel
.p2align 8
.type gated_mix__memory_aug_recurrent_mem_tr__ssm_conv_h3__prompt_kernel,@function
gated_mix__memory_aug_recurrent_mem_tr__ssm_conv_h3__prompt_kernel:
    s_cmp_ge_u32 s2, 256
    s_cbranch_scc1 L_exit
    s_load_dwordx4 s[4:7], s[0:1], 120
    s_load_dwordx8 s[60:67], s[0:1], 16
    s_getreg_b32 s3, hwreg(HW_REG_XCC_ID)
    s_and_b32 s3, s3, 7
    s_lshl_b32 s3, s3, 2
    s_lshr_b32 s3, 1130694418, s3
    s_and_b32 s3, s3, 7
    v_lshrrev_b32 v1, 6, v0
    s_mov_b32 s22, 0x80000
    v_readfirstlane_b32 s21, v1
    s_mov_b32 s10, 268435456
    s_mov_b32 s11, 0x20000
    s_mov_b32 s18, 256
    s_mov_b32 s19, 0x20000
    s_mov_b32 s23, 0
    s_lshr_b32 s28, s2, 3
    s_lshl_b32 s29, 1, s28
    v_mov_b32 v1, s29
    s_lshl_b32 s29, s3, 5
    s_add_u32 s28, s28, s29
    s_lshl_b32 s29, s3, 2
    s_add_u32 s29, s29, 128
    s_cmp_eq_u32 s3, 0
    s_cselect_b32 s59, 0, s29
    s_waitcnt lgkmcnt(0)
    s_mov_b32 s8, s6
    s_mov_b32 s9, s7
    s_mov_b32 s16, s4
    s_mov_b32 s17, s5
    s_mov_b32 s5, s28
L_dispatch:
    s_cmp_lt_u32 s5, 32
    s_cbranch_scc1 L_chain
    s_cmp_lt_u32 s5, 160
    s_cbranch_scc1 L_attn
    s_branch L_outp
L_el_fix:
    s_waitcnt vmcnt(0)
    s_barrier
    s_mov_b32 s23, 1
    s_cmp_lg_u32 s21, 0
    s_cbranch_scc1 L_el_wait
    s_mov_b64 exec, 1
    v_mov_b32 v2, 1
    s_lshl_b32 s29, s3, 2
    buffer_atomic_add v2, off, s[16:19], s29 offset:160 sc0
    s_waitcnt vmcnt(0)
    v_readfirstlane_b32 s28, v2
    s_nop 4
L_el_spin:
    buffer_load_dword v4, off, s[16:19], 0 sc1
    buffer_load_dwordx4 v[8:11], off, s[16:19], 0 offset:128 sc1
    buffer_load_dwordx4 v[12:15], off, s[16:19], 0 offset:144 sc1
    buffer_load_dwordx4 v[16:19], off, s[16:19], 0 offset:160 sc1
    buffer_load_dwordx4 v[20:23], off, s[16:19], 0 offset:176 sc1
    s_sub_u32 s22, s22, 1
    s_cbranch_scc1 L_exit
    s_waitcnt vmcnt(0)
    v_mov_b32 v8, v4
    s_mov_b32 s4, 0
    v_readfirstlane_b32 s30, v8
    v_readfirstlane_b32 s46, v16
    s_bcnt0_i32_b32 s38, s30
    s_add_u32 s4, s4, s46
    s_sub_u32 s4, s4, s38
    v_readfirstlane_b32 s31, v9
    v_readfirstlane_b32 s47, v17
    s_bcnt0_i32_b32 s39, s31
    s_add_u32 s4, s4, s47
    s_sub_u32 s4, s4, s39
    v_readfirstlane_b32 s32, v10
    v_readfirstlane_b32 s48, v18
    s_bcnt0_i32_b32 s40, s32
    s_add_u32 s4, s4, s48
    s_sub_u32 s4, s4, s40
    v_readfirstlane_b32 s33, v11
    v_readfirstlane_b32 s49, v19
    s_bcnt0_i32_b32 s41, s33
    s_add_u32 s4, s4, s49
    s_sub_u32 s4, s4, s41
    v_readfirstlane_b32 s34, v12
    v_readfirstlane_b32 s50, v20
    s_bcnt0_i32_b32 s42, s34
    s_add_u32 s4, s4, s50
    s_sub_u32 s4, s4, s42
    v_readfirstlane_b32 s35, v13
    v_readfirstlane_b32 s51, v21
    s_bcnt0_i32_b32 s43, s35
    s_add_u32 s4, s4, s51
    s_sub_u32 s4, s4, s43
    v_readfirstlane_b32 s36, v14
    v_readfirstlane_b32 s52, v22
    s_bcnt0_i32_b32 s44, s36
    s_add_u32 s4, s4, s52
    s_sub_u32 s4, s4, s44
    v_readfirstlane_b32 s37, v15
    v_readfirstlane_b32 s53, v23
    s_bcnt0_i32_b32 s45, s37
    s_add_u32 s4, s4, s53
    s_sub_u32 s4, s4, s45
    s_cmp_lg_u32 s4, 0
    s_cbranch_scc1 L_el_spin
    s_mov_b32 s4, 0
    s_cmp_lg_u32 s3, 0
    s_cbranch_scc1 L_el_n0
    s_mov_b32 s5, 0
    s_mov_b32 s29, s30
    s_cmp_lt_u32 s28, s38
    s_cbranch_scc1 L_el_pick
    s_sub_u32 s28, s28, s38
    s_add_u32 s4, s4, s28
    s_branch L_el_move
L_el_n0:
    s_sub_i32 s29, s46, s38
    s_max_i32 s29, s29, 0
    s_add_u32 s4, s4, s29
    s_cmp_lg_u32 s3, 1
    s_cbranch_scc1 L_el_n1
    s_mov_b32 s5, 32
    s_mov_b32 s29, s31
    s_cmp_lt_u32 s28, s39
    s_cbranch_scc1 L_el_pick
    s_sub_u32 s28, s28, s39
    s_add_u32 s4, s4, s28
    s_branch L_el_move
L_el_n1:
    s_sub_i32 s29, s47, s39
    s_max_i32 s29, s29, 0
    s_add_u32 s4, s4, s29
    s_cmp_lg_u32 s3, 2
    s_cbranch_scc1 L_el_n2
    s_mov_b32 s5, 64
    s_mov_b32 s29, s32
    s_cmp_lt_u32 s28, s40
    s_cbranch_scc1 L_el_pick
    s_sub_u32 s28, s28, s40
    s_add_u32 s4, s4, s28
    s_branch L_el_move
L_el_n2:
    s_sub_i32 s29, s48, s40
    s_max_i32 s29, s29, 0
    s_add_u32 s4, s4, s29
    s_cmp_lg_u32 s3, 3
    s_cbranch_scc1 L_el_n3
    s_mov_b32 s5, 96
    s_mov_b32 s29, s33
    s_cmp_lt_u32 s28, s41
    s_cbranch_scc1 L_el_pick
    s_sub_u32 s28, s28, s41
    s_add_u32 s4, s4, s28
    s_branch L_el_move
L_el_n3:
    s_sub_i32 s29, s49, s41
    s_max_i32 s29, s29, 0
    s_add_u32 s4, s4, s29
    s_cmp_lg_u32 s3, 4
    s_cbranch_scc1 L_el_n4
    s_mov_b32 s5, 128
    s_mov_b32 s29, s34
    s_cmp_lt_u32 s28, s42
    s_cbranch_scc1 L_el_pick
    s_sub_u32 s28, s28, s42
    s_add_u32 s4, s4, s28
    s_branch L_el_move
L_el_n4:
    s_sub_i32 s29, s50, s42
    s_max_i32 s29, s29, 0
    s_add_u32 s4, s4, s29
    s_cmp_lg_u32 s3, 5
    s_cbranch_scc1 L_el_n5
    s_mov_b32 s5, 160
    s_mov_b32 s29, s35
    s_cmp_lt_u32 s28, s43
    s_cbranch_scc1 L_el_pick
    s_sub_u32 s28, s28, s43
    s_add_u32 s4, s4, s28
    s_branch L_el_move
L_el_n5:
    s_sub_i32 s29, s51, s43
    s_max_i32 s29, s29, 0
    s_add_u32 s4, s4, s29
    s_cmp_lg_u32 s3, 6
    s_cbranch_scc1 L_el_n6
    s_mov_b32 s5, 192
    s_mov_b32 s29, s36
    s_cmp_lt_u32 s28, s44
    s_cbranch_scc1 L_el_pick
    s_sub_u32 s28, s28, s44
    s_add_u32 s4, s4, s28
    s_branch L_el_move
L_el_n6:
    s_sub_i32 s29, s52, s44
    s_max_i32 s29, s29, 0
    s_add_u32 s4, s4, s29
    s_cmp_lg_u32 s3, 7
    s_cbranch_scc1 L_el_n7
    s_mov_b32 s5, 224
    s_mov_b32 s29, s37
    s_cmp_lt_u32 s28, s45
    s_cbranch_scc1 L_el_pick
    s_sub_u32 s28, s28, s45
    s_add_u32 s4, s4, s28
    s_branch L_el_move
L_el_n7:
    s_sub_i32 s29, s53, s45
    s_max_i32 s29, s29, 0
    s_add_u32 s4, s4, s29
L_el_move:
    s_sub_i32 s54, s38, s46
    s_max_i32 s54, s54, 0
    s_mov_b32 s5, 0
    s_mov_b32 s29, s30
    s_add_u32 s28, s4, s46
    s_cmp_lt_u32 s4, s54
    s_cbranch_scc1 L_el_pick
    s_sub_u32 s4, s4, s54
    s_sub_i32 s54, s39, s47
    s_max_i32 s54, s54, 0
    s_mov_b32 s5, 32
    s_mov_b32 s29, s31
    s_add_u32 s28, s4, s47
    s_cmp_lt_u32 s4, s54
    s_cbranch_scc1 L_el_pick
    s_sub_u32 s4, s4, s54
    s_sub_i32 s54, s40, s48
    s_max_i32 s54, s54, 0
    s_mov_b32 s5, 64
    s_mov_b32 s29, s32
    s_add_u32 s28, s4, s48
    s_cmp_lt_u32 s4, s54
    s_cbranch_scc1 L_el_pick
    s_sub_u32 s4, s4, s54
    s_sub_i32 s54, s41, s49
    s_max_i32 s54, s54, 0
    s_mov_b32 s5, 96
    s_mov_b32 s29, s33
    s_add_u32 s28, s4, s49
    s_cmp_lt_u32 s4, s54
    s_cbranch_scc1 L_el_pick
    s_sub_u32 s4, s4, s54
    s_sub_i32 s54, s42, s50
    s_max_i32 s54, s54, 0
    s_mov_b32 s5, 128
    s_mov_b32 s29, s34
    s_add_u32 s28, s4, s50
    s_cmp_lt_u32 s4, s54
    s_cbranch_scc1 L_el_pick
    s_sub_u32 s4, s4, s54
    s_sub_i32 s54, s43, s51
    s_max_i32 s54, s54, 0
    s_mov_b32 s5, 160
    s_mov_b32 s29, s35
    s_add_u32 s28, s4, s51
    s_cmp_lt_u32 s4, s54
    s_cbranch_scc1 L_el_pick
    s_sub_u32 s4, s4, s54
    s_sub_i32 s54, s44, s52
    s_max_i32 s54, s54, 0
    s_mov_b32 s5, 192
    s_mov_b32 s29, s36
    s_add_u32 s28, s4, s52
    s_cmp_lt_u32 s4, s54
    s_cbranch_scc1 L_el_pick
    s_sub_u32 s4, s4, s54
    s_sub_i32 s54, s45, s53
    s_max_i32 s54, s54, 0
    s_mov_b32 s5, 224
    s_mov_b32 s29, s37
    s_add_u32 s28, s4, s53
    s_cmp_lt_u32 s4, s54
    s_cbranch_scc1 L_el_pick
    s_sub_u32 s4, s4, s54
    s_branch L_exit
L_el_pick:
    s_ff0_i32_b32 s4, s29
    s_bitset1_b32 s29, s4
    s_sub_u32 s28, s28, 1
    s_cbranch_scc0 L_el_pick
    s_add_u32 s5, s5, s4
    v_mov_b32 v2, s5
    v_mov_b32 v3, 14336
    ds_write_b32 v3, v2
    s_mov_b64 exec, -1
    s_waitcnt lgkmcnt(0)
L_el_wait:
    s_barrier
    v_mov_b32 v3, 14336
    ds_read_b32 v2, v3
    s_waitcnt lgkmcnt(0)
    v_readfirstlane_b32 s5, v2
    s_branch L_dispatch
    s_nop 3
L_exit:
    s_endpgm
L_attn:
    s_load_dwordx2 s[28:29], s[0:1], 0
    s_mov_b32 s30, 2097152
    s_mov_b32 s31, 0x20000
    s_lshr_b32 s20, s5, 5
    s_sub_u32 s20, s20, 1
    s_lshl_b32 s20, s20, 3
    s_and_b32 s32, s5, 7
    s_add_u32 s20, s20, s32
    s_bfe_u32 s40, s5, 0x20003
    s_lshl_b32 s34, s40, 15
    s_lshr_b32 s32, s21, 1
    s_lshl_b32 s32, s32, 14
    s_add_u32 s34, s34, s32
    s_and_b32 s32, s21, 1
    s_lshl_b32 s32, s32, 9
    s_add_u32 s34, s34, s32
    s_lshl_b32 s37, s40, 20
    s_add_u32 s37, s37, 16777216
    s_lshl_b32 s32, s20, 6
    s_add_u32 s36, s37, s32
    s_lshl_b32 s33, s20, 6
    s_add_u32 s39, s37, s33
    s_add_u32 s39, s39, 804864
    s_add_u32 s36, s36, 802816
    s_lshl_b32 s32, s20, 2
    s_add_u32 s32, s32, s21
    s_lshl_b32 s33, s32, 10
    s_add_u32 s35, s37, s33
    s_cmp_eq_u32 s40, 0
    s_cselect_b32 s33, 8192, 8192
    s_or_b32 s33, s33, 786432
    s_add_u32 s37, s37, s33
    s_lshl_b32 s38, s40, 18
    s_lshl_b32 s33, s32, 10
    s_add_u32 s38, s38, s33
    s_add_u32 s38, s38, 167772160
    s_lshl_b32 s42, s21, 13
    s_mov_b32 s41, 1040356334
    s_mov_b32 s24, 0xcccccccc
    s_mov_b32 s25, 0xcccccccc
    v_and_b32 v2, 63, v0
    v_and_b32 v3, 15, v0
    v_lshrrev_b32 v4, 4, v2
    v_lshlrev_b32 v10, 7, v2
    v_and_b32 v10, 0, v10
    v_lshlrev_b32 v2, 4, v2
    v_lshlrev_b32 v5, 4, v4
    v_lshl_add_u32 v5, v3, 10, v5
    v_lshlrev_b32 v26, 1, v4
    v_xor_b32 v26, v26, v3
    v_xor_b32 v27, 8, v26
    v_lshlrev_b32 v26, 4, v26
    v_lshlrev_b32 v27, 4, v27
    v_lshl_add_u32 v26, v4, 13, v26
    v_lshl_add_u32 v27, v4, 13, v27
    v_lshrrev_b32 v30, 2, v3
    v_and_b32 v31, 1, v4
    v_lshl_or_b32 v31, v31, 2, v30
    v_lshl_add_u32 v30, v4, 3, v30
    v_lshlrev_b32 v30, 8, v30
    v_and_b32 v32, 3, v3
    v_lshl_add_u32 v30, v32, 3, v30
    s_lshl_b32 s32, s21, 1
    v_xor_b32 v28, s32, v31
    v_xor_b32 v29, 1, v28
    v_lshl_add_u32 v28, v28, 5, v30
    v_lshl_add_u32 v29, v29, 5, v30
    v_add_u32 v28, 32768, v28
    v_add_u32 v29, 32768, v29
    s_lshl_b32 s68, s21, 18
    s_lshl_b32 s32, s20, 8
    s_add_u32 s68, s68, s32
    s_mov_b32 s14, 0x400000
    s_mov_b32 s15, 0x20000
    s_mov_b32 s12, s62
    s_mov_b32 s13, s63
    s_add_u32 s32, s68, 0
    s_add_u32 m0, s42, 32768
    s_nop 0
    buffer_load_dwordx4 v26, s[12:15], s32 offen lds
    s_add_u32 s32, s32, 32768
    s_add_u32 m0, m0, 1024
    s_nop 0
    buffer_load_dwordx4 v26, s[12:15], s32 offen lds
    s_add_u32 s32, s32, 32768
    s_add_u32 m0, m0, 1024
    s_nop 0
    buffer_load_dwordx4 v27, s[12:15], s32 offen lds
    s_add_u32 s32, s32, 32768
    s_add_u32 m0, m0, 1024
    s_nop 0
    buffer_load_dwordx4 v27, s[12:15], s32 offen lds
    s_add_u32 s32, s32, 32768
    s_add_u32 m0, m0, 1024
    s_nop 0
    buffer_load_dwordx4 v26, s[12:15], s32 offen lds
    s_add_u32 s32, s32, 32768
    s_add_u32 m0, m0, 1024
    s_nop 0
    buffer_load_dwordx4 v26, s[12:15], s32 offen lds
    s_add_u32 s32, s32, 32768
    s_add_u32 m0, m0, 1024
    s_nop 0
    buffer_load_dwordx4 v27, s[12:15], s32 offen lds
    s_add_u32 s32, s32, 32768
    s_add_u32 m0, m0, 1024
    s_nop 0
    buffer_load_dwordx4 v27, s[12:15], s32 offen lds
    s_mov_b32 s12, s62
    s_mov_b32 s13, s63
    s_add_u32 s32, s68, 1048576
    s_add_u32 m0, s42, 65536
    s_nop 0
    buffer_load_dwordx4 v26, s[12:15], s32 offen lds
    s_add_u32 s32, s32, 32768
    s_add_u32 m0, m0, 1024
    s_nop 0
    buffer_load_dwordx4 v26, s[12:15], s32 offen lds
    s_add_u32 s32, s32, 32768
    s_add_u32 m0, m0, 1024
    s_nop 0
    buffer_load_dwordx4 v27, s[12:15], s32 offen lds
    s_add_u32 s32, s32, 32768
    s_add_u32 m0, m0, 1024
    s_nop 0
    buffer_load_dwordx4 v27, s[12:15], s32 offen lds
    s_add_u32 s32, s32, 32768
    s_add_u32 m0, m0, 1024
    s_nop 0
    buffer_load_dwordx4 v26, s[12:15], s32 offen lds
    s_add_u32 s32, s32, 32768
    s_add_u32 m0, m0, 1024
    s_nop 0
    buffer_load_dwordx4 v26, s[12:15], s32 offen lds
    s_add_u32 s32, s32, 32768
    s_add_u32 m0, m0, 1024
    s_nop 0
    buffer_load_dwordx4 v27, s[12:15], s32 offen lds
    s_add_u32 s32, s32, 32768
    s_add_u32 m0, m0, 1024
    s_nop 0
    buffer_load_dwordx4 v27, s[12:15], s32 offen lds
    s_mov_b32 s12, s62
    s_mov_b32 s13, s63
    s_add_u32 s32, s68, 2097152
    s_add_u32 m0, s42, 98304
    s_nop 0
    buffer_load_dwordx4 v26, s[12:15], s32 offen lds
    s_add_u32 s32, s32, 32768
    s_add_u32 m0, m0, 1024
    s_nop 0
    buffer_load_dwordx4 v26, s[12:15], s32 offen lds
    s_add_u32 s32, s32, 32768
    s_add_u32 m0, m0, 1024
    s_nop 0
    buffer_load_dwordx4 v27, s[12:15], s32 offen lds
    s_add_u32 s32, s32, 32768
    s_add_u32 m0, m0, 1024
    s_nop 0
    buffer_load_dwordx4 v27, s[12:15], s32 offen lds
    s_add_u32 s32, s32, 32768
    s_add_u32 m0, m0, 1024
    s_nop 0
    buffer_load_dwordx4 v26, s[12:15], s32 offen lds
    s_add_u32 s32, s32, 32768
    s_add_u32 m0, m0, 1024
    s_nop 0
    buffer_load_dwordx4 v26, s[12:15], s32 offen lds
    s_add_u32 s32, s32, 32768
    s_add_u32 m0, m0, 1024
    s_nop 0
    buffer_load_dwordx4 v27, s[12:15], s32 offen lds
    s_add_u32 s32, s32, 32768
    s_add_u32 m0, m0, 1024
    s_nop 0
    buffer_load_dwordx4 v27, s[12:15], s32 offen lds
    s_mov_b32 s12, s62
    s_mov_b32 s13, s63
    s_add_u32 s32, s68, 3145728
    s_add_u32 m0, s42, 131072
    s_nop 0
    buffer_load_dwordx4 v26, s[12:15], s32 offen lds
    s_add_u32 s32, s32, 32768
    s_add_u32 m0, m0, 1024
    s_nop 0
    buffer_load_dwordx4 v26, s[12:15], s32 offen lds
    s_add_u32 s32, s32, 32768
    s_add_u32 m0, m0, 1024
    s_nop 0
    buffer_load_dwordx4 v27, s[12:15], s32 offen lds
    s_add_u32 s32, s32, 32768
    s_add_u32 m0, m0, 1024
    s_nop 0
    buffer_load_dwordx4 v27, s[12:15], s32 offen lds
    s_add_u32 s32, s32, 32768
    s_add_u32 m0, m0, 1024
    s_nop 0
    buffer_load_dwordx4 v26, s[12:15], s32 offen lds
    s_add_u32 s32, s32, 32768
    s_add_u32 m0, m0, 1024
    s_nop 0
    buffer_load_dwordx4 v26, s[12:15], s32 offen lds
    s_add_u32 s32, s32, 32768
    s_add_u32 m0, m0, 1024
    s_nop 0
    buffer_load_dwordx4 v27, s[12:15], s32 offen lds
    s_add_u32 s32, s32, 32768
    s_add_u32 m0, m0, 1024
    s_nop 0
    buffer_load_dwordx4 v27, s[12:15], s32 offen lds
    s_or_b32 s4, s23, s21
    s_cselect_b64 exec, 0, 1
    buffer_atomic_or v1, off, s[16:19], s59 sc0
    s_mov_b64 exec, -1
    v_lshrrev_b32 v30, 2, v3
    v_and_b32 v31, 1, v3
    v_mov_b32 v9, 0x4444
    v_mov_b32 v32, 0xeeee
    v_cndmask_b32 v9, v9, v32, s[24:25]
    v_lshlrev_b32 v31, 4, v31
    v_mov_b32 v32, 0x3f80
    v_lshlrev_b32 v32, v31, v32
    v_cmp_eq_u32 vcc, v4, v30
    s_nop 1
    v_cndmask_b32 v31, 0, v32, vcc
    v_cndmask_b32 v12, v31, 0, s[24:25]
    v_cndmask_b32 v13, 0, v31, s[24:25]
    v_lshlrev_b32 v31, 2, v4
    v_add_u32 v6, 32768, v2
    s_lshl_b32 s32, s21, 10
    v_add_u32 v7, s32, v6
    v_add_u32 v8, 98304, v2
    v_cmp_gt_u32 s[44:45], v31, v3
    v_add_u32 v31, 1, v31
    v_mov_b32 v14, 0x3f803f80
    v_cmp_gt_u32 s[46:47], v31, v3
    v_add_u32 v31, 1, v31
    v_mov_b32 v15, 0x3f803f80
    v_cmp_gt_u32 s[48:49], v31, v3
    v_add_u32 v31, 1, v31
    v_mov_b32 v16, 0x3f803f80
    v_cmp_gt_u32 s[50:51], v31, v3
    v_mov_b32 v17, 0x3f803f80
    v_mov_b32 v19, 0
    v_mov_b32 v20, 0
    v_mov_b32 v23, 0
    v_mov_b32 v24, 0
    v_and_b32 v31, 1, v3
    v_lshl_add_u32 v31, v30, 1, v31
    v_sub_u32 v31, v31, v3
    v_lshlrev_b32 v31, 4, v31
    v_bfe_u32 v32, v3, 1, 1
    v_lshl_add_u32 v31, v32, 3, v31
    s_lshr_b32 s32, s21, 1
    s_lshl_b32 s32, s32, 12
    s_and_b32 s33, s21, 1
    s_lshl_b32 s33, s33, 7
    s_add_u32 s32, s32, s33
    s_add_u32 s32, s32, 0x2000
    v_add_u32 v3, s32, v31
    s_waitcnt vmcnt(25)
    s_barrier
    ds_read_b64_tr_b16 a[0:1], v28 offset:0
    ds_read_b64_tr_b16 a[2:3], v28 offset:1024
    ds_read_b64_tr_b16 a[4:5], v28 offset:8192
    ds_read_b64_tr_b16 a[6:7], v28 offset:9216
    ds_read_b64_tr_b16 a[64:65], v29 offset:0
    ds_read_b64_tr_b16 a[66:67], v29 offset:1024
    ds_read_b64_tr_b16 a[68:69], v29 offset:8192
    ds_read_b64_tr_b16 a[70:71], v29 offset:9216
    ds_read_b64_tr_b16 a[8:9], v28 offset:16384
    ds_read_b64_tr_b16 a[10:11], v28 offset:17408
    ds_read_b64_tr_b16 a[12:13], v28 offset:24576
    ds_read_b64_tr_b16 a[14:15], v28 offset:25600
    ds_read_b64_tr_b16 a[72:73], v29 offset:16384
    ds_read_b64_tr_b16 a[74:75], v29 offset:17408
    ds_read_b64_tr_b16 a[76:77], v29 offset:24576
    ds_read_b64_tr_b16 a[78:79], v29 offset:25600
    s_waitcnt lgkmcnt(0)
    s_barrier
    s_mov_b32 s12, s64
    s_mov_b32 s13, s65
    s_add_u32 s32, s68, 0
    s_add_u32 m0, s42, 32768
    s_nop 0
    buffer_load_dwordx4 v26, s[12:15], s32 offen lds
    s_add_u32 s32, s32, 32768
    s_add_u32 m0, m0, 1024
    s_nop 0
    buffer_load_dwordx4 v26, s[12:15], s32 offen lds
    s_add_u32 s32, s32, 32768
    s_add_u32 m0, m0, 1024
    s_nop 0
    buffer_load_dwordx4 v27, s[12:15], s32 offen lds
    s_add_u32 s32, s32, 32768
    s_add_u32 m0, m0, 1024
    s_nop 0
    buffer_load_dwordx4 v27, s[12:15], s32 offen lds
    s_add_u32 s32, s32, 32768
    s_add_u32 m0, m0, 1024
    s_nop 0
    buffer_load_dwordx4 v26, s[12:15], s32 offen lds
    s_add_u32 s32, s32, 32768
    s_add_u32 m0, m0, 1024
    s_nop 0
    buffer_load_dwordx4 v26, s[12:15], s32 offen lds
    s_add_u32 s32, s32, 32768
    s_add_u32 m0, m0, 1024
    s_nop 0
    buffer_load_dwordx4 v27, s[12:15], s32 offen lds
    s_add_u32 s32, s32, 32768
    s_add_u32 m0, m0, 1024
    s_nop 0
    buffer_load_dwordx4 v27, s[12:15], s32 offen lds
    s_waitcnt vmcnt(25)
    s_barrier
    v_add_u32 v28, 32768, v28
    v_add_u32 v29, 32768, v29
    ds_read_b64_tr_b16 a[16:17], v28 offset:0
    ds_read_b64_tr_b16 a[18:19], v28 offset:1024
    ds_read_b64_tr_b16 a[20:21], v28 offset:8192
    ds_read_b64_tr_b16 a[22:23], v28 offset:9216
    ds_read_b64_tr_b16 a[80:81], v29 offset:0
    ds_read_b64_tr_b16 a[82:83], v29 offset:1024
    ds_read_b64_tr_b16 a[84:85], v29 offset:8192
    ds_read_b64_tr_b16 a[86:87], v29 offset:9216
    ds_read_b64_tr_b16 a[24:25], v28 offset:16384
    ds_read_b64_tr_b16 a[26:27], v28 offset:17408
    ds_read_b64_tr_b16 a[28:29], v28 offset:24576
    ds_read_b64_tr_b16 a[30:31], v28 offset:25600
    ds_read_b64_tr_b16 a[88:89], v29 offset:16384
    ds_read_b64_tr_b16 a[90:91], v29 offset:17408
    ds_read_b64_tr_b16 a[92:93], v29 offset:24576
    ds_read_b64_tr_b16 a[94:95], v29 offset:25600
    s_waitcnt lgkmcnt(0)
    s_barrier
    s_mov_b32 s12, s64
    s_mov_b32 s13, s65
    s_add_u32 s32, s68, 1048576
    s_add_u32 m0, s42, 65536
    s_nop 0
    buffer_load_dwordx4 v26, s[12:15], s32 offen lds
    s_add_u32 s32, s32, 32768
    s_add_u32 m0, m0, 1024
    s_nop 0
    buffer_load_dwordx4 v26, s[12:15], s32 offen lds
    s_add_u32 s32, s32, 32768
    s_add_u32 m0, m0, 1024
    s_nop 0
    buffer_load_dwordx4 v27, s[12:15], s32 offen lds
    s_add_u32 s32, s32, 32768
    s_add_u32 m0, m0, 1024
    s_nop 0
    buffer_load_dwordx4 v27, s[12:15], s32 offen lds
    s_add_u32 s32, s32, 32768
    s_add_u32 m0, m0, 1024
    s_nop 0
    buffer_load_dwordx4 v26, s[12:15], s32 offen lds
    s_add_u32 s32, s32, 32768
    s_add_u32 m0, m0, 1024
    s_nop 0
    buffer_load_dwordx4 v26, s[12:15], s32 offen lds
    s_add_u32 s32, s32, 32768
    s_add_u32 m0, m0, 1024
    s_nop 0
    buffer_load_dwordx4 v27, s[12:15], s32 offen lds
    s_add_u32 s32, s32, 32768
    s_add_u32 m0, m0, 1024
    s_nop 0
    buffer_load_dwordx4 v27, s[12:15], s32 offen lds
    s_waitcnt vmcnt(25)
    s_barrier
    v_add_u32 v28, 32768, v28
    v_add_u32 v29, 32768, v29
    ds_read_b64_tr_b16 a[32:33], v28 offset:0
    ds_read_b64_tr_b16 a[34:35], v28 offset:1024
    ds_read_b64_tr_b16 a[36:37], v28 offset:8192
    ds_read_b64_tr_b16 a[38:39], v28 offset:9216
    ds_read_b64_tr_b16 a[96:97], v29 offset:0
    ds_read_b64_tr_b16 a[98:99], v29 offset:1024
    ds_read_b64_tr_b16 a[100:101], v29 offset:8192
    ds_read_b64_tr_b16 a[102:103], v29 offset:9216
    ds_read_b64_tr_b16 a[40:41], v28 offset:16384
    ds_read_b64_tr_b16 a[42:43], v28 offset:17408
    ds_read_b64_tr_b16 a[44:45], v28 offset:24576
    ds_read_b64_tr_b16 a[46:47], v28 offset:25600
    ds_read_b64_tr_b16 a[104:105], v29 offset:16384
    ds_read_b64_tr_b16 a[106:107], v29 offset:17408
    ds_read_b64_tr_b16 a[108:109], v29 offset:24576
    ds_read_b64_tr_b16 a[110:111], v29 offset:25600
    s_waitcnt lgkmcnt(0)
    s_barrier
    s_mov_b32 s12, s64
    s_mov_b32 s13, s65
    s_add_u32 s32, s68, 2097152
    s_add_u32 m0, s42, 98304
    s_nop 0
    buffer_load_dwordx4 v26, s[12:15], s32 offen lds
    s_add_u32 s32, s32, 32768
    s_add_u32 m0, m0, 1024
    s_nop 0
    buffer_load_dwordx4 v26, s[12:15], s32 offen lds
    s_add_u32 s32, s32, 32768
    s_add_u32 m0, m0, 1024
    s_nop 0
    buffer_load_dwordx4 v27, s[12:15], s32 offen lds
    s_add_u32 s32, s32, 32768
    s_add_u32 m0, m0, 1024
    s_nop 0
    buffer_load_dwordx4 v27, s[12:15], s32 offen lds
    s_add_u32 s32, s32, 32768
    s_add_u32 m0, m0, 1024
    s_nop 0
    buffer_load_dwordx4 v26, s[12:15], s32 offen lds
    s_add_u32 s32, s32, 32768
    s_add_u32 m0, m0, 1024
    s_nop 0
    buffer_load_dwordx4 v26, s[12:15], s32 offen lds
    s_add_u32 s32, s32, 32768
    s_add_u32 m0, m0, 1024
    s_nop 0
    buffer_load_dwordx4 v27, s[12:15], s32 offen lds
    s_add_u32 s32, s32, 32768
    s_add_u32 m0, m0, 1024
    s_nop 0
    buffer_load_dwordx4 v27, s[12:15], s32 offen lds
    s_waitcnt vmcnt(25)
    s_barrier
    v_add_u32 v28, 32768, v28
    v_add_u32 v29, 32768, v29
    ds_read_b64_tr_b16 a[48:49], v28 offset:0
    ds_read_b64_tr_b16 a[50:51], v28 offset:1024
    ds_read_b64_tr_b16 a[52:53], v28 offset:8192
    ds_read_b64_tr_b16 a[54:55], v28 offset:9216
    ds_read_b64_tr_b16 a[112:113], v29 offset:0
    ds_read_b64_tr_b16 a[114:115], v29 offset:1024
    ds_read_b64_tr_b16 a[116:117], v29 offset:8192
    ds_read_b64_tr_b16 a[118:119], v29 offset:9216
    ds_read_b64_tr_b16 a[56:57], v28 offset:16384
    ds_read_b64_tr_b16 a[58:59], v28 offset:17408
    ds_read_b64_tr_b16 a[60:61], v28 offset:24576
    ds_read_b64_tr_b16 a[62:63], v28 offset:25600
    ds_read_b64_tr_b16 a[120:121], v29 offset:16384
    ds_read_b64_tr_b16 a[122:123], v29 offset:17408
    ds_read_b64_tr_b16 a[124:125], v29 offset:24576
    ds_read_b64_tr_b16 a[126:127], v29 offset:25600
    s_waitcnt lgkmcnt(0)
    s_barrier
    s_mov_b32 s12, s64
    s_mov_b32 s13, s65
    s_add_u32 s32, s68, 3145728
    s_add_u32 m0, s42, 131072
    s_nop 0
    buffer_load_dwordx4 v26, s[12:15], s32 offen lds
    s_add_u32 s32, s32, 32768
    s_add_u32 m0, m0, 1024
    s_nop 0
    buffer_load_dwordx4 v26, s[12:15], s32 offen lds
    s_add_u32 s32, s32, 32768
    s_add_u32 m0, m0, 1024
    s_nop 0
    buffer_load_dwordx4 v27, s[12:15], s32 offen lds
    s_add_u32 s32, s32, 32768
    s_add_u32 m0, m0, 1024
    s_nop 0
    buffer_load_dwordx4 v27, s[12:15], s32 offen lds
    s_add_u32 s32, s32, 32768
    s_add_u32 m0, m0, 1024
    s_nop 0
    buffer_load_dwordx4 v26, s[12:15], s32 offen lds
    s_add_u32 s32, s32, 32768
    s_add_u32 m0, m0, 1024
    s_nop 0
    buffer_load_dwordx4 v26, s[12:15], s32 offen lds
    s_add_u32 s32, s32, 32768
    s_add_u32 m0, m0, 1024
    s_nop 0
    buffer_load_dwordx4 v27, s[12:15], s32 offen lds
    s_add_u32 s32, s32, 32768
    s_add_u32 m0, m0, 1024
    s_nop 0
    buffer_load_dwordx4 v27, s[12:15], s32 offen lds
    s_waitcnt vmcnt(24)
    s_barrier
    s_cmp_lg_u32 s23, 0
    s_cbranch_scc1 L_ver_a
    v_mov_b32 v30, 14336
    s_cmp_lg_u32 s21, 0
    s_cbranch_scc1 L_verw_a
    s_waitcnt vmcnt(24)
    s_mov_b64 exec, 1
    ds_write_b32 v30, v1
    s_mov_b64 exec, -1
    s_waitcnt lgkmcnt(0)
L_verw_a:
    s_barrier
    ds_read_b32 v31, v30
    s_waitcnt lgkmcnt(0)
    v_readfirstlane_b32 s4, v31
    s_bitcmp1_b32 s4, s5
    s_cbranch_scc1 L_el_fix
    s_nop 2
L_ver_a:
    v_mov_b32 v1, 0xf149f2ca
    v_add_u32 v28, 4294868992, v28
    v_add_u32 v29, 4294868992, v29
    ds_read_b64_tr_b16 a[128:129], v28 offset:0
    ds_read_b64_tr_b16 a[130:131], v28 offset:1024
    ds_read_b64_tr_b16 a[132:133], v28 offset:8192
    ds_read_b64_tr_b16 a[134:135], v28 offset:9216
    ds_read_b64_tr_b16 a[192:193], v29 offset:0
    ds_read_b64_tr_b16 a[194:195], v29 offset:1024
    ds_read_b64_tr_b16 a[196:197], v29 offset:8192
    ds_read_b64_tr_b16 a[198:199], v29 offset:9216
    ds_read_b64_tr_b16 a[136:137], v28 offset:16384
    ds_read_b64_tr_b16 a[138:139], v28 offset:17408
    ds_read_b64_tr_b16 a[140:141], v28 offset:24576
    ds_read_b64_tr_b16 a[142:143], v28 offset:25600
    ds_read_b64_tr_b16 a[200:201], v29 offset:16384
    ds_read_b64_tr_b16 a[202:203], v29 offset:17408
    ds_read_b64_tr_b16 a[204:205], v29 offset:24576
    ds_read_b64_tr_b16 a[206:207], v29 offset:25600
    s_waitcnt lgkmcnt(0)
    s_barrier
    s_mov_b32 s12, s60
    s_mov_b32 s13, s61
    s_add_u32 s32, s68, 0
    s_add_u32 m0, s42, 32768
    s_nop 0
    buffer_load_dwordx4 v26, s[12:15], s32 offen lds
    s_add_u32 s32, s32, 32768
    s_add_u32 m0, m0, 1024
    s_nop 0
    buffer_load_dwordx4 v26, s[12:15], s32 offen lds
    s_add_u32 s32, s32, 32768
    s_add_u32 m0, m0, 1024
    s_nop 0
    buffer_load_dwordx4 v27, s[12:15], s32 offen lds
    s_add_u32 s32, s32, 32768
    s_add_u32 m0, m0, 1024
    s_nop 0
    buffer_load_dwordx4 v27, s[12:15], s32 offen lds
    s_add_u32 s32, s32, 32768
    s_add_u32 m0, m0, 1024
    s_nop 0
    buffer_load_dwordx4 v26, s[12:15], s32 offen lds
    s_add_u32 s32, s32, 32768
    s_add_u32 m0, m0, 1024
    s_nop 0
    buffer_load_dwordx4 v26, s[12:15], s32 offen lds
    s_add_u32 s32, s32, 32768
    s_add_u32 m0, m0, 1024
    s_nop 0
    buffer_load_dwordx4 v27, s[12:15], s32 offen lds
    s_add_u32 s32, s32, 32768
    s_add_u32 m0, m0, 1024
    s_nop 0
    buffer_load_dwordx4 v27, s[12:15], s32 offen lds
    s_waitcnt vmcnt(24)
    s_barrier
    s_mov_b32 m0, s42
    s_nop 0
    buffer_load_dwordx4 v5, s[28:31], s34 offen offset:0 lds
    s_add_u32 m0, m0, 960
    s_nop 0
    buffer_load_dwordx4 v5, s[28:31], s34 offen offset:64 lds
    s_add_u32 m0, m0, 960
    s_nop 0
    buffer_load_dwordx4 v5, s[28:31], s34 offen offset:128 lds
    s_add_u32 m0, m0, 960
    s_nop 0
    buffer_load_dwordx4 v5, s[28:31], s34 offen offset:192 lds
    s_add_u32 m0, m0, 960
    s_nop 0
    buffer_load_dwordx4 v5, s[28:31], s34 offen offset:256 lds
    s_add_u32 m0, m0, 960
    s_nop 0
    buffer_load_dwordx4 v5, s[28:31], s34 offen offset:320 lds
    s_add_u32 m0, m0, 960
    s_nop 0
    buffer_load_dwordx4 v5, s[28:31], s34 offen offset:384 lds
    s_add_u32 m0, m0, 960
    s_nop 0
    buffer_load_dwordx4 v5, s[28:31], s34 offen offset:448 lds
    s_add_u32 s34, s34, 131072
    v_add_u32 v28, 32768, v28
    v_add_u32 v29, 32768, v29
    ds_read_b64_tr_b16 a[144:145], v28 offset:0
    ds_read_b64_tr_b16 a[146:147], v28 offset:1024
    ds_read_b64_tr_b16 a[148:149], v28 offset:8192
    ds_read_b64_tr_b16 a[150:151], v28 offset:9216
    ds_read_b64_tr_b16 a[208:209], v29 offset:0
    ds_read_b64_tr_b16 a[210:211], v29 offset:1024
    ds_read_b64_tr_b16 a[212:213], v29 offset:8192
    ds_read_b64_tr_b16 a[214:215], v29 offset:9216
    ds_read_b64_tr_b16 a[152:153], v28 offset:16384
    ds_read_b64_tr_b16 a[154:155], v28 offset:17408
    ds_read_b64_tr_b16 a[156:157], v28 offset:24576
    ds_read_b64_tr_b16 a[158:159], v28 offset:25600
    ds_read_b64_tr_b16 a[216:217], v29 offset:16384
    ds_read_b64_tr_b16 a[218:219], v29 offset:17408
    ds_read_b64_tr_b16 a[220:221], v29 offset:24576
    ds_read_b64_tr_b16 a[222:223], v29 offset:25600
    s_waitcnt lgkmcnt(0)
    s_barrier
    s_mov_b32 s12, s60
    s_mov_b32 s13, s61
    s_add_u32 s32, s68, 1048576
    s_add_u32 m0, s42, 65536
    s_nop 0
    buffer_load_dwordx4 v26, s[12:15], s32 offen lds
    s_add_u32 s32, s32, 32768
    s_add_u32 m0, m0, 1024
    s_nop 0
    buffer_load_dwordx4 v26, s[12:15], s32 offen lds
    s_add_u32 s32, s32, 32768
    s_add_u32 m0, m0, 1024
    s_nop 0
    buffer_load_dwordx4 v27, s[12:15], s32 offen lds
    s_add_u32 s32, s32, 32768
    s_add_u32 m0, m0, 1024
    s_nop 0
    buffer_load_dwordx4 v27, s[12:15], s32 offen lds
    s_add_u32 s32, s32, 32768
    s_add_u32 m0, m0, 1024
    s_nop 0
    buffer_load_dwordx4 v26, s[12:15], s32 offen lds
    s_add_u32 s32, s32, 32768
    s_add_u32 m0, m0, 1024
    s_nop 0
    buffer_load_dwordx4 v26, s[12:15], s32 offen lds
    s_add_u32 s32, s32, 32768
    s_add_u32 m0, m0, 1024
    s_nop 0
    buffer_load_dwordx4 v27, s[12:15], s32 offen lds
    s_add_u32 s32, s32, 32768
    s_add_u32 m0, m0, 1024
    s_nop 0
    buffer_load_dwordx4 v27, s[12:15], s32 offen lds
    s_waitcnt vmcnt(32)
    s_barrier
    v_add_u32 v28, 32768, v28
    v_add_u32 v29, 32768, v29
    ds_read_b64_tr_b16 a[160:161], v28 offset:0
    ds_read_b64_tr_b16 a[162:163], v28 offset:1024
    ds_read_b64_tr_b16 a[164:165], v28 offset:8192
    ds_read_b64_tr_b16 a[166:167], v28 offset:9216
    ds_read_b64_tr_b16 a[224:225], v29 offset:0
    ds_read_b64_tr_b16 a[226:227], v29 offset:1024
    ds_read_b64_tr_b16 a[228:229], v29 offset:8192
    ds_read_b64_tr_b16 a[230:231], v29 offset:9216
    ds_read_b64_tr_b16 a[168:169], v28 offset:16384
    ds_read_b64_tr_b16 a[170:171], v28 offset:17408
    ds_read_b64_tr_b16 a[172:173], v28 offset:24576
    ds_read_b64_tr_b16 a[174:175], v28 offset:25600
    ds_read_b64_tr_b16 a[232:233], v29 offset:16384
    ds_read_b64_tr_b16 a[234:235], v29 offset:17408
    ds_read_b64_tr_b16 a[236:237], v29 offset:24576
    ds_read_b64_tr_b16 a[238:239], v29 offset:25600
    s_waitcnt lgkmcnt(0)
    s_barrier
    s_mov_b32 s12, s60
    s_mov_b32 s13, s61
    s_add_u32 s32, s68, 2097152
    s_add_u32 m0, s42, 98304
    s_nop 0
    buffer_load_dwordx4 v26, s[12:15], s32 offen lds
    s_add_u32 s32, s32, 32768
    s_add_u32 m0, m0, 1024
    s_nop 0
    buffer_load_dwordx4 v26, s[12:15], s32 offen lds
    s_add_u32 s32, s32, 32768
    s_add_u32 m0, m0, 1024
    s_nop 0
    buffer_load_dwordx4 v27, s[12:15], s32 offen lds
    s_add_u32 s32, s32, 32768
    s_add_u32 m0, m0, 1024
    s_nop 0
    buffer_load_dwordx4 v27, s[12:15], s32 offen lds
    s_add_u32 s32, s32, 32768
    s_add_u32 m0, m0, 1024
    s_nop 0
    buffer_load_dwordx4 v26, s[12:15], s32 offen lds
    s_add_u32 s32, s32, 32768
    s_add_u32 m0, m0, 1024
    s_nop 0
    buffer_load_dwordx4 v26, s[12:15], s32 offen lds
    s_add_u32 s32, s32, 32768
    s_add_u32 m0, m0, 1024
    s_nop 0
    buffer_load_dwordx4 v27, s[12:15], s32 offen lds
    s_add_u32 s32, s32, 32768
    s_add_u32 m0, m0, 1024
    s_nop 0
    buffer_load_dwordx4 v27, s[12:15], s32 offen lds
    s_waitcnt vmcnt(32)
    s_barrier
    v_add_u32 v28, 32768, v28
    v_add_u32 v29, 32768, v29
    ds_read_b64_tr_b16 a[176:177], v28 offset:0
    ds_read_b64_tr_b16 a[178:179], v28 offset:1024
    ds_read_b64_tr_b16 a[180:181], v28 offset:8192
    ds_read_b64_tr_b16 a[182:183], v28 offset:9216
    ds_read_b64_tr_b16 a[240:241], v29 offset:0
    ds_read_b64_tr_b16 a[242:243], v29 offset:1024
    ds_read_b64_tr_b16 a[244:245], v29 offset:8192
    ds_read_b64_tr_b16 a[246:247], v29 offset:9216
    ds_read_b64_tr_b16 a[184:185], v28 offset:16384
    ds_read_b64_tr_b16 a[186:187], v28 offset:17408
    ds_read_b64_tr_b16 a[188:189], v28 offset:24576
    ds_read_b64_tr_b16 a[190:191], v28 offset:25600
    ds_read_b64_tr_b16 a[248:249], v29 offset:16384
    ds_read_b64_tr_b16 a[250:251], v29 offset:17408
    ds_read_b64_tr_b16 a[252:253], v29 offset:24576
    ds_read_b64_tr_b16 a[254:255], v29 offset:25600
    s_waitcnt lgkmcnt(0)
    s_barrier
    s_mov_b32 s12, s60
    s_mov_b32 s13, s61
    s_add_u32 s32, s68, 3145728
    s_add_u32 m0, s42, 131072
    s_nop 0
    buffer_load_dwordx4 v26, s[12:15], s32 offen lds
    s_add_u32 s32, s32, 32768
    s_add_u32 m0, m0, 1024
    s_nop 0
    buffer_load_dwordx4 v26, s[12:15], s32 offen lds
    s_add_u32 s32, s32, 32768
    s_add_u32 m0, m0, 1024
    s_nop 0
    buffer_load_dwordx4 v27, s[12:15], s32 offen lds
    s_add_u32 s32, s32, 32768
    s_add_u32 m0, m0, 1024
    s_nop 0
    buffer_load_dwordx4 v27, s[12:15], s32 offen lds
    s_add_u32 s32, s32, 32768
    s_add_u32 m0, m0, 1024
    s_nop 0
    buffer_load_dwordx4 v26, s[12:15], s32 offen lds
    s_add_u32 s32, s32, 32768
    s_add_u32 m0, m0, 1024
    s_nop 0
    buffer_load_dwordx4 v26, s[12:15], s32 offen lds
    s_add_u32 s32, s32, 32768
    s_add_u32 m0, m0, 1024
    s_nop 0
    buffer_load_dwordx4 v27, s[12:15], s32 offen lds
    s_add_u32 s32, s32, 32768
    s_add_u32 m0, m0, 1024
    s_nop 0
    buffer_load_dwordx4 v27, s[12:15], s32 offen lds
    s_waitcnt vmcnt(32)
    s_barrier
    v_add_u32 v28, 4294868992, v28
    v_add_u32 v29, 4294868992, v29
    ds_read_b64_tr_b16 v[128:129], v28 offset:0
    ds_read_b64_tr_b16 v[130:131], v28 offset:1024
    ds_read_b64_tr_b16 v[132:133], v28 offset:8192
    ds_read_b64_tr_b16 v[134:135], v28 offset:9216
    ds_read_b64_tr_b16 v[192:193], v29 offset:0
    ds_read_b64_tr_b16 v[194:195], v29 offset:1024
    ds_read_b64_tr_b16 v[196:197], v29 offset:8192
    ds_read_b64_tr_b16 v[198:199], v29 offset:9216
    ds_read_b64_tr_b16 v[136:137], v28 offset:16384
    ds_read_b64_tr_b16 v[138:139], v28 offset:17408
    ds_read_b64_tr_b16 v[140:141], v28 offset:24576
    ds_read_b64_tr_b16 v[142:143], v28 offset:25600
    ds_read_b64_tr_b16 v[200:201], v29 offset:16384
    ds_read_b64_tr_b16 v[202:203], v29 offset:17408
    ds_read_b64_tr_b16 v[204:205], v29 offset:24576
    ds_read_b64_tr_b16 v[206:207], v29 offset:25600
    s_waitcnt lgkmcnt(0)
    s_barrier
    s_waitcnt vmcnt(16)
    s_barrier
    v_add_u32 v28, 32768, v28
    v_add_u32 v29, 32768, v29
    ds_read_b64_tr_b16 v[144:145], v28 offset:0
    ds_read_b64_tr_b16 v[146:147], v28 offset:1024
    ds_read_b64_tr_b16 v[148:149], v28 offset:8192
    ds_read_b64_tr_b16 v[150:151], v28 offset:9216
    ds_read_b64_tr_b16 v[208:209], v29 offset:0
    ds_read_b64_tr_b16 v[210:211], v29 offset:1024
    ds_read_b64_tr_b16 v[212:213], v29 offset:8192
    ds_read_b64_tr_b16 v[214:215], v29 offset:9216
    ds_read_b64_tr_b16 v[152:153], v28 offset:16384
    ds_read_b64_tr_b16 v[154:155], v28 offset:17408
    ds_read_b64_tr_b16 v[156:157], v28 offset:24576
    ds_read_b64_tr_b16 v[158:159], v28 offset:25600
    ds_read_b64_tr_b16 v[216:217], v29 offset:16384
    ds_read_b64_tr_b16 v[218:219], v29 offset:17408
    ds_read_b64_tr_b16 v[220:221], v29 offset:24576
    ds_read_b64_tr_b16 v[222:223], v29 offset:25600
    s_waitcnt lgkmcnt(0)
    s_barrier
    s_waitcnt vmcnt(8)
    s_barrier
    v_add_u32 v28, 32768, v28
    v_add_u32 v29, 32768, v29
    ds_read_b64_tr_b16 v[160:161], v28 offset:0
    ds_read_b64_tr_b16 v[162:163], v28 offset:1024
    ds_read_b64_tr_b16 v[164:165], v28 offset:8192
    ds_read_b64_tr_b16 v[166:167], v28 offset:9216
    ds_read_b64_tr_b16 v[224:225], v29 offset:0
    ds_read_b64_tr_b16 v[226:227], v29 offset:1024
    ds_read_b64_tr_b16 v[228:229], v29 offset:8192
    ds_read_b64_tr_b16 v[230:231], v29 offset:9216
    ds_read_b64_tr_b16 v[168:169], v28 offset:16384
    ds_read_b64_tr_b16 v[170:171], v28 offset:17408
    ds_read_b64_tr_b16 v[172:173], v28 offset:24576
    ds_read_b64_tr_b16 v[174:175], v28 offset:25600
    ds_read_b64_tr_b16 v[232:233], v29 offset:16384
    ds_read_b64_tr_b16 v[234:235], v29 offset:17408
    ds_read_b64_tr_b16 v[236:237], v29 offset:24576
    ds_read_b64_tr_b16 v[238:239], v29 offset:25600
    s_waitcnt lgkmcnt(0)
    s_barrier
    s_waitcnt vmcnt(0)
    s_barrier
    v_add_u32 v28, 32768, v28
    v_add_u32 v29, 32768, v29
    ds_read_b64_tr_b16 v[176:177], v28 offset:0
    ds_read_b64_tr_b16 v[178:179], v28 offset:1024
    ds_read_b64_tr_b16 v[180:181], v28 offset:8192
    ds_read_b64_tr_b16 v[182:183], v28 offset:9216
    ds_read_b64_tr_b16 v[240:241], v29 offset:0
    ds_read_b64_tr_b16 v[242:243], v29 offset:1024
    ds_read_b64_tr_b16 v[244:245], v29 offset:8192
    ds_read_b64_tr_b16 v[246:247], v29 offset:9216
    ds_read_b64_tr_b16 v[184:185], v28 offset:16384
    ds_read_b64_tr_b16 v[186:187], v28 offset:17408
    ds_read_b64_tr_b16 v[188:189], v28 offset:24576
    ds_read_b64_tr_b16 v[190:191], v28 offset:25600
    ds_read_b64_tr_b16 v[248:249], v29 offset:16384
    ds_read_b64_tr_b16 v[250:251], v29 offset:17408
    ds_read_b64_tr_b16 v[252:253], v29 offset:24576
    ds_read_b64_tr_b16 v[254:255], v29 offset:25600
    s_waitcnt lgkmcnt(0)
    s_barrier
    s_cmp_lg_u32 s21, 0
    s_cbranch_scc1 L_at_rdy_ok
L_at_rdy:
    buffer_load_dword v11, off, s[16:19], 0 offset:4 sc1
    s_sub_u32 s22, s22, 1
    s_cbranch_scc1 L_exit
    s_waitcnt vmcnt(0)
    v_readfirstlane_b32 s4, v11
    s_and_b32 s4, s4, 255
    s_cmp_lt_u32 s4, 32
    s_cbranch_scc1 L_at_rdy
    s_nop 1
L_at_rdy_ok:
    s_barrier
    s_mov_b32 s40, -2
    s_branch L_at_qkv
L_at_loop:
    ds_read_b128 v[28:31], v6 offset:0
    ds_read_b128 v[44:47], v6 offset:4096
    ds_read_b128 v[60:63], v6 offset:8192
    ds_read_b128 v[76:79], v6 offset:12288
    ds_read_b128 v[32:35], v6 offset:1024
    ds_read_b128 v[48:51], v6 offset:5120
    ds_read_b128 v[64:67], v6 offset:9216
    ds_read_b128 v[80:83], v6 offset:13312
    ds_read_b128 v[36:39], v6 offset:2048
    ds_read_b128 v[52:55], v6 offset:6144
    ds_read_b128 v[68:71], v6 offset:10240
    ds_read_b128 v[84:87], v6 offset:14336
    ds_read_b128 v[40:43], v6 offset:3072
    ds_read_b128 v[56:59], v6 offset:7168
    ds_read_b128 v[72:75], v6 offset:11264
    ds_read_b128 v[88:91], v6 offset:15360
    ds_read_b128 v[92:95], v7 offset:16384
    ds_read_b128 v[96:99], v7 offset:20480
    s_waitcnt lgkmcnt(15)
    v_mfma_f32_16x16x32_bf16 v[100:103], v[60:63], v[28:31], 0
    v_mfma_f32_16x16x32_bf16 v[104:107], v[60:63], v[44:47], 0
    s_waitcnt lgkmcnt(14)
    v_mfma_f32_16x16x32_bf16 v[108:111], v[76:79], v[44:47], 0
    s_waitcnt lgkmcnt(11)
    v_mfma_f32_16x16x32_bf16 v[100:103], v[64:67], v[32:35], v[100:103]
    v_mfma_f32_16x16x32_bf16 v[104:107], v[64:67], v[48:51], v[104:107]
    s_waitcnt lgkmcnt(10)
    v_mfma_f32_16x16x32_bf16 v[108:111], v[80:83], v[48:51], v[108:111]
    s_waitcnt lgkmcnt(7)
    v_mfma_f32_16x16x32_bf16 v[100:103], v[68:71], v[36:39], v[100:103]
    v_mfma_f32_16x16x32_bf16 v[104:107], v[68:71], v[52:55], v[104:107]
    s_waitcnt lgkmcnt(6)
    v_mfma_f32_16x16x32_bf16 v[108:111], v[84:87], v[52:55], v[108:111]
    s_waitcnt lgkmcnt(3)
    v_mfma_f32_16x16x32_bf16 v[100:103], v[72:75], v[40:43], v[100:103]
    v_mfma_f32_16x16x32_bf16 v[104:107], v[72:75], v[56:59], v[104:107]
    s_waitcnt lgkmcnt(2)
    v_mfma_f32_16x16x32_bf16 v[108:111], v[88:91], v[56:59], v[108:111]
    v_mov_b64 v[112:113], 0
    v_mov_b64 v[114:115], 0
    v_mov_b64 v[116:117], 0
    v_mov_b64 v[118:119], 0
    v_mov_b64 v[120:121], 0
    v_mov_b64 v[122:123], 0
    v_mov_b64 v[124:125], 0
    v_mov_b64 v[126:127], 0
    v_cndmask_b32 v100, v100, v1, s[44:45]
    v_cndmask_b32 v101, v101, v1, s[46:47]
    v_cndmask_b32 v102, v102, v1, s[48:49]
    v_cndmask_b32 v103, v103, v1, s[50:51]
    v_cndmask_b32 v108, v108, v1, s[44:45]
    v_cndmask_b32 v109, v109, v1, s[46:47]
    v_cndmask_b32 v110, v110, v1, s[48:49]
    v_cndmask_b32 v111, v111, v1, s[50:51]
    v_max3_f32 v18, v100, v101, v102
    v_max_f32 v18, v18, v103
    v_max3_f32 v22, v104, v105, v106
    v_max3_f32 v22, v22, v107, v108
    v_max3_f32 v22, v22, v109, v110
    v_max_f32 v22, v22, v111
    s_waitcnt lgkmcnt(0)
    s_cmp_eq_u32 s37, 83632128
    s_cselect_b32 s33, 1048576, 0
    s_sub_u32 s33, s37, s33
    s_cmp_lg_u32 s21, 0
    s_cbranch_scc1 L_at_pb
L_at_poll:
    buffer_load_dword v11, off, s[8:11], s33 offset:124 sc1
    s_sub_u32 s22, s22, 1
    s_cbranch_scc1 L_exit
    s_waitcnt vmcnt(0)
    v_cmp_eq_u32 vcc, -1, v11
    s_cbranch_vccnz L_at_poll
    s_nop 3
L_at_pb:
    s_barrier
L_at_got:
    s_add_u32 s32, s37, 4096
    buffer_load_dwordx4 v[60:63], v2, s[8:11], s37 offen offset:0 sc1
    buffer_load_dwordx4 v[64:67], v2, s[8:11], s37 offen offset:1024 sc1
    buffer_load_dwordx4 v[68:71], v2, s[8:11], s37 offen offset:2048 sc1
    buffer_load_dwordx4 v[72:75], v2, s[8:11], s37 offen offset:3072 sc1
    buffer_load_dwordx4 v[76:79], v2, s[8:11], s32 offen offset:0 sc1
    buffer_load_dwordx4 v[80:83], v2, s[8:11], s32 offen offset:1024 sc1
    buffer_load_dwordx4 v[84:87], v2, s[8:11], s32 offen offset:2048 sc1
    buffer_load_dwordx4 v[88:91], v2, s[8:11], s32 offen offset:3072 sc1
    s_waitcnt vmcnt(7)
    v_max3_u32 v11, v60, v61, v62
    s_waitcnt vmcnt(6)
    v_max3_u32 v11, v11, v63, v64
    v_max3_u32 v11, v11, v65, v66
    s_waitcnt vmcnt(5)
    v_max3_u32 v11, v11, v67, v68
    v_max3_u32 v11, v11, v69, v70
    s_waitcnt vmcnt(4)
    v_max3_u32 v11, v11, v71, v72
    v_max3_u32 v11, v11, v73, v74
    s_waitcnt vmcnt(3)
    v_max3_u32 v11, v11, v75, v76
    v_max3_u32 v11, v11, v77, v78
    s_waitcnt vmcnt(2)
    v_max3_u32 v11, v11, v79, v80
    v_max3_u32 v11, v11, v81, v82
    s_waitcnt vmcnt(1)
    v_max3_u32 v11, v11, v83, v84
    v_max3_u32 v11, v11, v85, v86
    s_waitcnt vmcnt(0)
    v_max3_u32 v11, v11, v87, v88
    v_max3_u32 v11, v11, v89, v90
    v_max_u32 v11, v11, v91
    v_cmp_eq_u32 vcc, -1, v11
    s_cbranch_vccnz L_at_miss
    v_smfmac_f32_16x16x64_bf16 v[112:115], v[60:63], a[0:7], v9
    v_smfmac_f32_16x16x64_bf16 v[116:119], v[60:63], a[64:71], v9
    v_smfmac_f32_16x16x64_bf16 v[112:115], v[64:67], a[8:15], v9
    v_smfmac_f32_16x16x64_bf16 v[116:119], v[64:67], a[72:79], v9
    v_smfmac_f32_16x16x64_bf16 v[112:115], v[68:71], a[16:23], v9
    v_smfmac_f32_16x16x64_bf16 v[116:119], v[68:71], a[80:87], v9
    v_smfmac_f32_16x16x64_bf16 v[112:115], v[72:75], a[24:31], v9
    v_smfmac_f32_16x16x64_bf16 v[116:119], v[72:75], a[88:95], v9
    v_smfmac_f32_16x16x64_bf16 v[112:115], v[76:79], a[32:39], v9
    v_smfmac_f32_16x16x64_bf16 v[116:119], v[76:79], a[96:103], v9
    v_smfmac_f32_16x16x64_bf16 v[112:115], v[80:83], a[40:47], v9
    v_smfmac_f32_16x16x64_bf16 v[116:119], v[80:83], a[104:111], v9
    v_smfmac_f32_16x16x64_bf16 v[112:115], v[84:87], a[48:55], v9
    v_smfmac_f32_16x16x64_bf16 v[116:119], v[84:87], a[112:119], v9
    v_smfmac_f32_16x16x64_bf16 v[112:115], v[88:91], a[56:63], v9
    v_smfmac_f32_16x16x64_bf16 v[116:119], v[88:91], a[120:127], v9
    v_smfmac_f32_16x16x64_bf16 v[120:123], v[60:63], a[128:135], v9
    v_smfmac_f32_16x16x64_bf16 v[124:127], v[60:63], a[192:199], v9
    v_smfmac_f32_16x16x64_bf16 v[120:123], v[64:67], a[136:143], v9
    v_add_f32 v112, v112, v114
    v_add_f32 v113, v113, v115
    v_add_f32 v116, v116, v118
    v_add_f32 v117, v117, v119
    v_cvt_pk_bf16_f32 v112, v112, v113
    v_cvt_pk_bf16_f32 v113, v116, v117
    v_smfmac_f32_16x16x64_bf16 v[124:127], v[64:67], a[200:207], v9
    v_mfma_f32_16x16x16_bf16 v[116:119], v[112:113], v[12:13], 0
    v_smfmac_f32_16x16x64_bf16 v[120:123], v[68:71], a[144:151], v9
    v_smfmac_f32_16x16x64_bf16 v[124:127], v[68:71], a[208:215], v9
    v_smfmac_f32_16x16x64_bf16 v[120:123], v[72:75], a[152:159], v9
    v_cvt_pk_bf16_f32 v112, v116, v117
    v_cvt_pk_bf16_f32 v113, v118, v119
    v_smfmac_f32_16x16x64_bf16 v[124:127], v[72:75], a[216:223], v9
    v_mov_b32_dpp v114, v112 quad_perm:[2,3,0,1] row_mask:0xf bank_mask:0xf
    v_mov_b32_dpp v115, v113 quad_perm:[2,3,0,1] row_mask:0xf bank_mask:0xf
    s_lshl_b32 s32, s21, 10
    v_add_u32 v26, s32, v8
    ds_write_b128 v26, v[112:115]
    v_smfmac_f32_16x16x64_bf16 v[120:123], v[76:79], a[160:167], v9
    v_smfmac_f32_16x16x64_bf16 v[124:127], v[76:79], a[224:231], v9
    v_smfmac_f32_16x16x64_bf16 v[120:123], v[80:83], a[168:175], v9
    v_smfmac_f32_16x16x64_bf16 v[124:127], v[80:83], a[232:239], v9
    v_smfmac_f32_16x16x64_bf16 v[120:123], v[84:87], a[176:183], v9
    v_smfmac_f32_16x16x64_bf16 v[124:127], v[84:87], a[240:247], v9
    v_smfmac_f32_16x16x64_bf16 v[120:123], v[88:91], a[184:191], v9
    v_smfmac_f32_16x16x64_bf16 v[124:127], v[88:91], a[248:255], v9
    s_waitcnt lgkmcnt(0)
    s_barrier
    ds_read_b128 v[60:63], v8 offset:0
    ds_read_b128 v[64:67], v8 offset:1024
    ds_read_b128 v[68:71], v8 offset:2048
    ds_read_b128 v[72:75], v8 offset:3072
    v_add_f32 v120, v120, v122
    v_add_f32 v121, v121, v123
    v_add_f32 v124, v124, v126
    v_add_f32 v125, v125, v127
    v_cvt_pk_bf16_f32 v120, v120, v121
    v_cvt_pk_bf16_f32 v121, v124, v125
    s_waitcnt lgkmcnt(3)
    v_mfma_f32_16x16x32_bf16 v[76:79], v[60:63], v[28:31], 0
    v_mfma_f32_16x16x32_bf16 v[80:83], v[60:63], v[44:47], 0
    s_waitcnt lgkmcnt(2)
    v_mfma_f32_16x16x32_bf16 v[76:79], v[64:67], v[32:35], v[76:79]
    v_mfma_f32_16x16x32_bf16 v[80:83], v[64:67], v[48:51], v[80:83]
    s_waitcnt lgkmcnt(1)
    v_mfma_f32_16x16x32_bf16 v[76:79], v[68:71], v[36:39], v[76:79]
    v_mfma_f32_16x16x32_bf16 v[80:83], v[68:71], v[52:55], v[80:83]
    s_waitcnt lgkmcnt(0)
    v_mfma_f32_16x16x32_bf16 v[76:79], v[72:75], v[40:43], v[76:79]
    v_mfma_f32_16x16x32_bf16 v[80:83], v[72:75], v[56:59], v[80:83]
    s_nop 3
    v_mul_f32 v76, s41, v76
    v_mul_f32 v77, s41, v77
    v_max3_f32 v18, v18, v76, v77
    s_nop 0
    v_mul_f32 v80, s41, v80
    v_mul_f32 v81, s41, v81
    v_max3_f32 v22, v22, v80, v81
    v_mov_b32 v11, v18
    v_mov_b32 v26, v22
    s_nop 0
    v_permlane16_swap_b32 v18, v11
    v_permlane16_swap_b32 v22, v26
    v_max_f32 v18, v18, v11
    v_max_f32 v22, v22, v26
    v_mov_b32 v11, v18
    v_mov_b32 v26, v22
    s_nop 0
    v_permlane32_swap_b32 v18, v11
    v_permlane32_swap_b32 v22, v26
    v_max_f32 v18, v18, v11
    v_max_f32 v22, v22, v26
    v_sub_f32 v100, v100, v18
    v_sub_f32 v101, v101, v18
    v_sub_f32 v102, v102, v18
    v_sub_f32 v103, v103, v18
    v_sub_f32 v76, v76, v18
    v_sub_f32 v77, v77, v18
    v_sub_f32 v104, v104, v22
    v_sub_f32 v105, v105, v22
    v_sub_f32 v106, v106, v22
    v_sub_f32 v107, v107, v22
    v_sub_f32 v108, v108, v22
    v_sub_f32 v109, v109, v22
    v_sub_f32 v110, v110, v22
    v_sub_f32 v111, v111, v22
    v_sub_f32 v80, v80, v22
    v_sub_f32 v81, v81, v22
    v_exp_f32 v100, v100
    v_exp_f32 v101, v101
    v_exp_f32 v102, v102
    v_exp_f32 v103, v103
    v_exp_f32 v76, v76
    v_exp_f32 v77, v77
    v_exp_f32 v104, v104
    v_exp_f32 v105, v105
    v_exp_f32 v106, v106
    v_exp_f32 v107, v107
    v_exp_f32 v108, v108
    v_exp_f32 v109, v109
    v_exp_f32 v110, v110
    v_exp_f32 v111, v111
    v_exp_f32 v80, v80
    v_exp_f32 v81, v81
    v_cvt_pk_bf16_f32 v100, v100, v101
    v_cvt_pk_bf16_f32 v101, v102, v103
    v_cvt_pk_bf16_f32 v102, v104, v105
    v_cvt_pk_bf16_f32 v103, v106, v107
    v_cvt_pk_bf16_f32 v104, v108, v109
    v_cvt_pk_bf16_f32 v105, v110, v111
    v_cvt_pk_bf16_f32 v18, v76, v77
    v_cvt_pk_bf16_f32 v21, v76, v77
    v_cvt_pk_bf16_f32 v22, v80, v81
    v_cvt_pk_bf16_f32 v25, v80, v81
    v_mfma_f32_16x16x32_bf16 v[88:91], v[14:17], v[102:105], 0
    v_mfma_f32_16x16x32_bf16 v[68:71], v[92:95], v[102:105], 0
    v_mfma_f32_16x16x32_bf16 v[72:75], v[96:99], v[102:105], 0
    v_mfma_f32_16x16x16_bf16 v[84:87], v[14:15], v[100:101], 0
    v_mfma_f32_16x16x16_bf16 v[60:63], v[92:93], v[100:101], 0
    v_mfma_f32_16x16x16_bf16 v[64:67], v[96:97], v[100:101], 0
    v_mfma_f32_16x16x16_bf16 v[84:87], v[14:15], v[18:19], v[84:87]
    v_mfma_f32_16x16x16_bf16 v[60:63], v[120:121], v[18:19], v[60:63]
    v_mfma_f32_16x16x16_bf16 v[64:67], v[120:121], v[20:21], v[64:67]
    v_mfma_f32_16x16x16_bf16 v[88:91], v[14:15], v[22:23], v[88:91]
    v_mfma_f32_16x16x16_bf16 v[68:71], v[120:121], v[22:23], v[68:71]
    v_mfma_f32_16x16x16_bf16 v[72:75], v[120:121], v[24:25], v[72:75]
    s_add_u32 s32, s38, 0x20000
    v_rcp_f32 v11, v84
    s_nop 0
    v_mul_f32 v60, v60, v11
    v_mul_f32 v61, v61, v11
    v_mul_f32 v62, v62, v11
    v_mul_f32 v63, v63, v11
    v_mul_f32 v64, v64, v11
    v_mul_f32 v65, v65, v11
    v_mul_f32 v66, v66, v11
    v_mul_f32 v67, v67, v11
    v_cvt_pk_bf16_f32 v60, v60, v61
    v_cvt_pk_bf16_f32 v61, v62, v63
    v_cvt_pk_bf16_f32 v62, v64, v65
    v_cvt_pk_bf16_f32 v63, v66, v67
    buffer_store_dwordx4 v[60:63], v2, s[8:11], s38 offen sc1
    v_rcp_f32 v26, v88
    s_nop 0
    v_mul_f32 v68, v68, v26
    v_mul_f32 v69, v69, v26
    v_mul_f32 v70, v70, v26
    v_mul_f32 v71, v71, v26
    v_mul_f32 v72, v72, v26
    v_mul_f32 v73, v73, v26
    v_mul_f32 v74, v74, v26
    v_mul_f32 v75, v75, v26
    v_cvt_pk_bf16_f32 v68, v68, v69
    v_cvt_pk_bf16_f32 v69, v70, v71
    v_cvt_pk_bf16_f32 v70, v72, v73
    v_cvt_pk_bf16_f32 v71, v74, v75
    buffer_store_dwordx4 v[68:71], v2, s[8:11], s32 offen sc1
    v_mov_b32 v11, 1
    s_waitcnt vmcnt(0)
    s_barrier
    s_cmp_lg_u32 s21, 0
    s_cbranch_scc1 L_at_nf
    s_mov_b64 exec, 1
    buffer_store_dword v11, off, s[8:11], s39 sc1
    s_mov_b64 exec, -1
    s_nop 0
L_at_nf:
    s_add_u32 s37, s37, 4194304
    s_bitset1_b32 s37, 13
    s_add_u32 s39, s39, 4194304
    s_add_u32 s38, s38, 1048576
    s_cmp_ge_i32 s40, 14
    s_cbranch_scc1 L_at_next
L_at_qkv:
    s_waitcnt vmcnt(0)
    s_barrier
    ds_read_b128 v[60:63], v2 offset:0
    ds_read_b128 v[64:67], v2 offset:16384
    ds_read_b128 v[68:71], v2 offset:1024
    ds_read_b128 v[72:75], v2 offset:17408
    ds_read_b128 v[76:79], v2 offset:2048
    ds_read_b128 v[80:83], v2 offset:18432
    s_waitcnt lgkmcnt(5)
    v_mfma_f32_16x16x32_bf16 v[28:31], a[0:3], v[60:63], 0
    v_mfma_f32_16x16x32_bf16 v[32:35], a[64:67], v[60:63], 0
    s_waitcnt lgkmcnt(4)
    v_mfma_f32_16x16x32_bf16 v[36:39], a[0:3], v[64:67], 0
    v_mfma_f32_16x16x32_bf16 v[40:43], a[64:67], v[64:67], 0
    v_mfma_f32_16x16x32_bf16 v[44:47], v[60:63], a[128:131], 0
    v_mfma_f32_16x16x32_bf16 v[48:51], v[60:63], a[192:195], 0
    v_mfma_f32_16x16x32_bf16 v[52:55], v[64:67], a[128:131], 0
    v_mfma_f32_16x16x32_bf16 v[56:59], v[64:67], a[192:195], 0
    v_mfma_f32_16x16x32_bf16 v[112:115], v[128:131], v[60:63], 0
    v_mfma_f32_16x16x32_bf16 v[116:119], v[192:195], v[60:63], 0
    v_mfma_f32_16x16x32_bf16 v[120:123], v[128:131], v[64:67], 0
    v_mfma_f32_16x16x32_bf16 v[124:127], v[192:195], v[64:67], 0
    ds_read_b128 v[84:87], v2 offset:3072
    ds_read_b128 v[88:91], v2 offset:19456
    s_waitcnt lgkmcnt(5)
    v_mfma_f32_16x16x32_bf16 v[28:31], a[4:7], v[68:71], v[28:31]
    v_mfma_f32_16x16x32_bf16 v[32:35], a[68:71], v[68:71], v[32:35]
    s_waitcnt lgkmcnt(4)
    v_mfma_f32_16x16x32_bf16 v[36:39], a[4:7], v[72:75], v[36:39]
    v_mfma_f32_16x16x32_bf16 v[40:43], a[68:71], v[72:75], v[40:43]
    v_mfma_f32_16x16x32_bf16 v[44:47], v[68:71], a[132:135], v[44:47]
    v_mfma_f32_16x16x32_bf16 v[48:51], v[68:71], a[196:199], v[48:51]
    v_mfma_f32_16x16x32_bf16 v[52:55], v[72:75], a[132:135], v[52:55]
    v_mfma_f32_16x16x32_bf16 v[56:59], v[72:75], a[196:199], v[56:59]
    v_mfma_f32_16x16x32_bf16 v[112:115], v[132:135], v[68:71], v[112:115]
    v_mfma_f32_16x16x32_bf16 v[116:119], v[196:199], v[68:71], v[116:119]
    v_mfma_f32_16x16x32_bf16 v[120:123], v[132:135], v[72:75], v[120:123]
    v_mfma_f32_16x16x32_bf16 v[124:127], v[196:199], v[72:75], v[124:127]
    ds_read_b128 v[60:63], v2 offset:4096
    ds_read_b128 v[64:67], v2 offset:20480
    s_waitcnt lgkmcnt(5)
    v_mfma_f32_16x16x32_bf16 v[28:31], a[8:11], v[76:79], v[28:31]
    v_mfma_f32_16x16x32_bf16 v[32:35], a[72:75], v[76:79], v[32:35]
    s_waitcnt lgkmcnt(4)
    v_mfma_f32_16x16x32_bf16 v[36:39], a[8:11], v[80:83], v[36:39]
    v_mfma_f32_16x16x32_bf16 v[40:43], a[72:75], v[80:83], v[40:43]
    v_mfma_f32_16x16x32_bf16 v[44:47], v[76:79], a[136:139], v[44:47]
    v_mfma_f32_16x16x32_bf16 v[48:51], v[76:79], a[200:203], v[48:51]
    v_mfma_f32_16x16x32_bf16 v[52:55], v[80:83], a[136:139], v[52:55]
    v_mfma_f32_16x16x32_bf16 v[56:59], v[80:83], a[200:203], v[56:59]
    v_mfma_f32_16x16x32_bf16 v[112:115], v[136:139], v[76:79], v[112:115]
    v_mfma_f32_16x16x32_bf16 v[116:119], v[200:203], v[76:79], v[116:119]
    v_mfma_f32_16x16x32_bf16 v[120:123], v[136:139], v[80:83], v[120:123]
    v_mfma_f32_16x16x32_bf16 v[124:127], v[200:203], v[80:83], v[124:127]
    ds_read_b128 v[68:71], v2 offset:5120
    ds_read_b128 v[72:75], v2 offset:21504
    s_waitcnt lgkmcnt(5)
    v_mfma_f32_16x16x32_bf16 v[28:31], a[12:15], v[84:87], v[28:31]
    v_mfma_f32_16x16x32_bf16 v[32:35], a[76:79], v[84:87], v[32:35]
    s_waitcnt lgkmcnt(4)
    v_mfma_f32_16x16x32_bf16 v[36:39], a[12:15], v[88:91], v[36:39]
    v_mfma_f32_16x16x32_bf16 v[40:43], a[76:79], v[88:91], v[40:43]
    v_mfma_f32_16x16x32_bf16 v[44:47], v[84:87], a[140:143], v[44:47]
    v_mfma_f32_16x16x32_bf16 v[48:51], v[84:87], a[204:207], v[48:51]
    v_mfma_f32_16x16x32_bf16 v[52:55], v[88:91], a[140:143], v[52:55]
    v_mfma_f32_16x16x32_bf16 v[56:59], v[88:91], a[204:207], v[56:59]
    v_mfma_f32_16x16x32_bf16 v[112:115], v[140:143], v[84:87], v[112:115]
    v_mfma_f32_16x16x32_bf16 v[116:119], v[204:207], v[84:87], v[116:119]
    v_mfma_f32_16x16x32_bf16 v[120:123], v[140:143], v[88:91], v[120:123]
    v_mfma_f32_16x16x32_bf16 v[124:127], v[204:207], v[88:91], v[124:127]
    ds_read_b128 v[76:79], v2 offset:6144
    ds_read_b128 v[80:83], v2 offset:22528
    s_waitcnt lgkmcnt(5)
    v_mfma_f32_16x16x32_bf16 v[28:31], a[16:19], v[60:63], v[28:31]
    v_mfma_f32_16x16x32_bf16 v[32:35], a[80:83], v[60:63], v[32:35]
    s_waitcnt lgkmcnt(4)
    v_mfma_f32_16x16x32_bf16 v[36:39], a[16:19], v[64:67], v[36:39]
    v_mfma_f32_16x16x32_bf16 v[40:43], a[80:83], v[64:67], v[40:43]
    v_mfma_f32_16x16x32_bf16 v[44:47], v[60:63], a[144:147], v[44:47]
    v_mfma_f32_16x16x32_bf16 v[48:51], v[60:63], a[208:211], v[48:51]
    v_mfma_f32_16x16x32_bf16 v[52:55], v[64:67], a[144:147], v[52:55]
    v_mfma_f32_16x16x32_bf16 v[56:59], v[64:67], a[208:211], v[56:59]
    v_mfma_f32_16x16x32_bf16 v[112:115], v[144:147], v[60:63], v[112:115]
    v_mfma_f32_16x16x32_bf16 v[116:119], v[208:211], v[60:63], v[116:119]
    v_mfma_f32_16x16x32_bf16 v[120:123], v[144:147], v[64:67], v[120:123]
    v_mfma_f32_16x16x32_bf16 v[124:127], v[208:211], v[64:67], v[124:127]
    ds_read_b128 v[84:87], v2 offset:7168
    ds_read_b128 v[88:91], v2 offset:23552
    s_waitcnt lgkmcnt(5)
    v_mfma_f32_16x16x32_bf16 v[28:31], a[20:23], v[68:71], v[28:31]
    v_mfma_f32_16x16x32_bf16 v[32:35], a[84:87], v[68:71], v[32:35]
    s_waitcnt lgkmcnt(4)
    v_mfma_f32_16x16x32_bf16 v[36:39], a[20:23], v[72:75], v[36:39]
    v_mfma_f32_16x16x32_bf16 v[40:43], a[84:87], v[72:75], v[40:43]
    v_mfma_f32_16x16x32_bf16 v[44:47], v[68:71], a[148:151], v[44:47]
    v_mfma_f32_16x16x32_bf16 v[48:51], v[68:71], a[212:215], v[48:51]
    v_mfma_f32_16x16x32_bf16 v[52:55], v[72:75], a[148:151], v[52:55]
    v_mfma_f32_16x16x32_bf16 v[56:59], v[72:75], a[212:215], v[56:59]
    v_mfma_f32_16x16x32_bf16 v[112:115], v[148:151], v[68:71], v[112:115]
    v_mfma_f32_16x16x32_bf16 v[116:119], v[212:215], v[68:71], v[116:119]
    v_mfma_f32_16x16x32_bf16 v[120:123], v[148:151], v[72:75], v[120:123]
    v_mfma_f32_16x16x32_bf16 v[124:127], v[212:215], v[72:75], v[124:127]
    ds_read_b128 v[60:63], v2 offset:8192
    ds_read_b128 v[64:67], v2 offset:24576
    s_waitcnt lgkmcnt(5)
    v_mfma_f32_16x16x32_bf16 v[28:31], a[24:27], v[76:79], v[28:31]
    v_mfma_f32_16x16x32_bf16 v[32:35], a[88:91], v[76:79], v[32:35]
    s_waitcnt lgkmcnt(4)
    v_mfma_f32_16x16x32_bf16 v[36:39], a[24:27], v[80:83], v[36:39]
    v_mfma_f32_16x16x32_bf16 v[40:43], a[88:91], v[80:83], v[40:43]
    v_mfma_f32_16x16x32_bf16 v[44:47], v[76:79], a[152:155], v[44:47]
    v_mfma_f32_16x16x32_bf16 v[48:51], v[76:79], a[216:219], v[48:51]
    v_mfma_f32_16x16x32_bf16 v[52:55], v[80:83], a[152:155], v[52:55]
    v_mfma_f32_16x16x32_bf16 v[56:59], v[80:83], a[216:219], v[56:59]
    v_mfma_f32_16x16x32_bf16 v[112:115], v[152:155], v[76:79], v[112:115]
    v_mfma_f32_16x16x32_bf16 v[116:119], v[216:219], v[76:79], v[116:119]
    v_mfma_f32_16x16x32_bf16 v[120:123], v[152:155], v[80:83], v[120:123]
    v_mfma_f32_16x16x32_bf16 v[124:127], v[216:219], v[80:83], v[124:127]
    ds_read_b128 v[68:71], v2 offset:9216
    ds_read_b128 v[72:75], v2 offset:25600
    s_waitcnt lgkmcnt(5)
    v_mfma_f32_16x16x32_bf16 v[28:31], a[28:31], v[84:87], v[28:31]
    v_mfma_f32_16x16x32_bf16 v[32:35], a[92:95], v[84:87], v[32:35]
    s_waitcnt lgkmcnt(4)
    v_mfma_f32_16x16x32_bf16 v[36:39], a[28:31], v[88:91], v[36:39]
    v_mfma_f32_16x16x32_bf16 v[40:43], a[92:95], v[88:91], v[40:43]
    v_mfma_f32_16x16x32_bf16 v[44:47], v[84:87], a[156:159], v[44:47]
    v_mfma_f32_16x16x32_bf16 v[48:51], v[84:87], a[220:223], v[48:51]
    v_mfma_f32_16x16x32_bf16 v[52:55], v[88:91], a[156:159], v[52:55]
    v_mfma_f32_16x16x32_bf16 v[56:59], v[88:91], a[220:223], v[56:59]
    v_mfma_f32_16x16x32_bf16 v[112:115], v[156:159], v[84:87], v[112:115]
    v_mfma_f32_16x16x32_bf16 v[116:119], v[220:223], v[84:87], v[116:119]
    v_mfma_f32_16x16x32_bf16 v[120:123], v[156:159], v[88:91], v[120:123]
    v_mfma_f32_16x16x32_bf16 v[124:127], v[220:223], v[88:91], v[124:127]
    ds_read_b128 v[76:79], v2 offset:10240
    ds_read_b128 v[80:83], v2 offset:26624
    s_waitcnt lgkmcnt(5)
    v_mfma_f32_16x16x32_bf16 v[28:31], a[32:35], v[60:63], v[28:31]
    v_mfma_f32_16x16x32_bf16 v[32:35], a[96:99], v[60:63], v[32:35]
    s_waitcnt lgkmcnt(4)
    v_mfma_f32_16x16x32_bf16 v[36:39], a[32:35], v[64:67], v[36:39]
    v_mfma_f32_16x16x32_bf16 v[40:43], a[96:99], v[64:67], v[40:43]
    v_mfma_f32_16x16x32_bf16 v[44:47], v[60:63], a[160:163], v[44:47]
    v_mfma_f32_16x16x32_bf16 v[48:51], v[60:63], a[224:227], v[48:51]
    v_mfma_f32_16x16x32_bf16 v[52:55], v[64:67], a[160:163], v[52:55]
    v_mfma_f32_16x16x32_bf16 v[56:59], v[64:67], a[224:227], v[56:59]
    v_mfma_f32_16x16x32_bf16 v[112:115], v[160:163], v[60:63], v[112:115]
    v_mfma_f32_16x16x32_bf16 v[116:119], v[224:227], v[60:63], v[116:119]
    v_mfma_f32_16x16x32_bf16 v[120:123], v[160:163], v[64:67], v[120:123]
    v_mfma_f32_16x16x32_bf16 v[124:127], v[224:227], v[64:67], v[124:127]
    ds_read_b128 v[84:87], v2 offset:11264
    ds_read_b128 v[88:91], v2 offset:27648
    s_waitcnt lgkmcnt(5)
    v_mfma_f32_16x16x32_bf16 v[28:31], a[36:39], v[68:71], v[28:31]
    v_mfma_f32_16x16x32_bf16 v[32:35], a[100:103], v[68:71], v[32:35]
    s_waitcnt lgkmcnt(4)
    v_mfma_f32_16x16x32_bf16 v[36:39], a[36:39], v[72:75], v[36:39]
    v_mfma_f32_16x16x32_bf16 v[40:43], a[100:103], v[72:75], v[40:43]
    v_mfma_f32_16x16x32_bf16 v[44:47], v[68:71], a[164:167], v[44:47]
    v_mfma_f32_16x16x32_bf16 v[48:51], v[68:71], a[228:231], v[48:51]
    v_mfma_f32_16x16x32_bf16 v[52:55], v[72:75], a[164:167], v[52:55]
    v_mfma_f32_16x16x32_bf16 v[56:59], v[72:75], a[228:231], v[56:59]
    v_mfma_f32_16x16x32_bf16 v[112:115], v[164:167], v[68:71], v[112:115]
    v_mfma_f32_16x16x32_bf16 v[116:119], v[228:231], v[68:71], v[116:119]
    v_mfma_f32_16x16x32_bf16 v[120:123], v[164:167], v[72:75], v[120:123]
    v_mfma_f32_16x16x32_bf16 v[124:127], v[228:231], v[72:75], v[124:127]
    ds_read_b128 v[60:63], v2 offset:12288
    ds_read_b128 v[64:67], v2 offset:28672
    s_waitcnt lgkmcnt(5)
    v_mfma_f32_16x16x32_bf16 v[28:31], a[40:43], v[76:79], v[28:31]
    v_mfma_f32_16x16x32_bf16 v[32:35], a[104:107], v[76:79], v[32:35]
    s_waitcnt lgkmcnt(4)
    v_mfma_f32_16x16x32_bf16 v[36:39], a[40:43], v[80:83], v[36:39]
    v_mfma_f32_16x16x32_bf16 v[40:43], a[104:107], v[80:83], v[40:43]
    v_mfma_f32_16x16x32_bf16 v[44:47], v[76:79], a[168:171], v[44:47]
    v_mfma_f32_16x16x32_bf16 v[48:51], v[76:79], a[232:235], v[48:51]
    v_mfma_f32_16x16x32_bf16 v[52:55], v[80:83], a[168:171], v[52:55]
    v_mfma_f32_16x16x32_bf16 v[56:59], v[80:83], a[232:235], v[56:59]
    v_mfma_f32_16x16x32_bf16 v[112:115], v[168:171], v[76:79], v[112:115]
    v_mfma_f32_16x16x32_bf16 v[116:119], v[232:235], v[76:79], v[116:119]
    v_mfma_f32_16x16x32_bf16 v[120:123], v[168:171], v[80:83], v[120:123]
    v_mfma_f32_16x16x32_bf16 v[124:127], v[232:235], v[80:83], v[124:127]
    ds_read_b128 v[68:71], v2 offset:13312
    ds_read_b128 v[72:75], v2 offset:29696
    s_waitcnt lgkmcnt(5)
    v_mfma_f32_16x16x32_bf16 v[28:31], a[44:47], v[84:87], v[28:31]
    v_mfma_f32_16x16x32_bf16 v[32:35], a[108:111], v[84:87], v[32:35]
    s_waitcnt lgkmcnt(4)
    v_mfma_f32_16x16x32_bf16 v[36:39], a[44:47], v[88:91], v[36:39]
    v_mfma_f32_16x16x32_bf16 v[40:43], a[108:111], v[88:91], v[40:43]
    v_mfma_f32_16x16x32_bf16 v[44:47], v[84:87], a[172:175], v[44:47]
    v_mfma_f32_16x16x32_bf16 v[48:51], v[84:87], a[236:239], v[48:51]
    v_mfma_f32_16x16x32_bf16 v[52:55], v[88:91], a[172:175], v[52:55]
    v_mfma_f32_16x16x32_bf16 v[56:59], v[88:91], a[236:239], v[56:59]
    v_mfma_f32_16x16x32_bf16 v[112:115], v[172:175], v[84:87], v[112:115]
    v_mfma_f32_16x16x32_bf16 v[116:119], v[236:239], v[84:87], v[116:119]
    v_mfma_f32_16x16x32_bf16 v[120:123], v[172:175], v[88:91], v[120:123]
    v_mfma_f32_16x16x32_bf16 v[124:127], v[236:239], v[88:91], v[124:127]
    ds_read_b128 v[76:79], v2 offset:14336
    ds_read_b128 v[80:83], v2 offset:30720
    s_waitcnt lgkmcnt(5)
    v_mfma_f32_16x16x32_bf16 v[28:31], a[48:51], v[60:63], v[28:31]
    v_mfma_f32_16x16x32_bf16 v[32:35], a[112:115], v[60:63], v[32:35]
    s_waitcnt lgkmcnt(4)
    v_mfma_f32_16x16x32_bf16 v[36:39], a[48:51], v[64:67], v[36:39]
    v_mfma_f32_16x16x32_bf16 v[40:43], a[112:115], v[64:67], v[40:43]
    v_mfma_f32_16x16x32_bf16 v[44:47], v[60:63], a[176:179], v[44:47]
    v_mfma_f32_16x16x32_bf16 v[48:51], v[60:63], a[240:243], v[48:51]
    v_mfma_f32_16x16x32_bf16 v[52:55], v[64:67], a[176:179], v[52:55]
    v_mfma_f32_16x16x32_bf16 v[56:59], v[64:67], a[240:243], v[56:59]
    v_mfma_f32_16x16x32_bf16 v[112:115], v[176:179], v[60:63], v[112:115]
    v_mfma_f32_16x16x32_bf16 v[116:119], v[240:243], v[60:63], v[116:119]
    v_mfma_f32_16x16x32_bf16 v[120:123], v[176:179], v[64:67], v[120:123]
    v_mfma_f32_16x16x32_bf16 v[124:127], v[240:243], v[64:67], v[124:127]
    ds_read_b128 v[84:87], v2 offset:15360
    ds_read_b128 v[88:91], v2 offset:31744
    s_waitcnt lgkmcnt(5)
    v_mfma_f32_16x16x32_bf16 v[28:31], a[52:55], v[68:71], v[28:31]
    v_mfma_f32_16x16x32_bf16 v[32:35], a[116:119], v[68:71], v[32:35]
    s_waitcnt lgkmcnt(4)
    v_mfma_f32_16x16x32_bf16 v[36:39], a[52:55], v[72:75], v[36:39]
    v_mfma_f32_16x16x32_bf16 v[40:43], a[116:119], v[72:75], v[40:43]
    v_mfma_f32_16x16x32_bf16 v[44:47], v[68:71], a[180:183], v[44:47]
    v_mfma_f32_16x16x32_bf16 v[48:51], v[68:71], a[244:247], v[48:51]
    v_mfma_f32_16x16x32_bf16 v[52:55], v[72:75], a[180:183], v[52:55]
    v_mfma_f32_16x16x32_bf16 v[56:59], v[72:75], a[244:247], v[56:59]
    v_mfma_f32_16x16x32_bf16 v[112:115], v[180:183], v[68:71], v[112:115]
    v_mfma_f32_16x16x32_bf16 v[116:119], v[244:247], v[68:71], v[116:119]
    v_mfma_f32_16x16x32_bf16 v[120:123], v[180:183], v[72:75], v[120:123]
    v_mfma_f32_16x16x32_bf16 v[124:127], v[244:247], v[72:75], v[124:127]
    s_waitcnt lgkmcnt(3)
    v_mfma_f32_16x16x32_bf16 v[28:31], a[56:59], v[76:79], v[28:31]
    v_mfma_f32_16x16x32_bf16 v[32:35], a[120:123], v[76:79], v[32:35]
    s_waitcnt lgkmcnt(2)
    v_mfma_f32_16x16x32_bf16 v[36:39], a[56:59], v[80:83], v[36:39]
    v_mfma_f32_16x16x32_bf16 v[40:43], a[120:123], v[80:83], v[40:43]
    v_mfma_f32_16x16x32_bf16 v[44:47], v[76:79], a[184:187], v[44:47]
    v_mfma_f32_16x16x32_bf16 v[48:51], v[76:79], a[248:251], v[48:51]
    v_mfma_f32_16x16x32_bf16 v[52:55], v[80:83], a[184:187], v[52:55]
    v_mfma_f32_16x16x32_bf16 v[56:59], v[80:83], a[248:251], v[56:59]
    v_mfma_f32_16x16x32_bf16 v[112:115], v[184:187], v[76:79], v[112:115]
    v_mfma_f32_16x16x32_bf16 v[116:119], v[248:251], v[76:79], v[116:119]
    v_mfma_f32_16x16x32_bf16 v[120:123], v[184:187], v[80:83], v[120:123]
    v_mfma_f32_16x16x32_bf16 v[124:127], v[248:251], v[80:83], v[124:127]
    s_waitcnt lgkmcnt(1)
    v_mfma_f32_16x16x32_bf16 v[28:31], a[60:63], v[84:87], v[28:31]
    v_mfma_f32_16x16x32_bf16 v[32:35], a[124:127], v[84:87], v[32:35]
    s_waitcnt lgkmcnt(0)
    v_mfma_f32_16x16x32_bf16 v[36:39], a[60:63], v[88:91], v[36:39]
    v_mfma_f32_16x16x32_bf16 v[40:43], a[124:127], v[88:91], v[40:43]
    v_mfma_f32_16x16x32_bf16 v[44:47], v[84:87], a[188:191], v[44:47]
    v_mfma_f32_16x16x32_bf16 v[48:51], v[84:87], a[252:255], v[48:51]
    v_mfma_f32_16x16x32_bf16 v[52:55], v[88:91], a[188:191], v[52:55]
    v_mfma_f32_16x16x32_bf16 v[56:59], v[88:91], a[252:255], v[56:59]
    v_mfma_f32_16x16x32_bf16 v[112:115], v[188:191], v[84:87], v[112:115]
    v_mfma_f32_16x16x32_bf16 v[116:119], v[252:255], v[84:87], v[116:119]
    v_mfma_f32_16x16x32_bf16 v[120:123], v[188:191], v[88:91], v[120:123]
    v_mfma_f32_16x16x32_bf16 v[124:127], v[252:255], v[88:91], v[124:127]
    v_mul_f32 v28, s41, v28
    v_mul_f32 v29, s41, v29
    v_mul_f32 v30, s41, v30
    v_mul_f32 v31, s41, v31
    v_cvt_pk_bf16_f32 v60, v28, v29
    v_cvt_pk_bf16_f32 v61, v30, v31
    v_mul_f32 v32, s41, v32
    v_mul_f32 v33, s41, v33
    v_mul_f32 v34, s41, v34
    v_mul_f32 v35, s41, v35
    v_cvt_pk_bf16_f32 v62, v32, v33
    v_cvt_pk_bf16_f32 v63, v34, v35
    v_mul_f32 v36, s41, v36
    v_mul_f32 v37, s41, v37
    v_mul_f32 v38, s41, v38
    v_mul_f32 v39, s41, v39
    v_cvt_pk_bf16_f32 v64, v36, v37
    v_cvt_pk_bf16_f32 v65, v38, v39
    v_mul_f32 v40, s41, v40
    v_mul_f32 v41, s41, v41
    v_mul_f32 v42, s41, v42
    v_mul_f32 v43, s41, v43
    v_cvt_pk_bf16_f32 v66, v40, v41
    v_cvt_pk_bf16_f32 v67, v42, v43
    ds_write_b128 v7, v[60:63] offset:8192
    ds_write_b128 v7, v[64:67] offset:12288
    v_cvt_pk_bf16_f32 v72, v44, v45
    v_cvt_pk_bf16_f32 v73, v46, v47
    v_cvt_pk_bf16_f32 v74, v52, v53
    v_cvt_pk_bf16_f32 v75, v54, v55
    s_add_u32 s32, s35, 262144
    buffer_store_dwordx4 v[72:75], v2, s[8:11], s32 offen sc1
    v_cvt_pk_bf16_f32 v76, v48, v49
    v_cvt_pk_bf16_f32 v77, v50, v51
    v_cvt_pk_bf16_f32 v78, v56, v57
    v_cvt_pk_bf16_f32 v79, v58, v59
    s_add_u32 s32, s35, 393216
    buffer_store_dwordx4 v[76:79], v2, s[8:11], s32 offen sc1
    v_add_u32 v26, v6, v3
    s_waitcnt lgkmcnt(0)
    s_barrier
    ds_read2st64_b64 v[60:63], v26 offset0:0 offset1:2
    ds_read2st64_b64 v[64:67], v26 offset0:4 offset1:6
    s_add_u32 s32, s35, 0
    s_waitcnt lgkmcnt(1)
    buffer_store_dwordx4 v[60:63], v2, s[8:11], s32 offen sc1
    s_add_u32 s32, s35, 131072
    s_waitcnt lgkmcnt(0)
    buffer_store_dwordx4 v[64:67], v2, s[8:11], s32 offen sc1
    v_cvt_pk_bf16_f32 v80, v112, v113
    v_cvt_pk_bf16_f32 v81, v114, v115
    v_cvt_pk_bf16_f32 v82, v116, v117
    v_cvt_pk_bf16_f32 v83, v118, v119
    v_cvt_pk_bf16_f32 v84, v120, v121
    v_cvt_pk_bf16_f32 v85, v122, v123
    v_cvt_pk_bf16_f32 v86, v124, v125
    v_cvt_pk_bf16_f32 v87, v126, v127
    ds_write_b128 v7, v[80:83] offset:0
    ds_write_b128 v7, v[72:75] offset:16384
    ds_write_b128 v7, v[84:87] offset:4096
    ds_write_b128 v7, v[76:79] offset:20480
L_at_pub:
    v_mov_b32 v11, 1
    s_waitcnt vmcnt(0) lgkmcnt(0)
    s_barrier
    s_cmp_lg_u32 s21, 0
    s_cbranch_scc1 L_at_nf2
    s_mov_b64 exec, 1
    buffer_store_dword v11, off, s[8:11], s36 sc1
    s_mov_b64 exec, -1
    s_nop 0
L_at_nf2:
    s_add_u32 s35, s35, 4194304
    s_add_u32 s36, s36, 4194304
    s_cmp_ge_i32 s40, 13
    s_cbranch_scc1 L_at_next
    s_mov_b32 m0, s42
    s_nop 0
    buffer_load_dwordx4 v5, s[28:31], s34 offen offset:0 lds
    s_add_u32 m0, m0, 960
    s_nop 0
    buffer_load_dwordx4 v5, s[28:31], s34 offen offset:64 lds
    s_add_u32 m0, m0, 960
    s_nop 0
    buffer_load_dwordx4 v5, s[28:31], s34 offen offset:128 lds
    s_add_u32 m0, m0, 960
    s_nop 0
    buffer_load_dwordx4 v5, s[28:31], s34 offen offset:192 lds
    s_add_u32 m0, m0, 960
    s_nop 0
    buffer_load_dwordx4 v5, s[28:31], s34 offen offset:256 lds
    s_add_u32 m0, m0, 960
    s_nop 0
    buffer_load_dwordx4 v5, s[28:31], s34 offen offset:320 lds
    s_add_u32 m0, m0, 960
    s_nop 0
    buffer_load_dwordx4 v5, s[28:31], s34 offen offset:384 lds
    s_add_u32 m0, m0, 960
    s_nop 0
    buffer_load_dwordx4 v5, s[28:31], s34 offen offset:448 lds
    s_add_u32 s34, s34, 131072
L_at_next:
    v_xor_b32 v6, 0x18000, v6
    v_xor_b32 v7, 0x18000, v7
    s_add_u32 s40, s40, 1
    s_cmp_lt_i32 s40, 0
    s_cbranch_scc1 L_at_qkv
    s_cmp_lt_i32 s40, 16
    s_cbranch_scc1 L_at_loop
    s_waitcnt vmcnt(0)
    s_endpgm
L_at_miss:
    s_sub_u32 s22, s22, 1
    s_cbranch_scc1 L_exit
    s_branch L_at_got
L_outp:
    s_load_dwordx2 s[28:29], s[0:1], 0
    s_mov_b32 s30, 2097152
    s_mov_b32 s31, 0x20000
    s_sub_u32 s42, s5, 160
    v_and_b32 v2, 63, v0
    v_and_b32 v3, 15, v0
    v_lshrrev_b32 v4, 4, v2
    v_lshlrev_b32 v2, 4, v2
    s_or_b32 s4, s23, s21
    s_cselect_b64 exec, 0, 1
    buffer_atomic_or v1, off, s[16:19], s59 sc0
    s_mov_b64 exec, -1
    s_cmp_lg_u32 s23, 0
    s_cbranch_scc1 L_ver_o
    v_mov_b32 v5, 14336
    s_cmp_lg_u32 s21, 0
    s_cbranch_scc1 L_verw_o
    s_waitcnt vmcnt(0)
    s_mov_b64 exec, 1
    ds_write_b32 v5, v1
    s_mov_b64 exec, -1
    s_waitcnt lgkmcnt(0)
L_verw_o:
    s_barrier
    ds_read_b32 v6, v5
    s_waitcnt lgkmcnt(0)
    v_readfirstlane_b32 s4, v6
    s_bitcmp1_b32 s4, s5
    s_cbranch_scc1 L_el_fix
    s_nop 2
L_ver_o:
    s_barrier
    s_cmp_lt_u32 s42, 64
    s_cbranch_scc1 L_ssm
    s_load_dwordx2 s[32:33], s[0:1], 8
    s_mov_b32 s34, 8192
    s_mov_b32 s35, 0x20000
    s_sub_u32 s43, s42, 64
    v_and_b32 v10, 3, v3
    v_and_b32 v11, 1, v4
    v_lshrrev_b32 v12, 1, v4
    v_lshlrev_b32 v13, 10, v11
    v_lshl_add_u32 v13, v10, 3, v13
    v_lshl_add_u32 v13, v12, 2, v13
    s_lshr_b32 s40, s43, 2
    s_lshl_b32 s40, s40, 5
    s_and_b32 s41, s43, 3
    s_lshl_b32 s41, s41, 11
    s_add_u32 s40, s40, s41
    s_lshl_b32 s41, s21, 8
    s_add_u32 s40, s40, s41
    s_waitcnt lgkmcnt(0)
    buffer_load_dword v14, v13, s[32:35], s40 offen
    v_lshlrev_b32 v11, 4, v4
    v_lshl_add_u32 v11, v10, 2, v11
    v_mov_b64 v[16:17], -1
    v_mov_b64 v[18:19], -1
    v_mov_b64 v[20:21], 0
    v_mov_b64 v[22:23], 0
    s_lshl_b32 s40, s43, 13
    s_lshl_b32 s41, s21, 11
    s_add_u32 s40, s40, s41
    buffer_store_dwordx4 v[20:23], v2, s[8:11], s40 offen sc1
    buffer_store_dwordx4 v[20:23], v2, s[8:11], s40 offen offset:1024 sc1
    s_add_u32 s40, s40, 183762944
    buffer_store_dwordx4 v[16:19], v2, s[8:11], s40 offen sc1
    buffer_store_dwordx4 v[16:19], v2, s[8:11], s40 offen offset:1024 sc1
    s_add_u32 s40, s40, 0x40000
    buffer_store_dwordx4 v[16:19], v2, s[8:11], s40 offen sc1
    buffer_store_dwordx4 v[16:19], v2, s[8:11], s40 offen offset:1024 sc1
    s_add_u32 s40, s40, 0x40000
    buffer_store_dwordx4 v[16:19], v2, s[8:11], s40 offen sc1
    buffer_store_dwordx4 v[16:19], v2, s[8:11], s40 offen offset:1024 sc1
    s_lshl_b32 s40, s43, 6
    s_add_u32 s41, s41, s40
    s_add_u32 s41, s41, 17563648
    s_lshl_b32 s40, s43, 1
    s_lshr_b32 s44, s21, 1
    s_add_u32 s40, s40, s44
    s_lshl_b32 s40, s40, 20
    s_and_b32 s44, s21, 1
    s_mul_i32 s44, s44, 10240
    s_add_u32 s40, s40, s44
    s_cmp_eq_u32 s40, 0
    s_cselect_b32 s44, 1, 0
    s_add_u32 s40, s40, 17571840
    buffer_store_dwordx4 v[16:19], v2, s[8:11], s40 offen sc1
    buffer_store_dwordx4 v[16:19], v2, s[8:11], s40 offen offset:1024 sc1
    s_cmp_eq_u32 s44, 1
    s_cbranch_scc1 L_init_z
    s_sub_u32 s40, s40, 4096
    buffer_store_dwordx4 v[16:19], v2, s[8:11], s40 offen offset:0 sc1
    buffer_store_dwordx4 v[16:19], v2, s[8:11], s40 offen offset:1024 sc1
    buffer_store_dwordx4 v[16:19], v2, s[8:11], s40 offen offset:2048 sc1
    buffer_store_dwordx4 v[16:19], v2, s[8:11], s40 offen offset:3072 sc1
    s_sub_u32 s40, s40, 4096
    buffer_store_dwordx4 v[16:19], v2, s[8:11], s40 offen offset:0 sc1
    buffer_store_dwordx4 v[16:19], v2, s[8:11], s40 offen offset:1024 sc1
    buffer_store_dwordx4 v[16:19], v2, s[8:11], s40 offen offset:2048 sc1
    buffer_store_dwordx4 v[16:19], v2, s[8:11], s40 offen offset:3072 sc1
    s_branch L_init_m
    s_nop 0
L_init_z:
    s_mov_b32 s40, 262144
    buffer_store_dwordx4 v[20:23], v2, s[8:11], s40 offen sc1
    s_nop 1
L_init_m:
    s_waitcnt vmcnt(0)
    v_cmp_gt_u32 vcc, 4, v3
    s_mov_b64 exec, vcc
    buffer_store_dword v14, v11, s[8:11], s41 offen sc1
    s_mov_b64 exec, -1
    v_mov_b32 v5, 1
    s_waitcnt vmcnt(0)
    s_barrier
    s_cmp_lg_u32 s21, 0
    s_cbranch_scc1 L_op_start
    s_mov_b64 exec, 1
    buffer_atomic_add v5, off, s[16:19], 0 offset:4
    s_mov_b64 exec, -1
    s_branch L_op_start
L_ssm:
    s_load_dwordx2 s[32:33], s[0:1], 64
    s_mov_b32 s34, 2097152
    s_mov_b32 s35, 0x20000
    s_load_dwordx2 s[36:37], s[0:1], 72
    s_mov_b32 s38, 2097152
    s_mov_b32 s39, 0x20000
    s_load_dwordx2 s[12:13], s[0:1], 88
    s_mov_b32 s14, 2097152
    s_mov_b32 s15, 0x20000
    s_load_dwordx2 s[6:7], s[0:1], 80
    s_load_dwordx2 s[48:49], s[0:1], 96
    s_lshl_b32 s40, s42, 4
    v_lshlrev_b32 v7, 13, v0
    v_add_u32 v7, s40, v7
    v_add_u32 v116, 4096, v7
    v_subrev_u32 v5, 3072, v7
    v_lshlrev_b32 v117, 4, v0
    s_lshl_b32 s41, s42, 6
    s_waitcnt lgkmcnt(0)
    s_load_dwordx16 s[84:99], s[6:7], s41
    s_load_dwordx4 s[80:83], s[48:49], s40
    buffer_load_dwordx4 v[8:11], v5, s[32:35], 0 offen offset:0
    buffer_load_dwordx4 v[12:15], v5, s[32:35], 0 offen offset:1024
    buffer_load_dwordx4 v[16:19], v5, s[32:35], 0 offen offset:2048
    buffer_load_dwordx4 v[20:23], v7, s[32:35], 0 offen offset:0
    buffer_load_dwordx4 v[24:27], v7, s[32:35], 0 offen offset:1024
    buffer_load_dwordx4 v[28:31], v7, s[32:35], 0 offen offset:2048
    buffer_load_dwordx4 v[32:35], v7, s[32:35], 0 offen offset:3072
    buffer_load_dwordx4 v[36:39], v116, s[32:35], 0 offen offset:0
    buffer_load_dwordx4 v[40:43], v116, s[32:35], 0 offen offset:1024
    buffer_load_dwordx4 v[44:47], v116, s[32:35], 0 offen offset:2048
    buffer_load_dwordx4 v[48:51], v116, s[32:35], 0 offen offset:3072
    buffer_load_dwordx4 v[52:55], v7, s[36:39], 0 offen offset:0
    buffer_load_dwordx4 v[56:59], v7, s[36:39], 0 offen offset:1024
    buffer_load_dwordx4 v[60:63], v7, s[36:39], 0 offen offset:2048
    buffer_load_dwordx4 v[64:67], v7, s[36:39], 0 offen offset:3072
    buffer_load_dwordx4 v[68:71], v116, s[36:39], 0 offen offset:0
    buffer_load_dwordx4 v[72:75], v116, s[36:39], 0 offen offset:1024
    buffer_load_dwordx4 v[76:79], v116, s[36:39], 0 offen offset:2048
    buffer_load_dwordx4 v[80:83], v116, s[36:39], 0 offen offset:3072
    s_lshl_b32 s43, s42, 15
    s_lshl_b32 s40, s21, 13
    s_add_u32 s43, s43, s40
    v_add_u32 v158, s43, v2
    v_subrev_u32 v6, 4, v158
    v_add_u32 v5, 4092, v158
    s_mov_b32 s40, 4096
    buffer_load_dwordx4 v[118:121], v158, s[12:15], 0 offen offset:0
    buffer_load_dword v134, v6, s[12:15], 0 offen
    buffer_load_dwordx4 v[122:125], v158, s[12:15], 0 offen offset:1024
    buffer_load_dword v135, v158, s[12:15], 0 offen offset:1020
    buffer_load_dwordx4 v[126:129], v158, s[12:15], 0 offen offset:2048
    buffer_load_dword v136, v158, s[12:15], 0 offen offset:2044
    buffer_load_dwordx4 v[130:133], v158, s[12:15], 0 offen offset:3072
    buffer_load_dword v137, v158, s[12:15], 0 offen offset:3068
    buffer_load_dwordx4 v[138:141], v158, s[12:15], s40 offen offset:0
    buffer_load_dword v154, v5, s[12:15], 0 offen offset:0
    buffer_load_dwordx4 v[142:145], v158, s[12:15], s40 offen offset:1024
    buffer_load_dword v155, v5, s[12:15], 0 offen offset:1024
    buffer_load_dwordx4 v[146:149], v158, s[12:15], s40 offen offset:2048
    buffer_load_dword v156, v5, s[12:15], 0 offen offset:2048
    buffer_load_dwordx4 v[150:153], v158, s[12:15], s40 offen offset:3072
    buffer_load_dword v157, v5, s[12:15], 0 offen offset:3072
    s_waitcnt lgkmcnt(0)
    s_lshl_b32 s48, s84, 16
    s_and_b32 s49, s84, 0xffff0000
    s_lshl_b32 s50, s85, 16
    s_and_b32 s51, s85, 0xffff0000
    s_lshl_b32 s52, s86, 16
    s_and_b32 s53, s86, 0xffff0000
    s_lshl_b32 s54, s87, 16
    s_and_b32 s55, s87, 0xffff0000
    s_lshl_b32 s56, s88, 16
    s_and_b32 s57, s88, 0xffff0000
    s_lshl_b32 s58, s89, 16
    s_and_b32 s59, s89, 0xffff0000
    s_lshl_b32 s60, s90, 16
    s_and_b32 s61, s90, 0xffff0000
    s_lshl_b32 s62, s91, 16
    s_and_b32 s63, s91, 0xffff0000
    s_lshl_b32 s64, s92, 16
    s_and_b32 s65, s92, 0xffff0000
    s_lshl_b32 s66, s93, 16
    s_and_b32 s67, s93, 0xffff0000
    s_lshl_b32 s68, s94, 16
    s_and_b32 s69, s94, 0xffff0000
    s_lshl_b32 s70, s95, 16
    s_and_b32 s71, s95, 0xffff0000
    s_lshl_b32 s72, s96, 16
    s_and_b32 s73, s96, 0xffff0000
    s_lshl_b32 s74, s97, 16
    s_and_b32 s75, s97, 0xffff0000
    s_lshl_b32 s76, s98, 16
    s_and_b32 s77, s98, 0xffff0000
    s_lshl_b32 s78, s99, 16
    s_and_b32 s79, s99, 0xffff0000
    s_lshl_b32 s84, s80, 16
    s_and_b32 s85, s80, 0xffff0000
    s_lshl_b32 s86, s81, 16
    s_and_b32 s87, s81, 0xffff0000
    s_lshl_b32 s88, s82, 16
    s_and_b32 s89, s82, 0xffff0000
    s_lshl_b32 s90, s83, 16
    s_and_b32 s91, s83, 0xffff0000
    s_waitcnt vmcnt(34)
    v_lshlrev_b32 v160, 16, v8
    s_waitcnt vmcnt(33)
    v_lshlrev_b32 v161, 16, v12
    s_waitcnt vmcnt(32)
    v_lshlrev_b32 v162, 16, v16
    s_waitcnt vmcnt(31)
    v_lshlrev_b32 v163, 16, v20
    s_waitcnt vmcnt(30)
    v_lshlrev_b32 v164, 16, v24
    s_waitcnt vmcnt(29)
    v_lshlrev_b32 v165, 16, v28
    s_waitcnt vmcnt(28)
    v_lshlrev_b32 v166, 16, v32
    s_waitcnt vmcnt(27)
    v_lshlrev_b32 v167, 16, v36
    s_waitcnt vmcnt(26)
    v_lshlrev_b32 v168, 16, v40
    s_waitcnt vmcnt(25)
    v_lshlrev_b32 v169, 16, v44
    s_waitcnt vmcnt(24)
    v_lshlrev_b32 v170, 16, v48
    s_waitcnt vmcnt(23)
    v_lshlrev_b32 v172, 16, v52
    s_waitcnt vmcnt(22)
    v_lshlrev_b32 v173, 16, v56
    s_waitcnt vmcnt(21)
    v_lshlrev_b32 v174, 16, v60
    s_waitcnt vmcnt(20)
    v_lshlrev_b32 v175, 16, v64
    s_waitcnt vmcnt(19)
    v_lshlrev_b32 v176, 16, v68
    s_waitcnt vmcnt(18)
    v_lshlrev_b32 v177, 16, v72
    s_waitcnt vmcnt(17)
    v_lshlrev_b32 v178, 16, v76
    s_waitcnt vmcnt(16)
    v_lshlrev_b32 v179, 16, v80
    v_mul_f32 v160, s51, v160
    v_fmac_f32 v160, s50, v161
    v_fmac_f32 v160, s49, v162
    v_fmac_f32 v160, s48, v163
    v_mul_f32 v172, v172, v160
    v_mul_f32 v161, s51, v161
    v_fmac_f32 v161, s50, v162
    v_fmac_f32 v161, s49, v163
    v_fmac_f32 v161, s48, v164
    v_mul_f32 v173, v173, v161
    v_mul_f32 v162, s51, v162
    v_fmac_f32 v162, s50, v163
    v_fmac_f32 v162, s49, v164
    v_fmac_f32 v162, s48, v165
    v_mul_f32 v174, v174, v162
    v_mul_f32 v163, s51, v163
    v_fmac_f32 v163, s50, v164
    v_fmac_f32 v163, s49, v165
    v_fmac_f32 v163, s48, v166
    v_mul_f32 v175, v175, v163
    v_mul_f32 v164, s51, v164
    v_fmac_f32 v164, s50, v165
    v_fmac_f32 v164, s49, v166
    v_fmac_f32 v164, s48, v167
    v_mul_f32 v176, v176, v164
    v_mul_f32 v165, s51, v165
    v_fmac_f32 v165, s50, v166
    v_fmac_f32 v165, s49, v167
    v_fmac_f32 v165, s48, v168
    v_mul_f32 v177, v177, v165
    v_mul_f32 v166, s51, v166
    v_fmac_f32 v166, s50, v167
    v_fmac_f32 v166, s49, v168
    v_fmac_f32 v166, s48, v169
    v_mul_f32 v178, v178, v166
    v_mul_f32 v167, s51, v167
    v_fmac_f32 v167, s50, v168
    v_fmac_f32 v167, s49, v169
    v_fmac_f32 v167, s48, v170
    v_mul_f32 v179, v179, v167
    v_cvt_pk_bf16_f32 v84, v179, v178
    v_cvt_pk_bf16_f32 v85, v177, v176
    v_cvt_pk_bf16_f32 v86, v175, v174
    v_cvt_pk_bf16_f32 v87, v173, v172
    ds_write_b128 v117, v[84:87] offset:0
    v_and_b32 v160, 0xffff0000, v8
    v_and_b32 v161, 0xffff0000, v12
    v_and_b32 v162, 0xffff0000, v16
    v_and_b32 v163, 0xffff0000, v20
    v_and_b32 v164, 0xffff0000, v24
    v_and_b32 v165, 0xffff0000, v28
    v_and_b32 v166, 0xffff0000, v32
    v_and_b32 v167, 0xffff0000, v36
    v_and_b32 v168, 0xffff0000, v40
    v_and_b32 v169, 0xffff0000, v44
    v_and_b32 v170, 0xffff0000, v48
    v_and_b32 v172, 0xffff0000, v52
    v_and_b32 v173, 0xffff0000, v56
    v_and_b32 v174, 0xffff0000, v60
    v_and_b32 v175, 0xffff0000, v64
    v_and_b32 v176, 0xffff0000, v68
    v_and_b32 v177, 0xffff0000, v72
    v_and_b32 v178, 0xffff0000, v76
    v_and_b32 v179, 0xffff0000, v80
    v_mul_f32 v160, s55, v160
    v_fmac_f32 v160, s54, v161
    v_fmac_f32 v160, s53, v162
    v_fmac_f32 v160, s52, v163
    v_mul_f32 v172, v172, v160
    v_mul_f32 v161, s55, v161
    v_fmac_f32 v161, s54, v162
    v_fmac_f32 v161, s53, v163
    v_fmac_f32 v161, s52, v164
    v_mul_f32 v173, v173, v161
    v_mul_f32 v162, s55, v162
    v_fmac_f32 v162, s54, v163
    v_fmac_f32 v162, s53, v164
    v_fmac_f32 v162, s52, v165
    v_mul_f32 v174, v174, v162
    v_mul_f32 v163, s55, v163
    v_fmac_f32 v163, s54, v164
    v_fmac_f32 v163, s53, v165
    v_fmac_f32 v163, s52, v166
    v_mul_f32 v175, v175, v163
    v_mul_f32 v164, s55, v164
    v_fmac_f32 v164, s54, v165
    v_fmac_f32 v164, s53, v166
    v_fmac_f32 v164, s52, v167
    v_mul_f32 v176, v176, v164
    v_mul_f32 v165, s55, v165
    v_fmac_f32 v165, s54, v166
    v_fmac_f32 v165, s53, v167
    v_fmac_f32 v165, s52, v168
    v_mul_f32 v177, v177, v165
    v_mul_f32 v166, s55, v166
    v_fmac_f32 v166, s54, v167
    v_fmac_f32 v166, s53, v168
    v_fmac_f32 v166, s52, v169
    v_mul_f32 v178, v178, v166
    v_mul_f32 v167, s55, v167
    v_fmac_f32 v167, s54, v168
    v_fmac_f32 v167, s53, v169
    v_fmac_f32 v167, s52, v170
    v_mul_f32 v179, v179, v167
    v_cvt_pk_bf16_f32 v88, v179, v178
    v_cvt_pk_bf16_f32 v89, v177, v176
    v_cvt_pk_bf16_f32 v90, v175, v174
    v_cvt_pk_bf16_f32 v91, v173, v172
    ds_write_b128 v117, v[88:91] offset:4096
    v_lshlrev_b32 v160, 16, v9
    v_lshlrev_b32 v161, 16, v13
    v_lshlrev_b32 v162, 16, v17
    v_lshlrev_b32 v163, 16, v21
    v_lshlrev_b32 v164, 16, v25
    v_lshlrev_b32 v165, 16, v29
    v_lshlrev_b32 v166, 16, v33
    v_lshlrev_b32 v167, 16, v37
    v_lshlrev_b32 v168, 16, v41
    v_lshlrev_b32 v169, 16, v45
    v_lshlrev_b32 v170, 16, v49
    v_lshlrev_b32 v172, 16, v53
    v_lshlrev_b32 v173, 16, v57
    v_lshlrev_b32 v174, 16, v61
    v_lshlrev_b32 v175, 16, v65
    v_lshlrev_b32 v176, 16, v69
    v_lshlrev_b32 v177, 16, v73
    v_lshlrev_b32 v178, 16, v77
    v_lshlrev_b32 v179, 16, v81
    v_mul_f32 v160, s59, v160
    v_fmac_f32 v160, s58, v161
    v_fmac_f32 v160, s57, v162
    v_fmac_f32 v160, s56, v163
    v_mul_f32 v172, v172, v160
    v_mul_f32 v161, s59, v161
    v_fmac_f32 v161, s58, v162
    v_fmac_f32 v161, s57, v163
    v_fmac_f32 v161, s56, v164
    v_mul_f32 v173, v173, v161
    v_mul_f32 v162, s59, v162
    v_fmac_f32 v162, s58, v163
    v_fmac_f32 v162, s57, v164
    v_fmac_f32 v162, s56, v165
    v_mul_f32 v174, v174, v162
    v_mul_f32 v163, s59, v163
    v_fmac_f32 v163, s58, v164
    v_fmac_f32 v163, s57, v165
    v_fmac_f32 v163, s56, v166
    v_mul_f32 v175, v175, v163
    v_mul_f32 v164, s59, v164
    v_fmac_f32 v164, s58, v165
    v_fmac_f32 v164, s57, v166
    v_fmac_f32 v164, s56, v167
    v_mul_f32 v176, v176, v164
    v_mul_f32 v165, s59, v165
    v_fmac_f32 v165, s58, v166
    v_fmac_f32 v165, s57, v167
    v_fmac_f32 v165, s56, v168
    v_mul_f32 v177, v177, v165
    v_mul_f32 v166, s59, v166
    v_fmac_f32 v166, s58, v167
    v_fmac_f32 v166, s57, v168
    v_fmac_f32 v166, s56, v169
    v_mul_f32 v178, v178, v166
    v_mul_f32 v167, s59, v167
    v_fmac_f32 v167, s58, v168
    v_fmac_f32 v167, s57, v169
    v_fmac_f32 v167, s56, v170
    v_mul_f32 v179, v179, v167
    v_cvt_pk_bf16_f32 v92, v179, v178
    v_cvt_pk_bf16_f32 v93, v177, v176
    v_cvt_pk_bf16_f32 v94, v175, v174
    v_cvt_pk_bf16_f32 v95, v173, v172
    ds_write_b128 v117, v[92:95] offset:8192
    v_and_b32 v160, 0xffff0000, v9
    v_and_b32 v161, 0xffff0000, v13
    v_and_b32 v162, 0xffff0000, v17
    v_and_b32 v163, 0xffff0000, v21
    v_and_b32 v164, 0xffff0000, v25
    v_and_b32 v165, 0xffff0000, v29
    v_and_b32 v166, 0xffff0000, v33
    v_and_b32 v167, 0xffff0000, v37
    v_and_b32 v168, 0xffff0000, v41
    v_and_b32 v169, 0xffff0000, v45
    v_and_b32 v170, 0xffff0000, v49
    v_and_b32 v172, 0xffff0000, v53
    v_and_b32 v173, 0xffff0000, v57
    v_and_b32 v174, 0xffff0000, v61
    v_and_b32 v175, 0xffff0000, v65
    v_and_b32 v176, 0xffff0000, v69
    v_and_b32 v177, 0xffff0000, v73
    v_and_b32 v178, 0xffff0000, v77
    v_and_b32 v179, 0xffff0000, v81
    v_mul_f32 v160, s63, v160
    v_fmac_f32 v160, s62, v161
    v_fmac_f32 v160, s61, v162
    v_fmac_f32 v160, s60, v163
    v_mul_f32 v172, v172, v160
    v_mul_f32 v161, s63, v161
    v_fmac_f32 v161, s62, v162
    v_fmac_f32 v161, s61, v163
    v_fmac_f32 v161, s60, v164
    v_mul_f32 v173, v173, v161
    v_mul_f32 v162, s63, v162
    v_fmac_f32 v162, s62, v163
    v_fmac_f32 v162, s61, v164
    v_fmac_f32 v162, s60, v165
    v_mul_f32 v174, v174, v162
    v_mul_f32 v163, s63, v163
    v_fmac_f32 v163, s62, v164
    v_fmac_f32 v163, s61, v165
    v_fmac_f32 v163, s60, v166
    v_mul_f32 v175, v175, v163
    v_mul_f32 v164, s63, v164
    v_fmac_f32 v164, s62, v165
    v_fmac_f32 v164, s61, v166
    v_fmac_f32 v164, s60, v167
    v_mul_f32 v176, v176, v164
    v_mul_f32 v165, s63, v165
    v_fmac_f32 v165, s62, v166
    v_fmac_f32 v165, s61, v167
    v_fmac_f32 v165, s60, v168
    v_mul_f32 v177, v177, v165
    v_mul_f32 v166, s63, v166
    v_fmac_f32 v166, s62, v167
    v_fmac_f32 v166, s61, v168
    v_fmac_f32 v166, s60, v169
    v_mul_f32 v178, v178, v166
    v_mul_f32 v167, s63, v167
    v_fmac_f32 v167, s62, v168
    v_fmac_f32 v167, s61, v169
    v_fmac_f32 v167, s60, v170
    v_mul_f32 v179, v179, v167
    v_cvt_pk_bf16_f32 v96, v179, v178
    v_cvt_pk_bf16_f32 v97, v177, v176
    v_cvt_pk_bf16_f32 v98, v175, v174
    v_cvt_pk_bf16_f32 v99, v173, v172
    ds_write_b128 v117, v[96:99] offset:12288
    v_lshlrev_b32 v160, 16, v10
    v_lshlrev_b32 v161, 16, v14
    v_lshlrev_b32 v162, 16, v18
    v_lshlrev_b32 v163, 16, v22
    v_lshlrev_b32 v164, 16, v26
    v_lshlrev_b32 v165, 16, v30
    v_lshlrev_b32 v166, 16, v34
    v_lshlrev_b32 v167, 16, v38
    v_lshlrev_b32 v168, 16, v42
    v_lshlrev_b32 v169, 16, v46
    v_lshlrev_b32 v170, 16, v50
    v_lshlrev_b32 v172, 16, v54
    v_lshlrev_b32 v173, 16, v58
    v_lshlrev_b32 v174, 16, v62
    v_lshlrev_b32 v175, 16, v66
    v_lshlrev_b32 v176, 16, v70
    v_lshlrev_b32 v177, 16, v74
    v_lshlrev_b32 v178, 16, v78
    v_lshlrev_b32 v179, 16, v82
    v_mul_f32 v160, s67, v160
    v_fmac_f32 v160, s66, v161
    v_fmac_f32 v160, s65, v162
    v_fmac_f32 v160, s64, v163
    v_mul_f32 v172, v172, v160
    v_mul_f32 v161, s67, v161
    v_fmac_f32 v161, s66, v162
    v_fmac_f32 v161, s65, v163
    v_fmac_f32 v161, s64, v164
    v_mul_f32 v173, v173, v161
    v_mul_f32 v162, s67, v162
    v_fmac_f32 v162, s66, v163
    v_fmac_f32 v162, s65, v164
    v_fmac_f32 v162, s64, v165
    v_mul_f32 v174, v174, v162
    v_mul_f32 v163, s67, v163
    v_fmac_f32 v163, s66, v164
    v_fmac_f32 v163, s65, v165
    v_fmac_f32 v163, s64, v166
    v_mul_f32 v175, v175, v163
    v_mul_f32 v164, s67, v164
    v_fmac_f32 v164, s66, v165
    v_fmac_f32 v164, s65, v166
    v_fmac_f32 v164, s64, v167
    v_mul_f32 v176, v176, v164
    v_mul_f32 v165, s67, v165
    v_fmac_f32 v165, s66, v166
    v_fmac_f32 v165, s65, v167
    v_fmac_f32 v165, s64, v168
    v_mul_f32 v177, v177, v165
    v_mul_f32 v166, s67, v166
    v_fmac_f32 v166, s66, v167
    v_fmac_f32 v166, s65, v168
    v_fmac_f32 v166, s64, v169
    v_mul_f32 v178, v178, v166
    v_mul_f32 v167, s67, v167
    v_fmac_f32 v167, s66, v168
    v_fmac_f32 v167, s65, v169
    v_fmac_f32 v167, s64, v170
    v_mul_f32 v179, v179, v167
    v_cvt_pk_bf16_f32 v100, v179, v178
    v_cvt_pk_bf16_f32 v101, v177, v176
    v_cvt_pk_bf16_f32 v102, v175, v174
    v_cvt_pk_bf16_f32 v103, v173, v172
    ds_write_b128 v117, v[100:103] offset:16384
    v_and_b32 v160, 0xffff0000, v10
    v_and_b32 v161, 0xffff0000, v14
    v_and_b32 v162, 0xffff0000, v18
    v_and_b32 v163, 0xffff0000, v22
    v_and_b32 v164, 0xffff0000, v26
    v_and_b32 v165, 0xffff0000, v30
    v_and_b32 v166, 0xffff0000, v34
    v_and_b32 v167, 0xffff0000, v38
    v_and_b32 v168, 0xffff0000, v42
    v_and_b32 v169, 0xffff0000, v46
    v_and_b32 v170, 0xffff0000, v50
    v_and_b32 v172, 0xffff0000, v54
    v_and_b32 v173, 0xffff0000, v58
    v_and_b32 v174, 0xffff0000, v62
    v_and_b32 v175, 0xffff0000, v66
    v_and_b32 v176, 0xffff0000, v70
    v_and_b32 v177, 0xffff0000, v74
    v_and_b32 v178, 0xffff0000, v78
    v_and_b32 v179, 0xffff0000, v82
    v_mul_f32 v160, s71, v160
    v_fmac_f32 v160, s70, v161
    v_fmac_f32 v160, s69, v162
    v_fmac_f32 v160, s68, v163
    v_mul_f32 v172, v172, v160
    v_mul_f32 v161, s71, v161
    v_fmac_f32 v161, s70, v162
    v_fmac_f32 v161, s69, v163
    v_fmac_f32 v161, s68, v164
    v_mul_f32 v173, v173, v161
    v_mul_f32 v162, s71, v162
    v_fmac_f32 v162, s70, v163
    v_fmac_f32 v162, s69, v164
    v_fmac_f32 v162, s68, v165
    v_mul_f32 v174, v174, v162
    v_mul_f32 v163, s71, v163
    v_fmac_f32 v163, s70, v164
    v_fmac_f32 v163, s69, v165
    v_fmac_f32 v163, s68, v166
    v_mul_f32 v175, v175, v163
    v_mul_f32 v164, s71, v164
    v_fmac_f32 v164, s70, v165
    v_fmac_f32 v164, s69, v166
    v_fmac_f32 v164, s68, v167
    v_mul_f32 v176, v176, v164
    v_mul_f32 v165, s71, v165
    v_fmac_f32 v165, s70, v166
    v_fmac_f32 v165, s69, v167
    v_fmac_f32 v165, s68, v168
    v_mul_f32 v177, v177, v165
    v_mul_f32 v166, s71, v166
    v_fmac_f32 v166, s70, v167
    v_fmac_f32 v166, s69, v168
    v_fmac_f32 v166, s68, v169
    v_mul_f32 v178, v178, v166
    v_mul_f32 v167, s71, v167
    v_fmac_f32 v167, s70, v168
    v_fmac_f32 v167, s69, v169
    v_fmac_f32 v167, s68, v170
    v_mul_f32 v179, v179, v167
    v_cvt_pk_bf16_f32 v104, v179, v178
    v_cvt_pk_bf16_f32 v105, v177, v176
    v_cvt_pk_bf16_f32 v106, v175, v174
    v_cvt_pk_bf16_f32 v107, v173, v172
    ds_write_b128 v117, v[104:107] offset:20480
    v_lshlrev_b32 v160, 16, v11
    v_lshlrev_b32 v161, 16, v15
    v_lshlrev_b32 v162, 16, v19
    v_lshlrev_b32 v163, 16, v23
    v_lshlrev_b32 v164, 16, v27
    v_lshlrev_b32 v165, 16, v31
    v_lshlrev_b32 v166, 16, v35
    v_lshlrev_b32 v167, 16, v39
    v_lshlrev_b32 v168, 16, v43
    v_lshlrev_b32 v169, 16, v47
    v_lshlrev_b32 v170, 16, v51
    v_lshlrev_b32 v172, 16, v55
    v_lshlrev_b32 v173, 16, v59
    v_lshlrev_b32 v174, 16, v63
    v_lshlrev_b32 v175, 16, v67
    v_lshlrev_b32 v176, 16, v71
    v_lshlrev_b32 v177, 16, v75
    v_lshlrev_b32 v178, 16, v79
    v_lshlrev_b32 v179, 16, v83
    v_mul_f32 v160, s75, v160
    v_fmac_f32 v160, s74, v161
    v_fmac_f32 v160, s73, v162
    v_fmac_f32 v160, s72, v163
    v_mul_f32 v172, v172, v160
    v_mul_f32 v161, s75, v161
    v_fmac_f32 v161, s74, v162
    v_fmac_f32 v161, s73, v163
    v_fmac_f32 v161, s72, v164
    v_mul_f32 v173, v173, v161
    v_mul_f32 v162, s75, v162
    v_fmac_f32 v162, s74, v163
    v_fmac_f32 v162, s73, v164
    v_fmac_f32 v162, s72, v165
    v_mul_f32 v174, v174, v162
    v_mul_f32 v163, s75, v163
    v_fmac_f32 v163, s74, v164
    v_fmac_f32 v163, s73, v165
    v_fmac_f32 v163, s72, v166
    v_mul_f32 v175, v175, v163
    v_mul_f32 v164, s75, v164
    v_fmac_f32 v164, s74, v165
    v_fmac_f32 v164, s73, v166
    v_fmac_f32 v164, s72, v167
    v_mul_f32 v176, v176, v164
    v_mul_f32 v165, s75, v165
    v_fmac_f32 v165, s74, v166
    v_fmac_f32 v165, s73, v167
    v_fmac_f32 v165, s72, v168
    v_mul_f32 v177, v177, v165
    v_mul_f32 v166, s75, v166
    v_fmac_f32 v166, s74, v167
    v_fmac_f32 v166, s73, v168
    v_fmac_f32 v166, s72, v169
    v_mul_f32 v178, v178, v166
    v_mul_f32 v167, s75, v167
    v_fmac_f32 v167, s74, v168
    v_fmac_f32 v167, s73, v169
    v_fmac_f32 v167, s72, v170
    v_mul_f32 v179, v179, v167
    v_cvt_pk_bf16_f32 v108, v179, v178
    v_cvt_pk_bf16_f32 v109, v177, v176
    v_cvt_pk_bf16_f32 v110, v175, v174
    v_cvt_pk_bf16_f32 v111, v173, v172
    ds_write_b128 v117, v[108:111] offset:24576
    v_and_b32 v160, 0xffff0000, v11
    v_and_b32 v161, 0xffff0000, v15
    v_and_b32 v162, 0xffff0000, v19
    v_and_b32 v163, 0xffff0000, v23
    v_and_b32 v164, 0xffff0000, v27
    v_and_b32 v165, 0xffff0000, v31
    v_and_b32 v166, 0xffff0000, v35
    v_and_b32 v167, 0xffff0000, v39
    v_and_b32 v168, 0xffff0000, v43
    v_and_b32 v169, 0xffff0000, v47
    v_and_b32 v170, 0xffff0000, v51
    v_and_b32 v172, 0xffff0000, v55
    v_and_b32 v173, 0xffff0000, v59
    v_and_b32 v174, 0xffff0000, v63
    v_and_b32 v175, 0xffff0000, v67
    v_and_b32 v176, 0xffff0000, v71
    v_and_b32 v177, 0xffff0000, v75
    v_and_b32 v178, 0xffff0000, v79
    v_and_b32 v179, 0xffff0000, v83
    v_mul_f32 v160, s79, v160
    v_fmac_f32 v160, s78, v161
    v_fmac_f32 v160, s77, v162
    v_fmac_f32 v160, s76, v163
    v_mul_f32 v172, v172, v160
    v_mul_f32 v161, s79, v161
    v_fmac_f32 v161, s78, v162
    v_fmac_f32 v161, s77, v163
    v_fmac_f32 v161, s76, v164
    v_mul_f32 v173, v173, v161
    v_mul_f32 v162, s79, v162
    v_fmac_f32 v162, s78, v163
    v_fmac_f32 v162, s77, v164
    v_fmac_f32 v162, s76, v165
    v_mul_f32 v174, v174, v162
    v_mul_f32 v163, s79, v163
    v_fmac_f32 v163, s78, v164
    v_fmac_f32 v163, s77, v165
    v_fmac_f32 v163, s76, v166
    v_mul_f32 v175, v175, v163
    v_mul_f32 v164, s79, v164
    v_fmac_f32 v164, s78, v165
    v_fmac_f32 v164, s77, v166
    v_fmac_f32 v164, s76, v167
    v_mul_f32 v176, v176, v164
    v_mul_f32 v165, s79, v165
    v_fmac_f32 v165, s78, v166
    v_fmac_f32 v165, s77, v167
    v_fmac_f32 v165, s76, v168
    v_mul_f32 v177, v177, v165
    v_mul_f32 v166, s79, v166
    v_fmac_f32 v166, s78, v167
    v_fmac_f32 v166, s77, v168
    v_fmac_f32 v166, s76, v169
    v_mul_f32 v178, v178, v166
    v_mul_f32 v167, s79, v167
    v_fmac_f32 v167, s78, v168
    v_fmac_f32 v167, s77, v169
    v_fmac_f32 v167, s76, v170
    v_mul_f32 v179, v179, v167
    v_cvt_pk_bf16_f32 v112, v179, v178
    v_cvt_pk_bf16_f32 v113, v177, v176
    v_cvt_pk_bf16_f32 v114, v175, v174
    v_cvt_pk_bf16_f32 v115, v173, v172
    ds_write_b128 v117, v[112:115] offset:28672
    buffer_load_dwordx4 v[52:55], v7, s[28:31], 0 offen offset:0
    buffer_load_dwordx4 v[56:59], v7, s[28:31], 0 offen offset:1024
    buffer_load_dwordx4 v[60:63], v7, s[28:31], 0 offen offset:2048
    buffer_load_dwordx4 v[64:67], v7, s[28:31], 0 offen offset:3072
    buffer_load_dwordx4 v[68:71], v116, s[28:31], 0 offen offset:0
    buffer_load_dwordx4 v[72:75], v116, s[28:31], 0 offen offset:1024
    buffer_load_dwordx4 v[76:79], v116, s[28:31], 0 offen offset:2048
    buffer_load_dwordx4 v[80:83], v116, s[28:31], 0 offen offset:3072
    s_mul_i32 s40, s21, 17152
    s_add_u32 s40, s40, 32768
    v_add_u32 v159, s40, v2
    v_mov_b64 v[180:181], 0
    v_mov_b64 v[182:183], 0
    s_mov_b64 exec, 0xff
    ds_write_b128 v159, v[180:183] offset:0
    ds_write_b128 v159, v[180:183] offset:4288
    ds_write_b128 v159, v[180:183] offset:8576
    ds_write_b128 v159, v[180:183] offset:12864
    s_mov_b64 exec, 1
    s_waitcnt vmcnt(22)
    v_mov_b32 v134, 0
    s_waitcnt vmcnt(14)
    v_mov_b32 v154, 0
    s_mov_b64 exec, -1
    ds_write_b128 v159, v[118:121] offset:128
    v_alignbit_b32 v180, v118, v134, 16
    v_alignbit_b32 v181, v119, v118, 16
    v_alignbit_b32 v182, v120, v119, 16
    v_alignbit_b32 v183, v121, v120, 16
    ds_write_b128 v159, v[180:183] offset:4416
    ds_write_b128 v159, v[122:125] offset:1152
    s_nop 0
    v_alignbit_b32 v180, v122, v135, 16
    v_alignbit_b32 v181, v123, v122, 16
    v_alignbit_b32 v182, v124, v123, 16
    v_alignbit_b32 v183, v125, v124, 16
    ds_write_b128 v159, v[180:183] offset:5440
    ds_write_b128 v159, v[126:129] offset:2176
    s_nop 0
    v_alignbit_b32 v180, v126, v136, 16
    v_alignbit_b32 v181, v127, v126, 16
    v_alignbit_b32 v182, v128, v127, 16
    v_alignbit_b32 v183, v129, v128, 16
    ds_write_b128 v159, v[180:183] offset:6464
    ds_write_b128 v159, v[130:133] offset:3200
    s_nop 0
    v_alignbit_b32 v180, v130, v137, 16
    v_alignbit_b32 v181, v131, v130, 16
    v_alignbit_b32 v182, v132, v131, 16
    v_alignbit_b32 v183, v133, v132, 16
    ds_write_b128 v159, v[180:183] offset:7488
    ds_write_b128 v159, v[138:141] offset:8704
    s_nop 0
    v_alignbit_b32 v180, v138, v154, 16
    v_alignbit_b32 v181, v139, v138, 16
    v_alignbit_b32 v182, v140, v139, 16
    v_alignbit_b32 v183, v141, v140, 16
    ds_write_b128 v159, v[180:183] offset:12992
    s_waitcnt vmcnt(13)
    ds_write_b128 v159, v[142:145] offset:9728
    s_waitcnt vmcnt(12)
    v_alignbit_b32 v180, v142, v155, 16
    v_alignbit_b32 v181, v143, v142, 16
    v_alignbit_b32 v182, v144, v143, 16
    v_alignbit_b32 v183, v145, v144, 16
    ds_write_b128 v159, v[180:183] offset:14016
    s_waitcnt vmcnt(11)
    ds_write_b128 v159, v[146:149] offset:10752
    s_waitcnt vmcnt(10)
    v_alignbit_b32 v180, v146, v156, 16
    v_alignbit_b32 v181, v147, v146, 16
    v_alignbit_b32 v182, v148, v147, 16
    v_alignbit_b32 v183, v149, v148, 16
    ds_write_b128 v159, v[180:183] offset:15040
    s_waitcnt vmcnt(9)
    ds_write_b128 v159, v[150:153] offset:11776
    s_waitcnt vmcnt(8)
    v_alignbit_b32 v180, v150, v157, 16
    v_alignbit_b32 v181, v151, v150, 16
    v_alignbit_b32 v182, v152, v151, 16
    v_alignbit_b32 v183, v153, v152, 16
    ds_write_b128 v159, v[180:183] offset:16064
    v_and_b32 v5, 31, v0
    v_bfe_u32 v6, v0, 5, 1
    v_lshlrev_b32 v9, 7, v5
    v_lshl_add_u32 v10, v6, 3, v9
    v_lshl_add_u32 v9, v6, 4, v9
    s_lshl_b32 s41, s21, 13
    v_add_u32 v9, s41, v9
    v_add_u32 v10, s41, v10
    v_cmp_eq_u32 vcc, 0, v5
    s_nop 1
    v_cndmask_b32 v11, -1, 0, vcc
    v_lshlrev_b32 v6, 3, v6
    v_sub_u32 v6, v5, v6
    v_add_u32 v6, 10, v6
    v_lshrrev_b32 v6, 1, v6
    v_lshlrev_b32 v8, 2, v6
    v_add_u32 v8, s40, v8
    v_and_b32 v5, 1, v5
    v_sub_u32 v5, 1, v5
    v_mul_u32_u24 v5, 4288, v5
    v_add_u32 v8, v8, v5
    s_mov_b32 s41, 0
    s_waitcnt lgkmcnt(0)
    s_barrier
L_ssm_ch:
    v_mov_b32 v44, v8
    ds_read_b128 v[12:15], v9 offset:0
    ds_read_b128 v[16:19], v9 offset:32
    ds_read_b128 v[20:23], v9 offset:64
    ds_read_b128 v[24:27], v9 offset:96
    ds_read2_b32 v[184:185], v44 offset0:0 offset1:1
    ds_read2_b32 v[186:187], v44 offset0:2 offset1:3
    ds_read2_b32 v[188:189], v44 offset0:8 offset1:9
    ds_read2_b32 v[190:191], v44 offset0:10 offset1:11
    ds_read2_b32 v[192:193], v44 offset0:16 offset1:17
    ds_read2_b32 v[194:195], v44 offset0:18 offset1:19
    ds_read2_b32 v[196:197], v44 offset0:24 offset1:25
    ds_read2_b32 v[198:199], v44 offset0:26 offset1:27
    ds_read2_b32 v[200:201], v44 offset0:32 offset1:33
    ds_read2_b32 v[202:203], v44 offset0:34 offset1:35
    ds_read2_b32 v[204:205], v44 offset0:40 offset1:41
    ds_read2_b32 v[206:207], v44 offset0:42 offset1:43
    s_waitcnt lgkmcnt(10)
    v_mfma_f32_32x32x16_bf16 v[118:133], v[184:187], v[24:27], 0
    ds_read2_b32 v[208:209], v44 offset0:48 offset1:49
    ds_read2_b32 v[210:211], v44 offset0:50 offset1:51
    v_and_b32_dpp v40, v24, v11 wave_shr:1 row_mask:0xf bank_mask:0xf bound_ctrl:0
    v_and_b32_dpp v41, v25, v11 wave_shr:1 row_mask:0xf bank_mask:0xf bound_ctrl:0
    s_waitcnt lgkmcnt(8)
    v_mfma_f32_32x32x16_bf16 v[134:149], v[192:195], v[24:27], 0
    v_and_b32_dpp v42, v26, v11 wave_shr:1 row_mask:0xf bank_mask:0xf bound_ctrl:0
    v_and_b32_dpp v43, v27, v11 wave_shr:1 row_mask:0xf bank_mask:0xf bound_ctrl:0
    v_mfma_f32_32x32x16_bf16 v[118:133], v[188:191], v[20:23], v[118:133]
    ds_read2_b32 v[212:213], v44 offset0:56 offset1:57
    ds_read2_b32 v[214:215], v44 offset0:58 offset1:59
    v_and_b32_dpp v36, v20, v11 wave_shr:1 row_mask:0xf bank_mask:0xf bound_ctrl:0
    v_and_b32_dpp v37, v21, v11 wave_shr:1 row_mask:0xf bank_mask:0xf bound_ctrl:0
    s_waitcnt lgkmcnt(8)
    v_mfma_f32_32x32x16_bf16 v[134:149], v[196:199], v[20:23], v[134:149]
    v_and_b32_dpp v38, v22, v11 wave_shr:1 row_mask:0xf bank_mask:0xf bound_ctrl:0
    v_and_b32_dpp v39, v23, v11 wave_shr:1 row_mask:0xf bank_mask:0xf bound_ctrl:0
    v_mfma_f32_32x32x16_bf16 v[118:133], v[192:195], v[16:19], v[118:133]
    ds_read2_b32 v[216:217], v44 offset0:64 offset1:65
    ds_read2_b32 v[218:219], v44 offset0:66 offset1:67
    v_and_b32_dpp v32, v16, v11 wave_shr:1 row_mask:0xf bank_mask:0xf bound_ctrl:0
    v_and_b32_dpp v33, v17, v11 wave_shr:1 row_mask:0xf bank_mask:0xf bound_ctrl:0
    s_waitcnt lgkmcnt(8)
    v_mfma_f32_32x32x16_bf16 v[134:149], v[200:203], v[16:19], v[134:149]
    v_and_b32_dpp v34, v18, v11 wave_shr:1 row_mask:0xf bank_mask:0xf bound_ctrl:0
    v_and_b32_dpp v35, v19, v11 wave_shr:1 row_mask:0xf bank_mask:0xf bound_ctrl:0
    v_mfma_f32_32x32x16_bf16 v[118:133], v[196:199], v[12:15], v[118:133]
    ds_read2_b32 v[220:221], v44 offset0:72 offset1:73
    ds_read2_b32 v[222:223], v44 offset0:74 offset1:75
    v_and_b32_dpp v28, v12, v11 wave_shr:1 row_mask:0xf bank_mask:0xf bound_ctrl:0
    v_and_b32_dpp v29, v13, v11 wave_shr:1 row_mask:0xf bank_mask:0xf bound_ctrl:0
    s_waitcnt lgkmcnt(8)
    v_mfma_f32_32x32x16_bf16 v[134:149], v[204:207], v[12:15], v[134:149]
    v_and_b32_dpp v30, v14, v11 wave_shr:1 row_mask:0xf bank_mask:0xf bound_ctrl:0
    v_and_b32_dpp v31, v15, v11 wave_shr:1 row_mask:0xf bank_mask:0xf bound_ctrl:0
    v_mfma_f32_32x32x16_bf16 v[118:133], v[200:203], v[40:43], v[118:133]
    ds_read2_b32 v[224:225], v44 offset0:80 offset1:81
    ds_read2_b32 v[226:227], v44 offset0:82 offset1:83
    v_and_b32_dpp v24, v40, v11 wave_shr:1 row_mask:0xf bank_mask:0xf bound_ctrl:0
    v_and_b32_dpp v25, v41, v11 wave_shr:1 row_mask:0xf bank_mask:0xf bound_ctrl:0
    s_waitcnt lgkmcnt(8)
    v_mfma_f32_32x32x16_bf16 v[134:149], v[208:211], v[40:43], v[134:149]
    v_and_b32_dpp v26, v42, v11 wave_shr:1 row_mask:0xf bank_mask:0xf bound_ctrl:0
    v_and_b32_dpp v27, v43, v11 wave_shr:1 row_mask:0xf bank_mask:0xf bound_ctrl:0
    v_mfma_f32_32x32x16_bf16 v[118:133], v[204:207], v[36:39], v[118:133]
    ds_read2_b32 v[228:229], v44 offset0:88 offset1:89
    ds_read2_b32 v[230:231], v44 offset0:90 offset1:91
    v_and_b32_dpp v20, v36, v11 wave_shr:1 row_mask:0xf bank_mask:0xf bound_ctrl:0
    v_and_b32_dpp v21, v37, v11 wave_shr:1 row_mask:0xf bank_mask:0xf bound_ctrl:0
    s_waitcnt lgkmcnt(8)
    v_mfma_f32_32x32x16_bf16 v[134:149], v[212:215], v[36:39], v[134:149]
    v_and_b32_dpp v22, v38, v11 wave_shr:1 row_mask:0xf bank_mask:0xf bound_ctrl:0
    v_and_b32_dpp v23, v39, v11 wave_shr:1 row_mask:0xf bank_mask:0xf bound_ctrl:0
    v_mfma_f32_32x32x16_bf16 v[118:133], v[208:211], v[32:35], v[118:133]
    ds_read2_b32 v[184:185], v44 offset0:96 offset1:97
    ds_read2_b32 v[186:187], v44 offset0:98 offset1:99
    v_and_b32_dpp v16, v32, v11 wave_shr:1 row_mask:0xf bank_mask:0xf bound_ctrl:0
    v_and_b32_dpp v17, v33, v11 wave_shr:1 row_mask:0xf bank_mask:0xf bound_ctrl:0
    s_waitcnt lgkmcnt(8)
    v_mfma_f32_32x32x16_bf16 v[134:149], v[216:219], v[32:35], v[134:149]
    v_and_b32_dpp v18, v34, v11 wave_shr:1 row_mask:0xf bank_mask:0xf bound_ctrl:0
    v_and_b32_dpp v19, v35, v11 wave_shr:1 row_mask:0xf bank_mask:0xf bound_ctrl:0
    v_mfma_f32_32x32x16_bf16 v[118:133], v[212:215], v[28:31], v[118:133]
    ds_read2_b32 v[188:189], v44 offset0:104 offset1:105
    ds_read2_b32 v[190:191], v44 offset0:106 offset1:107
    v_and_b32_dpp v12, v28, v11 wave_shr:1 row_mask:0xf bank_mask:0xf bound_ctrl:0
    v_and_b32_dpp v13, v29, v11 wave_shr:1 row_mask:0xf bank_mask:0xf bound_ctrl:0
    s_waitcnt lgkmcnt(8)
    v_mfma_f32_32x32x16_bf16 v[134:149], v[220:223], v[28:31], v[134:149]
    v_and_b32_dpp v14, v30, v11 wave_shr:1 row_mask:0xf bank_mask:0xf bound_ctrl:0
    v_and_b32_dpp v15, v31, v11 wave_shr:1 row_mask:0xf bank_mask:0xf bound_ctrl:0
    v_mfma_f32_32x32x16_bf16 v[118:133], v[216:219], v[24:27], v[118:133]
    ds_read2_b32 v[192:193], v44 offset0:112 offset1:113
    ds_read2_b32 v[194:195], v44 offset0:114 offset1:115
    v_and_b32_dpp v40, v24, v11 wave_shr:1 row_mask:0xf bank_mask:0xf bound_ctrl:0
    v_and_b32_dpp v41, v25, v11 wave_shr:1 row_mask:0xf bank_mask:0xf bound_ctrl:0
    s_waitcnt lgkmcnt(8)
    v_mfma_f32_32x32x16_bf16 v[134:149], v[224:227], v[24:27], v[134:149]
    v_and_b32_dpp v42, v26, v11 wave_shr:1 row_mask:0xf bank_mask:0xf bound_ctrl:0
    v_and_b32_dpp v43, v27, v11 wave_shr:1 row_mask:0xf bank_mask:0xf bound_ctrl:0
    v_mfma_f32_32x32x16_bf16 v[118:133], v[220:223], v[20:23], v[118:133]
    ds_read2_b32 v[196:197], v44 offset0:120 offset1:121
    ds_read2_b32 v[198:199], v44 offset0:122 offset1:123
    v_and_b32_dpp v36, v20, v11 wave_shr:1 row_mask:0xf bank_mask:0xf bound_ctrl:0
    v_and_b32_dpp v37, v21, v11 wave_shr:1 row_mask:0xf bank_mask:0xf bound_ctrl:0
    s_waitcnt lgkmcnt(8)
    v_mfma_f32_32x32x16_bf16 v[134:149], v[228:231], v[20:23], v[134:149]
    v_and_b32_dpp v38, v22, v11 wave_shr:1 row_mask:0xf bank_mask:0xf bound_ctrl:0
    v_and_b32_dpp v39, v23, v11 wave_shr:1 row_mask:0xf bank_mask:0xf bound_ctrl:0
    v_mfma_f32_32x32x16_bf16 v[118:133], v[224:227], v[16:19], v[118:133]
    ds_read2_b32 v[200:201], v44 offset0:128 offset1:129
    ds_read2_b32 v[202:203], v44 offset0:130 offset1:131
    v_and_b32_dpp v32, v16, v11 wave_shr:1 row_mask:0xf bank_mask:0xf bound_ctrl:0
    v_and_b32_dpp v33, v17, v11 wave_shr:1 row_mask:0xf bank_mask:0xf bound_ctrl:0
    s_waitcnt lgkmcnt(8)
    v_mfma_f32_32x32x16_bf16 v[134:149], v[184:187], v[16:19], v[134:149]
    v_and_b32_dpp v34, v18, v11 wave_shr:1 row_mask:0xf bank_mask:0xf bound_ctrl:0
    v_and_b32_dpp v35, v19, v11 wave_shr:1 row_mask:0xf bank_mask:0xf bound_ctrl:0
    v_mfma_f32_32x32x16_bf16 v[118:133], v[228:231], v[12:15], v[118:133]
    ds_read2_b32 v[204:205], v44 offset0:136 offset1:137
    ds_read2_b32 v[206:207], v44 offset0:138 offset1:139
    v_and_b32_dpp v28, v12, v11 wave_shr:1 row_mask:0xf bank_mask:0xf bound_ctrl:0
    v_and_b32_dpp v29, v13, v11 wave_shr:1 row_mask:0xf bank_mask:0xf bound_ctrl:0
    s_waitcnt lgkmcnt(8)
    v_mfma_f32_32x32x16_bf16 v[134:149], v[188:191], v[12:15], v[134:149]
    v_and_b32_dpp v30, v14, v11 wave_shr:1 row_mask:0xf bank_mask:0xf bound_ctrl:0
    v_and_b32_dpp v31, v15, v11 wave_shr:1 row_mask:0xf bank_mask:0xf bound_ctrl:0
    v_mfma_f32_32x32x16_bf16 v[118:133], v[184:187], v[40:43], v[118:133]
    ds_read2_b32 v[208:209], v44 offset0:144 offset1:145
    ds_read2_b32 v[210:211], v44 offset0:146 offset1:147
    v_and_b32_dpp v24, v40, v11 wave_shr:1 row_mask:0xf bank_mask:0xf bound_ctrl:0
    v_and_b32_dpp v25, v41, v11 wave_shr:1 row_mask:0xf bank_mask:0xf bound_ctrl:0
    s_waitcnt lgkmcnt(8)
    v_mfma_f32_32x32x16_bf16 v[134:149], v[192:195], v[40:43], v[134:149]
    v_and_b32_dpp v26, v42, v11 wave_shr:1 row_mask:0xf bank_mask:0xf bound_ctrl:0
    v_and_b32_dpp v27, v43, v11 wave_shr:1 row_mask:0xf bank_mask:0xf bound_ctrl:0
    v_mfma_f32_32x32x16_bf16 v[118:133], v[188:191], v[36:39], v[118:133]
    ds_read2_b32 v[212:213], v44 offset0:152 offset1:153
    ds_read2_b32 v[214:215], v44 offset0:154 offset1:155
    v_and_b32_dpp v20, v36, v11 wave_shr:1 row_mask:0xf bank_mask:0xf bound_ctrl:0
    v_and_b32_dpp v21, v37, v11 wave_shr:1 row_mask:0xf bank_mask:0xf bound_ctrl:0
    s_waitcnt lgkmcnt(8)
    v_mfma_f32_32x32x16_bf16 v[134:149], v[196:199], v[36:39], v[134:149]
    v_and_b32_dpp v22, v38, v11 wave_shr:1 row_mask:0xf bank_mask:0xf bound_ctrl:0
    v_and_b32_dpp v23, v39, v11 wave_shr:1 row_mask:0xf bank_mask:0xf bound_ctrl:0
    v_mfma_f32_32x32x16_bf16 v[118:133], v[192:195], v[32:35], v[118:133]
    ds_read2_b32 v[216:217], v44 offset0:160 offset1:161
    ds_read2_b32 v[218:219], v44 offset0:162 offset1:163
    v_and_b32_dpp v16, v32, v11 wave_shr:1 row_mask:0xf bank_mask:0xf bound_ctrl:0
    v_and_b32_dpp v17, v33, v11 wave_shr:1 row_mask:0xf bank_mask:0xf bound_ctrl:0
    s_waitcnt lgkmcnt(8)
    v_mfma_f32_32x32x16_bf16 v[134:149], v[200:203], v[32:35], v[134:149]
    v_and_b32_dpp v18, v34, v11 wave_shr:1 row_mask:0xf bank_mask:0xf bound_ctrl:0
    v_and_b32_dpp v19, v35, v11 wave_shr:1 row_mask:0xf bank_mask:0xf bound_ctrl:0
    v_mfma_f32_32x32x16_bf16 v[118:133], v[196:199], v[28:31], v[118:133]
    ds_read2_b32 v[220:221], v44 offset0:168 offset1:169
    ds_read2_b32 v[222:223], v44 offset0:170 offset1:171
    v_and_b32_dpp v12, v28, v11 wave_shr:1 row_mask:0xf bank_mask:0xf bound_ctrl:0
    v_and_b32_dpp v13, v29, v11 wave_shr:1 row_mask:0xf bank_mask:0xf bound_ctrl:0
    s_waitcnt lgkmcnt(8)
    v_mfma_f32_32x32x16_bf16 v[134:149], v[204:207], v[28:31], v[134:149]
    v_and_b32_dpp v14, v30, v11 wave_shr:1 row_mask:0xf bank_mask:0xf bound_ctrl:0
    v_and_b32_dpp v15, v31, v11 wave_shr:1 row_mask:0xf bank_mask:0xf bound_ctrl:0
    v_mfma_f32_32x32x16_bf16 v[118:133], v[200:203], v[24:27], v[118:133]
    ds_read2_b32 v[224:225], v44 offset0:176 offset1:177
    ds_read2_b32 v[226:227], v44 offset0:178 offset1:179
    v_and_b32_dpp v40, v24, v11 wave_shr:1 row_mask:0xf bank_mask:0xf bound_ctrl:0
    v_and_b32_dpp v41, v25, v11 wave_shr:1 row_mask:0xf bank_mask:0xf bound_ctrl:0
    s_waitcnt lgkmcnt(8)
    v_mfma_f32_32x32x16_bf16 v[134:149], v[208:211], v[24:27], v[134:149]
    v_and_b32_dpp v42, v26, v11 wave_shr:1 row_mask:0xf bank_mask:0xf bound_ctrl:0
    v_and_b32_dpp v43, v27, v11 wave_shr:1 row_mask:0xf bank_mask:0xf bound_ctrl:0
    v_mfma_f32_32x32x16_bf16 v[118:133], v[204:207], v[20:23], v[118:133]
    ds_read2_b32 v[228:229], v44 offset0:184 offset1:185
    ds_read2_b32 v[230:231], v44 offset0:186 offset1:187
    v_and_b32_dpp v36, v20, v11 wave_shr:1 row_mask:0xf bank_mask:0xf bound_ctrl:0
    v_and_b32_dpp v37, v21, v11 wave_shr:1 row_mask:0xf bank_mask:0xf bound_ctrl:0
    s_waitcnt lgkmcnt(8)
    v_mfma_f32_32x32x16_bf16 v[134:149], v[212:215], v[20:23], v[134:149]
    v_and_b32_dpp v38, v22, v11 wave_shr:1 row_mask:0xf bank_mask:0xf bound_ctrl:0
    v_and_b32_dpp v39, v23, v11 wave_shr:1 row_mask:0xf bank_mask:0xf bound_ctrl:0
    v_mfma_f32_32x32x16_bf16 v[118:133], v[208:211], v[16:19], v[118:133]
    ds_read2_b32 v[184:185], v44 offset0:192 offset1:193
    ds_read2_b32 v[186:187], v44 offset0:194 offset1:195
    v_and_b32_dpp v32, v16, v11 wave_shr:1 row_mask:0xf bank_mask:0xf bound_ctrl:0
    v_and_b32_dpp v33, v17, v11 wave_shr:1 row_mask:0xf bank_mask:0xf bound_ctrl:0
    s_waitcnt lgkmcnt(8)
    v_mfma_f32_32x32x16_bf16 v[134:149], v[216:219], v[16:19], v[134:149]
    v_and_b32_dpp v34, v18, v11 wave_shr:1 row_mask:0xf bank_mask:0xf bound_ctrl:0
    v_and_b32_dpp v35, v19, v11 wave_shr:1 row_mask:0xf bank_mask:0xf bound_ctrl:0
    v_mfma_f32_32x32x16_bf16 v[118:133], v[212:215], v[12:15], v[118:133]
    ds_read2_b32 v[188:189], v44 offset0:200 offset1:201
    ds_read2_b32 v[190:191], v44 offset0:202 offset1:203
    v_and_b32_dpp v28, v12, v11 wave_shr:1 row_mask:0xf bank_mask:0xf bound_ctrl:0
    v_and_b32_dpp v29, v13, v11 wave_shr:1 row_mask:0xf bank_mask:0xf bound_ctrl:0
    s_waitcnt lgkmcnt(8)
    v_mfma_f32_32x32x16_bf16 v[134:149], v[220:223], v[12:15], v[134:149]
    v_and_b32_dpp v30, v14, v11 wave_shr:1 row_mask:0xf bank_mask:0xf bound_ctrl:0
    v_and_b32_dpp v31, v15, v11 wave_shr:1 row_mask:0xf bank_mask:0xf bound_ctrl:0
    v_mfma_f32_32x32x16_bf16 v[118:133], v[216:219], v[40:43], v[118:133]
    ds_read2_b32 v[192:193], v44 offset0:208 offset1:209
    ds_read2_b32 v[194:195], v44 offset0:210 offset1:211
    v_and_b32_dpp v24, v40, v11 wave_shr:1 row_mask:0xf bank_mask:0xf bound_ctrl:0
    v_and_b32_dpp v25, v41, v11 wave_shr:1 row_mask:0xf bank_mask:0xf bound_ctrl:0
    s_waitcnt lgkmcnt(8)
    v_mfma_f32_32x32x16_bf16 v[134:149], v[224:227], v[40:43], v[134:149]
    v_and_b32_dpp v26, v42, v11 wave_shr:1 row_mask:0xf bank_mask:0xf bound_ctrl:0
    v_and_b32_dpp v27, v43, v11 wave_shr:1 row_mask:0xf bank_mask:0xf bound_ctrl:0
    v_mfma_f32_32x32x16_bf16 v[118:133], v[220:223], v[36:39], v[118:133]
    ds_read2_b32 v[196:197], v44 offset0:216 offset1:217
    ds_read2_b32 v[198:199], v44 offset0:218 offset1:219
    v_and_b32_dpp v20, v36, v11 wave_shr:1 row_mask:0xf bank_mask:0xf bound_ctrl:0
    v_and_b32_dpp v21, v37, v11 wave_shr:1 row_mask:0xf bank_mask:0xf bound_ctrl:0
    s_waitcnt lgkmcnt(8)
    v_mfma_f32_32x32x16_bf16 v[134:149], v[228:231], v[36:39], v[134:149]
    v_and_b32_dpp v22, v38, v11 wave_shr:1 row_mask:0xf bank_mask:0xf bound_ctrl:0
    v_and_b32_dpp v23, v39, v11 wave_shr:1 row_mask:0xf bank_mask:0xf bound_ctrl:0
    v_mfma_f32_32x32x16_bf16 v[118:133], v[224:227], v[32:35], v[118:133]
    ds_read2_b32 v[200:201], v44 offset0:224 offset1:225
    ds_read2_b32 v[202:203], v44 offset0:226 offset1:227
    v_and_b32_dpp v16, v32, v11 wave_shr:1 row_mask:0xf bank_mask:0xf bound_ctrl:0
    v_and_b32_dpp v17, v33, v11 wave_shr:1 row_mask:0xf bank_mask:0xf bound_ctrl:0
    s_waitcnt lgkmcnt(8)
    v_mfma_f32_32x32x16_bf16 v[134:149], v[184:187], v[32:35], v[134:149]
    v_and_b32_dpp v18, v34, v11 wave_shr:1 row_mask:0xf bank_mask:0xf bound_ctrl:0
    v_and_b32_dpp v19, v35, v11 wave_shr:1 row_mask:0xf bank_mask:0xf bound_ctrl:0
    v_mfma_f32_32x32x16_bf16 v[118:133], v[228:231], v[28:31], v[118:133]
    ds_read2_b32 v[204:205], v44 offset0:232 offset1:233
    ds_read2_b32 v[206:207], v44 offset0:234 offset1:235
    v_and_b32_dpp v12, v28, v11 wave_shr:1 row_mask:0xf bank_mask:0xf bound_ctrl:0
    v_and_b32_dpp v13, v29, v11 wave_shr:1 row_mask:0xf bank_mask:0xf bound_ctrl:0
    s_waitcnt lgkmcnt(8)
    v_mfma_f32_32x32x16_bf16 v[134:149], v[188:191], v[28:31], v[134:149]
    v_and_b32_dpp v14, v30, v11 wave_shr:1 row_mask:0xf bank_mask:0xf bound_ctrl:0
    v_and_b32_dpp v15, v31, v11 wave_shr:1 row_mask:0xf bank_mask:0xf bound_ctrl:0
    v_mfma_f32_32x32x16_bf16 v[118:133], v[184:187], v[24:27], v[118:133]
    ds_read2_b32 v[208:209], v44 offset0:240 offset1:241
    ds_read2_b32 v[210:211], v44 offset0:242 offset1:243
    v_and_b32_dpp v40, v24, v11 wave_shr:1 row_mask:0xf bank_mask:0xf bound_ctrl:0
    v_and_b32_dpp v41, v25, v11 wave_shr:1 row_mask:0xf bank_mask:0xf bound_ctrl:0
    s_waitcnt lgkmcnt(8)
    v_mfma_f32_32x32x16_bf16 v[134:149], v[192:195], v[24:27], v[134:149]
    v_and_b32_dpp v42, v26, v11 wave_shr:1 row_mask:0xf bank_mask:0xf bound_ctrl:0
    v_and_b32_dpp v43, v27, v11 wave_shr:1 row_mask:0xf bank_mask:0xf bound_ctrl:0
    v_mfma_f32_32x32x16_bf16 v[118:133], v[188:191], v[20:23], v[118:133]
    ds_read2_b32 v[212:213], v44 offset0:248 offset1:249
    ds_read2_b32 v[214:215], v44 offset0:250 offset1:251
    v_and_b32_dpp v36, v20, v11 wave_shr:1 row_mask:0xf bank_mask:0xf bound_ctrl:0
    v_and_b32_dpp v37, v21, v11 wave_shr:1 row_mask:0xf bank_mask:0xf bound_ctrl:0
    s_waitcnt lgkmcnt(8)
    v_mfma_f32_32x32x16_bf16 v[134:149], v[196:199], v[20:23], v[134:149]
    v_and_b32_dpp v38, v22, v11 wave_shr:1 row_mask:0xf bank_mask:0xf bound_ctrl:0
    v_and_b32_dpp v39, v23, v11 wave_shr:1 row_mask:0xf bank_mask:0xf bound_ctrl:0
    v_mfma_f32_32x32x16_bf16 v[118:133], v[192:195], v[16:19], v[118:133]
    v_add_u32 v44, 1024, v44
    ds_read2_b32 v[216:217], v44 offset0:0 offset1:1
    ds_read2_b32 v[218:219], v44 offset0:2 offset1:3
    v_and_b32_dpp v32, v16, v11 wave_shr:1 row_mask:0xf bank_mask:0xf bound_ctrl:0
    v_and_b32_dpp v33, v17, v11 wave_shr:1 row_mask:0xf bank_mask:0xf bound_ctrl:0
    s_waitcnt lgkmcnt(8)
    v_mfma_f32_32x32x16_bf16 v[134:149], v[200:203], v[16:19], v[134:149]
    v_and_b32_dpp v34, v18, v11 wave_shr:1 row_mask:0xf bank_mask:0xf bound_ctrl:0
    v_and_b32_dpp v35, v19, v11 wave_shr:1 row_mask:0xf bank_mask:0xf bound_ctrl:0
    v_mfma_f32_32x32x16_bf16 v[118:133], v[196:199], v[12:15], v[118:133]
    ds_read2_b32 v[220:221], v44 offset0:8 offset1:9
    ds_read2_b32 v[222:223], v44 offset0:10 offset1:11
    v_and_b32_dpp v28, v12, v11 wave_shr:1 row_mask:0xf bank_mask:0xf bound_ctrl:0
    v_and_b32_dpp v29, v13, v11 wave_shr:1 row_mask:0xf bank_mask:0xf bound_ctrl:0
    s_waitcnt lgkmcnt(8)
    v_mfma_f32_32x32x16_bf16 v[134:149], v[204:207], v[12:15], v[134:149]
    v_and_b32_dpp v30, v14, v11 wave_shr:1 row_mask:0xf bank_mask:0xf bound_ctrl:0
    v_and_b32_dpp v31, v15, v11 wave_shr:1 row_mask:0xf bank_mask:0xf bound_ctrl:0
    v_mfma_f32_32x32x16_bf16 v[118:133], v[200:203], v[40:43], v[118:133]
    ds_read2_b32 v[224:225], v44 offset0:16 offset1:17
    ds_read2_b32 v[226:227], v44 offset0:18 offset1:19
    v_and_b32_dpp v24, v40, v11 wave_shr:1 row_mask:0xf bank_mask:0xf bound_ctrl:0
    v_and_b32_dpp v25, v41, v11 wave_shr:1 row_mask:0xf bank_mask:0xf bound_ctrl:0
    s_waitcnt lgkmcnt(8)
    v_mfma_f32_32x32x16_bf16 v[134:149], v[208:211], v[40:43], v[134:149]
    v_and_b32_dpp v26, v42, v11 wave_shr:1 row_mask:0xf bank_mask:0xf bound_ctrl:0
    v_and_b32_dpp v27, v43, v11 wave_shr:1 row_mask:0xf bank_mask:0xf bound_ctrl:0
    v_mfma_f32_32x32x16_bf16 v[118:133], v[204:207], v[36:39], v[118:133]
    ds_read2_b32 v[228:229], v44 offset0:24 offset1:25
    ds_read2_b32 v[230:231], v44 offset0:26 offset1:27
    v_and_b32_dpp v20, v36, v11 wave_shr:1 row_mask:0xf bank_mask:0xf bound_ctrl:0
    v_and_b32_dpp v21, v37, v11 wave_shr:1 row_mask:0xf bank_mask:0xf bound_ctrl:0
    s_waitcnt lgkmcnt(8)
    v_mfma_f32_32x32x16_bf16 v[134:149], v[212:215], v[36:39], v[134:149]
    v_and_b32_dpp v22, v38, v11 wave_shr:1 row_mask:0xf bank_mask:0xf bound_ctrl:0
    v_and_b32_dpp v23, v39, v11 wave_shr:1 row_mask:0xf bank_mask:0xf bound_ctrl:0
    v_mfma_f32_32x32x16_bf16 v[118:133], v[208:211], v[32:35], v[118:133]
    ds_read2_b32 v[184:185], v44 offset0:32 offset1:33
    ds_read2_b32 v[186:187], v44 offset0:34 offset1:35
    v_and_b32_dpp v16, v32, v11 wave_shr:1 row_mask:0xf bank_mask:0xf bound_ctrl:0
    v_and_b32_dpp v17, v33, v11 wave_shr:1 row_mask:0xf bank_mask:0xf bound_ctrl:0
    s_waitcnt lgkmcnt(8)
    v_mfma_f32_32x32x16_bf16 v[134:149], v[216:219], v[32:35], v[134:149]
    v_and_b32_dpp v18, v34, v11 wave_shr:1 row_mask:0xf bank_mask:0xf bound_ctrl:0
    v_and_b32_dpp v19, v35, v11 wave_shr:1 row_mask:0xf bank_mask:0xf bound_ctrl:0
    v_mfma_f32_32x32x16_bf16 v[118:133], v[212:215], v[28:31], v[118:133]
    ds_read2_b32 v[188:189], v44 offset0:40 offset1:41
    ds_read2_b32 v[190:191], v44 offset0:42 offset1:43
    v_and_b32_dpp v12, v28, v11 wave_shr:1 row_mask:0xf bank_mask:0xf bound_ctrl:0
    v_and_b32_dpp v13, v29, v11 wave_shr:1 row_mask:0xf bank_mask:0xf bound_ctrl:0
    s_waitcnt lgkmcnt(8)
    v_mfma_f32_32x32x16_bf16 v[134:149], v[220:223], v[28:31], v[134:149]
    v_and_b32_dpp v14, v30, v11 wave_shr:1 row_mask:0xf bank_mask:0xf bound_ctrl:0
    v_and_b32_dpp v15, v31, v11 wave_shr:1 row_mask:0xf bank_mask:0xf bound_ctrl:0
    v_mfma_f32_32x32x16_bf16 v[118:133], v[216:219], v[24:27], v[118:133]
    ds_read2_b32 v[192:193], v44 offset0:48 offset1:49
    ds_read2_b32 v[194:195], v44 offset0:50 offset1:51
    v_and_b32_dpp v40, v24, v11 wave_shr:1 row_mask:0xf bank_mask:0xf bound_ctrl:0
    v_and_b32_dpp v41, v25, v11 wave_shr:1 row_mask:0xf bank_mask:0xf bound_ctrl:0
    s_waitcnt lgkmcnt(8)
    v_mfma_f32_32x32x16_bf16 v[134:149], v[224:227], v[24:27], v[134:149]
    v_and_b32_dpp v42, v26, v11 wave_shr:1 row_mask:0xf bank_mask:0xf bound_ctrl:0
    v_and_b32_dpp v43, v27, v11 wave_shr:1 row_mask:0xf bank_mask:0xf bound_ctrl:0
    v_mfma_f32_32x32x16_bf16 v[118:133], v[220:223], v[20:23], v[118:133]
    ds_read2_b32 v[196:197], v44 offset0:56 offset1:57
    ds_read2_b32 v[198:199], v44 offset0:58 offset1:59
    v_and_b32_dpp v36, v20, v11 wave_shr:1 row_mask:0xf bank_mask:0xf bound_ctrl:0
    v_and_b32_dpp v37, v21, v11 wave_shr:1 row_mask:0xf bank_mask:0xf bound_ctrl:0
    s_waitcnt lgkmcnt(8)
    v_mfma_f32_32x32x16_bf16 v[134:149], v[228:231], v[20:23], v[134:149]
    v_and_b32_dpp v38, v22, v11 wave_shr:1 row_mask:0xf bank_mask:0xf bound_ctrl:0
    v_and_b32_dpp v39, v23, v11 wave_shr:1 row_mask:0xf bank_mask:0xf bound_ctrl:0
    v_mfma_f32_32x32x16_bf16 v[118:133], v[224:227], v[16:19], v[118:133]
    ds_read2_b32 v[200:201], v44 offset0:64 offset1:65
    ds_read2_b32 v[202:203], v44 offset0:66 offset1:67
    v_and_b32_dpp v32, v16, v11 wave_shr:1 row_mask:0xf bank_mask:0xf bound_ctrl:0
    v_and_b32_dpp v33, v17, v11 wave_shr:1 row_mask:0xf bank_mask:0xf bound_ctrl:0
    s_waitcnt lgkmcnt(8)
    v_mfma_f32_32x32x16_bf16 v[134:149], v[184:187], v[16:19], v[134:149]
    v_and_b32_dpp v34, v18, v11 wave_shr:1 row_mask:0xf bank_mask:0xf bound_ctrl:0
    v_and_b32_dpp v35, v19, v11 wave_shr:1 row_mask:0xf bank_mask:0xf bound_ctrl:0
    v_mfma_f32_32x32x16_bf16 v[118:133], v[228:231], v[12:15], v[118:133]
    ds_read2_b32 v[204:205], v44 offset0:72 offset1:73
    ds_read2_b32 v[206:207], v44 offset0:74 offset1:75
    v_and_b32_dpp v28, v12, v11 wave_shr:1 row_mask:0xf bank_mask:0xf bound_ctrl:0
    v_and_b32_dpp v29, v13, v11 wave_shr:1 row_mask:0xf bank_mask:0xf bound_ctrl:0
    s_waitcnt lgkmcnt(8)
    v_mfma_f32_32x32x16_bf16 v[134:149], v[188:191], v[12:15], v[134:149]
    v_and_b32_dpp v30, v14, v11 wave_shr:1 row_mask:0xf bank_mask:0xf bound_ctrl:0
    v_and_b32_dpp v31, v15, v11 wave_shr:1 row_mask:0xf bank_mask:0xf bound_ctrl:0
    v_mfma_f32_32x32x16_bf16 v[118:133], v[184:187], v[40:43], v[118:133]
    ds_read2_b32 v[208:209], v44 offset0:80 offset1:81
    ds_read2_b32 v[210:211], v44 offset0:82 offset1:83
    v_and_b32_dpp v24, v40, v11 wave_shr:1 row_mask:0xf bank_mask:0xf bound_ctrl:0
    v_and_b32_dpp v25, v41, v11 wave_shr:1 row_mask:0xf bank_mask:0xf bound_ctrl:0
    s_waitcnt lgkmcnt(8)
    v_mfma_f32_32x32x16_bf16 v[134:149], v[192:195], v[40:43], v[134:149]
    v_and_b32_dpp v26, v42, v11 wave_shr:1 row_mask:0xf bank_mask:0xf bound_ctrl:0
    v_and_b32_dpp v27, v43, v11 wave_shr:1 row_mask:0xf bank_mask:0xf bound_ctrl:0
    v_mfma_f32_32x32x16_bf16 v[118:133], v[188:191], v[36:39], v[118:133]
    ds_read2_b32 v[212:213], v44 offset0:88 offset1:89
    ds_read2_b32 v[214:215], v44 offset0:90 offset1:91
    v_and_b32_dpp v20, v36, v11 wave_shr:1 row_mask:0xf bank_mask:0xf bound_ctrl:0
    v_and_b32_dpp v21, v37, v11 wave_shr:1 row_mask:0xf bank_mask:0xf bound_ctrl:0
    s_waitcnt lgkmcnt(8)
    v_mfma_f32_32x32x16_bf16 v[134:149], v[196:199], v[36:39], v[134:149]
    v_and_b32_dpp v22, v38, v11 wave_shr:1 row_mask:0xf bank_mask:0xf bound_ctrl:0
    v_and_b32_dpp v23, v39, v11 wave_shr:1 row_mask:0xf bank_mask:0xf bound_ctrl:0
    v_mfma_f32_32x32x16_bf16 v[118:133], v[192:195], v[32:35], v[118:133]
    ds_read2_b32 v[216:217], v44 offset0:96 offset1:97
    ds_read2_b32 v[218:219], v44 offset0:98 offset1:99
    v_and_b32_dpp v16, v32, v11 wave_shr:1 row_mask:0xf bank_mask:0xf bound_ctrl:0
    v_and_b32_dpp v17, v33, v11 wave_shr:1 row_mask:0xf bank_mask:0xf bound_ctrl:0
    s_waitcnt lgkmcnt(8)
    v_mfma_f32_32x32x16_bf16 v[134:149], v[200:203], v[32:35], v[134:149]
    v_and_b32_dpp v18, v34, v11 wave_shr:1 row_mask:0xf bank_mask:0xf bound_ctrl:0
    v_and_b32_dpp v19, v35, v11 wave_shr:1 row_mask:0xf bank_mask:0xf bound_ctrl:0
    v_mfma_f32_32x32x16_bf16 v[118:133], v[196:199], v[28:31], v[118:133]
    ds_read2_b32 v[220:221], v44 offset0:104 offset1:105
    ds_read2_b32 v[222:223], v44 offset0:106 offset1:107
    v_and_b32_dpp v12, v28, v11 wave_shr:1 row_mask:0xf bank_mask:0xf bound_ctrl:0
    v_and_b32_dpp v13, v29, v11 wave_shr:1 row_mask:0xf bank_mask:0xf bound_ctrl:0
    s_waitcnt lgkmcnt(8)
    v_mfma_f32_32x32x16_bf16 v[134:149], v[204:207], v[28:31], v[134:149]
    v_and_b32_dpp v14, v30, v11 wave_shr:1 row_mask:0xf bank_mask:0xf bound_ctrl:0
    v_and_b32_dpp v15, v31, v11 wave_shr:1 row_mask:0xf bank_mask:0xf bound_ctrl:0
    v_mfma_f32_32x32x16_bf16 v[118:133], v[200:203], v[24:27], v[118:133]
    ds_read2_b32 v[224:225], v44 offset0:112 offset1:113
    ds_read2_b32 v[226:227], v44 offset0:114 offset1:115
    v_and_b32_dpp v40, v24, v11 wave_shr:1 row_mask:0xf bank_mask:0xf bound_ctrl:0
    v_and_b32_dpp v41, v25, v11 wave_shr:1 row_mask:0xf bank_mask:0xf bound_ctrl:0
    s_waitcnt lgkmcnt(8)
    v_mfma_f32_32x32x16_bf16 v[134:149], v[208:211], v[24:27], v[134:149]
    v_and_b32_dpp v42, v26, v11 wave_shr:1 row_mask:0xf bank_mask:0xf bound_ctrl:0
    v_and_b32_dpp v43, v27, v11 wave_shr:1 row_mask:0xf bank_mask:0xf bound_ctrl:0
    v_mfma_f32_32x32x16_bf16 v[118:133], v[204:207], v[20:23], v[118:133]
    ds_read2_b32 v[228:229], v44 offset0:120 offset1:121
    ds_read2_b32 v[230:231], v44 offset0:122 offset1:123
    v_and_b32_dpp v36, v20, v11 wave_shr:1 row_mask:0xf bank_mask:0xf bound_ctrl:0
    v_and_b32_dpp v37, v21, v11 wave_shr:1 row_mask:0xf bank_mask:0xf bound_ctrl:0
    s_waitcnt lgkmcnt(8)
    v_mfma_f32_32x32x16_bf16 v[134:149], v[212:215], v[20:23], v[134:149]
    v_and_b32_dpp v38, v22, v11 wave_shr:1 row_mask:0xf bank_mask:0xf bound_ctrl:0
    v_and_b32_dpp v39, v23, v11 wave_shr:1 row_mask:0xf bank_mask:0xf bound_ctrl:0
    v_mfma_f32_32x32x16_bf16 v[118:133], v[208:211], v[16:19], v[118:133]
    ds_read2_b32 v[184:185], v44 offset0:128 offset1:129
    ds_read2_b32 v[186:187], v44 offset0:130 offset1:131
    v_and_b32_dpp v32, v16, v11 wave_shr:1 row_mask:0xf bank_mask:0xf bound_ctrl:0
    v_and_b32_dpp v33, v17, v11 wave_shr:1 row_mask:0xf bank_mask:0xf bound_ctrl:0
    s_waitcnt lgkmcnt(8)
    v_mfma_f32_32x32x16_bf16 v[134:149], v[216:219], v[16:19], v[134:149]
    v_and_b32_dpp v34, v18, v11 wave_shr:1 row_mask:0xf bank_mask:0xf bound_ctrl:0
    v_and_b32_dpp v35, v19, v11 wave_shr:1 row_mask:0xf bank_mask:0xf bound_ctrl:0
    v_mfma_f32_32x32x16_bf16 v[118:133], v[212:215], v[12:15], v[118:133]
    ds_read2_b32 v[188:189], v44 offset0:136 offset1:137
    ds_read2_b32 v[190:191], v44 offset0:138 offset1:139
    v_and_b32_dpp v28, v12, v11 wave_shr:1 row_mask:0xf bank_mask:0xf bound_ctrl:0
    v_and_b32_dpp v29, v13, v11 wave_shr:1 row_mask:0xf bank_mask:0xf bound_ctrl:0
    s_waitcnt lgkmcnt(8)
    v_mfma_f32_32x32x16_bf16 v[134:149], v[220:223], v[12:15], v[134:149]
    v_and_b32_dpp v30, v14, v11 wave_shr:1 row_mask:0xf bank_mask:0xf bound_ctrl:0
    v_and_b32_dpp v31, v15, v11 wave_shr:1 row_mask:0xf bank_mask:0xf bound_ctrl:0
    v_mfma_f32_32x32x16_bf16 v[118:133], v[216:219], v[40:43], v[118:133]
    ds_read2_b32 v[192:193], v44 offset0:144 offset1:145
    ds_read2_b32 v[194:195], v44 offset0:146 offset1:147
    v_and_b32_dpp v24, v40, v11 wave_shr:1 row_mask:0xf bank_mask:0xf bound_ctrl:0
    v_and_b32_dpp v25, v41, v11 wave_shr:1 row_mask:0xf bank_mask:0xf bound_ctrl:0
    s_waitcnt lgkmcnt(8)
    v_mfma_f32_32x32x16_bf16 v[134:149], v[224:227], v[40:43], v[134:149]
    v_and_b32_dpp v26, v42, v11 wave_shr:1 row_mask:0xf bank_mask:0xf bound_ctrl:0
    v_and_b32_dpp v27, v43, v11 wave_shr:1 row_mask:0xf bank_mask:0xf bound_ctrl:0
    v_mfma_f32_32x32x16_bf16 v[118:133], v[220:223], v[36:39], v[118:133]
    ds_read2_b32 v[196:197], v44 offset0:152 offset1:153
    ds_read2_b32 v[198:199], v44 offset0:154 offset1:155
    v_and_b32_dpp v20, v36, v11 wave_shr:1 row_mask:0xf bank_mask:0xf bound_ctrl:0
    v_and_b32_dpp v21, v37, v11 wave_shr:1 row_mask:0xf bank_mask:0xf bound_ctrl:0
    s_waitcnt lgkmcnt(8)
    v_mfma_f32_32x32x16_bf16 v[134:149], v[228:231], v[36:39], v[134:149]
    v_and_b32_dpp v22, v38, v11 wave_shr:1 row_mask:0xf bank_mask:0xf bound_ctrl:0
    v_and_b32_dpp v23, v39, v11 wave_shr:1 row_mask:0xf bank_mask:0xf bound_ctrl:0
    v_mfma_f32_32x32x16_bf16 v[118:133], v[224:227], v[32:35], v[118:133]
    ds_read2_b32 v[200:201], v44 offset0:160 offset1:161
    ds_read2_b32 v[202:203], v44 offset0:162 offset1:163
    v_and_b32_dpp v16, v32, v11 wave_shr:1 row_mask:0xf bank_mask:0xf bound_ctrl:0
    v_and_b32_dpp v17, v33, v11 wave_shr:1 row_mask:0xf bank_mask:0xf bound_ctrl:0
    s_waitcnt lgkmcnt(8)
    v_mfma_f32_32x32x16_bf16 v[134:149], v[184:187], v[32:35], v[134:149]
    v_and_b32_dpp v18, v34, v11 wave_shr:1 row_mask:0xf bank_mask:0xf bound_ctrl:0
    v_and_b32_dpp v19, v35, v11 wave_shr:1 row_mask:0xf bank_mask:0xf bound_ctrl:0
    v_mfma_f32_32x32x16_bf16 v[118:133], v[228:231], v[28:31], v[118:133]
    ds_read2_b32 v[204:205], v44 offset0:168 offset1:169
    ds_read2_b32 v[206:207], v44 offset0:170 offset1:171
    v_and_b32_dpp v12, v28, v11 wave_shr:1 row_mask:0xf bank_mask:0xf bound_ctrl:0
    v_and_b32_dpp v13, v29, v11 wave_shr:1 row_mask:0xf bank_mask:0xf bound_ctrl:0
    s_waitcnt lgkmcnt(8)
    v_mfma_f32_32x32x16_bf16 v[134:149], v[188:191], v[28:31], v[134:149]
    v_and_b32_dpp v14, v30, v11 wave_shr:1 row_mask:0xf bank_mask:0xf bound_ctrl:0
    v_and_b32_dpp v15, v31, v11 wave_shr:1 row_mask:0xf bank_mask:0xf bound_ctrl:0
    v_mfma_f32_32x32x16_bf16 v[118:133], v[184:187], v[24:27], v[118:133]
    ds_read2_b32 v[208:209], v44 offset0:176 offset1:177
    ds_read2_b32 v[210:211], v44 offset0:178 offset1:179
    v_and_b32_dpp v40, v24, v11 wave_shr:1 row_mask:0xf bank_mask:0xf bound_ctrl:0
    v_and_b32_dpp v41, v25, v11 wave_shr:1 row_mask:0xf bank_mask:0xf bound_ctrl:0
    s_waitcnt lgkmcnt(8)
    v_mfma_f32_32x32x16_bf16 v[134:149], v[192:195], v[24:27], v[134:149]
    v_and_b32_dpp v42, v26, v11 wave_shr:1 row_mask:0xf bank_mask:0xf bound_ctrl:0
    v_and_b32_dpp v43, v27, v11 wave_shr:1 row_mask:0xf bank_mask:0xf bound_ctrl:0
    v_mfma_f32_32x32x16_bf16 v[118:133], v[188:191], v[20:23], v[118:133]
    ds_read2_b32 v[212:213], v44 offset0:184 offset1:185
    ds_read2_b32 v[214:215], v44 offset0:186 offset1:187
    v_and_b32_dpp v36, v20, v11 wave_shr:1 row_mask:0xf bank_mask:0xf bound_ctrl:0
    v_and_b32_dpp v37, v21, v11 wave_shr:1 row_mask:0xf bank_mask:0xf bound_ctrl:0
    s_waitcnt lgkmcnt(8)
    v_mfma_f32_32x32x16_bf16 v[134:149], v[196:199], v[20:23], v[134:149]
    v_and_b32_dpp v38, v22, v11 wave_shr:1 row_mask:0xf bank_mask:0xf bound_ctrl:0
    v_and_b32_dpp v39, v23, v11 wave_shr:1 row_mask:0xf bank_mask:0xf bound_ctrl:0
    v_mfma_f32_32x32x16_bf16 v[118:133], v[192:195], v[16:19], v[118:133]
    ds_read2_b32 v[216:217], v44 offset0:192 offset1:193
    ds_read2_b32 v[218:219], v44 offset0:194 offset1:195
    v_and_b32_dpp v32, v16, v11 wave_shr:1 row_mask:0xf bank_mask:0xf bound_ctrl:0
    v_and_b32_dpp v33, v17, v11 wave_shr:1 row_mask:0xf bank_mask:0xf bound_ctrl:0
    s_waitcnt lgkmcnt(8)
    v_mfma_f32_32x32x16_bf16 v[134:149], v[200:203], v[16:19], v[134:149]
    v_and_b32_dpp v34, v18, v11 wave_shr:1 row_mask:0xf bank_mask:0xf bound_ctrl:0
    v_and_b32_dpp v35, v19, v11 wave_shr:1 row_mask:0xf bank_mask:0xf bound_ctrl:0
    v_mfma_f32_32x32x16_bf16 v[118:133], v[196:199], v[12:15], v[118:133]
    ds_read2_b32 v[220:221], v44 offset0:200 offset1:201
    ds_read2_b32 v[222:223], v44 offset0:202 offset1:203
    v_and_b32_dpp v28, v12, v11 wave_shr:1 row_mask:0xf bank_mask:0xf bound_ctrl:0
    v_and_b32_dpp v29, v13, v11 wave_shr:1 row_mask:0xf bank_mask:0xf bound_ctrl:0
    s_waitcnt lgkmcnt(8)
    v_mfma_f32_32x32x16_bf16 v[134:149], v[204:207], v[12:15], v[134:149]
    v_and_b32_dpp v30, v14, v11 wave_shr:1 row_mask:0xf bank_mask:0xf bound_ctrl:0
    v_and_b32_dpp v31, v15, v11 wave_shr:1 row_mask:0xf bank_mask:0xf bound_ctrl:0
    v_mfma_f32_32x32x16_bf16 v[118:133], v[200:203], v[40:43], v[118:133]
    ds_read2_b32 v[224:225], v44 offset0:208 offset1:209
    ds_read2_b32 v[226:227], v44 offset0:210 offset1:211
    v_and_b32_dpp v24, v40, v11 wave_shr:1 row_mask:0xf bank_mask:0xf bound_ctrl:0
    v_and_b32_dpp v25, v41, v11 wave_shr:1 row_mask:0xf bank_mask:0xf bound_ctrl:0
    s_waitcnt lgkmcnt(8)
    v_mfma_f32_32x32x16_bf16 v[134:149], v[208:211], v[40:43], v[134:149]
    v_and_b32_dpp v26, v42, v11 wave_shr:1 row_mask:0xf bank_mask:0xf bound_ctrl:0
    v_and_b32_dpp v27, v43, v11 wave_shr:1 row_mask:0xf bank_mask:0xf bound_ctrl:0
    v_mfma_f32_32x32x16_bf16 v[118:133], v[204:207], v[36:39], v[118:133]
    ds_read2_b32 v[228:229], v44 offset0:216 offset1:217
    ds_read2_b32 v[230:231], v44 offset0:218 offset1:219
    v_and_b32_dpp v20, v36, v11 wave_shr:1 row_mask:0xf bank_mask:0xf bound_ctrl:0
    v_and_b32_dpp v21, v37, v11 wave_shr:1 row_mask:0xf bank_mask:0xf bound_ctrl:0
    s_waitcnt lgkmcnt(8)
    v_mfma_f32_32x32x16_bf16 v[134:149], v[212:215], v[36:39], v[134:149]
    v_and_b32_dpp v22, v38, v11 wave_shr:1 row_mask:0xf bank_mask:0xf bound_ctrl:0
    v_and_b32_dpp v23, v39, v11 wave_shr:1 row_mask:0xf bank_mask:0xf bound_ctrl:0
    v_mfma_f32_32x32x16_bf16 v[118:133], v[208:211], v[32:35], v[118:133]
    ds_read2_b32 v[184:185], v44 offset0:224 offset1:225
    ds_read2_b32 v[186:187], v44 offset0:226 offset1:227
    v_and_b32_dpp v16, v32, v11 wave_shr:1 row_mask:0xf bank_mask:0xf bound_ctrl:0
    v_and_b32_dpp v17, v33, v11 wave_shr:1 row_mask:0xf bank_mask:0xf bound_ctrl:0
    s_waitcnt lgkmcnt(8)
    v_mfma_f32_32x32x16_bf16 v[134:149], v[216:219], v[32:35], v[134:149]
    v_and_b32_dpp v18, v34, v11 wave_shr:1 row_mask:0xf bank_mask:0xf bound_ctrl:0
    v_and_b32_dpp v19, v35, v11 wave_shr:1 row_mask:0xf bank_mask:0xf bound_ctrl:0
    v_mfma_f32_32x32x16_bf16 v[118:133], v[212:215], v[28:31], v[118:133]
    ds_read2_b32 v[188:189], v44 offset0:232 offset1:233
    ds_read2_b32 v[190:191], v44 offset0:234 offset1:235
    v_and_b32_dpp v12, v28, v11 wave_shr:1 row_mask:0xf bank_mask:0xf bound_ctrl:0
    v_and_b32_dpp v13, v29, v11 wave_shr:1 row_mask:0xf bank_mask:0xf bound_ctrl:0
    s_waitcnt lgkmcnt(8)
    v_mfma_f32_32x32x16_bf16 v[134:149], v[220:223], v[28:31], v[134:149]
    v_and_b32_dpp v14, v30, v11 wave_shr:1 row_mask:0xf bank_mask:0xf bound_ctrl:0
    v_and_b32_dpp v15, v31, v11 wave_shr:1 row_mask:0xf bank_mask:0xf bound_ctrl:0
    v_mfma_f32_32x32x16_bf16 v[118:133], v[216:219], v[24:27], v[118:133]
    ds_read2_b32 v[192:193], v44 offset0:240 offset1:241
    ds_read2_b32 v[194:195], v44 offset0:242 offset1:243
    v_and_b32_dpp v40, v24, v11 wave_shr:1 row_mask:0xf bank_mask:0xf bound_ctrl:0
    v_and_b32_dpp v41, v25, v11 wave_shr:1 row_mask:0xf bank_mask:0xf bound_ctrl:0
    s_waitcnt lgkmcnt(8)
    v_mfma_f32_32x32x16_bf16 v[134:149], v[224:227], v[24:27], v[134:149]
    v_and_b32_dpp v42, v26, v11 wave_shr:1 row_mask:0xf bank_mask:0xf bound_ctrl:0
    v_and_b32_dpp v43, v27, v11 wave_shr:1 row_mask:0xf bank_mask:0xf bound_ctrl:0
    v_mfma_f32_32x32x16_bf16 v[118:133], v[220:223], v[20:23], v[118:133]
    ds_read2_b32 v[196:197], v44 offset0:248 offset1:249
    ds_read2_b32 v[198:199], v44 offset0:250 offset1:251
    v_and_b32_dpp v36, v20, v11 wave_shr:1 row_mask:0xf bank_mask:0xf bound_ctrl:0
    v_and_b32_dpp v37, v21, v11 wave_shr:1 row_mask:0xf bank_mask:0xf bound_ctrl:0
    s_waitcnt lgkmcnt(8)
    v_mfma_f32_32x32x16_bf16 v[134:149], v[228:231], v[20:23], v[134:149]
    v_and_b32_dpp v38, v22, v11 wave_shr:1 row_mask:0xf bank_mask:0xf bound_ctrl:0
    v_and_b32_dpp v39, v23, v11 wave_shr:1 row_mask:0xf bank_mask:0xf bound_ctrl:0
    v_mfma_f32_32x32x16_bf16 v[118:133], v[224:227], v[16:19], v[118:133]
    v_add_u32 v44, 1024, v44
    ds_read2_b32 v[200:201], v44 offset0:0 offset1:1
    ds_read2_b32 v[202:203], v44 offset0:2 offset1:3
    v_and_b32_dpp v32, v16, v11 wave_shr:1 row_mask:0xf bank_mask:0xf bound_ctrl:0
    v_and_b32_dpp v33, v17, v11 wave_shr:1 row_mask:0xf bank_mask:0xf bound_ctrl:0
    s_waitcnt lgkmcnt(8)
    v_mfma_f32_32x32x16_bf16 v[134:149], v[184:187], v[16:19], v[134:149]
    v_and_b32_dpp v34, v18, v11 wave_shr:1 row_mask:0xf bank_mask:0xf bound_ctrl:0
    v_and_b32_dpp v35, v19, v11 wave_shr:1 row_mask:0xf bank_mask:0xf bound_ctrl:0
    v_mfma_f32_32x32x16_bf16 v[118:133], v[228:231], v[12:15], v[118:133]
    ds_read2_b32 v[204:205], v44 offset0:8 offset1:9
    ds_read2_b32 v[206:207], v44 offset0:10 offset1:11
    v_and_b32_dpp v28, v12, v11 wave_shr:1 row_mask:0xf bank_mask:0xf bound_ctrl:0
    v_and_b32_dpp v29, v13, v11 wave_shr:1 row_mask:0xf bank_mask:0xf bound_ctrl:0
    s_waitcnt lgkmcnt(8)
    v_mfma_f32_32x32x16_bf16 v[134:149], v[188:191], v[12:15], v[134:149]
    v_and_b32_dpp v30, v14, v11 wave_shr:1 row_mask:0xf bank_mask:0xf bound_ctrl:0
    v_and_b32_dpp v31, v15, v11 wave_shr:1 row_mask:0xf bank_mask:0xf bound_ctrl:0
    v_mfma_f32_32x32x16_bf16 v[118:133], v[184:187], v[40:43], v[118:133]
    ds_read2_b32 v[208:209], v44 offset0:16 offset1:17
    ds_read2_b32 v[210:211], v44 offset0:18 offset1:19
    v_and_b32_dpp v24, v40, v11 wave_shr:1 row_mask:0xf bank_mask:0xf bound_ctrl:0
    v_and_b32_dpp v25, v41, v11 wave_shr:1 row_mask:0xf bank_mask:0xf bound_ctrl:0
    s_waitcnt lgkmcnt(8)
    v_mfma_f32_32x32x16_bf16 v[134:149], v[192:195], v[40:43], v[134:149]
    v_and_b32_dpp v26, v42, v11 wave_shr:1 row_mask:0xf bank_mask:0xf bound_ctrl:0
    v_and_b32_dpp v27, v43, v11 wave_shr:1 row_mask:0xf bank_mask:0xf bound_ctrl:0
    v_mfma_f32_32x32x16_bf16 v[118:133], v[188:191], v[36:39], v[118:133]
    ds_read2_b32 v[212:213], v44 offset0:24 offset1:25
    ds_read2_b32 v[214:215], v44 offset0:26 offset1:27
    v_and_b32_dpp v20, v36, v11 wave_shr:1 row_mask:0xf bank_mask:0xf bound_ctrl:0
    v_and_b32_dpp v21, v37, v11 wave_shr:1 row_mask:0xf bank_mask:0xf bound_ctrl:0
    s_waitcnt lgkmcnt(8)
    v_mfma_f32_32x32x16_bf16 v[134:149], v[196:199], v[36:39], v[134:149]
    v_and_b32_dpp v22, v38, v11 wave_shr:1 row_mask:0xf bank_mask:0xf bound_ctrl:0
    v_and_b32_dpp v23, v39, v11 wave_shr:1 row_mask:0xf bank_mask:0xf bound_ctrl:0
    v_mfma_f32_32x32x16_bf16 v[118:133], v[192:195], v[32:35], v[118:133]
    ds_read2_b32 v[216:217], v44 offset0:32 offset1:33
    ds_read2_b32 v[218:219], v44 offset0:34 offset1:35
    v_and_b32_dpp v16, v32, v11 wave_shr:1 row_mask:0xf bank_mask:0xf bound_ctrl:0
    v_and_b32_dpp v17, v33, v11 wave_shr:1 row_mask:0xf bank_mask:0xf bound_ctrl:0
    s_waitcnt lgkmcnt(8)
    v_mfma_f32_32x32x16_bf16 v[134:149], v[200:203], v[32:35], v[134:149]
    v_and_b32_dpp v18, v34, v11 wave_shr:1 row_mask:0xf bank_mask:0xf bound_ctrl:0
    v_and_b32_dpp v19, v35, v11 wave_shr:1 row_mask:0xf bank_mask:0xf bound_ctrl:0
    v_mfma_f32_32x32x16_bf16 v[118:133], v[196:199], v[28:31], v[118:133]
    ds_read2_b32 v[220:221], v44 offset0:40 offset1:41
    ds_read2_b32 v[222:223], v44 offset0:42 offset1:43
    v_and_b32_dpp v12, v28, v11 wave_shr:1 row_mask:0xf bank_mask:0xf bound_ctrl:0
    v_and_b32_dpp v13, v29, v11 wave_shr:1 row_mask:0xf bank_mask:0xf bound_ctrl:0
    s_waitcnt lgkmcnt(8)
    v_mfma_f32_32x32x16_bf16 v[134:149], v[204:207], v[28:31], v[134:149]
    v_and_b32_dpp v14, v30, v11 wave_shr:1 row_mask:0xf bank_mask:0xf bound_ctrl:0
    v_and_b32_dpp v15, v31, v11 wave_shr:1 row_mask:0xf bank_mask:0xf bound_ctrl:0
    v_mfma_f32_32x32x16_bf16 v[118:133], v[200:203], v[24:27], v[118:133]
    ds_read2_b32 v[224:225], v44 offset0:48 offset1:49
    ds_read2_b32 v[226:227], v44 offset0:50 offset1:51
    v_and_b32_dpp v40, v24, v11 wave_shr:1 row_mask:0xf bank_mask:0xf bound_ctrl:0
    v_and_b32_dpp v41, v25, v11 wave_shr:1 row_mask:0xf bank_mask:0xf bound_ctrl:0
    s_waitcnt lgkmcnt(8)
    v_mfma_f32_32x32x16_bf16 v[134:149], v[208:211], v[24:27], v[134:149]
    v_and_b32_dpp v42, v26, v11 wave_shr:1 row_mask:0xf bank_mask:0xf bound_ctrl:0
    v_and_b32_dpp v43, v27, v11 wave_shr:1 row_mask:0xf bank_mask:0xf bound_ctrl:0
    v_mfma_f32_32x32x16_bf16 v[118:133], v[204:207], v[20:23], v[118:133]
    ds_read2_b32 v[228:229], v44 offset0:56 offset1:57
    ds_read2_b32 v[230:231], v44 offset0:58 offset1:59
    v_and_b32_dpp v36, v20, v11 wave_shr:1 row_mask:0xf bank_mask:0xf bound_ctrl:0
    v_and_b32_dpp v37, v21, v11 wave_shr:1 row_mask:0xf bank_mask:0xf bound_ctrl:0
    s_waitcnt lgkmcnt(8)
    v_mfma_f32_32x32x16_bf16 v[134:149], v[212:215], v[20:23], v[134:149]
    v_and_b32_dpp v38, v22, v11 wave_shr:1 row_mask:0xf bank_mask:0xf bound_ctrl:0
    v_and_b32_dpp v39, v23, v11 wave_shr:1 row_mask:0xf bank_mask:0xf bound_ctrl:0
    v_mfma_f32_32x32x16_bf16 v[118:133], v[208:211], v[16:19], v[118:133]
    ds_read2_b32 v[184:185], v44 offset0:64 offset1:65
    ds_read2_b32 v[186:187], v44 offset0:66 offset1:67
    v_and_b32_dpp v32, v16, v11 wave_shr:1 row_mask:0xf bank_mask:0xf bound_ctrl:0
    v_and_b32_dpp v33, v17, v11 wave_shr:1 row_mask:0xf bank_mask:0xf bound_ctrl:0
    s_waitcnt lgkmcnt(8)
    v_mfma_f32_32x32x16_bf16 v[134:149], v[216:219], v[16:19], v[134:149]
    v_and_b32_dpp v34, v18, v11 wave_shr:1 row_mask:0xf bank_mask:0xf bound_ctrl:0
    v_and_b32_dpp v35, v19, v11 wave_shr:1 row_mask:0xf bank_mask:0xf bound_ctrl:0
    v_mfma_f32_32x32x16_bf16 v[118:133], v[212:215], v[12:15], v[118:133]
    ds_read2_b32 v[188:189], v44 offset0:72 offset1:73
    ds_read2_b32 v[190:191], v44 offset0:74 offset1:75
    v_and_b32_dpp v28, v12, v11 wave_shr:1 row_mask:0xf bank_mask:0xf bound_ctrl:0
    v_and_b32_dpp v29, v13, v11 wave_shr:1 row_mask:0xf bank_mask:0xf bound_ctrl:0
    s_waitcnt lgkmcnt(8)
    v_mfma_f32_32x32x16_bf16 v[134:149], v[220:223], v[12:15], v[134:149]
    v_and_b32_dpp v30, v14, v11 wave_shr:1 row_mask:0xf bank_mask:0xf bound_ctrl:0
    v_and_b32_dpp v31, v15, v11 wave_shr:1 row_mask:0xf bank_mask:0xf bound_ctrl:0
    v_mfma_f32_32x32x16_bf16 v[118:133], v[216:219], v[40:43], v[118:133]
    ds_read2_b32 v[192:193], v44 offset0:80 offset1:81
    ds_read2_b32 v[194:195], v44 offset0:82 offset1:83
    v_and_b32_dpp v24, v40, v11 wave_shr:1 row_mask:0xf bank_mask:0xf bound_ctrl:0
    v_and_b32_dpp v25, v41, v11 wave_shr:1 row_mask:0xf bank_mask:0xf bound_ctrl:0
    s_waitcnt lgkmcnt(8)
    v_mfma_f32_32x32x16_bf16 v[134:149], v[224:227], v[40:43], v[134:149]
    v_and_b32_dpp v26, v42, v11 wave_shr:1 row_mask:0xf bank_mask:0xf bound_ctrl:0
    v_and_b32_dpp v27, v43, v11 wave_shr:1 row_mask:0xf bank_mask:0xf bound_ctrl:0
    v_mfma_f32_32x32x16_bf16 v[118:133], v[220:223], v[36:39], v[118:133]
    ds_read2_b32 v[196:197], v44 offset0:88 offset1:89
    ds_read2_b32 v[198:199], v44 offset0:90 offset1:91
    v_and_b32_dpp v20, v36, v11 wave_shr:1 row_mask:0xf bank_mask:0xf bound_ctrl:0
    v_and_b32_dpp v21, v37, v11 wave_shr:1 row_mask:0xf bank_mask:0xf bound_ctrl:0
    s_waitcnt lgkmcnt(8)
    v_mfma_f32_32x32x16_bf16 v[134:149], v[228:231], v[36:39], v[134:149]
    v_and_b32_dpp v22, v38, v11 wave_shr:1 row_mask:0xf bank_mask:0xf bound_ctrl:0
    v_and_b32_dpp v23, v39, v11 wave_shr:1 row_mask:0xf bank_mask:0xf bound_ctrl:0
    v_mfma_f32_32x32x16_bf16 v[118:133], v[224:227], v[32:35], v[118:133]
    ds_read2_b32 v[200:201], v44 offset0:96 offset1:97
    ds_read2_b32 v[202:203], v44 offset0:98 offset1:99
    v_and_b32_dpp v16, v32, v11 wave_shr:1 row_mask:0xf bank_mask:0xf bound_ctrl:0
    v_and_b32_dpp v17, v33, v11 wave_shr:1 row_mask:0xf bank_mask:0xf bound_ctrl:0
    s_waitcnt lgkmcnt(8)
    v_mfma_f32_32x32x16_bf16 v[134:149], v[184:187], v[32:35], v[134:149]
    v_and_b32_dpp v18, v34, v11 wave_shr:1 row_mask:0xf bank_mask:0xf bound_ctrl:0
    v_and_b32_dpp v19, v35, v11 wave_shr:1 row_mask:0xf bank_mask:0xf bound_ctrl:0
    v_mfma_f32_32x32x16_bf16 v[118:133], v[228:231], v[28:31], v[118:133]
    ds_read2_b32 v[204:205], v44 offset0:104 offset1:105
    ds_read2_b32 v[206:207], v44 offset0:106 offset1:107
    v_and_b32_dpp v12, v28, v11 wave_shr:1 row_mask:0xf bank_mask:0xf bound_ctrl:0
    v_and_b32_dpp v13, v29, v11 wave_shr:1 row_mask:0xf bank_mask:0xf bound_ctrl:0
    s_waitcnt lgkmcnt(8)
    v_mfma_f32_32x32x16_bf16 v[134:149], v[188:191], v[28:31], v[134:149]
    v_and_b32_dpp v14, v30, v11 wave_shr:1 row_mask:0xf bank_mask:0xf bound_ctrl:0
    v_and_b32_dpp v15, v31, v11 wave_shr:1 row_mask:0xf bank_mask:0xf bound_ctrl:0
    v_mfma_f32_32x32x16_bf16 v[118:133], v[184:187], v[24:27], v[118:133]
    ds_read2_b32 v[208:209], v44 offset0:112 offset1:113
    ds_read2_b32 v[210:211], v44 offset0:114 offset1:115
    v_and_b32_dpp v40, v24, v11 wave_shr:1 row_mask:0xf bank_mask:0xf bound_ctrl:0
    v_and_b32_dpp v41, v25, v11 wave_shr:1 row_mask:0xf bank_mask:0xf bound_ctrl:0
    s_waitcnt lgkmcnt(8)
    v_mfma_f32_32x32x16_bf16 v[134:149], v[192:195], v[24:27], v[134:149]
    v_and_b32_dpp v42, v26, v11 wave_shr:1 row_mask:0xf bank_mask:0xf bound_ctrl:0
    v_and_b32_dpp v43, v27, v11 wave_shr:1 row_mask:0xf bank_mask:0xf bound_ctrl:0
    v_mfma_f32_32x32x16_bf16 v[118:133], v[188:191], v[20:23], v[118:133]
    ds_read2_b32 v[212:213], v44 offset0:120 offset1:121
    ds_read2_b32 v[214:215], v44 offset0:122 offset1:123
    v_and_b32_dpp v36, v20, v11 wave_shr:1 row_mask:0xf bank_mask:0xf bound_ctrl:0
    v_and_b32_dpp v37, v21, v11 wave_shr:1 row_mask:0xf bank_mask:0xf bound_ctrl:0
    s_waitcnt lgkmcnt(8)
    v_mfma_f32_32x32x16_bf16 v[134:149], v[196:199], v[20:23], v[134:149]
    v_and_b32_dpp v38, v22, v11 wave_shr:1 row_mask:0xf bank_mask:0xf bound_ctrl:0
    v_and_b32_dpp v39, v23, v11 wave_shr:1 row_mask:0xf bank_mask:0xf bound_ctrl:0
    v_mfma_f32_32x32x16_bf16 v[118:133], v[192:195], v[16:19], v[118:133]
    ds_read2_b32 v[216:217], v44 offset0:128 offset1:129
    ds_read2_b32 v[218:219], v44 offset0:130 offset1:131
    v_and_b32_dpp v32, v16, v11 wave_shr:1 row_mask:0xf bank_mask:0xf bound_ctrl:0
    v_and_b32_dpp v33, v17, v11 wave_shr:1 row_mask:0xf bank_mask:0xf bound_ctrl:0
    s_waitcnt lgkmcnt(8)
    v_mfma_f32_32x32x16_bf16 v[134:149], v[200:203], v[16:19], v[134:149]
    v_and_b32_dpp v34, v18, v11 wave_shr:1 row_mask:0xf bank_mask:0xf bound_ctrl:0
    v_and_b32_dpp v35, v19, v11 wave_shr:1 row_mask:0xf bank_mask:0xf bound_ctrl:0
    v_mfma_f32_32x32x16_bf16 v[118:133], v[196:199], v[12:15], v[118:133]
    ds_read2_b32 v[220:221], v44 offset0:136 offset1:137
    ds_read2_b32 v[222:223], v44 offset0:138 offset1:139
    v_and_b32_dpp v28, v12, v11 wave_shr:1 row_mask:0xf bank_mask:0xf bound_ctrl:0
    v_and_b32_dpp v29, v13, v11 wave_shr:1 row_mask:0xf bank_mask:0xf bound_ctrl:0
    s_waitcnt lgkmcnt(8)
    v_mfma_f32_32x32x16_bf16 v[134:149], v[204:207], v[12:15], v[134:149]
    v_and_b32_dpp v30, v14, v11 wave_shr:1 row_mask:0xf bank_mask:0xf bound_ctrl:0
    v_and_b32_dpp v31, v15, v11 wave_shr:1 row_mask:0xf bank_mask:0xf bound_ctrl:0
    v_mfma_f32_32x32x16_bf16 v[118:133], v[200:203], v[40:43], v[118:133]
    ds_read2_b32 v[224:225], v44 offset0:144 offset1:145
    ds_read2_b32 v[226:227], v44 offset0:146 offset1:147
    v_and_b32_dpp v24, v40, v11 wave_shr:1 row_mask:0xf bank_mask:0xf bound_ctrl:0
    v_and_b32_dpp v25, v41, v11 wave_shr:1 row_mask:0xf bank_mask:0xf bound_ctrl:0
    s_waitcnt lgkmcnt(8)
    v_mfma_f32_32x32x16_bf16 v[134:149], v[208:211], v[40:43], v[134:149]
    v_and_b32_dpp v26, v42, v11 wave_shr:1 row_mask:0xf bank_mask:0xf bound_ctrl:0
    v_and_b32_dpp v27, v43, v11 wave_shr:1 row_mask:0xf bank_mask:0xf bound_ctrl:0
    v_mfma_f32_32x32x16_bf16 v[118:133], v[204:207], v[36:39], v[118:133]
    ds_read2_b32 v[228:229], v44 offset0:152 offset1:153
    ds_read2_b32 v[230:231], v44 offset0:154 offset1:155
    v_and_b32_dpp v20, v36, v11 wave_shr:1 row_mask:0xf bank_mask:0xf bound_ctrl:0
    v_and_b32_dpp v21, v37, v11 wave_shr:1 row_mask:0xf bank_mask:0xf bound_ctrl:0
    s_waitcnt lgkmcnt(8)
    v_mfma_f32_32x32x16_bf16 v[134:149], v[212:215], v[36:39], v[134:149]
    v_and_b32_dpp v22, v38, v11 wave_shr:1 row_mask:0xf bank_mask:0xf bound_ctrl:0
    v_and_b32_dpp v23, v39, v11 wave_shr:1 row_mask:0xf bank_mask:0xf bound_ctrl:0
    v_mfma_f32_32x32x16_bf16 v[118:133], v[208:211], v[32:35], v[118:133]
    ds_read2_b32 v[184:185], v44 offset0:160 offset1:161
    ds_read2_b32 v[186:187], v44 offset0:162 offset1:163
    v_and_b32_dpp v16, v32, v11 wave_shr:1 row_mask:0xf bank_mask:0xf bound_ctrl:0
    v_and_b32_dpp v17, v33, v11 wave_shr:1 row_mask:0xf bank_mask:0xf bound_ctrl:0
    s_waitcnt lgkmcnt(8)
    v_mfma_f32_32x32x16_bf16 v[134:149], v[216:219], v[32:35], v[134:149]
    v_and_b32_dpp v18, v34, v11 wave_shr:1 row_mask:0xf bank_mask:0xf bound_ctrl:0
    v_and_b32_dpp v19, v35, v11 wave_shr:1 row_mask:0xf bank_mask:0xf bound_ctrl:0
    v_mfma_f32_32x32x16_bf16 v[118:133], v[212:215], v[28:31], v[118:133]
    ds_read2_b32 v[188:189], v44 offset0:168 offset1:169
    ds_read2_b32 v[190:191], v44 offset0:170 offset1:171
    v_and_b32_dpp v12, v28, v11 wave_shr:1 row_mask:0xf bank_mask:0xf bound_ctrl:0
    v_and_b32_dpp v13, v29, v11 wave_shr:1 row_mask:0xf bank_mask:0xf bound_ctrl:0
    s_waitcnt lgkmcnt(8)
    v_mfma_f32_32x32x16_bf16 v[134:149], v[220:223], v[28:31], v[134:149]
    v_and_b32_dpp v14, v30, v11 wave_shr:1 row_mask:0xf bank_mask:0xf bound_ctrl:0
    v_and_b32_dpp v15, v31, v11 wave_shr:1 row_mask:0xf bank_mask:0xf bound_ctrl:0
    v_mfma_f32_32x32x16_bf16 v[118:133], v[216:219], v[24:27], v[118:133]
    ds_read2_b32 v[192:193], v44 offset0:176 offset1:177
    ds_read2_b32 v[194:195], v44 offset0:178 offset1:179
    v_and_b32_dpp v40, v24, v11 wave_shr:1 row_mask:0xf bank_mask:0xf bound_ctrl:0
    v_and_b32_dpp v41, v25, v11 wave_shr:1 row_mask:0xf bank_mask:0xf bound_ctrl:0
    s_waitcnt lgkmcnt(8)
    v_mfma_f32_32x32x16_bf16 v[134:149], v[224:227], v[24:27], v[134:149]
    v_and_b32_dpp v42, v26, v11 wave_shr:1 row_mask:0xf bank_mask:0xf bound_ctrl:0
    v_and_b32_dpp v43, v27, v11 wave_shr:1 row_mask:0xf bank_mask:0xf bound_ctrl:0
    v_mfma_f32_32x32x16_bf16 v[118:133], v[220:223], v[20:23], v[118:133]
    ds_read2_b32 v[196:197], v44 offset0:184 offset1:185
    ds_read2_b32 v[198:199], v44 offset0:186 offset1:187
    v_and_b32_dpp v36, v20, v11 wave_shr:1 row_mask:0xf bank_mask:0xf bound_ctrl:0
    v_and_b32_dpp v37, v21, v11 wave_shr:1 row_mask:0xf bank_mask:0xf bound_ctrl:0
    s_waitcnt lgkmcnt(8)
    v_mfma_f32_32x32x16_bf16 v[134:149], v[228:231], v[20:23], v[134:149]
    v_and_b32_dpp v38, v22, v11 wave_shr:1 row_mask:0xf bank_mask:0xf bound_ctrl:0
    v_and_b32_dpp v39, v23, v11 wave_shr:1 row_mask:0xf bank_mask:0xf bound_ctrl:0
    v_mfma_f32_32x32x16_bf16 v[118:133], v[224:227], v[16:19], v[118:133]
    ds_read2_b32 v[200:201], v44 offset0:192 offset1:193
    ds_read2_b32 v[202:203], v44 offset0:194 offset1:195
    v_and_b32_dpp v32, v16, v11 wave_shr:1 row_mask:0xf bank_mask:0xf bound_ctrl:0
    v_and_b32_dpp v33, v17, v11 wave_shr:1 row_mask:0xf bank_mask:0xf bound_ctrl:0
    s_waitcnt lgkmcnt(8)
    v_mfma_f32_32x32x16_bf16 v[134:149], v[184:187], v[16:19], v[134:149]
    v_and_b32_dpp v34, v18, v11 wave_shr:1 row_mask:0xf bank_mask:0xf bound_ctrl:0
    v_and_b32_dpp v35, v19, v11 wave_shr:1 row_mask:0xf bank_mask:0xf bound_ctrl:0
    v_mfma_f32_32x32x16_bf16 v[118:133], v[228:231], v[12:15], v[118:133]
    ds_read2_b32 v[204:205], v44 offset0:200 offset1:201
    ds_read2_b32 v[206:207], v44 offset0:202 offset1:203
    v_and_b32_dpp v28, v12, v11 wave_shr:1 row_mask:0xf bank_mask:0xf bound_ctrl:0
    v_and_b32_dpp v29, v13, v11 wave_shr:1 row_mask:0xf bank_mask:0xf bound_ctrl:0
    s_waitcnt lgkmcnt(8)
    v_mfma_f32_32x32x16_bf16 v[134:149], v[188:191], v[12:15], v[134:149]
    v_and_b32_dpp v30, v14, v11 wave_shr:1 row_mask:0xf bank_mask:0xf bound_ctrl:0
    v_and_b32_dpp v31, v15, v11 wave_shr:1 row_mask:0xf bank_mask:0xf bound_ctrl:0
    v_mfma_f32_32x32x16_bf16 v[118:133], v[184:187], v[40:43], v[118:133]
    ds_read2_b32 v[208:209], v44 offset0:208 offset1:209
    ds_read2_b32 v[210:211], v44 offset0:210 offset1:211
    v_and_b32_dpp v24, v40, v11 wave_shr:1 row_mask:0xf bank_mask:0xf bound_ctrl:0
    v_and_b32_dpp v25, v41, v11 wave_shr:1 row_mask:0xf bank_mask:0xf bound_ctrl:0
    s_waitcnt lgkmcnt(8)
    v_mfma_f32_32x32x16_bf16 v[134:149], v[192:195], v[40:43], v[134:149]
    v_and_b32_dpp v26, v42, v11 wave_shr:1 row_mask:0xf bank_mask:0xf bound_ctrl:0
    v_and_b32_dpp v27, v43, v11 wave_shr:1 row_mask:0xf bank_mask:0xf bound_ctrl:0
    v_mfma_f32_32x32x16_bf16 v[118:133], v[188:191], v[36:39], v[118:133]
    ds_read2_b32 v[212:213], v44 offset0:216 offset1:217
    ds_read2_b32 v[214:215], v44 offset0:218 offset1:219
    v_and_b32_dpp v20, v36, v11 wave_shr:1 row_mask:0xf bank_mask:0xf bound_ctrl:0
    v_and_b32_dpp v21, v37, v11 wave_shr:1 row_mask:0xf bank_mask:0xf bound_ctrl:0
    s_waitcnt lgkmcnt(8)
    v_mfma_f32_32x32x16_bf16 v[134:149], v[196:199], v[36:39], v[134:149]
    v_and_b32_dpp v22, v38, v11 wave_shr:1 row_mask:0xf bank_mask:0xf bound_ctrl:0
    v_and_b32_dpp v23, v39, v11 wave_shr:1 row_mask:0xf bank_mask:0xf bound_ctrl:0
    v_mfma_f32_32x32x16_bf16 v[118:133], v[192:195], v[32:35], v[118:133]
    ds_read2_b32 v[216:217], v44 offset0:224 offset1:225
    ds_read2_b32 v[218:219], v44 offset0:226 offset1:227
    v_and_b32_dpp v16, v32, v11 wave_shr:1 row_mask:0xf bank_mask:0xf bound_ctrl:0
    v_and_b32_dpp v17, v33, v11 wave_shr:1 row_mask:0xf bank_mask:0xf bound_ctrl:0
    s_waitcnt lgkmcnt(8)
    v_mfma_f32_32x32x16_bf16 v[134:149], v[200:203], v[32:35], v[134:149]
    v_and_b32_dpp v18, v34, v11 wave_shr:1 row_mask:0xf bank_mask:0xf bound_ctrl:0
    v_and_b32_dpp v19, v35, v11 wave_shr:1 row_mask:0xf bank_mask:0xf bound_ctrl:0
    v_mfma_f32_32x32x16_bf16 v[118:133], v[196:199], v[28:31], v[118:133]
    ds_read2_b32 v[220:221], v44 offset0:232 offset1:233
    ds_read2_b32 v[222:223], v44 offset0:234 offset1:235
    v_and_b32_dpp v12, v28, v11 wave_shr:1 row_mask:0xf bank_mask:0xf bound_ctrl:0
    v_and_b32_dpp v13, v29, v11 wave_shr:1 row_mask:0xf bank_mask:0xf bound_ctrl:0
    s_waitcnt lgkmcnt(8)
    v_mfma_f32_32x32x16_bf16 v[134:149], v[204:207], v[28:31], v[134:149]
    v_and_b32_dpp v14, v30, v11 wave_shr:1 row_mask:0xf bank_mask:0xf bound_ctrl:0
    v_and_b32_dpp v15, v31, v11 wave_shr:1 row_mask:0xf bank_mask:0xf bound_ctrl:0
    v_mfma_f32_32x32x16_bf16 v[118:133], v[200:203], v[24:27], v[118:133]
    ds_read2_b32 v[224:225], v44 offset0:240 offset1:241
    ds_read2_b32 v[226:227], v44 offset0:242 offset1:243
    v_and_b32_dpp v40, v24, v11 wave_shr:1 row_mask:0xf bank_mask:0xf bound_ctrl:0
    v_and_b32_dpp v41, v25, v11 wave_shr:1 row_mask:0xf bank_mask:0xf bound_ctrl:0
    s_waitcnt lgkmcnt(8)
    v_mfma_f32_32x32x16_bf16 v[134:149], v[208:211], v[24:27], v[134:149]
    v_and_b32_dpp v42, v26, v11 wave_shr:1 row_mask:0xf bank_mask:0xf bound_ctrl:0
    v_and_b32_dpp v43, v27, v11 wave_shr:1 row_mask:0xf bank_mask:0xf bound_ctrl:0
    v_mfma_f32_32x32x16_bf16 v[118:133], v[204:207], v[20:23], v[118:133]
    ds_read2_b32 v[228:229], v44 offset0:248 offset1:249
    ds_read2_b32 v[230:231], v44 offset0:250 offset1:251
    v_and_b32_dpp v36, v20, v11 wave_shr:1 row_mask:0xf bank_mask:0xf bound_ctrl:0
    v_and_b32_dpp v37, v21, v11 wave_shr:1 row_mask:0xf bank_mask:0xf bound_ctrl:0
    s_waitcnt lgkmcnt(8)
    v_mfma_f32_32x32x16_bf16 v[134:149], v[212:215], v[20:23], v[134:149]
    v_and_b32_dpp v38, v22, v11 wave_shr:1 row_mask:0xf bank_mask:0xf bound_ctrl:0
    v_and_b32_dpp v39, v23, v11 wave_shr:1 row_mask:0xf bank_mask:0xf bound_ctrl:0
    v_mfma_f32_32x32x16_bf16 v[118:133], v[208:211], v[16:19], v[118:133]
    v_add_u32 v44, 1024, v44
    ds_read2_b32 v[184:185], v44 offset0:0 offset1:1
    ds_read2_b32 v[186:187], v44 offset0:2 offset1:3
    v_and_b32_dpp v32, v16, v11 wave_shr:1 row_mask:0xf bank_mask:0xf bound_ctrl:0
    v_and_b32_dpp v33, v17, v11 wave_shr:1 row_mask:0xf bank_mask:0xf bound_ctrl:0
    s_waitcnt lgkmcnt(8)
    v_mfma_f32_32x32x16_bf16 v[134:149], v[216:219], v[16:19], v[134:149]
    v_and_b32_dpp v34, v18, v11 wave_shr:1 row_mask:0xf bank_mask:0xf bound_ctrl:0
    v_and_b32_dpp v35, v19, v11 wave_shr:1 row_mask:0xf bank_mask:0xf bound_ctrl:0
    v_mfma_f32_32x32x16_bf16 v[118:133], v[212:215], v[12:15], v[118:133]
    ds_read2_b32 v[188:189], v44 offset0:8 offset1:9
    ds_read2_b32 v[190:191], v44 offset0:10 offset1:11
    v_and_b32_dpp v28, v12, v11 wave_shr:1 row_mask:0xf bank_mask:0xf bound_ctrl:0
    v_and_b32_dpp v29, v13, v11 wave_shr:1 row_mask:0xf bank_mask:0xf bound_ctrl:0
    s_waitcnt lgkmcnt(8)
    v_mfma_f32_32x32x16_bf16 v[134:149], v[220:223], v[12:15], v[134:149]
    v_and_b32_dpp v30, v14, v11 wave_shr:1 row_mask:0xf bank_mask:0xf bound_ctrl:0
    v_and_b32_dpp v31, v15, v11 wave_shr:1 row_mask:0xf bank_mask:0xf bound_ctrl:0
    v_mfma_f32_32x32x16_bf16 v[118:133], v[216:219], v[40:43], v[118:133]
    ds_read2_b32 v[192:193], v44 offset0:16 offset1:17
    ds_read2_b32 v[194:195], v44 offset0:18 offset1:19
    v_and_b32_dpp v24, v40, v11 wave_shr:1 row_mask:0xf bank_mask:0xf bound_ctrl:0
    v_and_b32_dpp v25, v41, v11 wave_shr:1 row_mask:0xf bank_mask:0xf bound_ctrl:0
    s_waitcnt lgkmcnt(8)
    v_mfma_f32_32x32x16_bf16 v[134:149], v[224:227], v[40:43], v[134:149]
    v_and_b32_dpp v26, v42, v11 wave_shr:1 row_mask:0xf bank_mask:0xf bound_ctrl:0
    v_and_b32_dpp v27, v43, v11 wave_shr:1 row_mask:0xf bank_mask:0xf bound_ctrl:0
    v_mfma_f32_32x32x16_bf16 v[118:133], v[220:223], v[36:39], v[118:133]
    ds_read2_b32 v[196:197], v44 offset0:24 offset1:25
    ds_read2_b32 v[198:199], v44 offset0:26 offset1:27
    v_and_b32_dpp v20, v36, v11 wave_shr:1 row_mask:0xf bank_mask:0xf bound_ctrl:0
    v_and_b32_dpp v21, v37, v11 wave_shr:1 row_mask:0xf bank_mask:0xf bound_ctrl:0
    s_waitcnt lgkmcnt(8)
    v_mfma_f32_32x32x16_bf16 v[134:149], v[228:231], v[36:39], v[134:149]
    v_and_b32_dpp v22, v38, v11 wave_shr:1 row_mask:0xf bank_mask:0xf bound_ctrl:0
    v_and_b32_dpp v23, v39, v11 wave_shr:1 row_mask:0xf bank_mask:0xf bound_ctrl:0
    v_mfma_f32_32x32x16_bf16 v[118:133], v[224:227], v[32:35], v[118:133]
    ds_read2_b32 v[200:201], v44 offset0:32 offset1:33
    ds_read2_b32 v[202:203], v44 offset0:34 offset1:35
    v_and_b32_dpp v16, v32, v11 wave_shr:1 row_mask:0xf bank_mask:0xf bound_ctrl:0
    v_and_b32_dpp v17, v33, v11 wave_shr:1 row_mask:0xf bank_mask:0xf bound_ctrl:0
    s_waitcnt lgkmcnt(8)
    v_mfma_f32_32x32x16_bf16 v[134:149], v[184:187], v[32:35], v[134:149]
    v_and_b32_dpp v18, v34, v11 wave_shr:1 row_mask:0xf bank_mask:0xf bound_ctrl:0
    v_and_b32_dpp v19, v35, v11 wave_shr:1 row_mask:0xf bank_mask:0xf bound_ctrl:0
    v_mfma_f32_32x32x16_bf16 v[118:133], v[228:231], v[28:31], v[118:133]
    ds_read2_b32 v[204:205], v44 offset0:40 offset1:41
    ds_read2_b32 v[206:207], v44 offset0:42 offset1:43
    v_and_b32_dpp v12, v28, v11 wave_shr:1 row_mask:0xf bank_mask:0xf bound_ctrl:0
    v_and_b32_dpp v13, v29, v11 wave_shr:1 row_mask:0xf bank_mask:0xf bound_ctrl:0
    s_waitcnt lgkmcnt(8)
    v_mfma_f32_32x32x16_bf16 v[134:149], v[188:191], v[28:31], v[134:149]
    v_and_b32_dpp v14, v30, v11 wave_shr:1 row_mask:0xf bank_mask:0xf bound_ctrl:0
    v_and_b32_dpp v15, v31, v11 wave_shr:1 row_mask:0xf bank_mask:0xf bound_ctrl:0
    v_mfma_f32_32x32x16_bf16 v[118:133], v[184:187], v[24:27], v[118:133]
    ds_read2_b32 v[208:209], v44 offset0:48 offset1:49
    ds_read2_b32 v[210:211], v44 offset0:50 offset1:51
    v_and_b32_dpp v40, v24, v11 wave_shr:1 row_mask:0xf bank_mask:0xf bound_ctrl:0
    v_and_b32_dpp v41, v25, v11 wave_shr:1 row_mask:0xf bank_mask:0xf bound_ctrl:0
    s_waitcnt lgkmcnt(8)
    v_mfma_f32_32x32x16_bf16 v[134:149], v[192:195], v[24:27], v[134:149]
    v_and_b32_dpp v42, v26, v11 wave_shr:1 row_mask:0xf bank_mask:0xf bound_ctrl:0
    v_and_b32_dpp v43, v27, v11 wave_shr:1 row_mask:0xf bank_mask:0xf bound_ctrl:0
    v_mfma_f32_32x32x16_bf16 v[118:133], v[188:191], v[20:23], v[118:133]
    ds_read2_b32 v[212:213], v44 offset0:56 offset1:57
    ds_read2_b32 v[214:215], v44 offset0:58 offset1:59
    v_and_b32_dpp v36, v20, v11 wave_shr:1 row_mask:0xf bank_mask:0xf bound_ctrl:0
    v_and_b32_dpp v37, v21, v11 wave_shr:1 row_mask:0xf bank_mask:0xf bound_ctrl:0
    s_waitcnt lgkmcnt(8)
    v_mfma_f32_32x32x16_bf16 v[134:149], v[196:199], v[20:23], v[134:149]
    v_and_b32_dpp v38, v22, v11 wave_shr:1 row_mask:0xf bank_mask:0xf bound_ctrl:0
    v_and_b32_dpp v39, v23, v11 wave_shr:1 row_mask:0xf bank_mask:0xf bound_ctrl:0
    v_mfma_f32_32x32x16_bf16 v[118:133], v[192:195], v[16:19], v[118:133]
    ds_read2_b32 v[216:217], v44 offset0:64 offset1:65
    ds_read2_b32 v[218:219], v44 offset0:66 offset1:67
    v_and_b32_dpp v32, v16, v11 wave_shr:1 row_mask:0xf bank_mask:0xf bound_ctrl:0
    v_and_b32_dpp v33, v17, v11 wave_shr:1 row_mask:0xf bank_mask:0xf bound_ctrl:0
    s_waitcnt lgkmcnt(8)
    v_mfma_f32_32x32x16_bf16 v[134:149], v[200:203], v[16:19], v[134:149]
    v_and_b32_dpp v34, v18, v11 wave_shr:1 row_mask:0xf bank_mask:0xf bound_ctrl:0
    v_and_b32_dpp v35, v19, v11 wave_shr:1 row_mask:0xf bank_mask:0xf bound_ctrl:0
    v_mfma_f32_32x32x16_bf16 v[118:133], v[196:199], v[12:15], v[118:133]
    ds_read2_b32 v[220:221], v44 offset0:72 offset1:73
    ds_read2_b32 v[222:223], v44 offset0:74 offset1:75
    v_and_b32_dpp v28, v12, v11 wave_shr:1 row_mask:0xf bank_mask:0xf bound_ctrl:0
    v_and_b32_dpp v29, v13, v11 wave_shr:1 row_mask:0xf bank_mask:0xf bound_ctrl:0
    s_waitcnt lgkmcnt(8)
    v_mfma_f32_32x32x16_bf16 v[134:149], v[204:207], v[12:15], v[134:149]
    v_and_b32_dpp v30, v14, v11 wave_shr:1 row_mask:0xf bank_mask:0xf bound_ctrl:0
    v_and_b32_dpp v31, v15, v11 wave_shr:1 row_mask:0xf bank_mask:0xf bound_ctrl:0
    v_mfma_f32_32x32x16_bf16 v[118:133], v[200:203], v[40:43], v[118:133]
    ds_read2_b32 v[224:225], v44 offset0:80 offset1:81
    ds_read2_b32 v[226:227], v44 offset0:82 offset1:83
    v_and_b32_dpp v24, v40, v11 wave_shr:1 row_mask:0xf bank_mask:0xf bound_ctrl:0
    v_and_b32_dpp v25, v41, v11 wave_shr:1 row_mask:0xf bank_mask:0xf bound_ctrl:0
    s_waitcnt lgkmcnt(8)
    v_mfma_f32_32x32x16_bf16 v[134:149], v[208:211], v[40:43], v[134:149]
    v_and_b32_dpp v26, v42, v11 wave_shr:1 row_mask:0xf bank_mask:0xf bound_ctrl:0
    v_and_b32_dpp v27, v43, v11 wave_shr:1 row_mask:0xf bank_mask:0xf bound_ctrl:0
    v_mfma_f32_32x32x16_bf16 v[118:133], v[204:207], v[36:39], v[118:133]
    ds_read2_b32 v[228:229], v44 offset0:88 offset1:89
    ds_read2_b32 v[230:231], v44 offset0:90 offset1:91
    v_and_b32_dpp v20, v36, v11 wave_shr:1 row_mask:0xf bank_mask:0xf bound_ctrl:0
    v_and_b32_dpp v21, v37, v11 wave_shr:1 row_mask:0xf bank_mask:0xf bound_ctrl:0
    s_waitcnt lgkmcnt(8)
    v_mfma_f32_32x32x16_bf16 v[134:149], v[212:215], v[36:39], v[134:149]
    v_and_b32_dpp v22, v38, v11 wave_shr:1 row_mask:0xf bank_mask:0xf bound_ctrl:0
    v_and_b32_dpp v23, v39, v11 wave_shr:1 row_mask:0xf bank_mask:0xf bound_ctrl:0
    v_mfma_f32_32x32x16_bf16 v[118:133], v[208:211], v[32:35], v[118:133]
    ds_read2_b32 v[184:185], v44 offset0:96 offset1:97
    ds_read2_b32 v[186:187], v44 offset0:98 offset1:99
    v_and_b32_dpp v16, v32, v11 wave_shr:1 row_mask:0xf bank_mask:0xf bound_ctrl:0
    v_and_b32_dpp v17, v33, v11 wave_shr:1 row_mask:0xf bank_mask:0xf bound_ctrl:0
    s_waitcnt lgkmcnt(8)
    v_mfma_f32_32x32x16_bf16 v[134:149], v[216:219], v[32:35], v[134:149]
    v_and_b32_dpp v18, v34, v11 wave_shr:1 row_mask:0xf bank_mask:0xf bound_ctrl:0
    v_and_b32_dpp v19, v35, v11 wave_shr:1 row_mask:0xf bank_mask:0xf bound_ctrl:0
    v_mfma_f32_32x32x16_bf16 v[118:133], v[212:215], v[28:31], v[118:133]
    ds_read2_b32 v[188:189], v44 offset0:104 offset1:105
    ds_read2_b32 v[190:191], v44 offset0:106 offset1:107
    v_and_b32_dpp v12, v28, v11 wave_shr:1 row_mask:0xf bank_mask:0xf bound_ctrl:0
    v_and_b32_dpp v13, v29, v11 wave_shr:1 row_mask:0xf bank_mask:0xf bound_ctrl:0
    s_waitcnt lgkmcnt(8)
    v_mfma_f32_32x32x16_bf16 v[134:149], v[220:223], v[28:31], v[134:149]
    v_and_b32_dpp v14, v30, v11 wave_shr:1 row_mask:0xf bank_mask:0xf bound_ctrl:0
    v_and_b32_dpp v15, v31, v11 wave_shr:1 row_mask:0xf bank_mask:0xf bound_ctrl:0
    v_mfma_f32_32x32x16_bf16 v[118:133], v[216:219], v[24:27], v[118:133]
    ds_read2_b32 v[192:193], v44 offset0:112 offset1:113
    ds_read2_b32 v[194:195], v44 offset0:114 offset1:115
    v_and_b32_dpp v40, v24, v11 wave_shr:1 row_mask:0xf bank_mask:0xf bound_ctrl:0
    v_and_b32_dpp v41, v25, v11 wave_shr:1 row_mask:0xf bank_mask:0xf bound_ctrl:0
    s_waitcnt lgkmcnt(8)
    v_mfma_f32_32x32x16_bf16 v[134:149], v[224:227], v[24:27], v[134:149]
    v_and_b32_dpp v42, v26, v11 wave_shr:1 row_mask:0xf bank_mask:0xf bound_ctrl:0
    v_and_b32_dpp v43, v27, v11 wave_shr:1 row_mask:0xf bank_mask:0xf bound_ctrl:0
    v_mfma_f32_32x32x16_bf16 v[118:133], v[220:223], v[20:23], v[118:133]
    ds_read2_b32 v[196:197], v44 offset0:120 offset1:121
    ds_read2_b32 v[198:199], v44 offset0:122 offset1:123
    v_and_b32_dpp v36, v20, v11 wave_shr:1 row_mask:0xf bank_mask:0xf bound_ctrl:0
    v_and_b32_dpp v37, v21, v11 wave_shr:1 row_mask:0xf bank_mask:0xf bound_ctrl:0
    s_waitcnt lgkmcnt(8)
    v_mfma_f32_32x32x16_bf16 v[134:149], v[228:231], v[20:23], v[134:149]
    v_and_b32_dpp v38, v22, v11 wave_shr:1 row_mask:0xf bank_mask:0xf bound_ctrl:0
    v_and_b32_dpp v39, v23, v11 wave_shr:1 row_mask:0xf bank_mask:0xf bound_ctrl:0
    v_mfma_f32_32x32x16_bf16 v[118:133], v[224:227], v[16:19], v[118:133]
    ds_read2_b32 v[200:201], v44 offset0:128 offset1:129
    ds_read2_b32 v[202:203], v44 offset0:130 offset1:131
    v_and_b32_dpp v32, v16, v11 wave_shr:1 row_mask:0xf bank_mask:0xf bound_ctrl:0
    v_and_b32_dpp v33, v17, v11 wave_shr:1 row_mask:0xf bank_mask:0xf bound_ctrl:0
    s_waitcnt lgkmcnt(8)
    v_mfma_f32_32x32x16_bf16 v[134:149], v[184:187], v[16:19], v[134:149]
    v_and_b32_dpp v34, v18, v11 wave_shr:1 row_mask:0xf bank_mask:0xf bound_ctrl:0
    v_and_b32_dpp v35, v19, v11 wave_shr:1 row_mask:0xf bank_mask:0xf bound_ctrl:0
    v_mfma_f32_32x32x16_bf16 v[118:133], v[228:231], v[12:15], v[118:133]
    ds_read2_b32 v[204:205], v44 offset0:136 offset1:137
    ds_read2_b32 v[206:207], v44 offset0:138 offset1:139
    v_and_b32_dpp v28, v12, v11 wave_shr:1 row_mask:0xf bank_mask:0xf bound_ctrl:0
    v_and_b32_dpp v29, v13, v11 wave_shr:1 row_mask:0xf bank_mask:0xf bound_ctrl:0
    s_waitcnt lgkmcnt(8)
    v_mfma_f32_32x32x16_bf16 v[134:149], v[188:191], v[12:15], v[134:149]
    v_and_b32_dpp v30, v14, v11 wave_shr:1 row_mask:0xf bank_mask:0xf bound_ctrl:0
    v_and_b32_dpp v31, v15, v11 wave_shr:1 row_mask:0xf bank_mask:0xf bound_ctrl:0
    v_mfma_f32_32x32x16_bf16 v[118:133], v[184:187], v[40:43], v[118:133]
    ds_read2_b32 v[208:209], v44 offset0:144 offset1:145
    ds_read2_b32 v[210:211], v44 offset0:146 offset1:147
    v_and_b32_dpp v24, v40, v11 wave_shr:1 row_mask:0xf bank_mask:0xf bound_ctrl:0
    v_and_b32_dpp v25, v41, v11 wave_shr:1 row_mask:0xf bank_mask:0xf bound_ctrl:0
    s_waitcnt lgkmcnt(8)
    v_mfma_f32_32x32x16_bf16 v[134:149], v[192:195], v[40:43], v[134:149]
    v_and_b32_dpp v26, v42, v11 wave_shr:1 row_mask:0xf bank_mask:0xf bound_ctrl:0
    v_and_b32_dpp v27, v43, v11 wave_shr:1 row_mask:0xf bank_mask:0xf bound_ctrl:0
    v_mfma_f32_32x32x16_bf16 v[118:133], v[188:191], v[36:39], v[118:133]
    ds_read2_b32 v[212:213], v44 offset0:152 offset1:153
    ds_read2_b32 v[214:215], v44 offset0:154 offset1:155
    v_and_b32_dpp v20, v36, v11 wave_shr:1 row_mask:0xf bank_mask:0xf bound_ctrl:0
    v_and_b32_dpp v21, v37, v11 wave_shr:1 row_mask:0xf bank_mask:0xf bound_ctrl:0
    s_waitcnt lgkmcnt(8)
    v_mfma_f32_32x32x16_bf16 v[134:149], v[196:199], v[36:39], v[134:149]
    v_and_b32_dpp v22, v38, v11 wave_shr:1 row_mask:0xf bank_mask:0xf bound_ctrl:0
    v_and_b32_dpp v23, v39, v11 wave_shr:1 row_mask:0xf bank_mask:0xf bound_ctrl:0
    v_mfma_f32_32x32x16_bf16 v[118:133], v[192:195], v[32:35], v[118:133]
    ds_read2_b32 v[216:217], v44 offset0:160 offset1:161
    ds_read2_b32 v[218:219], v44 offset0:162 offset1:163
    v_and_b32_dpp v16, v32, v11 wave_shr:1 row_mask:0xf bank_mask:0xf bound_ctrl:0
    v_and_b32_dpp v17, v33, v11 wave_shr:1 row_mask:0xf bank_mask:0xf bound_ctrl:0
    s_waitcnt lgkmcnt(8)
    v_mfma_f32_32x32x16_bf16 v[134:149], v[200:203], v[32:35], v[134:149]
    v_and_b32_dpp v18, v34, v11 wave_shr:1 row_mask:0xf bank_mask:0xf bound_ctrl:0
    v_and_b32_dpp v19, v35, v11 wave_shr:1 row_mask:0xf bank_mask:0xf bound_ctrl:0
    v_mfma_f32_32x32x16_bf16 v[118:133], v[196:199], v[28:31], v[118:133]
    ds_read2_b32 v[220:221], v44 offset0:168 offset1:169
    ds_read2_b32 v[222:223], v44 offset0:170 offset1:171
    v_and_b32_dpp v12, v28, v11 wave_shr:1 row_mask:0xf bank_mask:0xf bound_ctrl:0
    v_and_b32_dpp v13, v29, v11 wave_shr:1 row_mask:0xf bank_mask:0xf bound_ctrl:0
    s_waitcnt lgkmcnt(8)
    v_mfma_f32_32x32x16_bf16 v[134:149], v[204:207], v[28:31], v[134:149]
    v_and_b32_dpp v14, v30, v11 wave_shr:1 row_mask:0xf bank_mask:0xf bound_ctrl:0
    v_and_b32_dpp v15, v31, v11 wave_shr:1 row_mask:0xf bank_mask:0xf bound_ctrl:0
    v_mfma_f32_32x32x16_bf16 v[118:133], v[200:203], v[24:27], v[118:133]
    ds_read2_b32 v[224:225], v44 offset0:176 offset1:177
    ds_read2_b32 v[226:227], v44 offset0:178 offset1:179
    v_and_b32_dpp v40, v24, v11 wave_shr:1 row_mask:0xf bank_mask:0xf bound_ctrl:0
    v_and_b32_dpp v41, v25, v11 wave_shr:1 row_mask:0xf bank_mask:0xf bound_ctrl:0
    s_waitcnt lgkmcnt(8)
    v_mfma_f32_32x32x16_bf16 v[134:149], v[208:211], v[24:27], v[134:149]
    v_and_b32_dpp v42, v26, v11 wave_shr:1 row_mask:0xf bank_mask:0xf bound_ctrl:0
    v_and_b32_dpp v43, v27, v11 wave_shr:1 row_mask:0xf bank_mask:0xf bound_ctrl:0
    v_mfma_f32_32x32x16_bf16 v[118:133], v[204:207], v[20:23], v[118:133]
    ds_read2_b32 v[228:229], v44 offset0:184 offset1:185
    ds_read2_b32 v[230:231], v44 offset0:186 offset1:187
    v_and_b32_dpp v36, v20, v11 wave_shr:1 row_mask:0xf bank_mask:0xf bound_ctrl:0
    v_and_b32_dpp v37, v21, v11 wave_shr:1 row_mask:0xf bank_mask:0xf bound_ctrl:0
    s_waitcnt lgkmcnt(8)
    v_mfma_f32_32x32x16_bf16 v[134:149], v[212:215], v[20:23], v[134:149]
    v_and_b32_dpp v38, v22, v11 wave_shr:1 row_mask:0xf bank_mask:0xf bound_ctrl:0
    v_and_b32_dpp v39, v23, v11 wave_shr:1 row_mask:0xf bank_mask:0xf bound_ctrl:0
    v_mfma_f32_32x32x16_bf16 v[118:133], v[208:211], v[16:19], v[118:133]
    ds_read2_b32 v[184:185], v44 offset0:192 offset1:193
    ds_read2_b32 v[186:187], v44 offset0:194 offset1:195
    v_and_b32_dpp v32, v16, v11 wave_shr:1 row_mask:0xf bank_mask:0xf bound_ctrl:0
    v_and_b32_dpp v33, v17, v11 wave_shr:1 row_mask:0xf bank_mask:0xf bound_ctrl:0
    s_waitcnt lgkmcnt(8)
    v_mfma_f32_32x32x16_bf16 v[134:149], v[216:219], v[16:19], v[134:149]
    v_and_b32_dpp v34, v18, v11 wave_shr:1 row_mask:0xf bank_mask:0xf bound_ctrl:0
    v_and_b32_dpp v35, v19, v11 wave_shr:1 row_mask:0xf bank_mask:0xf bound_ctrl:0
    v_mfma_f32_32x32x16_bf16 v[118:133], v[212:215], v[12:15], v[118:133]
    ds_read2_b32 v[188:189], v44 offset0:200 offset1:201
    ds_read2_b32 v[190:191], v44 offset0:202 offset1:203
    v_and_b32_dpp v28, v12, v11 wave_shr:1 row_mask:0xf bank_mask:0xf bound_ctrl:0
    v_and_b32_dpp v29, v13, v11 wave_shr:1 row_mask:0xf bank_mask:0xf bound_ctrl:0
    s_waitcnt lgkmcnt(8)
    v_mfma_f32_32x32x16_bf16 v[134:149], v[220:223], v[12:15], v[134:149]
    v_and_b32_dpp v30, v14, v11 wave_shr:1 row_mask:0xf bank_mask:0xf bound_ctrl:0
    v_and_b32_dpp v31, v15, v11 wave_shr:1 row_mask:0xf bank_mask:0xf bound_ctrl:0
    v_mfma_f32_32x32x16_bf16 v[118:133], v[216:219], v[40:43], v[118:133]
    ds_read2_b32 v[192:193], v44 offset0:208 offset1:209
    ds_read2_b32 v[194:195], v44 offset0:210 offset1:211
    v_and_b32_dpp v24, v40, v11 wave_shr:1 row_mask:0xf bank_mask:0xf bound_ctrl:0
    v_and_b32_dpp v25, v41, v11 wave_shr:1 row_mask:0xf bank_mask:0xf bound_ctrl:0
    s_waitcnt lgkmcnt(8)
    v_mfma_f32_32x32x16_bf16 v[134:149], v[224:227], v[40:43], v[134:149]
    v_and_b32_dpp v26, v42, v11 wave_shr:1 row_mask:0xf bank_mask:0xf bound_ctrl:0
    v_and_b32_dpp v27, v43, v11 wave_shr:1 row_mask:0xf bank_mask:0xf bound_ctrl:0
    v_mfma_f32_32x32x16_bf16 v[118:133], v[220:223], v[36:39], v[118:133]
    ds_read2_b32 v[196:197], v44 offset0:216 offset1:217
    ds_read2_b32 v[198:199], v44 offset0:218 offset1:219
    v_and_b32_dpp v20, v36, v11 wave_shr:1 row_mask:0xf bank_mask:0xf bound_ctrl:0
    v_and_b32_dpp v21, v37, v11 wave_shr:1 row_mask:0xf bank_mask:0xf bound_ctrl:0
    s_waitcnt lgkmcnt(8)
    v_mfma_f32_32x32x16_bf16 v[134:149], v[228:231], v[36:39], v[134:149]
    v_and_b32_dpp v22, v38, v11 wave_shr:1 row_mask:0xf bank_mask:0xf bound_ctrl:0
    v_and_b32_dpp v23, v39, v11 wave_shr:1 row_mask:0xf bank_mask:0xf bound_ctrl:0
    v_mfma_f32_32x32x16_bf16 v[118:133], v[224:227], v[32:35], v[118:133]
    ds_read2_b32 v[200:201], v44 offset0:224 offset1:225
    ds_read2_b32 v[202:203], v44 offset0:226 offset1:227
    v_and_b32_dpp v16, v32, v11 wave_shr:1 row_mask:0xf bank_mask:0xf bound_ctrl:0
    v_and_b32_dpp v17, v33, v11 wave_shr:1 row_mask:0xf bank_mask:0xf bound_ctrl:0
    s_waitcnt lgkmcnt(8)
    v_mfma_f32_32x32x16_bf16 v[134:149], v[184:187], v[32:35], v[134:149]
    v_and_b32_dpp v18, v34, v11 wave_shr:1 row_mask:0xf bank_mask:0xf bound_ctrl:0
    v_and_b32_dpp v19, v35, v11 wave_shr:1 row_mask:0xf bank_mask:0xf bound_ctrl:0
    v_mfma_f32_32x32x16_bf16 v[118:133], v[228:231], v[28:31], v[118:133]
    ds_read2_b32 v[204:205], v44 offset0:232 offset1:233
    ds_read2_b32 v[206:207], v44 offset0:234 offset1:235
    v_and_b32_dpp v12, v28, v11 wave_shr:1 row_mask:0xf bank_mask:0xf bound_ctrl:0
    v_and_b32_dpp v13, v29, v11 wave_shr:1 row_mask:0xf bank_mask:0xf bound_ctrl:0
    s_waitcnt lgkmcnt(8)
    v_mfma_f32_32x32x16_bf16 v[134:149], v[188:191], v[28:31], v[134:149]
    v_and_b32_dpp v14, v30, v11 wave_shr:1 row_mask:0xf bank_mask:0xf bound_ctrl:0
    v_and_b32_dpp v15, v31, v11 wave_shr:1 row_mask:0xf bank_mask:0xf bound_ctrl:0
    v_mfma_f32_32x32x16_bf16 v[118:133], v[184:187], v[24:27], v[118:133]
    ds_read2_b32 v[208:209], v44 offset0:240 offset1:241
    ds_read2_b32 v[210:211], v44 offset0:242 offset1:243
    v_and_b32_dpp v40, v24, v11 wave_shr:1 row_mask:0xf bank_mask:0xf bound_ctrl:0
    v_and_b32_dpp v41, v25, v11 wave_shr:1 row_mask:0xf bank_mask:0xf bound_ctrl:0
    s_waitcnt lgkmcnt(8)
    v_mfma_f32_32x32x16_bf16 v[134:149], v[192:195], v[24:27], v[134:149]
    v_and_b32_dpp v42, v26, v11 wave_shr:1 row_mask:0xf bank_mask:0xf bound_ctrl:0
    v_and_b32_dpp v43, v27, v11 wave_shr:1 row_mask:0xf bank_mask:0xf bound_ctrl:0
    v_mfma_f32_32x32x16_bf16 v[118:133], v[188:191], v[20:23], v[118:133]
    ds_read2_b32 v[212:213], v44 offset0:248 offset1:249
    ds_read2_b32 v[214:215], v44 offset0:250 offset1:251
    v_and_b32_dpp v36, v20, v11 wave_shr:1 row_mask:0xf bank_mask:0xf bound_ctrl:0
    v_and_b32_dpp v37, v21, v11 wave_shr:1 row_mask:0xf bank_mask:0xf bound_ctrl:0
    s_waitcnt lgkmcnt(8)
    v_mfma_f32_32x32x16_bf16 v[134:149], v[196:199], v[20:23], v[134:149]
    v_and_b32_dpp v38, v22, v11 wave_shr:1 row_mask:0xf bank_mask:0xf bound_ctrl:0
    v_and_b32_dpp v39, v23, v11 wave_shr:1 row_mask:0xf bank_mask:0xf bound_ctrl:0
    v_mfma_f32_32x32x16_bf16 v[118:133], v[192:195], v[16:19], v[118:133]
    v_add_u32 v44, 1024, v44
    ds_read2_b32 v[216:217], v44 offset0:0 offset1:1
    ds_read2_b32 v[218:219], v44 offset0:2 offset1:3
    v_and_b32_dpp v32, v16, v11 wave_shr:1 row_mask:0xf bank_mask:0xf bound_ctrl:0
    v_and_b32_dpp v33, v17, v11 wave_shr:1 row_mask:0xf bank_mask:0xf bound_ctrl:0
    s_waitcnt lgkmcnt(8)
    v_mfma_f32_32x32x16_bf16 v[134:149], v[200:203], v[16:19], v[134:149]
    v_and_b32_dpp v34, v18, v11 wave_shr:1 row_mask:0xf bank_mask:0xf bound_ctrl:0
    v_and_b32_dpp v35, v19, v11 wave_shr:1 row_mask:0xf bank_mask:0xf bound_ctrl:0
    v_mfma_f32_32x32x16_bf16 v[118:133], v[196:199], v[12:15], v[118:133]
    ds_read2_b32 v[220:221], v44 offset0:8 offset1:9
    ds_read2_b32 v[222:223], v44 offset0:10 offset1:11
    v_and_b32_dpp v28, v12, v11 wave_shr:1 row_mask:0xf bank_mask:0xf bound_ctrl:0
    v_and_b32_dpp v29, v13, v11 wave_shr:1 row_mask:0xf bank_mask:0xf bound_ctrl:0
    s_waitcnt lgkmcnt(8)
    v_mfma_f32_32x32x16_bf16 v[134:149], v[204:207], v[12:15], v[134:149]
    v_and_b32_dpp v30, v14, v11 wave_shr:1 row_mask:0xf bank_mask:0xf bound_ctrl:0
    v_and_b32_dpp v31, v15, v11 wave_shr:1 row_mask:0xf bank_mask:0xf bound_ctrl:0
    v_mfma_f32_32x32x16_bf16 v[118:133], v[200:203], v[40:43], v[118:133]
    s_waitcnt lgkmcnt(6)
    v_mfma_f32_32x32x16_bf16 v[134:149], v[208:211], v[40:43], v[134:149]
    v_mfma_f32_32x32x16_bf16 v[118:133], v[204:207], v[36:39], v[118:133]
    s_waitcnt lgkmcnt(4)
    v_mfma_f32_32x32x16_bf16 v[134:149], v[212:215], v[36:39], v[134:149]
    v_mfma_f32_32x32x16_bf16 v[118:133], v[208:211], v[32:35], v[118:133]
    s_waitcnt lgkmcnt(2)
    v_mfma_f32_32x32x16_bf16 v[134:149], v[216:219], v[32:35], v[134:149]
    v_mfma_f32_32x32x16_bf16 v[118:133], v[212:215], v[28:31], v[118:133]
    s_waitcnt lgkmcnt(0)
    v_mfma_f32_32x32x16_bf16 v[134:149], v[220:223], v[28:31], v[134:149]
    s_nop 3
    v_cvt_pk_bf16_f32 v118, v118, v119
    v_cvt_pk_bf16_f32 v119, v120, v121
    ds_write_b64 v10, v[118:119] offset:0
    v_cvt_pk_bf16_f32 v122, v122, v123
    v_cvt_pk_bf16_f32 v123, v124, v125
    ds_write_b64 v10, v[122:123] offset:16
    v_cvt_pk_bf16_f32 v126, v126, v127
    v_cvt_pk_bf16_f32 v127, v128, v129
    ds_write_b64 v10, v[126:127] offset:32
    v_cvt_pk_bf16_f32 v130, v130, v131
    v_cvt_pk_bf16_f32 v131, v132, v133
    ds_write_b64 v10, v[130:131] offset:48
    v_cvt_pk_bf16_f32 v134, v134, v135
    v_cvt_pk_bf16_f32 v135, v136, v137
    ds_write_b64 v10, v[134:135] offset:64
    v_cvt_pk_bf16_f32 v138, v138, v139
    v_cvt_pk_bf16_f32 v139, v140, v141
    ds_write_b64 v10, v[138:139] offset:80
    v_cvt_pk_bf16_f32 v142, v142, v143
    v_cvt_pk_bf16_f32 v143, v144, v145
    ds_write_b64 v10, v[142:143] offset:96
    v_cvt_pk_bf16_f32 v146, v146, v147
    v_cvt_pk_bf16_f32 v147, v148, v149
    ds_write_b64 v10, v[146:147] offset:112
    v_add_u32 v9, 4096, v9
    v_add_u32 v10, 4096, v10
    v_add_u32 v8, 8576, v8
    s_add_u32 s41, s41, 1
    s_waitcnt lgkmcnt(0)
    s_cmp_lt_u32 s41, 2
    s_cbranch_scc1 L_ssm_ch
    s_barrier
    ds_read_b128 v[184:187], v117 offset:0
    ds_read_b128 v[188:191], v117 offset:4096
    ds_read_b128 v[192:195], v117 offset:8192
    ds_read_b128 v[196:199], v117 offset:12288
    ds_read_b128 v[200:203], v117 offset:16384
    ds_read_b128 v[204:207], v117 offset:20480
    ds_read_b128 v[208:211], v117 offset:24576
    ds_read_b128 v[212:215], v117 offset:28672
    s_mov_b32 s40, 184549376
    s_waitcnt lgkmcnt(7)
    v_lshlrev_b32 v28, 16, v184
    v_and_b32 v36, 0xffff0000, v87
    s_waitcnt vmcnt(7)
    v_lshlrev_b32 v37, 16, v52
    v_fmac_f32 v28, s84, v36
    v_mul_f32 v28, v28, v37
    s_waitcnt lgkmcnt(6)
    v_lshlrev_b32 v29, 16, v188
    v_and_b32 v38, 0xffff0000, v91
    v_and_b32 v39, 0xffff0000, v52
    v_fmac_f32 v29, s85, v38
    v_mul_f32 v29, v29, v39
    s_waitcnt lgkmcnt(5)
    v_lshlrev_b32 v30, 16, v192
    v_and_b32 v36, 0xffff0000, v95
    v_lshlrev_b32 v37, 16, v53
    v_fmac_f32 v30, s86, v36
    v_mul_f32 v30, v30, v37
    s_waitcnt lgkmcnt(4)
    v_lshlrev_b32 v31, 16, v196
    v_and_b32 v38, 0xffff0000, v99
    v_and_b32 v39, 0xffff0000, v53
    v_fmac_f32 v31, s87, v38
    v_mul_f32 v31, v31, v39
    s_waitcnt lgkmcnt(3)
    v_lshlrev_b32 v32, 16, v200
    v_and_b32 v36, 0xffff0000, v103
    v_lshlrev_b32 v37, 16, v54
    v_fmac_f32 v32, s88, v36
    v_mul_f32 v32, v32, v37
    s_waitcnt lgkmcnt(2)
    v_lshlrev_b32 v33, 16, v204
    v_and_b32 v38, 0xffff0000, v107
    v_and_b32 v39, 0xffff0000, v54
    v_fmac_f32 v33, s89, v38
    v_mul_f32 v33, v33, v39
    s_waitcnt lgkmcnt(1)
    v_lshlrev_b32 v34, 16, v208
    v_and_b32 v36, 0xffff0000, v111
    v_lshlrev_b32 v37, 16, v55
    v_fmac_f32 v34, s90, v36
    v_mul_f32 v34, v34, v37
    s_waitcnt lgkmcnt(0)
    v_lshlrev_b32 v35, 16, v212
    v_and_b32 v38, 0xffff0000, v115
    v_and_b32 v39, 0xffff0000, v55
    v_fmac_f32 v35, s91, v38
    v_mul_f32 v35, v35, v39
    v_cvt_pk_bf16_f32 v12, v28, v29
    v_cvt_pk_bf16_f32 v13, v30, v31
    v_cvt_pk_bf16_f32 v14, v32, v33
    v_cvt_pk_bf16_f32 v15, v34, v35
    buffer_store_dwordx4 v[12:15], v7, s[8:11], s40 offen offset:0 sc1
    v_and_b32 v28, 0xffff0000, v184
    v_lshlrev_b32 v36, 16, v87
    s_waitcnt vmcnt(7)
    v_lshlrev_b32 v37, 16, v56
    v_fmac_f32 v28, s84, v36
    v_mul_f32 v28, v28, v37
    v_and_b32 v29, 0xffff0000, v188
    v_lshlrev_b32 v38, 16, v91
    v_and_b32 v39, 0xffff0000, v56
    v_fmac_f32 v29, s85, v38
    v_mul_f32 v29, v29, v39
    v_and_b32 v30, 0xffff0000, v192
    v_lshlrev_b32 v36, 16, v95
    v_lshlrev_b32 v37, 16, v57
    v_fmac_f32 v30, s86, v36
    v_mul_f32 v30, v30, v37
    v_and_b32 v31, 0xffff0000, v196
    v_lshlrev_b32 v38, 16, v99
    v_and_b32 v39, 0xffff0000, v57
    v_fmac_f32 v31, s87, v38
    v_mul_f32 v31, v31, v39
    v_and_b32 v32, 0xffff0000, v200
    v_lshlrev_b32 v36, 16, v103
    v_lshlrev_b32 v37, 16, v58
    v_fmac_f32 v32, s88, v36
    v_mul_f32 v32, v32, v37
    v_and_b32 v33, 0xffff0000, v204
    v_lshlrev_b32 v38, 16, v107
    v_and_b32 v39, 0xffff0000, v58
    v_fmac_f32 v33, s89, v38
    v_mul_f32 v33, v33, v39
    v_and_b32 v34, 0xffff0000, v208
    v_lshlrev_b32 v36, 16, v111
    v_lshlrev_b32 v37, 16, v59
    v_fmac_f32 v34, s90, v36
    v_mul_f32 v34, v34, v37
    v_and_b32 v35, 0xffff0000, v212
    v_lshlrev_b32 v38, 16, v115
    v_and_b32 v39, 0xffff0000, v59
    v_fmac_f32 v35, s91, v38
    v_mul_f32 v35, v35, v39
    v_cvt_pk_bf16_f32 v16, v28, v29
    v_cvt_pk_bf16_f32 v17, v30, v31
    v_cvt_pk_bf16_f32 v18, v32, v33
    v_cvt_pk_bf16_f32 v19, v34, v35
    buffer_store_dwordx4 v[16:19], v7, s[8:11], s40 offen offset:1024 sc1
    v_lshlrev_b32 v28, 16, v185
    v_and_b32 v36, 0xffff0000, v86
    s_waitcnt vmcnt(7)
    v_lshlrev_b32 v37, 16, v60
    v_fmac_f32 v28, s84, v36
    v_mul_f32 v28, v28, v37
    v_lshlrev_b32 v29, 16, v189
    v_and_b32 v38, 0xffff0000, v90
    v_and_b32 v39, 0xffff0000, v60
    v_fmac_f32 v29, s85, v38
    v_mul_f32 v29, v29, v39
    v_lshlrev_b32 v30, 16, v193
    v_and_b32 v36, 0xffff0000, v94
    v_lshlrev_b32 v37, 16, v61
    v_fmac_f32 v30, s86, v36
    v_mul_f32 v30, v30, v37
    v_lshlrev_b32 v31, 16, v197
    v_and_b32 v38, 0xffff0000, v98
    v_and_b32 v39, 0xffff0000, v61
    v_fmac_f32 v31, s87, v38
    v_mul_f32 v31, v31, v39
    v_lshlrev_b32 v32, 16, v201
    v_and_b32 v36, 0xffff0000, v102
    v_lshlrev_b32 v37, 16, v62
    v_fmac_f32 v32, s88, v36
    v_mul_f32 v32, v32, v37
    v_lshlrev_b32 v33, 16, v205
    v_and_b32 v38, 0xffff0000, v106
    v_and_b32 v39, 0xffff0000, v62
    v_fmac_f32 v33, s89, v38
    v_mul_f32 v33, v33, v39
    v_lshlrev_b32 v34, 16, v209
    v_and_b32 v36, 0xffff0000, v110
    v_lshlrev_b32 v37, 16, v63
    v_fmac_f32 v34, s90, v36
    v_mul_f32 v34, v34, v37
    v_lshlrev_b32 v35, 16, v213
    v_and_b32 v38, 0xffff0000, v114
    v_and_b32 v39, 0xffff0000, v63
    v_fmac_f32 v35, s91, v38
    v_mul_f32 v35, v35, v39
    v_cvt_pk_bf16_f32 v20, v28, v29
    v_cvt_pk_bf16_f32 v21, v30, v31
    v_cvt_pk_bf16_f32 v22, v32, v33
    v_cvt_pk_bf16_f32 v23, v34, v35
    buffer_store_dwordx4 v[20:23], v7, s[8:11], s40 offen offset:2048 sc1
    v_and_b32 v28, 0xffff0000, v185
    v_lshlrev_b32 v36, 16, v86
    s_waitcnt vmcnt(7)
    v_lshlrev_b32 v37, 16, v64
    v_fmac_f32 v28, s84, v36
    v_mul_f32 v28, v28, v37
    v_and_b32 v29, 0xffff0000, v189
    v_lshlrev_b32 v38, 16, v90
    v_and_b32 v39, 0xffff0000, v64
    v_fmac_f32 v29, s85, v38
    v_mul_f32 v29, v29, v39
    v_and_b32 v30, 0xffff0000, v193
    v_lshlrev_b32 v36, 16, v94
    v_lshlrev_b32 v37, 16, v65
    v_fmac_f32 v30, s86, v36
    v_mul_f32 v30, v30, v37
    v_and_b32 v31, 0xffff0000, v197
    v_lshlrev_b32 v38, 16, v98
    v_and_b32 v39, 0xffff0000, v65
    v_fmac_f32 v31, s87, v38
    v_mul_f32 v31, v31, v39
    v_and_b32 v32, 0xffff0000, v201
    v_lshlrev_b32 v36, 16, v102
    v_lshlrev_b32 v37, 16, v66
    v_fmac_f32 v32, s88, v36
    v_mul_f32 v32, v32, v37
    v_and_b32 v33, 0xffff0000, v205
    v_lshlrev_b32 v38, 16, v106
    v_and_b32 v39, 0xffff0000, v66
    v_fmac_f32 v33, s89, v38
    v_mul_f32 v33, v33, v39
    v_and_b32 v34, 0xffff0000, v209
    v_lshlrev_b32 v36, 16, v110
    v_lshlrev_b32 v37, 16, v67
    v_fmac_f32 v34, s90, v36
    v_mul_f32 v34, v34, v37
    v_and_b32 v35, 0xffff0000, v213
    v_lshlrev_b32 v38, 16, v114
    v_and_b32 v39, 0xffff0000, v67
    v_fmac_f32 v35, s91, v38
    v_mul_f32 v35, v35, v39
    v_cvt_pk_bf16_f32 v24, v28, v29
    v_cvt_pk_bf16_f32 v25, v30, v31
    v_cvt_pk_bf16_f32 v26, v32, v33
    v_cvt_pk_bf16_f32 v27, v34, v35
    buffer_store_dwordx4 v[24:27], v7, s[8:11], s40 offen offset:3072 sc1
    v_lshlrev_b32 v28, 16, v186
    v_and_b32 v36, 0xffff0000, v85
    s_waitcnt vmcnt(7)
    v_lshlrev_b32 v37, 16, v68
    v_fmac_f32 v28, s84, v36
    v_mul_f32 v28, v28, v37
    v_lshlrev_b32 v29, 16, v190
    v_and_b32 v38, 0xffff0000, v89
    v_and_b32 v39, 0xffff0000, v68
    v_fmac_f32 v29, s85, v38
    v_mul_f32 v29, v29, v39
    v_lshlrev_b32 v30, 16, v194
    v_and_b32 v36, 0xffff0000, v93
    v_lshlrev_b32 v37, 16, v69
    v_fmac_f32 v30, s86, v36
    v_mul_f32 v30, v30, v37
    v_lshlrev_b32 v31, 16, v198
    v_and_b32 v38, 0xffff0000, v97
    v_and_b32 v39, 0xffff0000, v69
    v_fmac_f32 v31, s87, v38
    v_mul_f32 v31, v31, v39
    v_lshlrev_b32 v32, 16, v202
    v_and_b32 v36, 0xffff0000, v101
    v_lshlrev_b32 v37, 16, v70
    v_fmac_f32 v32, s88, v36
    v_mul_f32 v32, v32, v37
    v_lshlrev_b32 v33, 16, v206
    v_and_b32 v38, 0xffff0000, v105
    v_and_b32 v39, 0xffff0000, v70
    v_fmac_f32 v33, s89, v38
    v_mul_f32 v33, v33, v39
    v_lshlrev_b32 v34, 16, v210
    v_and_b32 v36, 0xffff0000, v109
    v_lshlrev_b32 v37, 16, v71
    v_fmac_f32 v34, s90, v36
    v_mul_f32 v34, v34, v37
    v_lshlrev_b32 v35, 16, v214
    v_and_b32 v38, 0xffff0000, v113
    v_and_b32 v39, 0xffff0000, v71
    v_fmac_f32 v35, s91, v38
    v_mul_f32 v35, v35, v39
    v_cvt_pk_bf16_f32 v12, v28, v29
    v_cvt_pk_bf16_f32 v13, v30, v31
    v_cvt_pk_bf16_f32 v14, v32, v33
    v_cvt_pk_bf16_f32 v15, v34, v35
    buffer_store_dwordx4 v[12:15], v116, s[8:11], s40 offen offset:0 sc1
    v_and_b32 v28, 0xffff0000, v186
    v_lshlrev_b32 v36, 16, v85
    s_waitcnt vmcnt(7)
    v_lshlrev_b32 v37, 16, v72
    v_fmac_f32 v28, s84, v36
    v_mul_f32 v28, v28, v37
    v_and_b32 v29, 0xffff0000, v190
    v_lshlrev_b32 v38, 16, v89
    v_and_b32 v39, 0xffff0000, v72
    v_fmac_f32 v29, s85, v38
    v_mul_f32 v29, v29, v39
    v_and_b32 v30, 0xffff0000, v194
    v_lshlrev_b32 v36, 16, v93
    v_lshlrev_b32 v37, 16, v73
    v_fmac_f32 v30, s86, v36
    v_mul_f32 v30, v30, v37
    v_and_b32 v31, 0xffff0000, v198
    v_lshlrev_b32 v38, 16, v97
    v_and_b32 v39, 0xffff0000, v73
    v_fmac_f32 v31, s87, v38
    v_mul_f32 v31, v31, v39
    v_and_b32 v32, 0xffff0000, v202
    v_lshlrev_b32 v36, 16, v101
    v_lshlrev_b32 v37, 16, v74
    v_fmac_f32 v32, s88, v36
    v_mul_f32 v32, v32, v37
    v_and_b32 v33, 0xffff0000, v206
    v_lshlrev_b32 v38, 16, v105
    v_and_b32 v39, 0xffff0000, v74
    v_fmac_f32 v33, s89, v38
    v_mul_f32 v33, v33, v39
    v_and_b32 v34, 0xffff0000, v210
    v_lshlrev_b32 v36, 16, v109
    v_lshlrev_b32 v37, 16, v75
    v_fmac_f32 v34, s90, v36
    v_mul_f32 v34, v34, v37
    v_and_b32 v35, 0xffff0000, v214
    v_lshlrev_b32 v38, 16, v113
    v_and_b32 v39, 0xffff0000, v75
    v_fmac_f32 v35, s91, v38
    v_mul_f32 v35, v35, v39
    v_cvt_pk_bf16_f32 v16, v28, v29
    v_cvt_pk_bf16_f32 v17, v30, v31
    v_cvt_pk_bf16_f32 v18, v32, v33
    v_cvt_pk_bf16_f32 v19, v34, v35
    buffer_store_dwordx4 v[16:19], v116, s[8:11], s40 offen offset:1024 sc1
    v_lshlrev_b32 v28, 16, v187
    v_and_b32 v36, 0xffff0000, v84
    s_waitcnt vmcnt(7)
    v_lshlrev_b32 v37, 16, v76
    v_fmac_f32 v28, s84, v36
    v_mul_f32 v28, v28, v37
    v_lshlrev_b32 v29, 16, v191
    v_and_b32 v38, 0xffff0000, v88
    v_and_b32 v39, 0xffff0000, v76
    v_fmac_f32 v29, s85, v38
    v_mul_f32 v29, v29, v39
    v_lshlrev_b32 v30, 16, v195
    v_and_b32 v36, 0xffff0000, v92
    v_lshlrev_b32 v37, 16, v77
    v_fmac_f32 v30, s86, v36
    v_mul_f32 v30, v30, v37
    v_lshlrev_b32 v31, 16, v199
    v_and_b32 v38, 0xffff0000, v96
    v_and_b32 v39, 0xffff0000, v77
    v_fmac_f32 v31, s87, v38
    v_mul_f32 v31, v31, v39
    v_lshlrev_b32 v32, 16, v203
    v_and_b32 v36, 0xffff0000, v100
    v_lshlrev_b32 v37, 16, v78
    v_fmac_f32 v32, s88, v36
    v_mul_f32 v32, v32, v37
    v_lshlrev_b32 v33, 16, v207
    v_and_b32 v38, 0xffff0000, v104
    v_and_b32 v39, 0xffff0000, v78
    v_fmac_f32 v33, s89, v38
    v_mul_f32 v33, v33, v39
    v_lshlrev_b32 v34, 16, v211
    v_and_b32 v36, 0xffff0000, v108
    v_lshlrev_b32 v37, 16, v79
    v_fmac_f32 v34, s90, v36
    v_mul_f32 v34, v34, v37
    v_lshlrev_b32 v35, 16, v215
    v_and_b32 v38, 0xffff0000, v112
    v_and_b32 v39, 0xffff0000, v79
    v_fmac_f32 v35, s91, v38
    v_mul_f32 v35, v35, v39
    v_cvt_pk_bf16_f32 v20, v28, v29
    v_cvt_pk_bf16_f32 v21, v30, v31
    v_cvt_pk_bf16_f32 v22, v32, v33
    v_cvt_pk_bf16_f32 v23, v34, v35
    buffer_store_dwordx4 v[20:23], v116, s[8:11], s40 offen offset:2048 sc1
    v_and_b32 v28, 0xffff0000, v187
    v_lshlrev_b32 v36, 16, v84
    s_waitcnt vmcnt(7)
    v_lshlrev_b32 v37, 16, v80
    v_fmac_f32 v28, s84, v36
    v_mul_f32 v28, v28, v37
    v_and_b32 v29, 0xffff0000, v191
    v_lshlrev_b32 v38, 16, v88
    v_and_b32 v39, 0xffff0000, v80
    v_fmac_f32 v29, s85, v38
    v_mul_f32 v29, v29, v39
    v_and_b32 v30, 0xffff0000, v195
    v_lshlrev_b32 v36, 16, v92
    v_lshlrev_b32 v37, 16, v81
    v_fmac_f32 v30, s86, v36
    v_mul_f32 v30, v30, v37
    v_and_b32 v31, 0xffff0000, v199
    v_lshlrev_b32 v38, 16, v96
    v_and_b32 v39, 0xffff0000, v81
    v_fmac_f32 v31, s87, v38
    v_mul_f32 v31, v31, v39
    v_and_b32 v32, 0xffff0000, v203
    v_lshlrev_b32 v36, 16, v100
    v_lshlrev_b32 v37, 16, v82
    v_fmac_f32 v32, s88, v36
    v_mul_f32 v32, v32, v37
    v_and_b32 v33, 0xffff0000, v207
    v_lshlrev_b32 v38, 16, v104
    v_and_b32 v39, 0xffff0000, v82
    v_fmac_f32 v33, s89, v38
    v_mul_f32 v33, v33, v39
    v_and_b32 v34, 0xffff0000, v211
    v_lshlrev_b32 v36, 16, v108
    v_lshlrev_b32 v37, 16, v83
    v_fmac_f32 v34, s90, v36
    v_mul_f32 v34, v34, v37
    v_and_b32 v35, 0xffff0000, v215
    v_lshlrev_b32 v38, 16, v112
    v_and_b32 v39, 0xffff0000, v83
    v_fmac_f32 v35, s91, v38
    v_mul_f32 v35, v35, v39
    v_cvt_pk_bf16_f32 v24, v28, v29
    v_cvt_pk_bf16_f32 v25, v30, v31
    v_cvt_pk_bf16_f32 v26, v32, v33
    v_cvt_pk_bf16_f32 v27, v34, v35
    buffer_store_dwordx4 v[24:27], v116, s[8:11], s40 offen offset:3072 sc1
    s_waitcnt vmcnt(0)
    s_barrier
    s_cmp_lg_u32 s21, 0
    s_cbranch_scc1 L_op_start
    v_mov_b32 v5, 1
    s_mov_b64 exec, 1
    buffer_atomic_add v5, off, s[16:19], 0 offset:196
    s_mov_b64 exec, -1
    s_nop 0
L_op_start:
    s_load_dwordx2 s[12:13], s[0:1], 40
    s_mov_b32 s14, 4194304
    s_mov_b32 s15, 0x20000
    s_load_dwordx2 s[32:33], s[0:1], 104
    s_mov_b32 s34, 1024
    s_mov_b32 s35, 0x20000
    s_load_dwordx2 s[36:37], s[0:1], 112
    s_mov_b32 s38, 2097152
    s_mov_b32 s39, 0x20000
    v_lshrrev_b32 v5, 6, v2
    v_and_b32 v6, 0x30, v2
    v_lshl_add_u32 v7, v5, 10, v6
    s_and_b32 s40, s42, 15
    s_lshl_b32 s40, s40, 6
    s_lshl_b32 s41, s21, 20
    s_add_u32 s43, s40, s41
    s_mov_b32 s57, s41
    s_lshl_b32 s58, s40, 5
    s_and_b32 s58, s58, 30720
    s_lshl_b32 s41, s58, 5
    s_add_u32 s43, s43, s41
    s_lshl_b32 s41, s21, 15
    v_add_u32 v8, s41, v2
    v_lshlrev_b32 v9, 4, v4
    v_and_b32 v10, 31, v0
    v_lshlrev_b32 v10, 6, v10
    s_lshr_b32 s44, s42, 5
    s_cmp_eq_u32 s44, 2
    s_cselect_b32 s44, 50, s44
    s_bfe_u32 s47, s42, 0x10004
    s_lshl_b32 s46, s44, 1
    s_add_u32 s47, s47, s46
    s_lshl_b32 s46, s47, 17
    s_add_u32 s46, s46, s41
    s_add_u32 s46, s46, 167772160
    s_lshl_b32 s47, s47, 14
    s_lshl_b32 s45, s44, 20
    s_add_u32 s45, s45, 17582080
    s_lshl_b32 s48, s21, 8
    s_mov_b32 s49, s40
    s_waitcnt lgkmcnt(0)
    buffer_load_dwordx4 v[12:15], v9, s[32:35], s48 offen offset:0
    buffer_load_dwordx4 v[16:19], v9, s[32:35], s48 offen offset:64
    buffer_load_dwordx4 v[20:23], v9, s[32:35], s48 offen offset:128
    buffer_load_dwordx4 v[24:27], v9, s[32:35], s48 offen offset:192
    v_lshl_add_u32 v9, v3, 10, v9
    v_mov_b32 v225, v2
    s_mov_b32 m0, s41
    s_nop 0
    buffer_load_dwordx4 v7, s[12:15], s43 offen lds
    s_add_u32 s43, s43, 16384
    s_add_u32 m0, m0, 1024
    s_nop 0
    buffer_load_dwordx4 v7, s[12:15], s43 offen lds
    s_add_u32 s43, s43, 16384
    s_add_u32 m0, m0, 1024
    s_nop 0
    buffer_load_dwordx4 v7, s[12:15], s43 offen lds
    s_add_u32 s43, s43, 16384
    s_add_u32 m0, m0, 1024
    s_nop 0
    buffer_load_dwordx4 v7, s[12:15], s43 offen lds
    s_add_u32 s43, s43, 16384
    s_add_u32 m0, m0, 1024
    s_and_b32 s43, s43, 0xfffff
    s_or_b32 s43, s43, s57
    buffer_load_dwordx4 v7, s[12:15], s43 offen lds
    s_add_u32 s43, s43, 16384
    s_add_u32 m0, m0, 1024
    s_nop 0
    buffer_load_dwordx4 v7, s[12:15], s43 offen lds
    s_add_u32 s43, s43, 16384
    s_add_u32 m0, m0, 1024
    s_nop 0
    buffer_load_dwordx4 v7, s[12:15], s43 offen lds
    s_add_u32 s43, s43, 16384
    s_add_u32 m0, m0, 1024
    s_nop 0
    buffer_load_dwordx4 v7, s[12:15], s43 offen lds
    s_add_u32 s43, s43, 16384
    s_add_u32 m0, m0, 1024
    s_and_b32 s43, s43, 0xfffff
    s_or_b32 s43, s43, s57
    buffer_load_dwordx4 v7, s[12:15], s43 offen lds
    s_add_u32 s43, s43, 16384
    s_add_u32 m0, m0, 1024
    s_nop 0
    buffer_load_dwordx4 v7, s[12:15], s43 offen lds
    s_add_u32 s43, s43, 16384
    s_add_u32 m0, m0, 1024
    s_nop 0
    buffer_load_dwordx4 v7, s[12:15], s43 offen lds
    s_add_u32 s43, s43, 16384
    s_add_u32 m0, m0, 1024
    s_nop 0
    buffer_load_dwordx4 v7, s[12:15], s43 offen lds
    s_add_u32 s43, s43, 16384
    s_add_u32 m0, m0, 1024
    s_and_b32 s43, s43, 0xfffff
    s_or_b32 s43, s43, s57
    buffer_load_dwordx4 v7, s[12:15], s43 offen lds
    s_add_u32 s43, s43, 16384
    s_add_u32 m0, m0, 1024
    s_nop 0
    buffer_load_dwordx4 v7, s[12:15], s43 offen lds
    s_add_u32 s43, s43, 16384
    s_add_u32 m0, m0, 1024
    s_nop 0
    buffer_load_dwordx4 v7, s[12:15], s43 offen lds
    s_add_u32 s43, s43, 16384
    s_add_u32 m0, m0, 1024
    s_nop 0
    buffer_load_dwordx4 v7, s[12:15], s43 offen lds
    s_add_u32 s43, s43, 16384
    s_add_u32 m0, m0, 1024
    s_and_b32 s43, s43, 0xfffff
    s_or_b32 s43, s43, s57
    buffer_load_dwordx4 v7, s[12:15], s43 offen lds
    s_add_u32 s43, s43, 16384
    s_add_u32 m0, m0, 1024
    s_nop 0
    buffer_load_dwordx4 v7, s[12:15], s43 offen lds
    s_add_u32 s43, s43, 16384
    s_add_u32 m0, m0, 1024
    s_nop 0
    buffer_load_dwordx4 v7, s[12:15], s43 offen lds
    s_add_u32 s43, s43, 16384
    s_add_u32 m0, m0, 1024
    s_nop 0
    buffer_load_dwordx4 v7, s[12:15], s43 offen lds
    s_add_u32 s43, s43, 16384
    s_add_u32 m0, m0, 1024
    s_and_b32 s43, s43, 0xfffff
    s_or_b32 s43, s43, s57
    buffer_load_dwordx4 v7, s[12:15], s43 offen lds
    s_add_u32 s43, s43, 16384
    s_add_u32 m0, m0, 1024
    s_nop 0
    buffer_load_dwordx4 v7, s[12:15], s43 offen lds
    s_add_u32 s43, s43, 16384
    s_add_u32 m0, m0, 1024
    s_nop 0
    buffer_load_dwordx4 v7, s[12:15], s43 offen lds
    s_add_u32 s43, s43, 16384
    s_add_u32 m0, m0, 1024
    s_nop 0
    buffer_load_dwordx4 v7, s[12:15], s43 offen lds
    s_add_u32 s43, s43, 16384
    s_add_u32 m0, m0, 1024
    s_and_b32 s43, s43, 0xfffff
    s_or_b32 s43, s43, s57
    buffer_load_dwordx4 v7, s[12:15], s43 offen lds
    s_add_u32 s43, s43, 16384
    s_add_u32 m0, m0, 1024
    s_nop 0
    buffer_load_dwordx4 v7, s[12:15], s43 offen lds
    s_add_u32 s43, s43, 16384
    s_add_u32 m0, m0, 1024
    s_nop 0
    buffer_load_dwordx4 v7, s[12:15], s43 offen lds
    s_add_u32 s43, s43, 16384
    s_add_u32 m0, m0, 1024
    s_nop 0
    buffer_load_dwordx4 v7, s[12:15], s43 offen lds
    s_add_u32 s43, s43, 16384
    s_add_u32 m0, m0, 1024
    s_and_b32 s43, s43, 0xfffff
    s_or_b32 s43, s43, s57
    buffer_load_dwordx4 v7, s[12:15], s43 offen lds
    s_add_u32 s43, s43, 16384
    s_add_u32 m0, m0, 1024
    s_nop 0
    buffer_load_dwordx4 v7, s[12:15], s43 offen lds
    s_add_u32 s43, s43, 16384
    s_add_u32 m0, m0, 1024
    s_nop 0
    buffer_load_dwordx4 v7, s[12:15], s43 offen lds
    s_add_u32 s43, s43, 16384
    s_add_u32 m0, m0, 1024
    s_nop 0
    buffer_load_dwordx4 v7, s[12:15], s43 offen lds
    s_add_u32 s43, s43, 16384
    s_add_u32 m0, m0, 1024
    s_and_b32 s43, s43, 0xfffff
    s_or_b32 s43, s43, s57
    s_waitcnt vmcnt(24)
    ds_read_b64_tr_b16 a[0:1], v8 offset:0
    ds_read_b64_tr_b16 a[2:3], v8 offset:1024
    ds_read_b64_tr_b16 a[4:5], v8 offset:8
    ds_read_b64_tr_b16 a[6:7], v8 offset:1032
    ds_read_b64_tr_b16 a[8:9], v8 offset:2048
    ds_read_b64_tr_b16 a[10:11], v8 offset:3072
    ds_read_b64_tr_b16 a[12:13], v8 offset:2056
    ds_read_b64_tr_b16 a[14:15], v8 offset:3080
    ds_read_b64_tr_b16 a[16:17], v8 offset:4096
    ds_read_b64_tr_b16 a[18:19], v8 offset:5120
    ds_read_b64_tr_b16 a[20:21], v8 offset:4104
    ds_read_b64_tr_b16 a[22:23], v8 offset:5128
    ds_read_b64_tr_b16 a[24:25], v8 offset:6144
    ds_read_b64_tr_b16 a[26:27], v8 offset:7168
    ds_read_b64_tr_b16 a[28:29], v8 offset:6152
    ds_read_b64_tr_b16 a[30:31], v8 offset:7176
    s_waitcnt vmcnt(16)
    ds_read_b64_tr_b16 a[32:33], v8 offset:8192
    ds_read_b64_tr_b16 a[34:35], v8 offset:9216
    ds_read_b64_tr_b16 a[36:37], v8 offset:8200
    ds_read_b64_tr_b16 a[38:39], v8 offset:9224
    ds_read_b64_tr_b16 a[40:41], v8 offset:10240
    ds_read_b64_tr_b16 a[42:43], v8 offset:11264
    ds_read_b64_tr_b16 a[44:45], v8 offset:10248
    ds_read_b64_tr_b16 a[46:47], v8 offset:11272
    ds_read_b64_tr_b16 a[48:49], v8 offset:12288
    ds_read_b64_tr_b16 a[50:51], v8 offset:13312
    ds_read_b64_tr_b16 a[52:53], v8 offset:12296
    ds_read_b64_tr_b16 a[54:55], v8 offset:13320
    ds_read_b64_tr_b16 a[56:57], v8 offset:14336
    ds_read_b64_tr_b16 a[58:59], v8 offset:15360
    ds_read_b64_tr_b16 a[60:61], v8 offset:14344
    ds_read_b64_tr_b16 a[62:63], v8 offset:15368
    s_waitcnt vmcnt(8)
    ds_read_b64_tr_b16 a[64:65], v8 offset:16384
    ds_read_b64_tr_b16 a[66:67], v8 offset:17408
    ds_read_b64_tr_b16 a[68:69], v8 offset:16392
    ds_read_b64_tr_b16 a[70:71], v8 offset:17416
    ds_read_b64_tr_b16 a[72:73], v8 offset:18432
    ds_read_b64_tr_b16 a[74:75], v8 offset:19456
    ds_read_b64_tr_b16 a[76:77], v8 offset:18440
    ds_read_b64_tr_b16 a[78:79], v8 offset:19464
    ds_read_b64_tr_b16 a[80:81], v8 offset:20480
    ds_read_b64_tr_b16 a[82:83], v8 offset:21504
    ds_read_b64_tr_b16 a[84:85], v8 offset:20488
    ds_read_b64_tr_b16 a[86:87], v8 offset:21512
    ds_read_b64_tr_b16 a[88:89], v8 offset:22528
    ds_read_b64_tr_b16 a[90:91], v8 offset:23552
    ds_read_b64_tr_b16 a[92:93], v8 offset:22536
    ds_read_b64_tr_b16 a[94:95], v8 offset:23560
    s_waitcnt vmcnt(0)
    ds_read_b64_tr_b16 a[96:97], v8 offset:24576
    ds_read_b64_tr_b16 a[98:99], v8 offset:25600
    ds_read_b64_tr_b16 a[100:101], v8 offset:24584
    ds_read_b64_tr_b16 a[102:103], v8 offset:25608
    ds_read_b64_tr_b16 a[104:105], v8 offset:26624
    ds_read_b64_tr_b16 a[106:107], v8 offset:27648
    ds_read_b64_tr_b16 a[108:109], v8 offset:26632
    ds_read_b64_tr_b16 a[110:111], v8 offset:27656
    ds_read_b64_tr_b16 a[112:113], v8 offset:28672
    ds_read_b64_tr_b16 a[114:115], v8 offset:29696
    ds_read_b64_tr_b16 a[116:117], v8 offset:28680
    ds_read_b64_tr_b16 a[118:119], v8 offset:29704
    ds_read_b64_tr_b16 a[120:121], v8 offset:30720
    ds_read_b64_tr_b16 a[122:123], v8 offset:31744
    ds_read_b64_tr_b16 a[124:125], v8 offset:30728
    ds_read_b64_tr_b16 a[126:127], v8 offset:31752
    s_waitcnt lgkmcnt(0)
    s_mov_b32 m0, s41
    s_nop 0
    buffer_load_dwordx4 v7, s[12:15], s43 offen lds
    s_add_u32 s43, s43, 16384
    s_add_u32 m0, m0, 1024
    s_nop 0
    buffer_load_dwordx4 v7, s[12:15], s43 offen lds
    s_add_u32 s43, s43, 16384
    s_add_u32 m0, m0, 1024
    s_nop 0
    buffer_load_dwordx4 v7, s[12:15], s43 offen lds
    s_add_u32 s43, s43, 16384
    s_add_u32 m0, m0, 1024
    s_nop 0
    buffer_load_dwordx4 v7, s[12:15], s43 offen lds
    s_add_u32 s43, s43, 16384
    s_add_u32 m0, m0, 1024
    s_and_b32 s43, s43, 0xfffff
    s_or_b32 s43, s43, s57
    buffer_load_dwordx4 v7, s[12:15], s43 offen lds
    s_add_u32 s43, s43, 16384
    s_add_u32 m0, m0, 1024
    s_nop 0
    buffer_load_dwordx4 v7, s[12:15], s43 offen lds
    s_add_u32 s43, s43, 16384
    s_add_u32 m0, m0, 1024
    s_nop 0
    buffer_load_dwordx4 v7, s[12:15], s43 offen lds
    s_add_u32 s43, s43, 16384
    s_add_u32 m0, m0, 1024
    s_nop 0
    buffer_load_dwordx4 v7, s[12:15], s43 offen lds
    s_add_u32 s43, s43, 16384
    s_add_u32 m0, m0, 1024
    s_and_b32 s43, s43, 0xfffff
    s_or_b32 s43, s43, s57
    buffer_load_dwordx4 v7, s[12:15], s43 offen lds
    s_add_u32 s43, s43, 16384
    s_add_u32 m0, m0, 1024
    s_nop 0
    buffer_load_dwordx4 v7, s[12:15], s43 offen lds
    s_add_u32 s43, s43, 16384
    s_add_u32 m0, m0, 1024
    s_nop 0
    buffer_load_dwordx4 v7, s[12:15], s43 offen lds
    s_add_u32 s43, s43, 16384
    s_add_u32 m0, m0, 1024
    s_nop 0
    buffer_load_dwordx4 v7, s[12:15], s43 offen lds
    s_add_u32 s43, s43, 16384
    s_add_u32 m0, m0, 1024
    s_and_b32 s43, s43, 0xfffff
    s_or_b32 s43, s43, s57
    buffer_load_dwordx4 v7, s[12:15], s43 offen lds
    s_add_u32 s43, s43, 16384
    s_add_u32 m0, m0, 1024
    s_nop 0
    buffer_load_dwordx4 v7, s[12:15], s43 offen lds
    s_add_u32 s43, s43, 16384
    s_add_u32 m0, m0, 1024
    s_nop 0
    buffer_load_dwordx4 v7, s[12:15], s43 offen lds
    s_add_u32 s43, s43, 16384
    s_add_u32 m0, m0, 1024
    s_nop 0
    buffer_load_dwordx4 v7, s[12:15], s43 offen lds
    s_add_u32 s43, s43, 16384
    s_add_u32 m0, m0, 1024
    s_and_b32 s43, s43, 0xfffff
    s_or_b32 s43, s43, s57
    buffer_load_dwordx4 v7, s[12:15], s43 offen lds
    s_add_u32 s43, s43, 16384
    s_add_u32 m0, m0, 1024
    s_nop 0
    buffer_load_dwordx4 v7, s[12:15], s43 offen lds
    s_add_u32 s43, s43, 16384
    s_add_u32 m0, m0, 1024
    s_nop 0
    buffer_load_dwordx4 v7, s[12:15], s43 offen lds
    s_add_u32 s43, s43, 16384
    s_add_u32 m0, m0, 1024
    s_nop 0
    buffer_load_dwordx4 v7, s[12:15], s43 offen lds
    s_add_u32 s43, s43, 16384
    s_add_u32 m0, m0, 1024
    s_and_b32 s43, s43, 0xfffff
    s_or_b32 s43, s43, s57
    buffer_load_dwordx4 v7, s[12:15], s43 offen lds
    s_add_u32 s43, s43, 16384
    s_add_u32 m0, m0, 1024
    s_nop 0
    buffer_load_dwordx4 v7, s[12:15], s43 offen lds
    s_add_u32 s43, s43, 16384
    s_add_u32 m0, m0, 1024
    s_nop 0
    buffer_load_dwordx4 v7, s[12:15], s43 offen lds
    s_add_u32 s43, s43, 16384
    s_add_u32 m0, m0, 1024
    s_nop 0
    buffer_load_dwordx4 v7, s[12:15], s43 offen lds
    s_add_u32 s43, s43, 16384
    s_add_u32 m0, m0, 1024
    s_and_b32 s43, s43, 0xfffff
    s_or_b32 s43, s43, s57
    buffer_load_dwordx4 v7, s[12:15], s43 offen lds
    s_add_u32 s43, s43, 16384
    s_add_u32 m0, m0, 1024
    s_nop 0
    buffer_load_dwordx4 v7, s[12:15], s43 offen lds
    s_add_u32 s43, s43, 16384
    s_add_u32 m0, m0, 1024
    s_nop 0
    buffer_load_dwordx4 v7, s[12:15], s43 offen lds
    s_add_u32 s43, s43, 16384
    s_add_u32 m0, m0, 1024
    s_nop 0
    buffer_load_dwordx4 v7, s[12:15], s43 offen lds
    s_add_u32 s43, s43, 16384
    s_add_u32 m0, m0, 1024
    s_and_b32 s43, s43, 0xfffff
    s_or_b32 s43, s43, s57
    buffer_load_dwordx4 v7, s[12:15], s43 offen lds
    s_add_u32 s43, s43, 16384
    s_add_u32 m0, m0, 1024
    s_nop 0
    buffer_load_dwordx4 v7, s[12:15], s43 offen lds
    s_add_u32 s43, s43, 16384
    s_add_u32 m0, m0, 1024
    s_nop 0
    buffer_load_dwordx4 v7, s[12:15], s43 offen lds
    s_add_u32 s43, s43, 16384
    s_add_u32 m0, m0, 1024
    s_nop 0
    buffer_load_dwordx4 v7, s[12:15], s43 offen lds
    s_add_u32 s43, s43, 16384
    s_add_u32 m0, m0, 1024
    s_and_b32 s43, s43, 0xfffff
    s_or_b32 s43, s43, s57
    s_waitcnt vmcnt(24)
    ds_read_b64_tr_b16 a[128:129], v8 offset:0
    ds_read_b64_tr_b16 a[130:131], v8 offset:1024
    ds_read_b64_tr_b16 a[132:133], v8 offset:8
    ds_read_b64_tr_b16 a[134:135], v8 offset:1032
    ds_read_b64_tr_b16 a[136:137], v8 offset:2048
    ds_read_b64_tr_b16 a[138:139], v8 offset:3072
    ds_read_b64_tr_b16 a[140:141], v8 offset:2056
    ds_read_b64_tr_b16 a[142:143], v8 offset:3080
    ds_read_b64_tr_b16 a[144:145], v8 offset:4096
    ds_read_b64_tr_b16 a[146:147], v8 offset:5120
    ds_read_b64_tr_b16 a[148:149], v8 offset:4104
    ds_read_b64_tr_b16 a[150:151], v8 offset:5128
    ds_read_b64_tr_b16 a[152:153], v8 offset:6144
    ds_read_b64_tr_b16 a[154:155], v8 offset:7168
    ds_read_b64_tr_b16 a[156:157], v8 offset:6152
    ds_read_b64_tr_b16 a[158:159], v8 offset:7176
    s_waitcnt vmcnt(16)
    ds_read_b64_tr_b16 a[160:161], v8 offset:8192
    ds_read_b64_tr_b16 a[162:163], v8 offset:9216
    ds_read_b64_tr_b16 a[164:165], v8 offset:8200
    ds_read_b64_tr_b16 a[166:167], v8 offset:9224
    ds_read_b64_tr_b16 a[168:169], v8 offset:10240
    ds_read_b64_tr_b16 a[170:171], v8 offset:11264
    ds_read_b64_tr_b16 a[172:173], v8 offset:10248
    ds_read_b64_tr_b16 a[174:175], v8 offset:11272
    ds_read_b64_tr_b16 a[176:177], v8 offset:12288
    ds_read_b64_tr_b16 a[178:179], v8 offset:13312
    ds_read_b64_tr_b16 a[180:181], v8 offset:12296
    ds_read_b64_tr_b16 a[182:183], v8 offset:13320
    ds_read_b64_tr_b16 a[184:185], v8 offset:14336
    ds_read_b64_tr_b16 a[186:187], v8 offset:15360
    ds_read_b64_tr_b16 a[188:189], v8 offset:14344
    ds_read_b64_tr_b16 a[190:191], v8 offset:15368
    s_waitcnt vmcnt(8)
    ds_read_b64_tr_b16 a[192:193], v8 offset:16384
    ds_read_b64_tr_b16 a[194:195], v8 offset:17408
    ds_read_b64_tr_b16 a[196:197], v8 offset:16392
    ds_read_b64_tr_b16 a[198:199], v8 offset:17416
    ds_read_b64_tr_b16 a[200:201], v8 offset:18432
    ds_read_b64_tr_b16 a[202:203], v8 offset:19456
    ds_read_b64_tr_b16 a[204:205], v8 offset:18440
    ds_read_b64_tr_b16 a[206:207], v8 offset:19464
    ds_read_b64_tr_b16 a[208:209], v8 offset:20480
    ds_read_b64_tr_b16 a[210:211], v8 offset:21504
    ds_read_b64_tr_b16 a[212:213], v8 offset:20488
    ds_read_b64_tr_b16 a[214:215], v8 offset:21512
    ds_read_b64_tr_b16 a[216:217], v8 offset:22528
    ds_read_b64_tr_b16 a[218:219], v8 offset:23552
    ds_read_b64_tr_b16 a[220:221], v8 offset:22536
    ds_read_b64_tr_b16 a[222:223], v8 offset:23560
    s_waitcnt vmcnt(0)
    ds_read_b64_tr_b16 a[224:225], v8 offset:24576
    ds_read_b64_tr_b16 a[226:227], v8 offset:25600
    ds_read_b64_tr_b16 a[228:229], v8 offset:24584
    ds_read_b64_tr_b16 a[230:231], v8 offset:25608
    ds_read_b64_tr_b16 a[232:233], v8 offset:26624
    ds_read_b64_tr_b16 a[234:235], v8 offset:27648
    ds_read_b64_tr_b16 a[236:237], v8 offset:26632
    ds_read_b64_tr_b16 a[238:239], v8 offset:27656
    ds_read_b64_tr_b16 a[240:241], v8 offset:28672
    ds_read_b64_tr_b16 a[242:243], v8 offset:29696
    ds_read_b64_tr_b16 a[244:245], v8 offset:28680
    ds_read_b64_tr_b16 a[246:247], v8 offset:29704
    ds_read_b64_tr_b16 a[248:249], v8 offset:30720
    ds_read_b64_tr_b16 a[250:251], v8 offset:31744
    ds_read_b64_tr_b16 a[252:253], v8 offset:30728
    ds_read_b64_tr_b16 a[254:255], v8 offset:31752
    s_waitcnt lgkmcnt(0)
    s_cmp_lg_u32 s21, 0
    s_cbranch_scc1 L_op_rdy_ok
L_op_rdy:
    buffer_load_dword v5, off, s[16:19], 0 offset:4 sc1
    s_sub_u32 s22, s22, 1
    s_cbranch_scc1 L_exit
    s_waitcnt vmcnt(0)
    v_readfirstlane_b32 s4, v5
    s_and_b32 s4, s4, 255
    s_cmp_lt_u32 s4, 32
    s_cbranch_scc1 L_op_rdy
    s_nop 1
L_op_rdy_ok:
    s_barrier
    s_mul_i32 s41, s21, 3072
    v_add_u32 v11, s41, v2
    s_mov_b64 s[52:53], -1
    s_mov_b64 s[54:55], 0
    s_mov_b64 s[60:61], -1
    s_mov_b32 s62, 0
    s_cmp_lg_u32 s21, 0
    s_cbranch_scc1 L_op_ssm_ok
L_op_ssm:
    buffer_load_dword v5, off, s[16:19], 0 offset:196 sc1
    s_sub_u32 s22, s22, 1
    s_cbranch_scc1 L_exit
    s_waitcnt vmcnt(0)
    v_readfirstlane_b32 s4, v5
    s_and_b32 s4, s4, 255
    s_cmp_lt_u32 s4, 64
    s_cbranch_scc1 L_op_ssm
    s_nop 1
L_op_ssm_ok:
    s_barrier
L_op_loop:
    s_add_u32 s40, s47, s48
    buffer_load_dwordx4 v[28:31], v9, s[28:31], s40 offen offset:0
    buffer_load_dwordx4 v[32:35], v9, s[28:31], s40 offen offset:64
    buffer_load_dwordx4 v[36:39], v9, s[28:31], s40 offen offset:128
    buffer_load_dwordx4 v[40:43], v9, s[28:31], s40 offen offset:192
    s_add_u32 s50, s47, s49
    s_add_u32 s40, s50, 184549376
    buffer_load_dwordx4 v[44:47], v9, s[8:11], s40 offen sc1
L_op_in:
    s_cmp_ge_u32 s44, 62
    s_cbranch_scc1 L_op_poll
    s_cmp_lg_u32 s21, 0
    s_cbranch_scc1 L_op_pb
    s_cmp_eq_u64 s[60:61], 0
    s_cbranch_scc1 L_op_pb
L_op_fl:
    buffer_load_dword v5, v10, s[8:11], s45 offen sc1
    s_sub_u32 s22, s22, 1
    s_cbranch_scc1 L_exit
    s_waitcnt vmcnt(0)
    v_cmp_eq_u32 vcc, -1, v5
    s_cbranch_vccnz L_op_fl
    s_nop 3
L_op_pb:
    s_barrier
    s_cmp_eq_u32 s54, 0
    s_cbranch_scc1 L_op_got
L_op_poll:
    buffer_load_dword v5, v7, s[8:11], s51 offen sc1
    s_sub_u32 s22, s22, 1
    s_cbranch_scc1 L_exit
    s_waitcnt vmcnt(0)
    v_cmp_eq_u32 vcc, -1, v5
    s_cbranch_vccnz L_op_poll
    s_nop 3
L_op_got:
    s_add_u32 s40, s46, s58
    s_cmp_lg_u32 s52, -1
    s_cbranch_scc1 L_op_half
    buffer_load_dwordx4 v[68:71], v2, s[8:11], s40 offen offset:0 sc1
    s_add_u32 s58, s58, 2048
    s_and_b32 s58, s58, 0x7fff
    buffer_load_dwordx4 v[72:75], v2, s[8:11], s40 offen offset:1024 sc1
    s_add_u32 s40, s46, s58
    buffer_load_dwordx4 v[76:79], v2, s[8:11], s40 offen offset:0 sc1
    s_add_u32 s58, s58, 2048
    s_and_b32 s58, s58, 0x7fff
    buffer_load_dwordx4 v[80:83], v2, s[8:11], s40 offen offset:1024 sc1
    s_add_u32 s40, s46, s58
    buffer_load_dwordx4 v[84:87], v2, s[8:11], s40 offen offset:0 sc1
    s_add_u32 s58, s58, 2048
    s_and_b32 s58, s58, 0x7fff
    buffer_load_dwordx4 v[88:91], v2, s[8:11], s40 offen offset:1024 sc1
    s_add_u32 s40, s46, s58
    buffer_load_dwordx4 v[92:95], v2, s[8:11], s40 offen offset:0 sc1
    s_add_u32 s58, s58, 2048
    s_and_b32 s58, s58, 0x7fff
    buffer_load_dwordx4 v[96:99], v2, s[8:11], s40 offen offset:1024 sc1
    s_add_u32 s40, s46, s58
    buffer_load_dwordx4 v[100:103], v2, s[8:11], s40 offen offset:0 sc1
    s_add_u32 s58, s58, 2048
    s_and_b32 s58, s58, 0x7fff
    buffer_load_dwordx4 v[104:107], v2, s[8:11], s40 offen offset:1024 sc1
    s_add_u32 s40, s46, s58
    buffer_load_dwordx4 v[108:111], v2, s[8:11], s40 offen offset:0 sc1
    s_add_u32 s58, s58, 2048
    s_and_b32 s58, s58, 0x7fff
    buffer_load_dwordx4 v[112:115], v2, s[8:11], s40 offen offset:1024 sc1
    s_add_u32 s40, s46, s58
    buffer_load_dwordx4 v[116:119], v2, s[8:11], s40 offen offset:0 sc1
    s_add_u32 s58, s58, 2048
    s_and_b32 s58, s58, 0x7fff
    buffer_load_dwordx4 v[120:123], v2, s[8:11], s40 offen offset:1024 sc1
    s_add_u32 s40, s46, s58
    buffer_load_dwordx4 v[124:127], v2, s[8:11], s40 offen offset:0 sc1
    s_add_u32 s58, s58, 2048
    s_and_b32 s58, s58, 0x7fff
    buffer_load_dwordx4 v[128:131], v2, s[8:11], s40 offen offset:1024 sc1
    s_add_u32 s40, s46, s58
    buffer_load_dwordx4 v[132:135], v2, s[8:11], s40 offen offset:0 sc1
    s_add_u32 s58, s58, 2048
    s_and_b32 s58, s58, 0x7fff
    buffer_load_dwordx4 v[136:139], v2, s[8:11], s40 offen offset:1024 sc1
    s_add_u32 s40, s46, s58
    buffer_load_dwordx4 v[140:143], v2, s[8:11], s40 offen offset:0 sc1
    s_add_u32 s58, s58, 2048
    s_and_b32 s58, s58, 0x7fff
    buffer_load_dwordx4 v[144:147], v2, s[8:11], s40 offen offset:1024 sc1
    s_add_u32 s40, s46, s58
    buffer_load_dwordx4 v[148:151], v2, s[8:11], s40 offen offset:0 sc1
    s_add_u32 s58, s58, 2048
    s_and_b32 s58, s58, 0x7fff
    buffer_load_dwordx4 v[152:155], v2, s[8:11], s40 offen offset:1024 sc1
    s_add_u32 s40, s46, s58
    buffer_load_dwordx4 v[156:159], v2, s[8:11], s40 offen offset:0 sc1
    s_add_u32 s58, s58, 2048
    s_and_b32 s58, s58, 0x7fff
    buffer_load_dwordx4 v[160:163], v2, s[8:11], s40 offen offset:1024 sc1
    s_add_u32 s40, s46, s58
    buffer_load_dwordx4 v[164:167], v2, s[8:11], s40 offen offset:0 sc1
    s_add_u32 s58, s58, 2048
    s_and_b32 s58, s58, 0x7fff
    buffer_load_dwordx4 v[168:171], v2, s[8:11], s40 offen offset:1024 sc1
    s_add_u32 s40, s46, s58
    buffer_load_dwordx4 v[172:175], v2, s[8:11], s40 offen offset:0 sc1
    s_add_u32 s58, s58, 2048
    s_and_b32 s58, s58, 0x7fff
    buffer_load_dwordx4 v[176:179], v2, s[8:11], s40 offen offset:1024 sc1
    s_add_u32 s40, s46, s58
    buffer_load_dwordx4 v[180:183], v2, s[8:11], s40 offen offset:0 sc1
    s_add_u32 s58, s58, 2048
    s_and_b32 s58, s58, 0x7fff
    buffer_load_dwordx4 v[184:187], v2, s[8:11], s40 offen offset:1024 sc1
    s_add_u32 s40, s46, s58
    buffer_load_dwordx4 v[188:191], v2, s[8:11], s40 offen offset:0 sc1
    s_add_u32 s58, s58, 2048
    s_and_b32 s58, s58, 0x7fff
    buffer_load_dwordx4 v[192:195], v2, s[8:11], s40 offen offset:1024 sc1
    s_add_u32 s40, s46, s58
    s_mov_b64 exec, -1
    v_mov_b32 v6, 0
    s_add_u32 s40, s45, 2097152
    buffer_load_dword v224, v10, s[8:11], s40 offen sc1
    s_waitcnt vmcnt(33)
    v_mfma_f32_16x16x32_bf16 v[64:67], v[12:15], v[28:31], 0
    v_mfma_f32_16x16x32_bf16 v[64:67], v[16:19], v[32:35], v[64:67]
    v_mfma_f32_16x16x32_bf16 v[64:67], v[20:23], v[36:39], v[64:67]
    v_mfma_f32_16x16x32_bf16 v[64:67], v[24:27], v[40:43], v[64:67]
    s_waitcnt vmcnt(32)
    v_mfma_f32_16x16x32_bf16 v[48:51], a[0:3], v[68:71], 0
    v_mfma_f32_16x16x32_bf16 v[52:55], a[4:7], v[68:71], 0
    s_waitcnt vmcnt(31)
    v_mfma_f32_16x16x32_bf16 v[56:59], a[8:11], v[72:75], 0
    v_mfma_f32_16x16x32_bf16 v[60:63], a[12:15], v[72:75], 0
    v_max3_u32 v6, v6, v68, v72
    s_waitcnt vmcnt(30)
    v_mfma_f32_16x16x32_bf16 v[48:51], a[16:19], v[76:79], v[48:51]
    v_mfma_f32_16x16x32_bf16 v[52:55], a[20:23], v[76:79], v[52:55]
    s_waitcnt vmcnt(29)
    v_mfma_f32_16x16x32_bf16 v[56:59], a[24:27], v[80:83], v[56:59]
    v_mfma_f32_16x16x32_bf16 v[60:63], a[28:31], v[80:83], v[60:63]
    v_max3_u32 v6, v6, v76, v80
    s_waitcnt vmcnt(28)
    v_mfma_f32_16x16x32_bf16 v[48:51], a[32:35], v[84:87], v[48:51]
    v_mfma_f32_16x16x32_bf16 v[52:55], a[36:39], v[84:87], v[52:55]
    s_waitcnt vmcnt(27)
    v_mfma_f32_16x16x32_bf16 v[56:59], a[40:43], v[88:91], v[56:59]
    v_mfma_f32_16x16x32_bf16 v[60:63], a[44:47], v[88:91], v[60:63]
    v_max3_u32 v6, v6, v84, v88
    s_waitcnt vmcnt(26)
    v_mfma_f32_16x16x32_bf16 v[48:51], a[48:51], v[92:95], v[48:51]
    v_mfma_f32_16x16x32_bf16 v[52:55], a[52:55], v[92:95], v[52:55]
    s_waitcnt vmcnt(25)
    v_mfma_f32_16x16x32_bf16 v[56:59], a[56:59], v[96:99], v[56:59]
    v_mfma_f32_16x16x32_bf16 v[60:63], a[60:63], v[96:99], v[60:63]
    v_max3_u32 v6, v6, v92, v96
    s_waitcnt vmcnt(24)
    v_mfma_f32_16x16x32_bf16 v[48:51], a[64:67], v[100:103], v[48:51]
    v_mfma_f32_16x16x32_bf16 v[52:55], a[68:71], v[100:103], v[52:55]
    s_waitcnt vmcnt(23)
    v_mfma_f32_16x16x32_bf16 v[56:59], a[72:75], v[104:107], v[56:59]
    v_mfma_f32_16x16x32_bf16 v[60:63], a[76:79], v[104:107], v[60:63]
    v_max3_u32 v6, v6, v100, v104
    s_waitcnt vmcnt(22)
    v_mfma_f32_16x16x32_bf16 v[48:51], a[80:83], v[108:111], v[48:51]
    v_mfma_f32_16x16x32_bf16 v[52:55], a[84:87], v[108:111], v[52:55]
    s_waitcnt vmcnt(21)
    v_mfma_f32_16x16x32_bf16 v[56:59], a[88:91], v[112:115], v[56:59]
    v_mfma_f32_16x16x32_bf16 v[60:63], a[92:95], v[112:115], v[60:63]
    v_max3_u32 v6, v6, v108, v112
    s_waitcnt vmcnt(20)
    v_mfma_f32_16x16x32_bf16 v[48:51], a[96:99], v[116:119], v[48:51]
    v_mfma_f32_16x16x32_bf16 v[52:55], a[100:103], v[116:119], v[52:55]
    s_waitcnt vmcnt(19)
    v_mfma_f32_16x16x32_bf16 v[56:59], a[104:107], v[120:123], v[56:59]
    v_mfma_f32_16x16x32_bf16 v[60:63], a[108:111], v[120:123], v[60:63]
    v_max3_u32 v6, v6, v116, v120
    s_waitcnt vmcnt(18)
    v_mfma_f32_16x16x32_bf16 v[48:51], a[112:115], v[124:127], v[48:51]
    v_mfma_f32_16x16x32_bf16 v[52:55], a[116:119], v[124:127], v[52:55]
    s_waitcnt vmcnt(17)
    v_mfma_f32_16x16x32_bf16 v[56:59], a[120:123], v[128:131], v[56:59]
    v_mfma_f32_16x16x32_bf16 v[60:63], a[124:127], v[128:131], v[60:63]
    v_max3_u32 v6, v6, v124, v128
    s_waitcnt vmcnt(16)
    v_mfma_f32_16x16x32_bf16 v[48:51], a[128:131], v[132:135], v[48:51]
    v_mfma_f32_16x16x32_bf16 v[52:55], a[132:135], v[132:135], v[52:55]
    s_waitcnt vmcnt(15)
    v_mfma_f32_16x16x32_bf16 v[56:59], a[136:139], v[136:139], v[56:59]
    v_mfma_f32_16x16x32_bf16 v[60:63], a[140:143], v[136:139], v[60:63]
    v_max3_u32 v6, v6, v132, v136
    s_waitcnt vmcnt(14)
    v_mfma_f32_16x16x32_bf16 v[48:51], a[144:147], v[140:143], v[48:51]
    v_mfma_f32_16x16x32_bf16 v[52:55], a[148:151], v[140:143], v[52:55]
    s_waitcnt vmcnt(13)
    v_mfma_f32_16x16x32_bf16 v[56:59], a[152:155], v[144:147], v[56:59]
    v_mfma_f32_16x16x32_bf16 v[60:63], a[156:159], v[144:147], v[60:63]
    v_max3_u32 v6, v6, v140, v144
    s_waitcnt vmcnt(12)
    v_mfma_f32_16x16x32_bf16 v[48:51], a[160:163], v[148:151], v[48:51]
    v_mfma_f32_16x16x32_bf16 v[52:55], a[164:167], v[148:151], v[52:55]
    s_waitcnt vmcnt(11)
    v_mfma_f32_16x16x32_bf16 v[56:59], a[168:171], v[152:155], v[56:59]
    v_mfma_f32_16x16x32_bf16 v[60:63], a[172:175], v[152:155], v[60:63]
    v_max3_u32 v6, v6, v148, v152
    s_waitcnt vmcnt(10)
    v_mfma_f32_16x16x32_bf16 v[48:51], a[176:179], v[156:159], v[48:51]
    v_mfma_f32_16x16x32_bf16 v[52:55], a[180:183], v[156:159], v[52:55]
    s_waitcnt vmcnt(9)
    v_mfma_f32_16x16x32_bf16 v[56:59], a[184:187], v[160:163], v[56:59]
    v_mfma_f32_16x16x32_bf16 v[60:63], a[188:191], v[160:163], v[60:63]
    v_max3_u32 v6, v6, v156, v160
    s_waitcnt vmcnt(8)
    v_mfma_f32_16x16x32_bf16 v[48:51], a[192:195], v[164:167], v[48:51]
    v_mfma_f32_16x16x32_bf16 v[52:55], a[196:199], v[164:167], v[52:55]
    s_waitcnt vmcnt(7)
    v_mfma_f32_16x16x32_bf16 v[56:59], a[200:203], v[168:171], v[56:59]
    v_mfma_f32_16x16x32_bf16 v[60:63], a[204:207], v[168:171], v[60:63]
    v_max3_u32 v6, v6, v164, v168
    s_waitcnt vmcnt(6)
    v_mfma_f32_16x16x32_bf16 v[48:51], a[208:211], v[172:175], v[48:51]
    v_mfma_f32_16x16x32_bf16 v[52:55], a[212:215], v[172:175], v[52:55]
    s_waitcnt vmcnt(5)
    v_mfma_f32_16x16x32_bf16 v[56:59], a[216:219], v[176:179], v[56:59]
    v_mfma_f32_16x16x32_bf16 v[60:63], a[220:223], v[176:179], v[60:63]
    v_max3_u32 v6, v6, v172, v176
    s_waitcnt vmcnt(4)
    v_mfma_f32_16x16x32_bf16 v[48:51], a[224:227], v[180:183], v[48:51]
    v_mfma_f32_16x16x32_bf16 v[52:55], a[228:231], v[180:183], v[52:55]
    s_waitcnt vmcnt(3)
    v_mfma_f32_16x16x32_bf16 v[56:59], a[232:235], v[184:187], v[56:59]
    v_mfma_f32_16x16x32_bf16 v[60:63], a[236:239], v[184:187], v[60:63]
    v_max3_u32 v6, v6, v180, v184
    s_waitcnt vmcnt(2)
    v_mfma_f32_16x16x32_bf16 v[48:51], a[240:243], v[188:191], v[48:51]
    v_mfma_f32_16x16x32_bf16 v[52:55], a[244:247], v[188:191], v[52:55]
    s_waitcnt vmcnt(1)
    v_mfma_f32_16x16x32_bf16 v[56:59], a[248:251], v[192:195], v[56:59]
    v_mfma_f32_16x16x32_bf16 v[60:63], a[252:255], v[192:195], v[60:63]
    v_max3_u32 v6, v6, v188, v192
    v_cmp_eq_u32 vcc, -1, v6
    s_and_b64 vcc, vcc, s[54:55]
    s_cbranch_scc1 L_op_poll
    s_cmp_lg_u32 s54, 0
    s_cbranch_scc1 L_op_nf
    s_waitcnt vmcnt(0)
    v_cmp_eq_u32 s[60:61], -1, v224
L_op_nf:
    v_add_f32 v48, v48, v56
    v_add_f32 v49, v49, v57
    v_add_f32 v50, v50, v58
    v_add_f32 v51, v51, v59
    v_add_f32 v52, v52, v60
    v_add_f32 v53, v53, v61
    v_add_f32 v54, v54, v62
    v_add_f32 v55, v55, v63
L_op_red:
    s_cmp_eq_u32 s21, 0
    s_cbranch_scc1 L_op_w0
    ds_write_b128 v11, v[48:51]
    ds_write_b128 v11, v[52:55] offset:1024
    ds_write_b32 v11, v64 offset:2048
    s_waitcnt lgkmcnt(0)
    s_barrier
    s_branch L_op_next
L_op_w0:
    s_barrier
    ds_read_b32 v221, v11 offset:5120
    ds_read_b32 v222, v11 offset:8192
    ds_read_b32 v223, v11 offset:11264
    ds_read_b128 v[196:199], v11 offset:3072
    ds_read_b128 v[200:203], v11 offset:4096
    ds_read_b128 v[204:207], v11 offset:6144
    ds_read_b128 v[208:211], v11 offset:7168
    ds_read_b128 v[212:215], v11 offset:9216
    ds_read_b128 v[216:219], v11 offset:10240
    s_waitcnt lgkmcnt(8)
    v_add_f32 v64, v64, v221
    s_waitcnt lgkmcnt(6)
    v_add_f32 v222, v222, v223
    v_add_f32 v64, v64, v222
    v_mul_f32 v64, 0xbfb8aa3b, v64
    v_exp_f32 v64, v64
    s_nop 0
    v_add_f32 v64, 1.0, v64
    v_rcp_f32 v64, v64
    s_nop 0
    v_sub_f32 v65, 1.0, v64
    v_lshlrev_b32 v56, 16, v44
    v_mul_f32 v56, v56, v65
    v_and_b32 v57, 0xffff0000, v44
    v_mul_f32 v57, v57, v65
    v_lshlrev_b32 v58, 16, v45
    v_mul_f32 v58, v58, v65
    v_and_b32 v59, 0xffff0000, v45
    v_mul_f32 v59, v59, v65
    v_lshlrev_b32 v60, 16, v46
    v_mul_f32 v60, v60, v65
    v_and_b32 v61, 0xffff0000, v46
    v_mul_f32 v61, v61, v65
    v_lshlrev_b32 v62, 16, v47
    v_mul_f32 v62, v62, v65
    v_and_b32 v63, 0xffff0000, v47
    v_mul_f32 v63, v63, v65
    s_waitcnt lgkmcnt(5)
    v_add_f32 v48, v48, v196
    s_waitcnt lgkmcnt(1)
    v_add_f32 v204, v204, v212
    v_add_f32 v48, v48, v204
    v_fmac_f32 v56, v48, v64
    v_add_f32 v49, v49, v197
    v_add_f32 v205, v205, v213
    v_add_f32 v49, v49, v205
    v_fmac_f32 v57, v49, v64
    v_add_f32 v50, v50, v198
    v_add_f32 v206, v206, v214
    v_add_f32 v50, v50, v206
    v_fmac_f32 v58, v50, v64
    v_add_f32 v51, v51, v199
    v_add_f32 v207, v207, v215
    v_add_f32 v51, v51, v207
    v_fmac_f32 v59, v51, v64
    v_add_f32 v52, v52, v200
    s_waitcnt lgkmcnt(0)
    v_add_f32 v208, v208, v216
    v_add_f32 v52, v52, v208
    v_fmac_f32 v60, v52, v64
    v_add_f32 v53, v53, v201
    v_add_f32 v209, v209, v217
    v_add_f32 v53, v53, v209
    v_fmac_f32 v61, v53, v64
    v_add_f32 v54, v54, v202
    v_add_f32 v210, v210, v218
    v_add_f32 v54, v54, v210
    v_fmac_f32 v62, v54, v64
    v_add_f32 v55, v55, v203
    v_add_f32 v211, v211, v219
    v_add_f32 v55, v55, v211
    v_fmac_f32 v63, v55, v64
    v_cvt_pk_bf16_f32 v196, v56, v57
    v_cvt_pk_bf16_f32 v197, v58, v59
    v_cvt_pk_bf16_f32 v198, v60, v61
    v_cvt_pk_bf16_f32 v199, v62, v63
    s_mov_b64 exec, s[52:53]
    buffer_store_dwordx4 v[196:199], v9, s[36:39], s50 offen sc0 sc1 nt
    s_nop 1
L_op_next:
    s_cmp_ge_u32 s44, 48
    s_cbranch_scc1 L_op_n3
    v_xor_b32 v11, 0x4000, v11
    s_add_u32 s47, s47, 65536
    s_add_u32 s46, s46, 524288
    s_add_u32 s45, s45, 2097152
    s_add_u32 s44, s44, 2
    s_branch L_op_loop
L_op_n3:
    s_mov_b64 exec, -1
    s_cmp_ge_u32 s44, 62
    s_cbranch_scc1 L_op_end
    v_xor_b32 v11, 0x4000, v11
    s_bitcmp1_b32 s44, 0
    s_cselect_b32 s40, 4, 2
    s_cmp_ge_u32 s44, 59
    s_cselect_b32 s40, 2, s40
    s_cmp_lt_u32 s44, 55
    s_cselect_b32 s40, 3, s40
    s_cmp_eq_u32 s40, 2
    s_cselect_b64 s[60:61], s[60:61], -1
    s_add_u32 s44, s44, s40
    s_lshl_b32 s41, s40, 15
    s_add_u32 s47, s47, s41
    s_lshl_b32 s41, s40, 18
    s_add_u32 s46, s46, s41
    s_lshl_b32 s41, s40, 20
    s_add_u32 s45, s45, s41
    s_cmp_lt_u32 s44, 61
    s_cbranch_scc1 L_op_loop
    s_mov_b64 s[54:55], -1
    s_mov_b64 s[60:61], -1
    s_sub_u32 s45, s45, 1048576
    s_add_u32 s51, s46, 1008
    v_and_b32 v7, 0x1f0, v2
    v_lshlrev_b32 v7, 6, v7
    s_cmp_eq_u32 s44, 62
    s_cbranch_scc1 L_op_loop
    s_lshr_b32 s56, s42, 5
    s_lshl_b32 s56, s56, 3
    s_lshl_b32 s52, 0x00ff00ff, s56
    s_mov_b32 s53, s52
    s_lshl_b32 s41, s56, 4
    s_add_u32 s51, s46, s41
    s_add_u32 s51, s51, 880
    v_xor_b32 v225, 0x480, v2
    v_cndmask_b32 v225, v225, v2, s[52:53]
    s_branch L_op_loop
    s_nop 0
L_op_half:
    buffer_load_dwordx4 v[68:71], v225, s[8:11], s40 offen sc1
    s_add_u32 s58, s58, 2048
    s_and_b32 s58, s58, 0x7fff
    s_add_u32 s40, s46, s58
    buffer_load_dwordx4 v[72:75], v225, s[8:11], s40 offen sc1
    s_add_u32 s58, s58, 2048
    s_and_b32 s58, s58, 0x7fff
    s_add_u32 s40, s46, s58
    buffer_load_dwordx4 v[76:79], v225, s[8:11], s40 offen sc1
    s_add_u32 s58, s58, 2048
    s_and_b32 s58, s58, 0x7fff
    s_add_u32 s40, s46, s58
    buffer_load_dwordx4 v[80:83], v225, s[8:11], s40 offen sc1
    s_add_u32 s58, s58, 2048
    s_and_b32 s58, s58, 0x7fff
    s_add_u32 s40, s46, s58
    buffer_load_dwordx4 v[84:87], v225, s[8:11], s40 offen sc1
    s_add_u32 s58, s58, 2048
    s_and_b32 s58, s58, 0x7fff
    s_add_u32 s40, s46, s58
    buffer_load_dwordx4 v[88:91], v225, s[8:11], s40 offen sc1
    s_add_u32 s58, s58, 2048
    s_and_b32 s58, s58, 0x7fff
    s_add_u32 s40, s46, s58
    buffer_load_dwordx4 v[92:95], v225, s[8:11], s40 offen sc1
    s_add_u32 s58, s58, 2048
    s_and_b32 s58, s58, 0x7fff
    s_add_u32 s40, s46, s58
    buffer_load_dwordx4 v[96:99], v225, s[8:11], s40 offen sc1
    s_add_u32 s58, s58, 2048
    s_and_b32 s58, s58, 0x7fff
    s_add_u32 s40, s46, s58
    buffer_load_dwordx4 v[100:103], v225, s[8:11], s40 offen sc1
    s_add_u32 s58, s58, 2048
    s_and_b32 s58, s58, 0x7fff
    s_add_u32 s40, s46, s58
    buffer_load_dwordx4 v[104:107], v225, s[8:11], s40 offen sc1
    s_add_u32 s58, s58, 2048
    s_and_b32 s58, s58, 0x7fff
    s_add_u32 s40, s46, s58
    buffer_load_dwordx4 v[108:111], v225, s[8:11], s40 offen sc1
    s_add_u32 s58, s58, 2048
    s_and_b32 s58, s58, 0x7fff
    s_add_u32 s40, s46, s58
    buffer_load_dwordx4 v[112:115], v225, s[8:11], s40 offen sc1
    s_add_u32 s58, s58, 2048
    s_and_b32 s58, s58, 0x7fff
    s_add_u32 s40, s46, s58
    buffer_load_dwordx4 v[116:119], v225, s[8:11], s40 offen sc1
    s_add_u32 s58, s58, 2048
    s_and_b32 s58, s58, 0x7fff
    s_add_u32 s40, s46, s58
    buffer_load_dwordx4 v[120:123], v225, s[8:11], s40 offen sc1
    s_add_u32 s58, s58, 2048
    s_and_b32 s58, s58, 0x7fff
    s_add_u32 s40, s46, s58
    buffer_load_dwordx4 v[124:127], v225, s[8:11], s40 offen sc1
    s_add_u32 s58, s58, 2048
    s_and_b32 s58, s58, 0x7fff
    s_add_u32 s40, s46, s58
    buffer_load_dwordx4 v[128:131], v225, s[8:11], s40 offen sc1
    s_add_u32 s58, s58, 2048
    s_and_b32 s58, s58, 0x7fff
    s_add_u32 s40, s46, s58
    v_mov_b32 v6, 0
    s_waitcnt vmcnt(16)
    v_mfma_f32_16x16x32_bf16 v[64:67], v[12:15], v[28:31], 0
    v_mfma_f32_16x16x32_bf16 v[64:67], v[16:19], v[32:35], v[64:67]
    v_mfma_f32_16x16x32_bf16 v[64:67], v[20:23], v[36:39], v[64:67]
    v_mfma_f32_16x16x32_bf16 v[64:67], v[24:27], v[40:43], v[64:67]
    s_waitcnt vmcnt(15)
    v_mfma_f32_16x16x32_bf16 v[48:51], a[0:3], v[68:71], 0
    v_mfma_f32_16x16x32_bf16 v[52:55], a[4:7], v[68:71], 0
    v_mfma_f32_16x16x32_bf16 v[56:59], a[8:11], v[68:71], 0
    v_mfma_f32_16x16x32_bf16 v[60:63], a[12:15], v[68:71], 0
    s_waitcnt vmcnt(14)
    v_mfma_f32_16x16x32_bf16 v[48:51], a[16:19], v[72:75], v[48:51]
    v_mfma_f32_16x16x32_bf16 v[52:55], a[20:23], v[72:75], v[52:55]
    v_mfma_f32_16x16x32_bf16 v[56:59], a[24:27], v[72:75], v[56:59]
    v_mfma_f32_16x16x32_bf16 v[60:63], a[28:31], v[72:75], v[60:63]
    v_max3_u32 v6, v6, v68, v72
    s_waitcnt vmcnt(13)
    v_mfma_f32_16x16x32_bf16 v[48:51], a[32:35], v[76:79], v[48:51]
    v_mfma_f32_16x16x32_bf16 v[52:55], a[36:39], v[76:79], v[52:55]
    v_mfma_f32_16x16x32_bf16 v[56:59], a[40:43], v[76:79], v[56:59]
    v_mfma_f32_16x16x32_bf16 v[60:63], a[44:47], v[76:79], v[60:63]
    s_waitcnt vmcnt(12)
    v_mfma_f32_16x16x32_bf16 v[48:51], a[48:51], v[80:83], v[48:51]
    v_mfma_f32_16x16x32_bf16 v[52:55], a[52:55], v[80:83], v[52:55]
    v_mfma_f32_16x16x32_bf16 v[56:59], a[56:59], v[80:83], v[56:59]
    v_mfma_f32_16x16x32_bf16 v[60:63], a[60:63], v[80:83], v[60:63]
    v_max3_u32 v6, v6, v76, v80
    s_waitcnt vmcnt(11)
    v_mfma_f32_16x16x32_bf16 v[48:51], a[64:67], v[84:87], v[48:51]
    v_mfma_f32_16x16x32_bf16 v[52:55], a[68:71], v[84:87], v[52:55]
    v_mfma_f32_16x16x32_bf16 v[56:59], a[72:75], v[84:87], v[56:59]
    v_mfma_f32_16x16x32_bf16 v[60:63], a[76:79], v[84:87], v[60:63]
    s_waitcnt vmcnt(10)
    v_mfma_f32_16x16x32_bf16 v[48:51], a[80:83], v[88:91], v[48:51]
    v_mfma_f32_16x16x32_bf16 v[52:55], a[84:87], v[88:91], v[52:55]
    v_mfma_f32_16x16x32_bf16 v[56:59], a[88:91], v[88:91], v[56:59]
    v_mfma_f32_16x16x32_bf16 v[60:63], a[92:95], v[88:91], v[60:63]
    v_max3_u32 v6, v6, v84, v88
    s_waitcnt vmcnt(9)
    v_mfma_f32_16x16x32_bf16 v[48:51], a[96:99], v[92:95], v[48:51]
    v_mfma_f32_16x16x32_bf16 v[52:55], a[100:103], v[92:95], v[52:55]
    v_mfma_f32_16x16x32_bf16 v[56:59], a[104:107], v[92:95], v[56:59]
    v_mfma_f32_16x16x32_bf16 v[60:63], a[108:111], v[92:95], v[60:63]
    s_waitcnt vmcnt(8)
    v_mfma_f32_16x16x32_bf16 v[48:51], a[112:115], v[96:99], v[48:51]
    v_mfma_f32_16x16x32_bf16 v[52:55], a[116:119], v[96:99], v[52:55]
    v_mfma_f32_16x16x32_bf16 v[56:59], a[120:123], v[96:99], v[56:59]
    v_mfma_f32_16x16x32_bf16 v[60:63], a[124:127], v[96:99], v[60:63]
    v_max3_u32 v6, v6, v92, v96
    s_waitcnt vmcnt(7)
    v_mfma_f32_16x16x32_bf16 v[48:51], a[128:131], v[100:103], v[48:51]
    v_mfma_f32_16x16x32_bf16 v[52:55], a[132:135], v[100:103], v[52:55]
    v_mfma_f32_16x16x32_bf16 v[56:59], a[136:139], v[100:103], v[56:59]
    v_mfma_f32_16x16x32_bf16 v[60:63], a[140:143], v[100:103], v[60:63]
    s_waitcnt vmcnt(6)
    v_mfma_f32_16x16x32_bf16 v[48:51], a[144:147], v[104:107], v[48:51]
    v_mfma_f32_16x16x32_bf16 v[52:55], a[148:151], v[104:107], v[52:55]
    v_mfma_f32_16x16x32_bf16 v[56:59], a[152:155], v[104:107], v[56:59]
    v_mfma_f32_16x16x32_bf16 v[60:63], a[156:159], v[104:107], v[60:63]
    v_max3_u32 v6, v6, v100, v104
    s_waitcnt vmcnt(5)
    v_mfma_f32_16x16x32_bf16 v[48:51], a[160:163], v[108:111], v[48:51]
    v_mfma_f32_16x16x32_bf16 v[52:55], a[164:167], v[108:111], v[52:55]
    v_mfma_f32_16x16x32_bf16 v[56:59], a[168:171], v[108:111], v[56:59]
    v_mfma_f32_16x16x32_bf16 v[60:63], a[172:175], v[108:111], v[60:63]
    s_waitcnt vmcnt(4)
    v_mfma_f32_16x16x32_bf16 v[48:51], a[176:179], v[112:115], v[48:51]
    v_mfma_f32_16x16x32_bf16 v[52:55], a[180:183], v[112:115], v[52:55]
    v_mfma_f32_16x16x32_bf16 v[56:59], a[184:187], v[112:115], v[56:59]
    v_mfma_f32_16x16x32_bf16 v[60:63], a[188:191], v[112:115], v[60:63]
    v_max3_u32 v6, v6, v108, v112
    s_waitcnt vmcnt(3)
    v_mfma_f32_16x16x32_bf16 v[48:51], a[192:195], v[116:119], v[48:51]
    v_mfma_f32_16x16x32_bf16 v[52:55], a[196:199], v[116:119], v[52:55]
    v_mfma_f32_16x16x32_bf16 v[56:59], a[200:203], v[116:119], v[56:59]
    v_mfma_f32_16x16x32_bf16 v[60:63], a[204:207], v[116:119], v[60:63]
    s_waitcnt vmcnt(2)
    v_mfma_f32_16x16x32_bf16 v[48:51], a[208:211], v[120:123], v[48:51]
    v_mfma_f32_16x16x32_bf16 v[52:55], a[212:215], v[120:123], v[52:55]
    v_mfma_f32_16x16x32_bf16 v[56:59], a[216:219], v[120:123], v[56:59]
    v_mfma_f32_16x16x32_bf16 v[60:63], a[220:223], v[120:123], v[60:63]
    v_max3_u32 v6, v6, v116, v120
    s_waitcnt vmcnt(1)
    v_mfma_f32_16x16x32_bf16 v[48:51], a[224:227], v[124:127], v[48:51]
    v_mfma_f32_16x16x32_bf16 v[52:55], a[228:231], v[124:127], v[52:55]
    v_mfma_f32_16x16x32_bf16 v[56:59], a[232:235], v[124:127], v[56:59]
    v_mfma_f32_16x16x32_bf16 v[60:63], a[236:239], v[124:127], v[60:63]
    s_waitcnt vmcnt(0)
    v_mfma_f32_16x16x32_bf16 v[48:51], a[240:243], v[128:131], v[48:51]
    v_mfma_f32_16x16x32_bf16 v[52:55], a[244:247], v[128:131], v[52:55]
    v_mfma_f32_16x16x32_bf16 v[56:59], a[248:251], v[128:131], v[56:59]
    v_mfma_f32_16x16x32_bf16 v[60:63], a[252:255], v[128:131], v[60:63]
    v_max3_u32 v6, v6, v124, v128
    v_cmp_eq_u32 vcc, -1, v6
    s_and_b64 vcc, vcc, s[54:55]
    s_cbranch_scc1 L_op_poll
    v_add_f32_dpp v48, v56, v48 row_ror:8 row_mask:0xf bank_mask:0xf
    v_add_f32_dpp v49, v57, v49 row_ror:8 row_mask:0xf bank_mask:0xf
    v_add_f32_dpp v50, v58, v50 row_ror:8 row_mask:0xf bank_mask:0xf
    v_add_f32_dpp v51, v59, v51 row_ror:8 row_mask:0xf bank_mask:0xf
    v_add_f32_dpp v52, v60, v52 row_ror:8 row_mask:0xf bank_mask:0xf
    v_add_f32_dpp v53, v61, v53 row_ror:8 row_mask:0xf bank_mask:0xf
    v_add_f32_dpp v54, v62, v54 row_ror:8 row_mask:0xf bank_mask:0xf
    v_add_f32_dpp v55, v63, v55 row_ror:8 row_mask:0xf bank_mask:0xf
    s_branch L_op_red
    s_nop 0
L_op_end:
    s_mov_b64 exec, -1
    s_waitcnt vmcnt(0)
    s_endpgm
L_chain:
    s_mov_b32 s20, s5
    s_cmp_eq_u32 s21, 1
    s_cbranch_scc1 L_chain_w1
    s_cmp_eq_u32 s21, 2
    s_cbranch_scc1 L_chain_w2
    s_cmp_eq_u32 s21, 3
    s_cbranch_scc1 L_chain_w3
L_chain_w0:
    v_and_b32 v10, 63, v0
    v_lshlrev_b32 v6, 4, v10
    s_mov_b32 s14, 0x400000
    s_mov_b32 s15, 0x20000
    s_mov_b32 s12, s66
    s_mov_b32 s13, s67
    s_lshl_b32 s40, s20, 17
    s_add_u32 s40, s40, 0
    s_mov_b32 m0, 32768
    s_nop 0
    buffer_load_dwordx4 v6, s[12:15], s40 offen lds
    s_add_u32 s40, s40, 1024
    s_mov_b32 m0, 33792
    s_nop 0
    buffer_load_dwordx4 v6, s[12:15], s40 offen lds
    s_add_u32 s40, s40, 1024
    s_mov_b32 m0, 34816
    s_nop 0
    buffer_load_dwordx4 v6, s[12:15], s40 offen lds
    s_add_u32 s40, s40, 1024
    s_mov_b32 m0, 35840
    s_nop 0
    buffer_load_dwordx4 v6, s[12:15], s40 offen lds
    s_add_u32 s40, s40, 1024
    s_mov_b32 m0, 36864
    s_nop 0
    buffer_load_dwordx4 v6, s[12:15], s40 offen lds
    s_add_u32 s40, s40, 1024
    s_mov_b32 m0, 37888
    s_nop 0
    buffer_load_dwordx4 v6, s[12:15], s40 offen lds
    s_add_u32 s40, s40, 1024
    s_mov_b32 m0, 38912
    s_nop 0
    buffer_load_dwordx4 v6, s[12:15], s40 offen lds
    s_add_u32 s40, s40, 1024
    s_mov_b32 m0, 39936
    s_nop 0
    buffer_load_dwordx4 v6, s[12:15], s40 offen lds
    s_mov_b32 s12, s66
    s_mov_b32 s13, s67
    s_lshl_b32 s40, s20, 17
    s_add_u32 s40, s40, 32768
    s_mov_b32 m0, 65536
    s_nop 0
    buffer_load_dwordx4 v6, s[12:15], s40 offen lds
    s_add_u32 s40, s40, 1024
    s_mov_b32 m0, 66560
    s_nop 0
    buffer_load_dwordx4 v6, s[12:15], s40 offen lds
    s_add_u32 s40, s40, 1024
    s_mov_b32 m0, 67584
    s_nop 0
    buffer_load_dwordx4 v6, s[12:15], s40 offen lds
    s_add_u32 s40, s40, 1024
    s_mov_b32 m0, 68608
    s_nop 0
    buffer_load_dwordx4 v6, s[12:15], s40 offen lds
    s_add_u32 s40, s40, 1024
    s_mov_b32 m0, 69632
    s_nop 0
    buffer_load_dwordx4 v6, s[12:15], s40 offen lds
    s_add_u32 s40, s40, 1024
    s_mov_b32 m0, 70656
    s_nop 0
    buffer_load_dwordx4 v6, s[12:15], s40 offen lds
    s_add_u32 s40, s40, 1024
    s_mov_b32 m0, 71680
    s_nop 0
    buffer_load_dwordx4 v6, s[12:15], s40 offen lds
    s_add_u32 s40, s40, 1024
    s_mov_b32 m0, 72704
    s_nop 0
    buffer_load_dwordx4 v6, s[12:15], s40 offen lds
    s_mov_b32 s12, s66
    s_mov_b32 s13, s67
    s_lshl_b32 s40, s20, 17
    s_add_u32 s40, s40, 65536
    s_mov_b32 m0, 98304
    s_nop 0
    buffer_load_dwordx4 v6, s[12:15], s40 offen lds
    s_add_u32 s40, s40, 1024
    s_mov_b32 m0, 99328
    s_nop 0
    buffer_load_dwordx4 v6, s[12:15], s40 offen lds
    s_add_u32 s40, s40, 1024
    s_mov_b32 m0, 100352
    s_nop 0
    buffer_load_dwordx4 v6, s[12:15], s40 offen lds
    s_add_u32 s40, s40, 1024
    s_mov_b32 m0, 101376
    s_nop 0
    buffer_load_dwordx4 v6, s[12:15], s40 offen lds
    s_add_u32 s40, s40, 1024
    s_mov_b32 m0, 102400
    s_nop 0
    buffer_load_dwordx4 v6, s[12:15], s40 offen lds
    s_add_u32 s40, s40, 1024
    s_mov_b32 m0, 103424
    s_nop 0
    buffer_load_dwordx4 v6, s[12:15], s40 offen lds
    s_add_u32 s40, s40, 1024
    s_mov_b32 m0, 104448
    s_nop 0
    buffer_load_dwordx4 v6, s[12:15], s40 offen lds
    s_add_u32 s40, s40, 1024
    s_mov_b32 m0, 105472
    s_nop 0
    buffer_load_dwordx4 v6, s[12:15], s40 offen lds
    s_mov_b32 s12, s66
    s_mov_b32 s13, s67
    s_lshl_b32 s40, s20, 17
    s_add_u32 s40, s40, 98304
    s_mov_b32 m0, 131072
    s_nop 0
    buffer_load_dwordx4 v6, s[12:15], s40 offen lds
    s_add_u32 s40, s40, 1024
    s_mov_b32 m0, 132096
    s_nop 0
    buffer_load_dwordx4 v6, s[12:15], s40 offen lds
    s_add_u32 s40, s40, 1024
    s_mov_b32 m0, 133120
    s_nop 0
    buffer_load_dwordx4 v6, s[12:15], s40 offen lds
    s_add_u32 s40, s40, 1024
    s_mov_b32 m0, 134144
    s_nop 0
    buffer_load_dwordx4 v6, s[12:15], s40 offen lds
    s_add_u32 s40, s40, 1024
    s_mov_b32 m0, 135168
    s_nop 0
    buffer_load_dwordx4 v6, s[12:15], s40 offen lds
    s_add_u32 s40, s40, 1024
    s_mov_b32 m0, 136192
    s_nop 0
    buffer_load_dwordx4 v6, s[12:15], s40 offen lds
    s_add_u32 s40, s40, 1024
    s_mov_b32 m0, 137216
    s_nop 0
    buffer_load_dwordx4 v6, s[12:15], s40 offen lds
    s_add_u32 s40, s40, 1024
    s_mov_b32 m0, 138240
    s_nop 0
    buffer_load_dwordx4 v6, s[12:15], s40 offen lds
    s_or_b32 s4, s23, s21
    s_cselect_b64 exec, 0, 1
    buffer_atomic_or v1, off, s[16:19], s59 sc0
    s_mov_b64 exec, -1
    v_and_b32 v2, 15, v0
    v_lshrrev_b32 v3, 4, v10
    v_lshlrev_b32 v4, 1, v3
    v_xor_b32 v4, v4, v2
    v_xor_b32 v5, 8, v4
    v_lshlrev_b32 v4, 4, v4
    v_lshlrev_b32 v5, 4, v5
    v_lshl_add_u32 v4, v3, 13, v4
    v_lshl_add_u32 v5, v3, 13, v5
    v_lshrrev_b32 v14, 2, v2
    v_and_b32 v15, 1, v3
    v_lshl_or_b32 v15, v15, 2, v14
    v_lshl_add_u32 v14, v3, 3, v14
    v_lshlrev_b32 v14, 8, v14
    v_and_b32 v16, 3, v2
    v_lshl_add_u32 v14, v16, 3, v14
    v_xor_b32 v7, 0, v15
    v_xor_b32 v8, 1, v15
    v_lshl_add_u32 v7, v7, 5, v14
    v_lshl_add_u32 v8, v8, 5, v14
    v_add_u32 v7, 32768, v7
    v_add_u32 v8, 32768, v8
    v_lshlrev_b32 v16, 2, v2
    v_add_u32 v16, 32768, v16
    v_lshl_add_u32 v9, v3, 12, v16
    v_lshrrev_b32 v14, 1, v3
    v_lshl_add_u32 v14, v14, 12, v16
    v_add_u32 v14, 0, v14
    v_and_b32 v15, 1, v3
    v_lshl_add_u32 v11, v15, 14, v14
    v_xor_b32 v15, 1, v15
    v_lshl_add_u32 v12, v15, 14, v14
    s_mov_b32 s41, 0x05040100
    s_mov_b32 s42, 0x07060302
    s_lshl_b32 s37, s20, 6
    s_add_u32 s37, s37, 17580032
    s_waitcnt vmcnt(25)
    s_barrier
    ds_read2st64_b32 v[18:19], v11 offset0:0 offset1:4
    ds_read2st64_b32 v[20:21], v12 offset0:0 offset1:4
    ds_read2st64_b32 v[22:23], v11 offset0:8 offset1:12
    ds_read2st64_b32 v[24:25], v12 offset0:8 offset1:12
    ds_read2st64_b32 v[26:27], v11 offset0:32 offset1:36
    ds_read2st64_b32 v[28:29], v12 offset0:32 offset1:36
    ds_read2st64_b32 v[30:31], v11 offset0:40 offset1:44
    ds_read2st64_b32 v[32:33], v12 offset0:40 offset1:44
    ds_read2st64_b32 v[34:35], v11 offset0:1 offset1:5
    ds_read2st64_b32 v[36:37], v12 offset0:1 offset1:5
    ds_read2st64_b32 v[38:39], v11 offset0:9 offset1:13
    ds_read2st64_b32 v[40:41], v12 offset0:9 offset1:13
    ds_read2st64_b32 v[42:43], v11 offset0:33 offset1:37
    ds_read2st64_b32 v[44:45], v12 offset0:33 offset1:37
    ds_read2st64_b32 v[46:47], v11 offset0:41 offset1:45
    ds_read2st64_b32 v[48:49], v12 offset0:41 offset1:45
    ds_read2st64_b32 v[50:51], v11 offset0:2 offset1:6
    ds_read2st64_b32 v[52:53], v12 offset0:2 offset1:6
    ds_read2st64_b32 v[54:55], v11 offset0:10 offset1:14
    ds_read2st64_b32 v[56:57], v12 offset0:10 offset1:14
    ds_read2st64_b32 v[58:59], v11 offset0:34 offset1:38
    ds_read2st64_b32 v[60:61], v12 offset0:34 offset1:38
    ds_read2st64_b32 v[62:63], v11 offset0:42 offset1:46
    ds_read2st64_b32 v[64:65], v12 offset0:42 offset1:46
    ds_read2st64_b32 v[66:67], v11 offset0:3 offset1:7
    ds_read2st64_b32 v[68:69], v12 offset0:3 offset1:7
    ds_read2st64_b32 v[70:71], v11 offset0:11 offset1:15
    ds_read2st64_b32 v[72:73], v12 offset0:11 offset1:15
    ds_read2st64_b32 v[74:75], v11 offset0:35 offset1:39
    ds_read2st64_b32 v[76:77], v12 offset0:35 offset1:39
    ds_read2st64_b32 v[78:79], v11 offset0:43 offset1:47
    ds_read2st64_b32 v[80:81], v12 offset0:43 offset1:47
    s_waitcnt lgkmcnt(0)
    s_barrier
    s_mov_b32 s12, s64
    s_mov_b32 s13, s65
    s_lshl_b32 s40, s20, 8
    s_add_u32 s40, s40, 0
    s_mov_b32 m0, 32768
    s_nop 0
    buffer_load_dwordx4 v4, s[12:15], s40 offen lds
    s_add_u32 s40, s40, 32768
    s_mov_b32 m0, 33792
    s_nop 0
    buffer_load_dwordx4 v4, s[12:15], s40 offen lds
    s_add_u32 s40, s40, 32768
    s_mov_b32 m0, 34816
    s_nop 0
    buffer_load_dwordx4 v5, s[12:15], s40 offen lds
    s_add_u32 s40, s40, 32768
    s_mov_b32 m0, 35840
    s_nop 0
    buffer_load_dwordx4 v5, s[12:15], s40 offen lds
    s_add_u32 s40, s40, 32768
    s_mov_b32 m0, 36864
    s_nop 0
    buffer_load_dwordx4 v4, s[12:15], s40 offen lds
    s_add_u32 s40, s40, 32768
    s_mov_b32 m0, 37888
    s_nop 0
    buffer_load_dwordx4 v4, s[12:15], s40 offen lds
    s_add_u32 s40, s40, 32768
    s_mov_b32 m0, 38912
    s_nop 0
    buffer_load_dwordx4 v5, s[12:15], s40 offen lds
    s_add_u32 s40, s40, 32768
    s_mov_b32 m0, 39936
    s_nop 0
    buffer_load_dwordx4 v5, s[12:15], s40 offen lds
    v_perm_b32 v82, v19, v18, s41
    v_perm_b32 v83, v21, v20, s42
    v_perm_b32 v84, v23, v22, s41
    v_perm_b32 v85, v25, v24, s42
    v_perm_b32 v86, v27, v26, s41
    v_perm_b32 v87, v29, v28, s42
    v_perm_b32 v88, v31, v30, s41
    v_perm_b32 v89, v33, v32, s42
    v_perm_b32 v144, v35, v34, s41
    v_perm_b32 v145, v37, v36, s42
    v_perm_b32 v146, v39, v38, s41
    v_perm_b32 v147, v41, v40, s42
    v_perm_b32 v148, v43, v42, s41
    v_perm_b32 v149, v45, v44, s42
    v_perm_b32 v150, v47, v46, s41
    v_perm_b32 v151, v49, v48, s42
    v_perm_b32 v152, v51, v50, s41
    v_perm_b32 v153, v53, v52, s42
    v_perm_b32 v154, v55, v54, s41
    v_perm_b32 v155, v57, v56, s42
    v_perm_b32 v156, v59, v58, s41
    v_perm_b32 v157, v61, v60, s42
    v_perm_b32 v158, v63, v62, s41
    v_perm_b32 v159, v65, v64, s42
    v_perm_b32 v90, v67, v66, s41
    v_perm_b32 v91, v69, v68, s42
    v_perm_b32 v92, v71, v70, s41
    v_perm_b32 v93, v73, v72, s42
    v_perm_b32 v94, v75, v74, s41
    v_perm_b32 v95, v77, v76, s42
    v_perm_b32 v96, v79, v78, s41
    v_perm_b32 v97, v81, v80, s42
    v_add_u32 v13, 16384, v6
    ds_write_b128 v13, v[82:85]
    ds_write_b128 v13, v[86:89] offset:1024
    v_add_u32 v13, 24576, v6
    ds_write_b128 v13, v[90:93]
    ds_write_b128 v13, v[94:97] offset:1024
    s_waitcnt vmcnt(25)
    s_barrier
    v_add_u32 v9, 32768, v9
    ds_read2st64_b32 v[18:19], v9 offset0:0 offset1:4
    ds_read2st64_b32 v[20:21], v9 offset0:8 offset1:12
    ds_read2st64_b32 v[22:23], v9 offset0:64 offset1:68
    ds_read2st64_b32 v[24:25], v9 offset0:72 offset1:76
    ds_read2st64_b32 v[26:27], v9 offset0:1 offset1:5
    ds_read2st64_b32 v[28:29], v9 offset0:9 offset1:13
    ds_read2st64_b32 v[30:31], v9 offset0:65 offset1:69
    ds_read2st64_b32 v[32:33], v9 offset0:73 offset1:77
    ds_read2st64_b32 v[34:35], v9 offset0:2 offset1:6
    ds_read2st64_b32 v[36:37], v9 offset0:10 offset1:14
    ds_read2st64_b32 v[38:39], v9 offset0:66 offset1:70
    ds_read2st64_b32 v[40:41], v9 offset0:74 offset1:78
    ds_read2st64_b32 v[42:43], v9 offset0:3 offset1:7
    ds_read2st64_b32 v[44:45], v9 offset0:11 offset1:15
    ds_read2st64_b32 v[46:47], v9 offset0:67 offset1:71
    ds_read2st64_b32 v[48:49], v9 offset0:75 offset1:79
    s_waitcnt lgkmcnt(0)
    s_barrier
    s_mov_b32 s12, s64
    s_mov_b32 s13, s65
    s_lshl_b32 s40, s20, 8
    s_add_u32 s40, s40, 1048576
    s_mov_b32 m0, 65536
    s_nop 0
    buffer_load_dwordx4 v4, s[12:15], s40 offen lds
    s_add_u32 s40, s40, 32768
    s_mov_b32 m0, 66560
    s_nop 0
    buffer_load_dwordx4 v4, s[12:15], s40 offen lds
    s_add_u32 s40, s40, 32768
    s_mov_b32 m0, 67584
    s_nop 0
    buffer_load_dwordx4 v5, s[12:15], s40 offen lds
    s_add_u32 s40, s40, 32768
    s_mov_b32 m0, 68608
    s_nop 0
    buffer_load_dwordx4 v5, s[12:15], s40 offen lds
    s_add_u32 s40, s40, 32768
    s_mov_b32 m0, 69632
    s_nop 0
    buffer_load_dwordx4 v4, s[12:15], s40 offen lds
    s_add_u32 s40, s40, 32768
    s_mov_b32 m0, 70656
    s_nop 0
    buffer_load_dwordx4 v4, s[12:15], s40 offen lds
    s_add_u32 s40, s40, 32768
    s_mov_b32 m0, 71680
    s_nop 0
    buffer_load_dwordx4 v5, s[12:15], s40 offen lds
    s_add_u32 s40, s40, 32768
    s_mov_b32 m0, 72704
    s_nop 0
    buffer_load_dwordx4 v5, s[12:15], s40 offen lds
    v_perm_b32 v160, v19, v18, s41
    v_perm_b32 v161, v19, v18, s42
    v_perm_b32 v162, v21, v20, s41
    v_perm_b32 v163, v21, v20, s42
    v_perm_b32 v164, v23, v22, s41
    v_perm_b32 v165, v23, v22, s42
    v_perm_b32 v166, v25, v24, s41
    v_perm_b32 v167, v25, v24, s42
    v_perm_b32 v82, v27, v26, s41
    v_perm_b32 v83, v27, v26, s42
    v_perm_b32 v84, v29, v28, s41
    v_perm_b32 v85, v29, v28, s42
    v_perm_b32 v86, v31, v30, s41
    v_perm_b32 v87, v31, v30, s42
    v_perm_b32 v88, v33, v32, s41
    v_perm_b32 v89, v33, v32, s42
    v_perm_b32 v90, v35, v34, s41
    v_perm_b32 v91, v35, v34, s42
    v_perm_b32 v92, v37, v36, s41
    v_perm_b32 v93, v37, v36, s42
    v_perm_b32 v94, v39, v38, s41
    v_perm_b32 v95, v39, v38, s42
    v_perm_b32 v96, v41, v40, s41
    v_perm_b32 v97, v41, v40, s42
    v_perm_b32 v216, v43, v42, s41
    v_perm_b32 v217, v43, v42, s42
    v_perm_b32 v218, v45, v44, s41
    v_perm_b32 v219, v45, v44, s42
    v_perm_b32 v220, v47, v46, s41
    v_perm_b32 v221, v47, v46, s42
    v_perm_b32 v222, v49, v48, s41
    v_perm_b32 v223, v49, v48, s42
    s_waitcnt vmcnt(25)
    s_barrier
    v_add_u32 v9, 32768, v9
    ds_read2st64_b32 v[18:19], v9 offset0:0 offset1:4
    ds_read2st64_b32 v[20:21], v9 offset0:8 offset1:12
    ds_read2st64_b32 v[22:23], v9 offset0:64 offset1:68
    ds_read2st64_b32 v[24:25], v9 offset0:72 offset1:76
    ds_read2st64_b32 v[26:27], v9 offset0:1 offset1:5
    ds_read2st64_b32 v[28:29], v9 offset0:9 offset1:13
    ds_read2st64_b32 v[30:31], v9 offset0:65 offset1:69
    ds_read2st64_b32 v[32:33], v9 offset0:73 offset1:77
    ds_read2st64_b32 v[34:35], v9 offset0:2 offset1:6
    ds_read2st64_b32 v[36:37], v9 offset0:10 offset1:14
    ds_read2st64_b32 v[38:39], v9 offset0:66 offset1:70
    ds_read2st64_b32 v[40:41], v9 offset0:74 offset1:78
    ds_read2st64_b32 v[42:43], v9 offset0:3 offset1:7
    ds_read2st64_b32 v[44:45], v9 offset0:11 offset1:15
    ds_read2st64_b32 v[46:47], v9 offset0:67 offset1:71
    ds_read2st64_b32 v[48:49], v9 offset0:75 offset1:79
    s_waitcnt lgkmcnt(0)
    s_barrier
    s_mov_b32 s12, s64
    s_mov_b32 s13, s65
    s_lshl_b32 s40, s20, 8
    s_add_u32 s40, s40, 2097152
    s_mov_b32 m0, 98304
    s_nop 0
    buffer_load_dwordx4 v4, s[12:15], s40 offen lds
    s_add_u32 s40, s40, 32768
    s_mov_b32 m0, 99328
    s_nop 0
    buffer_load_dwordx4 v4, s[12:15], s40 offen lds
    s_add_u32 s40, s40, 32768
    s_mov_b32 m0, 100352
    s_nop 0
    buffer_load_dwordx4 v5, s[12:15], s40 offen lds
    s_add_u32 s40, s40, 32768
    s_mov_b32 m0, 101376
    s_nop 0
    buffer_load_dwordx4 v5, s[12:15], s40 offen lds
    s_add_u32 s40, s40, 32768
    s_mov_b32 m0, 102400
    s_nop 0
    buffer_load_dwordx4 v4, s[12:15], s40 offen lds
    s_add_u32 s40, s40, 32768
    s_mov_b32 m0, 103424
    s_nop 0
    buffer_load_dwordx4 v4, s[12:15], s40 offen lds
    s_add_u32 s40, s40, 32768
    s_mov_b32 m0, 104448
    s_nop 0
    buffer_load_dwordx4 v5, s[12:15], s40 offen lds
    s_add_u32 s40, s40, 32768
    s_mov_b32 m0, 105472
    s_nop 0
    buffer_load_dwordx4 v5, s[12:15], s40 offen lds
    v_perm_b32 v168, v19, v18, s41
    v_perm_b32 v169, v19, v18, s42
    v_perm_b32 v170, v21, v20, s41
    v_perm_b32 v171, v21, v20, s42
    v_perm_b32 v172, v23, v22, s41
    v_perm_b32 v173, v23, v22, s42
    v_perm_b32 v174, v25, v24, s41
    v_perm_b32 v175, v25, v24, s42
    v_perm_b32 v184, v27, v26, s41
    v_perm_b32 v185, v27, v26, s42
    v_perm_b32 v186, v29, v28, s41
    v_perm_b32 v187, v29, v28, s42
    v_perm_b32 v188, v31, v30, s41
    v_perm_b32 v189, v31, v30, s42
    v_perm_b32 v190, v33, v32, s41
    v_perm_b32 v191, v33, v32, s42
    v_perm_b32 v200, v35, v34, s41
    v_perm_b32 v201, v35, v34, s42
    v_perm_b32 v202, v37, v36, s41
    v_perm_b32 v203, v37, v36, s42
    v_perm_b32 v204, v39, v38, s41
    v_perm_b32 v205, v39, v38, s42
    v_perm_b32 v206, v41, v40, s41
    v_perm_b32 v207, v41, v40, s42
    v_perm_b32 v98, v43, v42, s41
    v_perm_b32 v99, v43, v42, s42
    v_perm_b32 v100, v45, v44, s41
    v_perm_b32 v101, v45, v44, s42
    v_perm_b32 v102, v47, v46, s41
    v_perm_b32 v103, v47, v46, s42
    v_perm_b32 v104, v49, v48, s41
    v_perm_b32 v105, v49, v48, s42
    s_waitcnt vmcnt(25)
    s_barrier
    v_add_u32 v9, 32768, v9
    ds_read2st64_b32 v[18:19], v9 offset0:0 offset1:4
    ds_read2st64_b32 v[20:21], v9 offset0:8 offset1:12
    ds_read2st64_b32 v[22:23], v9 offset0:64 offset1:68
    ds_read2st64_b32 v[24:25], v9 offset0:72 offset1:76
    ds_read2st64_b32 v[26:27], v9 offset0:1 offset1:5
    ds_read2st64_b32 v[28:29], v9 offset0:9 offset1:13
    ds_read2st64_b32 v[30:31], v9 offset0:65 offset1:69
    ds_read2st64_b32 v[32:33], v9 offset0:73 offset1:77
    ds_read2st64_b32 v[34:35], v9 offset0:2 offset1:6
    ds_read2st64_b32 v[36:37], v9 offset0:10 offset1:14
    ds_read2st64_b32 v[38:39], v9 offset0:66 offset1:70
    ds_read2st64_b32 v[40:41], v9 offset0:74 offset1:78
    ds_read2st64_b32 v[42:43], v9 offset0:3 offset1:7
    ds_read2st64_b32 v[44:45], v9 offset0:11 offset1:15
    ds_read2st64_b32 v[46:47], v9 offset0:67 offset1:71
    ds_read2st64_b32 v[48:49], v9 offset0:75 offset1:79
    s_waitcnt lgkmcnt(0)
    s_barrier
    s_mov_b32 s12, s64
    s_mov_b32 s13, s65
    s_lshl_b32 s40, s20, 8
    s_add_u32 s40, s40, 3145728
    s_mov_b32 m0, 131072
    s_nop 0
    buffer_load_dwordx4 v4, s[12:15], s40 offen lds
    s_add_u32 s40, s40, 32768
    s_mov_b32 m0, 132096
    s_nop 0
    buffer_load_dwordx4 v4, s[12:15], s40 offen lds
    s_add_u32 s40, s40, 32768
    s_mov_b32 m0, 133120
    s_nop 0
    buffer_load_dwordx4 v5, s[12:15], s40 offen lds
    s_add_u32 s40, s40, 32768
    s_mov_b32 m0, 134144
    s_nop 0
    buffer_load_dwordx4 v5, s[12:15], s40 offen lds
    s_add_u32 s40, s40, 32768
    s_mov_b32 m0, 135168
    s_nop 0
    buffer_load_dwordx4 v4, s[12:15], s40 offen lds
    s_add_u32 s40, s40, 32768
    s_mov_b32 m0, 136192
    s_nop 0
    buffer_load_dwordx4 v4, s[12:15], s40 offen lds
    s_add_u32 s40, s40, 32768
    s_mov_b32 m0, 137216
    s_nop 0
    buffer_load_dwordx4 v5, s[12:15], s40 offen lds
    s_add_u32 s40, s40, 32768
    s_mov_b32 m0, 138240
    s_nop 0
    buffer_load_dwordx4 v5, s[12:15], s40 offen lds
    v_perm_b32 v176, v19, v18, s41
    v_perm_b32 v177, v19, v18, s42
    v_perm_b32 v178, v21, v20, s41
    v_perm_b32 v179, v21, v20, s42
    v_perm_b32 v180, v23, v22, s41
    v_perm_b32 v181, v23, v22, s42
    v_perm_b32 v182, v25, v24, s41
    v_perm_b32 v183, v25, v24, s42
    v_perm_b32 v192, v27, v26, s41
    v_perm_b32 v193, v27, v26, s42
    v_perm_b32 v194, v29, v28, s41
    v_perm_b32 v195, v29, v28, s42
    v_perm_b32 v196, v31, v30, s41
    v_perm_b32 v197, v31, v30, s42
    v_perm_b32 v198, v33, v32, s41
    v_perm_b32 v199, v33, v32, s42
    v_perm_b32 v208, v35, v34, s41
    v_perm_b32 v209, v35, v34, s42
    v_perm_b32 v210, v37, v36, s41
    v_perm_b32 v211, v37, v36, s42
    v_perm_b32 v212, v39, v38, s41
    v_perm_b32 v213, v39, v38, s42
    v_perm_b32 v214, v41, v40, s41
    v_perm_b32 v215, v41, v40, s42
    v_perm_b32 v224, v43, v42, s41
    v_perm_b32 v225, v43, v42, s42
    v_perm_b32 v226, v45, v44, s41
    v_perm_b32 v227, v45, v44, s42
    v_perm_b32 v228, v47, v46, s41
    v_perm_b32 v229, v47, v46, s42
    v_perm_b32 v230, v49, v48, s41
    v_perm_b32 v231, v49, v48, s42
    s_waitcnt vmcnt(24)
    s_barrier
    s_cmp_lg_u32 s23, 0
    s_cbranch_scc1 L_ver_c0
    v_mov_b32 v14, 14336
    s_cmp_lg_u32 s21, 0
    s_cbranch_scc1 L_verw_c0
    s_waitcnt vmcnt(24)
    s_mov_b64 exec, 1
    ds_write_b32 v14, v1
    s_mov_b64 exec, -1
    s_waitcnt lgkmcnt(0)
L_verw_c0:
    s_barrier
    ds_read_b32 v15, v14
    s_waitcnt lgkmcnt(0)
    v_readfirstlane_b32 s4, v15
    s_bitcmp1_b32 s4, s5
    s_cbranch_scc1 L_el_fix
    s_nop 2
L_ver_c0:
    s_cmp_lg_u32 s3, 0
    s_cselect_b32 s40, 0x10000, 0
    s_bitset1_b32 s40, 8
    v_mov_b32 v1, s40
    s_mov_b64 exec, 1
    buffer_atomic_add v1, off, s[16:19], 0 offset:4
    s_mov_b64 exec, -1
    ds_read_b64_tr_b16 a[208:209], v7 offset:0
    ds_read_b64_tr_b16 a[210:211], v7 offset:1024
    ds_read_b64_tr_b16 a[212:213], v7 offset:8192
    ds_read_b64_tr_b16 a[214:215], v7 offset:9216
    ds_read_b64_tr_b16 a[216:217], v8 offset:0
    ds_read_b64_tr_b16 a[218:219], v8 offset:1024
    ds_read_b64_tr_b16 a[220:221], v8 offset:8192
    ds_read_b64_tr_b16 a[222:223], v8 offset:9216
    ds_read_b64_tr_b16 v[18:19], v7 offset:16384
    ds_read_b64_tr_b16 v[20:21], v7 offset:17408
    ds_read_b64_tr_b16 v[22:23], v7 offset:24576
    ds_read_b64_tr_b16 v[24:25], v7 offset:25600
    ds_read_b64_tr_b16 a[224:225], v8 offset:16384
    ds_read_b64_tr_b16 a[226:227], v8 offset:17408
    ds_read_b64_tr_b16 a[228:229], v8 offset:24576
    ds_read_b64_tr_b16 a[230:231], v8 offset:25600
    s_waitcnt lgkmcnt(0)
    s_barrier
    s_mov_b32 s12, s62
    s_mov_b32 s13, s63
    s_lshl_b32 s40, s20, 8
    s_add_u32 s40, s40, 0
    s_mov_b32 m0, 32768
    s_nop 0
    buffer_load_dwordx4 v4, s[12:15], s40 offen lds
    s_add_u32 s40, s40, 32768
    s_mov_b32 m0, 33792
    s_nop 0
    buffer_load_dwordx4 v4, s[12:15], s40 offen lds
    s_add_u32 s40, s40, 32768
    s_mov_b32 m0, 34816
    s_nop 0
    buffer_load_dwordx4 v5, s[12:15], s40 offen lds
    s_add_u32 s40, s40, 32768
    s_mov_b32 m0, 35840
    s_nop 0
    buffer_load_dwordx4 v5, s[12:15], s40 offen lds
    s_add_u32 s40, s40, 32768
    s_mov_b32 m0, 36864
    s_nop 0
    buffer_load_dwordx4 v4, s[12:15], s40 offen lds
    s_add_u32 s40, s40, 32768
    s_mov_b32 m0, 37888
    s_nop 0
    buffer_load_dwordx4 v4, s[12:15], s40 offen lds
    s_add_u32 s40, s40, 32768
    s_mov_b32 m0, 38912
    s_nop 0
    buffer_load_dwordx4 v5, s[12:15], s40 offen lds
    s_add_u32 s40, s40, 32768
    s_mov_b32 m0, 39936
    s_nop 0
    buffer_load_dwordx4 v5, s[12:15], s40 offen lds
    s_waitcnt vmcnt(25)
    s_barrier
    v_add_u32 v7, 32768, v7
    v_add_u32 v8, 32768, v8
    ds_read_b64_tr_b16 v[26:27], v7 offset:0
    ds_read_b64_tr_b16 v[28:29], v7 offset:1024
    ds_read_b64_tr_b16 v[30:31], v7 offset:8192
    ds_read_b64_tr_b16 v[32:33], v7 offset:9216
    ds_read_b64_tr_b16 a[192:193], v8 offset:0
    ds_read_b64_tr_b16 a[194:195], v8 offset:1024
    ds_read_b64_tr_b16 a[196:197], v8 offset:8192
    ds_read_b64_tr_b16 a[198:199], v8 offset:9216
    ds_read_b64_tr_b16 a[232:233], v7 offset:16384
    ds_read_b64_tr_b16 a[234:235], v7 offset:17408
    ds_read_b64_tr_b16 a[236:237], v7 offset:24576
    ds_read_b64_tr_b16 a[238:239], v7 offset:25600
    ds_read_b64_tr_b16 a[240:241], v8 offset:16384
    ds_read_b64_tr_b16 a[242:243], v8 offset:17408
    ds_read_b64_tr_b16 a[244:245], v8 offset:24576
    ds_read_b64_tr_b16 a[246:247], v8 offset:25600
    s_waitcnt lgkmcnt(0)
    s_barrier
    s_mov_b32 s12, s62
    s_mov_b32 s13, s63
    s_lshl_b32 s40, s20, 8
    s_add_u32 s40, s40, 1048576
    s_mov_b32 m0, 65536
    s_nop 0
    buffer_load_dwordx4 v4, s[12:15], s40 offen lds
    s_add_u32 s40, s40, 32768
    s_mov_b32 m0, 66560
    s_nop 0
    buffer_load_dwordx4 v4, s[12:15], s40 offen lds
    s_add_u32 s40, s40, 32768
    s_mov_b32 m0, 67584
    s_nop 0
    buffer_load_dwordx4 v5, s[12:15], s40 offen lds
    s_add_u32 s40, s40, 32768
    s_mov_b32 m0, 68608
    s_nop 0
    buffer_load_dwordx4 v5, s[12:15], s40 offen lds
    s_add_u32 s40, s40, 32768
    s_mov_b32 m0, 69632
    s_nop 0
    buffer_load_dwordx4 v4, s[12:15], s40 offen lds
    s_add_u32 s40, s40, 32768
    s_mov_b32 m0, 70656
    s_nop 0
    buffer_load_dwordx4 v4, s[12:15], s40 offen lds
    s_add_u32 s40, s40, 32768
    s_mov_b32 m0, 71680
    s_nop 0
    buffer_load_dwordx4 v5, s[12:15], s40 offen lds
    s_add_u32 s40, s40, 32768
    s_mov_b32 m0, 72704
    s_nop 0
    buffer_load_dwordx4 v5, s[12:15], s40 offen lds
    s_waitcnt vmcnt(25)
    s_barrier
    v_add_u32 v7, 32768, v7
    v_add_u32 v8, 32768, v8
    ds_read_b64_tr_b16 a[200:201], v7 offset:0
    ds_read_b64_tr_b16 a[202:203], v7 offset:1024
    ds_read_b64_tr_b16 a[204:205], v7 offset:8192
    ds_read_b64_tr_b16 a[206:207], v7 offset:9216
    ds_read_b64_tr_b16 v[34:35], v8 offset:0
    ds_read_b64_tr_b16 v[36:37], v8 offset:1024
    ds_read_b64_tr_b16 v[38:39], v8 offset:8192
    ds_read_b64_tr_b16 v[40:41], v8 offset:9216
    ds_read_b64_tr_b16 v[42:43], v7 offset:16384
    ds_read_b64_tr_b16 v[44:45], v7 offset:17408
    ds_read_b64_tr_b16 v[46:47], v7 offset:24576
    ds_read_b64_tr_b16 v[48:49], v7 offset:25600
    ds_read_b64_tr_b16 a[248:249], v8 offset:16384
    ds_read_b64_tr_b16 a[250:251], v8 offset:17408
    ds_read_b64_tr_b16 a[252:253], v8 offset:24576
    ds_read_b64_tr_b16 a[254:255], v8 offset:25600
    s_waitcnt lgkmcnt(0)
    s_barrier
    s_mov_b32 s12, s62
    s_mov_b32 s13, s63
    s_lshl_b32 s40, s20, 8
    s_add_u32 s40, s40, 2097152
    s_mov_b32 m0, 98304
    s_nop 0
    buffer_load_dwordx4 v4, s[12:15], s40 offen lds
    s_add_u32 s40, s40, 32768
    s_mov_b32 m0, 99328
    s_nop 0
    buffer_load_dwordx4 v4, s[12:15], s40 offen lds
    s_add_u32 s40, s40, 32768
    s_mov_b32 m0, 100352
    s_nop 0
    buffer_load_dwordx4 v5, s[12:15], s40 offen lds
    s_add_u32 s40, s40, 32768
    s_mov_b32 m0, 101376
    s_nop 0
    buffer_load_dwordx4 v5, s[12:15], s40 offen lds
    s_add_u32 s40, s40, 32768
    s_mov_b32 m0, 102400
    s_nop 0
    buffer_load_dwordx4 v4, s[12:15], s40 offen lds
    s_add_u32 s40, s40, 32768
    s_mov_b32 m0, 103424
    s_nop 0
    buffer_load_dwordx4 v4, s[12:15], s40 offen lds
    s_add_u32 s40, s40, 32768
    s_mov_b32 m0, 104448
    s_nop 0
    buffer_load_dwordx4 v5, s[12:15], s40 offen lds
    s_add_u32 s40, s40, 32768
    s_mov_b32 m0, 105472
    s_nop 0
    buffer_load_dwordx4 v5, s[12:15], s40 offen lds
    s_waitcnt vmcnt(25)
    s_barrier
    v_add_u32 v7, 32768, v7
    v_add_u32 v8, 32768, v8
    ds_read_b64_tr_b16 v[232:233], v7 offset:0
    ds_read_b64_tr_b16 v[234:235], v7 offset:1024
    ds_read_b64_tr_b16 v[236:237], v7 offset:8192
    ds_read_b64_tr_b16 v[238:239], v7 offset:9216
    ds_read_b64_tr_b16 v[50:51], v8 offset:0
    ds_read_b64_tr_b16 v[52:53], v8 offset:1024
    ds_read_b64_tr_b16 v[54:55], v8 offset:8192
    ds_read_b64_tr_b16 v[56:57], v8 offset:9216
    ds_read_b64_tr_b16 v[240:241], v7 offset:16384
    ds_read_b64_tr_b16 v[242:243], v7 offset:17408
    ds_read_b64_tr_b16 v[244:245], v7 offset:24576
    ds_read_b64_tr_b16 v[246:247], v7 offset:25600
    ds_read_b64_tr_b16 v[248:249], v8 offset:16384
    ds_read_b64_tr_b16 v[250:251], v8 offset:17408
    ds_read_b64_tr_b16 v[252:253], v8 offset:24576
    ds_read_b64_tr_b16 v[254:255], v8 offset:25600
    s_waitcnt lgkmcnt(0)
    s_barrier
    s_mov_b32 s12, s62
    s_mov_b32 s13, s63
    s_lshl_b32 s40, s20, 8
    s_add_u32 s40, s40, 3145728
    s_mov_b32 m0, 131072
    s_nop 0
    buffer_load_dwordx4 v4, s[12:15], s40 offen lds
    s_add_u32 s40, s40, 32768
    s_mov_b32 m0, 132096
    s_nop 0
    buffer_load_dwordx4 v4, s[12:15], s40 offen lds
    s_add_u32 s40, s40, 32768
    s_mov_b32 m0, 133120
    s_nop 0
    buffer_load_dwordx4 v5, s[12:15], s40 offen lds
    s_add_u32 s40, s40, 32768
    s_mov_b32 m0, 134144
    s_nop 0
    buffer_load_dwordx4 v5, s[12:15], s40 offen lds
    s_add_u32 s40, s40, 32768
    s_mov_b32 m0, 135168
    s_nop 0
    buffer_load_dwordx4 v4, s[12:15], s40 offen lds
    s_add_u32 s40, s40, 32768
    s_mov_b32 m0, 136192
    s_nop 0
    buffer_load_dwordx4 v4, s[12:15], s40 offen lds
    s_add_u32 s40, s40, 32768
    s_mov_b32 m0, 137216
    s_nop 0
    buffer_load_dwordx4 v5, s[12:15], s40 offen lds
    s_add_u32 s40, s40, 32768
    s_mov_b32 m0, 138240
    s_nop 0
    buffer_load_dwordx4 v5, s[12:15], s40 offen lds
    buffer_load_dword v1, off, s[16:19], 0 offset:4 sc1
    s_waitcnt vmcnt(25)
    s_barrier
    v_add_u32 v7, 4294868992, v7
    v_add_u32 v8, 4294868992, v8
    ds_read_b64_tr_b16 a[120:121], v7 offset:0
    ds_read_b64_tr_b16 a[122:123], v7 offset:1024
    ds_read_b64_tr_b16 a[124:125], v7 offset:8192
    ds_read_b64_tr_b16 a[126:127], v7 offset:9216
    ds_read_b64_tr_b16 a[128:129], v8 offset:0
    ds_read_b64_tr_b16 a[130:131], v8 offset:1024
    ds_read_b64_tr_b16 a[132:133], v8 offset:8192
    ds_read_b64_tr_b16 a[134:135], v8 offset:9216
    ds_read_b64_tr_b16 v[58:59], v7 offset:16384
    ds_read_b64_tr_b16 v[60:61], v7 offset:17408
    ds_read_b64_tr_b16 v[62:63], v7 offset:24576
    ds_read_b64_tr_b16 v[64:65], v7 offset:25600
    ds_read_b64_tr_b16 a[136:137], v8 offset:16384
    ds_read_b64_tr_b16 a[138:139], v8 offset:17408
    ds_read_b64_tr_b16 a[140:141], v8 offset:24576
    ds_read_b64_tr_b16 a[142:143], v8 offset:25600
    s_waitcnt lgkmcnt(0)
    s_barrier
    s_mov_b32 s12, s60
    s_mov_b32 s13, s61
    s_lshl_b32 s40, s20, 8
    s_add_u32 s40, s40, 0
    s_mov_b32 m0, 32768
    s_nop 0
    buffer_load_dwordx4 v4, s[12:15], s40 offen lds
    s_add_u32 s40, s40, 32768
    s_mov_b32 m0, 33792
    s_nop 0
    buffer_load_dwordx4 v4, s[12:15], s40 offen lds
    s_add_u32 s40, s40, 32768
    s_mov_b32 m0, 34816
    s_nop 0
    buffer_load_dwordx4 v5, s[12:15], s40 offen lds
    s_add_u32 s40, s40, 32768
    s_mov_b32 m0, 35840
    s_nop 0
    buffer_load_dwordx4 v5, s[12:15], s40 offen lds
    s_add_u32 s40, s40, 32768
    s_mov_b32 m0, 36864
    s_nop 0
    buffer_load_dwordx4 v4, s[12:15], s40 offen lds
    s_add_u32 s40, s40, 32768
    s_mov_b32 m0, 37888
    s_nop 0
    buffer_load_dwordx4 v4, s[12:15], s40 offen lds
    s_add_u32 s40, s40, 32768
    s_mov_b32 m0, 38912
    s_nop 0
    buffer_load_dwordx4 v5, s[12:15], s40 offen lds
    s_add_u32 s40, s40, 32768
    s_mov_b32 m0, 39936
    s_nop 0
    buffer_load_dwordx4 v5, s[12:15], s40 offen lds
    s_waitcnt vmcnt(25)
    s_barrier
    v_add_u32 v7, 32768, v7
    v_add_u32 v8, 32768, v8
    ds_read_b64_tr_b16 a[16:17], v7 offset:0
    ds_read_b64_tr_b16 a[18:19], v7 offset:1024
    ds_read_b64_tr_b16 a[20:21], v7 offset:8192
    ds_read_b64_tr_b16 a[22:23], v7 offset:9216
    ds_read_b64_tr_b16 a[24:25], v8 offset:0
    ds_read_b64_tr_b16 a[26:27], v8 offset:1024
    ds_read_b64_tr_b16 a[28:29], v8 offset:8192
    ds_read_b64_tr_b16 a[30:31], v8 offset:9216
    ds_read_b64_tr_b16 a[144:145], v7 offset:16384
    ds_read_b64_tr_b16 a[146:147], v7 offset:17408
    ds_read_b64_tr_b16 a[148:149], v7 offset:24576
    ds_read_b64_tr_b16 a[150:151], v7 offset:25600
    ds_read_b64_tr_b16 v[66:67], v8 offset:16384
    ds_read_b64_tr_b16 v[68:69], v8 offset:17408
    ds_read_b64_tr_b16 v[70:71], v8 offset:24576
    ds_read_b64_tr_b16 v[72:73], v8 offset:25600
    s_waitcnt lgkmcnt(0)
    s_barrier
    s_mov_b32 s12, s60
    s_mov_b32 s13, s61
    s_lshl_b32 s40, s20, 8
    s_add_u32 s40, s40, 1048576
    s_mov_b32 m0, 65536
    s_nop 0
    buffer_load_dwordx4 v4, s[12:15], s40 offen lds
    s_add_u32 s40, s40, 32768
    s_mov_b32 m0, 66560
    s_nop 0
    buffer_load_dwordx4 v4, s[12:15], s40 offen lds
    s_add_u32 s40, s40, 32768
    s_mov_b32 m0, 67584
    s_nop 0
    buffer_load_dwordx4 v5, s[12:15], s40 offen lds
    s_add_u32 s40, s40, 32768
    s_mov_b32 m0, 68608
    s_nop 0
    buffer_load_dwordx4 v5, s[12:15], s40 offen lds
    s_add_u32 s40, s40, 32768
    s_mov_b32 m0, 69632
    s_nop 0
    buffer_load_dwordx4 v4, s[12:15], s40 offen lds
    s_add_u32 s40, s40, 32768
    s_mov_b32 m0, 70656
    s_nop 0
    buffer_load_dwordx4 v4, s[12:15], s40 offen lds
    s_add_u32 s40, s40, 32768
    s_mov_b32 m0, 71680
    s_nop 0
    buffer_load_dwordx4 v5, s[12:15], s40 offen lds
    s_add_u32 s40, s40, 32768
    s_mov_b32 m0, 72704
    s_nop 0
    buffer_load_dwordx4 v5, s[12:15], s40 offen lds
    s_waitcnt vmcnt(25)
    s_barrier
    v_add_u32 v7, 32768, v7
    v_add_u32 v8, 32768, v8
    ds_read_b64_tr_b16 a[40:41], v7 offset:0
    ds_read_b64_tr_b16 a[42:43], v7 offset:1024
    ds_read_b64_tr_b16 a[44:45], v7 offset:8192
    ds_read_b64_tr_b16 a[46:47], v7 offset:9216
    ds_read_b64_tr_b16 a[48:49], v8 offset:0
    ds_read_b64_tr_b16 a[50:51], v8 offset:1024
    ds_read_b64_tr_b16 a[52:53], v8 offset:8192
    ds_read_b64_tr_b16 a[54:55], v8 offset:9216
    ds_read_b64_tr_b16 a[152:153], v7 offset:16384
    ds_read_b64_tr_b16 a[154:155], v7 offset:17408
    ds_read_b64_tr_b16 a[156:157], v7 offset:24576
    ds_read_b64_tr_b16 a[158:159], v7 offset:25600
    ds_read_b64_tr_b16 a[160:161], v8 offset:16384
    ds_read_b64_tr_b16 a[162:163], v8 offset:17408
    ds_read_b64_tr_b16 a[164:165], v8 offset:24576
    ds_read_b64_tr_b16 a[166:167], v8 offset:25600
    s_waitcnt lgkmcnt(0)
    s_barrier
    s_mov_b32 s12, s60
    s_mov_b32 s13, s61
    s_lshl_b32 s40, s20, 8
    s_add_u32 s40, s40, 2097152
    s_mov_b32 m0, 98304
    s_nop 0
    buffer_load_dwordx4 v4, s[12:15], s40 offen lds
    s_add_u32 s40, s40, 32768
    s_mov_b32 m0, 99328
    s_nop 0
    buffer_load_dwordx4 v4, s[12:15], s40 offen lds
    s_add_u32 s40, s40, 32768
    s_mov_b32 m0, 100352
    s_nop 0
    buffer_load_dwordx4 v5, s[12:15], s40 offen lds
    s_add_u32 s40, s40, 32768
    s_mov_b32 m0, 101376
    s_nop 0
    buffer_load_dwordx4 v5, s[12:15], s40 offen lds
    s_add_u32 s40, s40, 32768
    s_mov_b32 m0, 102400
    s_nop 0
    buffer_load_dwordx4 v4, s[12:15], s40 offen lds
    s_add_u32 s40, s40, 32768
    s_mov_b32 m0, 103424
    s_nop 0
    buffer_load_dwordx4 v4, s[12:15], s40 offen lds
    s_add_u32 s40, s40, 32768
    s_mov_b32 m0, 104448
    s_nop 0
    buffer_load_dwordx4 v5, s[12:15], s40 offen lds
    s_add_u32 s40, s40, 32768
    s_mov_b32 m0, 105472
    s_nop 0
    buffer_load_dwordx4 v5, s[12:15], s40 offen lds
    s_waitcnt vmcnt(25)
    s_barrier
    v_add_u32 v7, 32768, v7
    v_add_u32 v8, 32768, v8
    ds_read_b64_tr_b16 v[74:75], v7 offset:0
    ds_read_b64_tr_b16 v[76:77], v7 offset:1024
    ds_read_b64_tr_b16 v[78:79], v7 offset:8192
    ds_read_b64_tr_b16 v[80:81], v7 offset:9216
    ds_read_b64_tr_b16 a[168:169], v8 offset:0
    ds_read_b64_tr_b16 a[170:171], v8 offset:1024
    ds_read_b64_tr_b16 a[172:173], v8 offset:8192
    ds_read_b64_tr_b16 a[174:175], v8 offset:9216
    ds_read_b64_tr_b16 a[176:177], v7 offset:16384
    ds_read_b64_tr_b16 a[178:179], v7 offset:17408
    ds_read_b64_tr_b16 a[180:181], v7 offset:24576
    ds_read_b64_tr_b16 a[182:183], v7 offset:25600
    ds_read_b64_tr_b16 a[184:185], v8 offset:16384
    ds_read_b64_tr_b16 a[186:187], v8 offset:17408
    ds_read_b64_tr_b16 a[188:189], v8 offset:24576
    ds_read_b64_tr_b16 a[190:191], v8 offset:25600
    s_waitcnt lgkmcnt(0)
    s_barrier
    s_mov_b32 s12, s60
    s_mov_b32 s13, s61
    s_lshl_b32 s40, s20, 8
    s_add_u32 s40, s40, 3145728
    s_mov_b32 m0, 131072
    s_nop 0
    buffer_load_dwordx4 v4, s[12:15], s40 offen lds
    s_add_u32 s40, s40, 32768
    s_mov_b32 m0, 132096
    s_nop 0
    buffer_load_dwordx4 v4, s[12:15], s40 offen lds
    s_add_u32 s40, s40, 32768
    s_mov_b32 m0, 133120
    s_nop 0
    buffer_load_dwordx4 v5, s[12:15], s40 offen lds
    s_add_u32 s40, s40, 32768
    s_mov_b32 m0, 134144
    s_nop 0
    buffer_load_dwordx4 v5, s[12:15], s40 offen lds
    s_add_u32 s40, s40, 32768
    s_mov_b32 m0, 135168
    s_nop 0
    buffer_load_dwordx4 v4, s[12:15], s40 offen lds
    s_add_u32 s40, s40, 32768
    s_mov_b32 m0, 136192
    s_nop 0
    buffer_load_dwordx4 v4, s[12:15], s40 offen lds
    s_add_u32 s40, s40, 32768
    s_mov_b32 m0, 137216
    s_nop 0
    buffer_load_dwordx4 v5, s[12:15], s40 offen lds
    s_add_u32 s40, s40, 32768
    s_mov_b32 m0, 138240
    s_nop 0
    buffer_load_dwordx4 v5, s[12:15], s40 offen lds
    s_waitcnt vmcnt(24)
    s_barrier
    v_add_u32 v7, 4294868992, v7
    v_add_u32 v8, 4294868992, v8
    ds_read_b64_tr_b16 v[106:107], v7 offset:0
    ds_read_b64_tr_b16 v[108:109], v7 offset:1024
    ds_read_b64_tr_b16 v[110:111], v7 offset:8192
    ds_read_b64_tr_b16 v[112:113], v7 offset:9216
    ds_read_b64_tr_b16 a[56:57], v8 offset:0
    ds_read_b64_tr_b16 a[58:59], v8 offset:1024
    ds_read_b64_tr_b16 a[60:61], v8 offset:8192
    ds_read_b64_tr_b16 a[62:63], v8 offset:9216
    ds_read_b64_tr_b16 a[64:65], v7 offset:16384
    ds_read_b64_tr_b16 a[66:67], v7 offset:17408
    ds_read_b64_tr_b16 a[68:69], v7 offset:24576
    ds_read_b64_tr_b16 a[70:71], v7 offset:25600
    ds_read_b64_tr_b16 a[72:73], v8 offset:16384
    ds_read_b64_tr_b16 a[74:75], v8 offset:17408
    ds_read_b64_tr_b16 a[76:77], v8 offset:24576
    ds_read_b64_tr_b16 a[78:79], v8 offset:25600
    s_waitcnt lgkmcnt(0)
    s_barrier
    v_add_u32 v13, 32768, v6
    ds_write_b128 v13, v[82:85]
    ds_write_b128 v13, v[86:89] offset:1024
    v_add_u32 v13, 40960, v6
    ds_write_b128 v13, v[90:93]
    ds_write_b128 v13, v[94:97] offset:1024
    v_add_u32 v13, 49152, v6
    ds_write_b128 v13, v[98:101]
    ds_write_b128 v13, v[102:105] offset:1024
    v_add_u32 v13, 57344, v6
    ds_write_b128 v13, v[18:21]
    ds_write_b128 v13, v[22:25] offset:1024
    v_readfirstlane_b32 s74, v1
    s_and_b32 s40, s74, 0xffff
    s_cmp_eq_u32 s40, 8224
    s_cbranch_scc1 L_c0_rdy
    s_nop 1
L_c0_rdyl:
    buffer_load_dword v1, off, s[16:19], 0 offset:4 sc1
    s_sub_u32 s22, s22, 1
    s_cbranch_scc1 L_exit
    s_waitcnt vmcnt(0)
    v_readfirstlane_b32 s74, v1
    s_and_b32 s40, s74, 0xffff
    s_cmp_lg_u32 s40, 8224
    s_cbranch_scc1 L_c0_rdyl
    s_nop 1
L_c0_rdy:
    s_waitcnt vmcnt(16)
    s_barrier
    v_add_u32 v7, 32768, v7
    v_add_u32 v8, 32768, v8
    ds_read_b64_tr_b16 a[0:1], v7 offset:0
    ds_read_b64_tr_b16 a[2:3], v7 offset:1024
    ds_read_b64_tr_b16 a[4:5], v7 offset:8192
    ds_read_b64_tr_b16 a[6:7], v7 offset:9216
    ds_read_b64_tr_b16 a[8:9], v8 offset:0
    ds_read_b64_tr_b16 a[10:11], v8 offset:1024
    ds_read_b64_tr_b16 a[12:13], v8 offset:8192
    ds_read_b64_tr_b16 a[14:15], v8 offset:9216
    ds_read_b64_tr_b16 v[18:19], v7 offset:16384
    ds_read_b64_tr_b16 v[20:21], v7 offset:17408
    ds_read_b64_tr_b16 v[22:23], v7 offset:24576
    ds_read_b64_tr_b16 v[24:25], v7 offset:25600
    ds_read_b64_tr_b16 a[80:81], v8 offset:16384
    ds_read_b64_tr_b16 a[82:83], v8 offset:17408
    ds_read_b64_tr_b16 a[84:85], v8 offset:24576
    ds_read_b64_tr_b16 a[86:87], v8 offset:25600
    s_waitcnt lgkmcnt(0)
    s_barrier
    v_add_u32 v13, 65536, v6
    ds_write_b128 v13, v[26:29]
    ds_write_b128 v13, v[30:33] offset:1024
    v_add_u32 v13, 73728, v6
    ds_write_b128 v13, v[34:37]
    ds_write_b128 v13, v[38:41] offset:1024
    v_add_u32 v13, 81920, v6
    ds_write_b128 v13, v[42:45]
    ds_write_b128 v13, v[46:49] offset:1024
    v_add_u32 v13, 90112, v6
    ds_write_b128 v13, v[50:53]
    ds_write_b128 v13, v[54:57] offset:1024
    v_and_b32 v14, 1, v10
    v_lshlrev_b32 v14, 20, v14
    v_add_u32 v14, s37, v14
    buffer_load_dword v1, v14, s[8:11], 0 offen sc1
    s_waitcnt vmcnt(9)
    s_barrier
    v_add_u32 v7, 32768, v7
    v_add_u32 v8, 32768, v8
    ds_read_b64_tr_b16 a[32:33], v7 offset:0
    ds_read_b64_tr_b16 a[34:35], v7 offset:1024
    ds_read_b64_tr_b16 a[36:37], v7 offset:8192
    ds_read_b64_tr_b16 a[38:39], v7 offset:9216
    ds_read_b64_tr_b16 v[26:27], v8 offset:0
    ds_read_b64_tr_b16 v[28:29], v8 offset:1024
    ds_read_b64_tr_b16 v[30:31], v8 offset:8192
    ds_read_b64_tr_b16 v[32:33], v8 offset:9216
    ds_read_b64_tr_b16 a[88:89], v7 offset:16384
    ds_read_b64_tr_b16 a[90:91], v7 offset:17408
    ds_read_b64_tr_b16 a[92:93], v7 offset:24576
    ds_read_b64_tr_b16 a[94:95], v7 offset:25600
    ds_read_b64_tr_b16 v[34:35], v8 offset:16384
    ds_read_b64_tr_b16 v[36:37], v8 offset:17408
    ds_read_b64_tr_b16 v[38:39], v8 offset:24576
    ds_read_b64_tr_b16 v[40:41], v8 offset:25600
    s_waitcnt lgkmcnt(0)
    s_barrier
    v_add_u32 v13, 98304, v6
    ds_write_b128 v13, v[58:61]
    ds_write_b128 v13, v[62:65] offset:1024
    v_add_u32 v13, 106496, v6
    ds_write_b128 v13, v[66:69]
    ds_write_b128 v13, v[70:73] offset:1024
    v_add_u32 v13, 114688, v6
    ds_write_b128 v13, v[74:77]
    ds_write_b128 v13, v[78:81] offset:1024
    v_add_u32 v13, 122880, v6
    ds_write_b128 v13, v[106:109]
    ds_write_b128 v13, v[110:113] offset:1024
    s_waitcnt vmcnt(1)
    s_barrier
    v_add_u32 v7, 32768, v7
    v_add_u32 v8, 32768, v8
    ds_read_b64_tr_b16 a[96:97], v7 offset:0
    ds_read_b64_tr_b16 a[98:99], v7 offset:1024
    ds_read_b64_tr_b16 a[100:101], v7 offset:8192
    ds_read_b64_tr_b16 a[102:103], v7 offset:9216
    ds_read_b64_tr_b16 a[104:105], v8 offset:0
    ds_read_b64_tr_b16 a[106:107], v8 offset:1024
    ds_read_b64_tr_b16 a[108:109], v8 offset:8192
    ds_read_b64_tr_b16 a[110:111], v8 offset:9216
    ds_read_b64_tr_b16 v[42:43], v7 offset:16384
    ds_read_b64_tr_b16 v[44:45], v7 offset:17408
    ds_read_b64_tr_b16 v[46:47], v7 offset:24576
    ds_read_b64_tr_b16 v[48:49], v7 offset:25600
    ds_read_b64_tr_b16 a[112:113], v8 offset:16384
    ds_read_b64_tr_b16 a[114:115], v8 offset:17408
    ds_read_b64_tr_b16 a[116:117], v8 offset:24576
    ds_read_b64_tr_b16 a[118:119], v8 offset:25600
    s_waitcnt lgkmcnt(0)
    s_barrier
    v_add_u32 v13, 131072, v6
    ds_write_b128 v13, v[18:21]
    ds_write_b128 v13, v[22:25] offset:1024
    v_add_u32 v13, 139264, v6
    ds_write_b128 v13, v[26:29]
    ds_write_b128 v13, v[30:33] offset:1024
    v_add_u32 v13, 147456, v6
    ds_write_b128 v13, v[34:37]
    ds_write_b128 v13, v[38:41] offset:1024
    v_add_u32 v13, 155648, v6
    ds_write_b128 v13, v[42:45]
    ds_write_b128 v13, v[46:49] offset:1024
    s_waitcnt vmcnt(0)
    v_cmp_eq_u32 vcc, -1, v1
    s_cbranch_vccz L_c0_kv
    s_nop 3
L_c0_kvl:
    buffer_load_dword v1, v14, s[8:11], 0 offen sc1
    s_sub_u32 s22, s22, 1
    s_cbranch_scc1 L_exit
    s_waitcnt vmcnt(0)
    v_cmp_eq_u32 vcc, -1, v1
    s_cbranch_vccnz L_c0_kvl
    s_nop 3
L_c0_kv:
    s_lshl_b32 s34, s20, 12
    s_add_u32 s34, s34, 16777216
    s_add_u32 s72, s34, 0x40000
    v_add_u32 v14, 0x20000, v6
    s_lshl_b32 s29, s20, 13
    s_add_u32 s29, s29, 0
    s_waitcnt lgkmcnt(0)
    buffer_load_dwordx4 v[80:83], v6, s[8:11], s34 offen sc1
    buffer_load_dwordx4 v[84:87], v14, s[8:11], s34 offen sc1
    buffer_load_dwordx4 v[88:91], v6, s[8:11], s72 offen sc1
    buffer_load_dwordx4 v[92:95], v14, s[8:11], s72 offen sc1
    buffer_load_dwordx4 v[96:99], v6, s[8:11], s29 offen offset:0 sc1
    buffer_load_dwordx4 v[100:103], v6, s[8:11], s29 offen offset:1024 sc1
    s_lshl_b32 s36, s20, 6
    s_add_u32 s36, s36, 0
    v_mbcnt_lo_u32_b32 v141, -1, 0
    v_mbcnt_hi_u32_b32 v141, -1, v141
    v_and_b32 v106, 15, v141
    v_lshrrev_b32 v107, 4, v141
    v_lshrrev_b32 v108, 2, v106
    v_bfe_u32 v109, v106, 1, 1
    v_and_b32 v123, 1, v106
    v_lshl_add_u32 v122, v108, 1, v123
    s_mov_b32 s24, 0xcccccccc
    s_mov_b32 s25, 0xcccccccc
    s_mov_b32 s26, 0x33333333
    s_mov_b32 s27, 0x33333333
    s_mov_b32 s70, 0x3f803f80
    s_mov_b32 s71, 0x3f803f80
    v_lshlrev_b32 v127, 4, v141
    v_add_u32 v128, 0x10000, v127
    v_add_u32 v129, 0x20000, v127
    v_mov_b32 v126, 0x4444
    v_mov_b32 v124, 0xeeee
    v_cndmask_b32 v126, v126, v124, s[24:25]
    v_lshlrev_b32 v123, 4, v123
    v_mov_b32 v124, 0x3f80
    v_lshlrev_b32 v124, v123, v124
    v_cndmask_b32 v124, v124, 0, s[24:25]
    v_cmp_eq_u32 vcc, 0, v108
    s_nop 1
    v_cndmask_b32 v114, 0, v124, vcc
    v_cmp_eq_u32 vcc, 1, v108
    s_nop 1
    v_cndmask_b32 v115, 0, v124, vcc
    v_cmp_eq_u32 vcc, 2, v108
    s_nop 1
    v_cndmask_b32 v116, 0, v124, vcc
    v_cmp_eq_u32 vcc, 3, v108
    s_nop 1
    v_cndmask_b32 v117, 0, v124, vcc
    ds_write_b128 v127, v[114:117] offset:13312
    v_mov_b32 v118, 0
    v_mov_b32 v119, 0
    v_mov_b32 v120, 0
    v_mov_b32 v121, 0
    v_mov_b32 v123, 12800
    ds_write_b128 v123, v[118:121]
    v_lshrrev_b32 v123, 3, v106
    v_lshlrev_b32 v123, 15, v123
    v_lshl_add_u32 v123, v107, 13, v123
    v_and_b32 v124, 7, v106
    v_lshl_add_u32 v123, v124, 3, v123
    v_lshrrev_b32 v124, 11, v123
    v_add_u32 v124, s20, v124
    v_add_u32 v124, 0, v124
    v_and_b32 v124, 31, v124
    v_lshl_add_u32 v123, v124, 6, v123
    v_add_u32 v130, 0, v123
    s_mov_b32 s69, 4096
    v_and_b32 v124, 3, v106
    v_lshlrev_b32 v123, 4, v107
    v_lshl_add_u32 v123, v124, 2, v123
    v_add_u32 v123, s36, v123
    v_mov_b32 v124, 0x40000000
    v_cmp_gt_u32 vcc, 4, v106
    s_nop 1
    v_cndmask_b32 v131, v124, v123, vcc
    s_lshl_b32 s40, s20, 8
    v_add_u32 v123, s40, v127
    v_cmp_gt_u32 vcc, 16, v141
    s_nop 1
    v_cndmask_b32 v137, v124, v123, vcc
    s_lshl_b32 s35, s20, 4
    s_add_u32 s35, s35, 262144
    v_xor_b32 v125, v107, v108
    v_lshlrev_b32 v125, 3, v125
    v_lshl_add_u32 v143, v106, 5, v125
    v_lshlrev_b32 v125, 3, v141
    v_lshlrev_b32 v123, 3, v107
    v_xor_b32 v140, v125, v123
    v_lshrrev_b32 v125, 1, v107
    v_lshl_add_u32 v125, v122, 2, v125
    v_lshlrev_b32 v125, 4, v125
    v_and_b32 v123, 1, v107
    v_lshl_add_u32 v125, v123, 2, v125
    v_lshl_add_u32 v125, v109, 1, v125
    v_add_u32 v132, 12288, v125
    v_lshl_add_u32 v123, v122, 2, v107
    v_lshlrev_b32 v123, 4, v123
    v_add_u32 v123, 12288, v123
    v_mov_b32 v124, 12800
    v_cndmask_b32 v133, v123, v124, s[24:25]
    v_cndmask_b32 v134, v124, v123, s[24:25]
    v_mul_u32_u24 v123, 288, v122
    v_lshl_add_u32 v124, v109, 5, v123
    v_lshl_add_u32 v135, v107, 3, v124
    v_lshl_add_u32 v136, v107, 4, v123
    v_lshlrev_b32 v124, 7, v141
    v_mov_b32 v125, 0x40000000
    v_cmp_gt_u32 vcc, 0, v141
    s_nop 1
    v_cndmask_b32 v124, v125, v124, vcc
    s_add_u32 s40, s36, 18612224
    s_sub_u32 s40, s40, s34
    v_mov_b32 v125, s40
    v_cmp_gt_u32 vcc, 32, v141
    s_nop 1
    v_cndmask_b32 v124, v125, v124, vcc
    s_add_u32 s40, s37, 1048576
    s_sub_u32 s40, s40, s34
    v_mov_b32 v125, s40
    v_cmp_gt_u32 vcc, 33, v141
    s_nop 1
    v_cndmask_b32 v124, v125, v124, vcc
    v_mov_b32 v125, 0x40000000
    v_cmp_gt_u32 vcc, 33, v141
    s_nop 1
    v_cndmask_b32 v139, v125, v124, vcc
    buffer_load_dword v138, v139, s[8:11], s34 offen sc1
    s_mov_b32 s30, 17565696
    s_mov_b32 s68, 17567744
    s_mov_b32 s32, 17563648
    s_mov_b32 s33, 17571840
    s_mov_b32 s28, 0
    s_mov_b32 s38, 0
    s_mov_b32 s39, 1040356334
    s_mov_b32 s44, 729808896
    s_mov_b32 s45, 671088640
    v_lshlrev_b32 v123, 9, v141
    v_mov_b32 v124, 0x40000000
    v_cmp_gt_u32 vcc, 2, v141
    s_nop 1
    v_cndmask_b32 v137, v124, v123, vcc
    s_mov_b32 s31, 262144
    s_lshr_b32 s5, s74, 16
    s_cmp_eq_u32 s5, 0
    s_cbranch_scc0 L_chain_slow0
    s_add_u32 s34, s34, 1048576
    s_add_u32 s72, s72, 1048576
    s_add_u32 s37, s37, 1048576
    s_mov_b32 s43, 1
    s_mov_b32 s28, 1
    ds_read_b128 v[32:35], v129 offset:8192
    ds_read_b128 v[36:39], v129 offset:9216
    ds_read_b128 v[40:43], v128 offset:57344
    ds_read_b128 v[44:47], v128 offset:58368
    v_mov_b64 v[56:57], 0
    v_mov_b64 v[58:59], 0
    v_mov_b64 v[60:61], 0
    v_mov_b64 v[62:63], 0
    v_mov_b64 v[64:65], 0
    v_mov_b64 v[66:67], 0
    v_mov_b64 v[68:69], 0
    v_mov_b64 v[70:71], 0
    v_mov_b64 v[72:73], 0
    v_mov_b64 v[74:75], 0
    v_mov_b64 v[76:77], 0
    v_mov_b64 v[78:79], 0
    v_mov_b32 v142, s43
    s_waitcnt lgkmcnt(0)
    buffer_load_dwordx4 v[8:11], v127, s[8:11], s30 offen sc1
    buffer_load_dwordx4 v[16:19], v127, s[8:11], s68 offen sc1
    s_branch LF0_bAw
.p2align 6
LF0_pollP:
    s_waitcnt vmcnt(1)
    v_mfma_f32_16x16x32_bf16 v[110:113], v[122:125], v[0:3], 0
    v_bitop3_b32 v141, v0, s28, 1 bitop3:0x28
    s_waitcnt vmcnt(0)
    v_mfma_f32_16x16x32_bf16 v[110:113], v[122:125], v[4:7], v[110:113]
    v_bitop3_b32 v141, v4, s28, v141 bitop3:0x28
    v_cmp_ne_u32 vcc, 1, v141
    s_nop 2
    s_cbranch_vccnz LF0_retryP
LF0_Pok:
    s_nop 0
    v_add_f32_dpp v110, v110, v110 row_ror:4 row_mask:0xf bank_mask:0xf
    v_add_f32_dpp v111, v111, v111 row_ror:4 row_mask:0xf bank_mask:0xf
    s_cmp_ge_u32 s38, 63
    v_add_f32_dpp v110, v110, v110 row_ror:8 row_mask:0xf bank_mask:0xf
    v_add_f32_dpp v111, v111, v111 row_ror:8 row_mask:0xf bank_mask:0xf
    v_cvt_pk_bf16_f32 v112, v110, v111
LF0_Mst:
    buffer_store_dword v112, v131, s[8:11], s32 offen
    s_cbranch_scc1 LF0_done
    s_waitcnt vmcnt(0)
    v_mov_b64 v[88:89], v[96:97]
    v_mov_b64 v[90:91], v[98:99]
    v_mov_b64 v[92:93], v[100:101]
    s_nop 9
    buffer_load_dwordx4 v[8:11], v127, s[8:11], s30 offen sc1
    v_mov_b64 v[94:95], v[102:103]
    v_mov_b64 v[80:81], v[48:49]
    v_mov_b64 v[82:83], v[50:51]
    v_mov_b64 v[84:85], v[52:53]
    v_mov_b64 v[86:87], v[54:55]
    v_mov_b64 v[56:57], 0
    v_mov_b64 v[58:59], 0
    v_mov_b64 v[60:61], 0
    v_mov_b64 v[62:63], 0
    v_mov_b64 v[64:65], 0
    v_mov_b64 v[66:67], 0
    v_mov_b64 v[68:69], 0
    v_mov_b64 v[70:71], 0
    v_mov_b64 v[72:73], 0
    v_mov_b64 v[74:75], 0
    v_mov_b64 v[76:77], 0
    v_mov_b64 v[78:79], 0
    s_add_u32 s34, s34, 1048576
    s_add_u32 s72, s72, 1048576
    ds_read_b128 v[32:35], v129 offset:8192
    ds_read_b128 v[36:39], v129 offset:9216
    ds_read_b128 v[40:43], v128 offset:57344
    ds_read_b128 v[44:47], v128 offset:58368
    buffer_load_dwordx4 v[16:19], v127, s[8:11], s68 offen sc1
LF0_bAw:
    s_waitcnt vmcnt(1)
LF0_bA:
    v_cmp_eq_u32 vcc, -1, v8
    v_smfmac_f32_16x16x64_bf16 v[56:59], v[8:11], a[0:7], v126
    ds_write_b128 v127, v[8:11] offset:2048
    v_smfmac_f32_16x16x64_bf16 v[60:63], v[8:11], a[8:15], v126
    s_cbranch_vccnz LF0_retryE
    s_waitcnt vmcnt(0)
    v_cmp_eq_u32 vcc, -1, v16
    v_smfmac_f32_16x16x64_bf16 v[64:67], v[8:11], a[16:23], v126
    ds_write_b128 v127, v[16:19] offset:4096
    v_smfmac_f32_16x16x64_bf16 v[68:71], v[8:11], a[24:31], v126
    s_cbranch_vccnz LF0_retryL
LF0_Lok:
    v_smfmac_f32_16x16x64_bf16 v[56:59], v[16:19], a[32:39], v126
    s_waitcnt lgkmcnt(4)
    v_smfmac_f32_16x16x64_bf16 v[60:63], v[16:19], v[32:39], v126
    ds_read_b128 v[36:39], v129 offset:1024
    s_waitcnt lgkmcnt(2)
    s_waitcnt lgkmcnt(1)
    s_barrier
    ds_read_b128 v[0:3], v127 offset:0
    v_smfmac_f32_16x16x64_bf16 v[64:67], v[16:19], a[40:47], v126
    ds_read_b128 v[32:35], v129 offset:0
    ds_read_b128 v[4:7], v127 offset:1024
    v_smfmac_f32_16x16x64_bf16 v[68:71], v[16:19], a[48:55], v126
    buffer_load_dwordx4 v[96:99], v127, s[8:11], s72 offen sc1
    ds_read_b128 v[12:15], v127 offset:3072
    ds_read_b128 v[20:23], v127 offset:5120
    s_waitcnt lgkmcnt(4)
    v_smfmac_f32_16x16x64_bf16 v[56:59], v[0:3], v[40:47], v126
    ds_read_b128 v[44:47], v129 offset:17408
    v_smfmac_f32_16x16x64_bf16 v[60:63], v[0:3], a[56:63], v126
    ds_read_b128 v[24:27], v127 offset:6144
    s_waitcnt lgkmcnt(4)
    v_smfmac_f32_16x16x64_bf16 v[56:59], v[4:7], a[64:71], v126
    ds_read_b128 v[40:43], v129 offset:16384
    v_smfmac_f32_16x16x64_bf16 v[60:63], v[4:7], a[72:79], v126
    buffer_load_dwordx4 v[100:103], v129, s[8:11], s72 offen sc1
    s_waitcnt lgkmcnt(4)
    v_smfmac_f32_16x16x64_bf16 v[56:59], v[12:15], v[32:39], v126
    ds_read_b128 v[36:39], v129 offset:25600
    v_mov_b64 v[124:125], s[70:71]
    v_smfmac_f32_16x16x64_bf16 v[60:63], v[12:15], a[80:87], v126
    ds_read_b128 v[32:35], v129 offset:24576
    s_waitcnt lgkmcnt(5)
    v_smfmac_f32_16x16x64_bf16 v[56:59], v[20:23], a[88:95], v126
    ds_read_b128 v[28:31], v127 offset:7168
    s_waitcnt lgkmcnt(3)
    v_smfmac_f32_16x16x64_bf16 v[60:63], v[20:23], v[40:47], v126
    ds_read_b128 v[40:43], v128 offset:32768
    v_smfmac_f32_16x16x64_bf16 v[56:59], v[24:27], a[96:103], v126
    ds_read_b128 v[44:47], v128 offset:33792
    v_smfmac_f32_16x16x64_bf16 v[60:63], v[24:27], a[104:111], v126
    buffer_load_dword v138, v139, s[8:11], s34 offen sc1
    s_waitcnt lgkmcnt(2)
    v_smfmac_f32_16x16x64_bf16 v[56:59], v[28:31], v[32:39], v126
    buffer_load_dwordx4 v[48:51], v127, s[8:11], s34 offen sc1
    v_smfmac_f32_16x16x64_bf16 v[60:63], v[28:31], a[112:119], v126
    ds_read_b128 v[32:35], v128 offset:40960
    v_smfmac_f32_16x16x64_bf16 v[64:67], v[0:3], a[120:127], v126
    ds_read_b128 v[36:39], v128 offset:41984
    v_add_f32 v57, v57, v59
    v_smfmac_f32_16x16x64_bf16 v[68:71], v[0:3], a[128:135], v126
    v_add_f32 v56, v56, v58
    s_waitcnt lgkmcnt(2)
    v_smfmac_f32_16x16x64_bf16 v[64:67], v[4:7], v[40:47], v126
    ds_read_b128 v[40:43], v128 offset:49152
    v_add_f32 v60, v60, v62
    v_smfmac_f32_16x16x64_bf16 v[68:71], v[4:7], a[136:143], v126
    buffer_load_dwordx4 v[52:55], v129, s[8:11], s34 offen sc1
    v_smfmac_f32_16x16x64_bf16 v[64:67], v[12:15], a[144:151], v126
    ds_read_b128 v[44:47], v128 offset:50176
    v_cvt_pk_bf16_f32 v56, v56, v57
    v_add_f32 v61, v61, v63
    v_cvt_pk_bf16_f32 v57, v60, v61
    s_waitcnt lgkmcnt(2)
    v_smfmac_f32_16x16x64_bf16 v[68:71], v[12:15], v[32:39], v126
    ds_write_b64 v143, v[56:57] offset:8192
    v_smfmac_f32_16x16x64_bf16 v[64:67], v[20:23], a[152:159], v126
    ds_read_b128 v[36:39], v128 offset:1024
    v_smfmac_f32_16x16x64_bf16 v[68:71], v[20:23], a[160:167], v126
    ds_read_b128 v[32:35], v128 offset:0
    v_mov_b64 v[122:123], s[70:71]
    s_waitcnt lgkmcnt(3)
    v_smfmac_f32_16x16x64_bf16 v[64:67], v[24:27], v[40:47], v126
    ds_read_b128 v[44:47], v128 offset:9216
    v_smfmac_f32_16x16x64_bf16 v[68:71], v[24:27], a[168:175], v126
    s_waitcnt lgkmcnt(3)
    s_barrier
    v_smfmac_f32_16x16x64_bf16 v[64:67], v[28:31], a[176:183], v126
    ds_read_b64_tr_b16 v[56:57], v140 offset:8192
    ds_read_b64_tr_b16 v[58:59], v140 offset:8704
    v_smfmac_f32_16x16x64_bf16 v[68:71], v[28:31], a[184:191], v126
    ds_read_b64_tr_b16 v[62:63], v140 offset:9728
    ds_read_b64_tr_b16 v[60:61], v140 offset:9216
    s_waitcnt lgkmcnt(5)
    v_smfmac_f32_16x16x64_bf16 v[72:75], v[8:11], v[32:39], v126
    ds_read_b128 v[40:43], v128 offset:8192
    v_add_f32 v65, v65, v67
    v_smfmac_f32_16x16x64_bf16 v[76:79], v[8:11], a[192:199], v126
    ds_read_b128 v[36:39], v127 offset:58368
    v_add_f32 v68, v68, v70
    v_smfmac_f32_16x16x64_bf16 v[72:75], v[16:19], a[200:207], v126
    ds_read_b128 v[32:35], v127 offset:57344
    v_add_f32 v69, v69, v71
    s_waitcnt lgkmcnt(5)
    v_mfma_f32_16x16x32_bf16 v[106:109], v[80:83], v[56:59], 0
    v_add_f32 v64, v64, v66
    v_cvt_pk_bf16_f32 v64, v64, v65
    s_waitcnt lgkmcnt(3)
    v_mfma_f32_16x16x32_bf16 v[106:109], v[84:87], v[60:63], v[106:109]
    v_cvt_pk_bf16_f32 v65, v68, v69
    s_waitcnt lgkmcnt(2)
    v_smfmac_f32_16x16x64_bf16 v[76:79], v[16:19], v[40:47], v126
    ds_write_b64 v143, v[64:65] offset:10240
    v_smfmac_f32_16x16x64_bf16 v[72:75], v[0:3], a[208:215], v126
    ds_read_b128 v[40:43], v128 offset:16384
    v_cndmask_b32 v107, v107, v108, s[24:25]
    v_cndmask_b32 v106, v106, v109, s[24:25]
    v_smfmac_f32_16x16x64_bf16 v[76:79], v[0:3], a[216:223], v126
    ds_read_b128 v[44:47], v128 offset:17408
    v_add_f32_dpp v104, v107, v106 quad_perm:[2,3,0,1] row_mask:0xf bank_mask:0xf
    v_exp_f32 v141, v104
    v_mov_b64 v[2:3], 0
    v_cvt_pk_bf16_f32 v141, v141, v141
    s_waitcnt lgkmcnt(3)
    v_smfmac_f32_16x16x64_bf16 v[72:75], v[4:7], v[32:39], v126
    ds_write_b16 v132, v141
    v_smfmac_f32_16x16x64_bf16 v[76:79], v[4:7], a[224:231], v126
    v_mov_b64 v[6:7], 0
    v_smfmac_f32_16x16x64_bf16 v[72:75], v[12:15], a[232:239], v126
    ds_read_b128 v[32:35], v128 offset:24576
    v_mov_b64 v[0:1], 0
    v_smfmac_f32_16x16x64_bf16 v[76:79], v[12:15], a[240:247], v126
    ds_read_b128 v[36:39], v128 offset:25600
    s_waitcnt lgkmcnt(2)
    s_barrier
    v_smfmac_f32_16x16x64_bf16 v[72:75], v[20:23], v[40:47], v126
    ds_read_b64_tr_b16 v[64:65], v140 offset:10240
    ds_read_b64_tr_b16 v[66:67], v140 offset:10752
    v_smfmac_f32_16x16x64_bf16 v[76:79], v[20:23], a[248:255], v126
    ds_read_b64_tr_b16 v[70:71], v140 offset:11776
    ds_read_b64_tr_b16 v[68:69], v140 offset:11264
    v_smfmac_f32_16x16x64_bf16 v[72:75], v[24:27], v[232:239], v126
    ds_read_b128 v[110:113], v133
    v_mov_b64 v[10:11], 0
    s_waitcnt lgkmcnt(5)
    v_smfmac_f32_16x16x64_bf16 v[76:79], v[24:27], v[32:39], v126
    ds_read_b128 v[32:35], v127 offset:24576
    v_mov_b64 v[12:13], 0
    v_smfmac_f32_16x16x64_bf16 v[72:75], v[28:31], v[240:247], v126
    ds_read_b128 v[44:47], v127 offset:17408
    v_mov_b64 v[14:15], 0
    s_waitcnt lgkmcnt(5)
    v_mfma_f32_16x16x32_bf16 v[106:109], v[64:67], v[56:59], 0
    ds_read_b128 v[114:117], v134
    v_mov_b64 v[4:5], 0
    s_waitcnt lgkmcnt(4)
    v_mfma_f32_16x16x32_bf16 v[106:109], v[68:71], v[60:63], v[106:109]
    v_add_f32 v73, v73, v75
    v_mov_b32 v71, s43
    s_waitcnt lgkmcnt(3)
    v_mfma_f32_16x16x32_bf16 v[64:67], v[122:125], v[110:113], 0
    v_add_f32 v72, v72, v74
    v_cvt_pk_bf16_f32 v72, v72, v73
    v_mfma_f32_16x16x32_bf16 v[118:121], v[88:91], v[110:113], 0
    v_cndmask_b32 v107, v107, v108, s[24:25]
    v_cndmask_b32 v106, v106, v109, s[24:25]
    v_smfmac_f32_16x16x64_bf16 v[76:79], v[28:31], v[248:255], v126
    ds_read_b128 v[36:39], v127 offset:25600
    v_add_f32_dpp v105, v107, v106 quad_perm:[2,3,0,1] row_mask:0xf bank_mask:0xf
    v_mul_f32 v105, s39, v105
    v_exp_f32 v107, v105
    s_waitcnt lgkmcnt(1)
    v_mfma_f32_16x16x32_bf16 v[118:121], v[92:95], v[114:117], v[118:121]
    v_mov_b32_dpp v108, v107 quad_perm:[2,3,0,1] row_mask:0xf bank_mask:0xf
    v_cvt_pk_bf16_f32 v107, v107, v108
    v_cndmask_b32 v69, 0, v107, s[24:25]
    v_cndmask_b32 v68, v107, 0, s[24:25]
    v_add_f32 v77, v77, v79
    v_add_f32 v76, v76, v78
    v_mfma_f32_16x16x16_bf16 v[64:67], v[122:123], v[68:69], v[64:67]
    v_cvt_pk_bf16_f32 v73, v77, v76
    ds_read_b128 v[40:43], v127 offset:16384
    s_nop 0
    v_mfma_f32_16x16x16_bf16 v[118:121], v[72:73], v[68:69], v[118:121]
    buffer_store_dword v71, v137, s[8:11], s35 offen
    s_nop 2
    v_rcp_f32_dpp v141, v64 quad_perm:[0,1,0,1] row_mask:0xf bank_mask:0xf
    v_subrev_u32 v142, s44, v64
    v_mov_b64 v[8:9], 0
    v_cmp_le_u32 vcc, s45, v142
LF0_norm:
    v_mul_f32 v118, v118, v141
    v_mul_f32 v119, v119, v141
    v_mul_f32 v120, v120, v141
    v_mul_f32 v121, v121, v141
    v_cvt_pk_bf16_f32 v60, v118, v119
    v_cvt_pk_bf16_f32 v61, v120, v121
    ds_write_b64 v135, v[60:61] offset:5120
    s_and_b64 vcc, vcc, s[26:27]
    s_cbranch_scc1 LF0_fallback
    buffer_load_dword v138, v127, s[8:11], s31 offen sc1
    v_mov_b32_dpp v62, v60 quad_perm:[2,3,0,1] row_mask:0xf bank_mask:0xf
    v_mov_b32_dpp v63, v61 quad_perm:[2,3,0,1] row_mask:0xf bank_mask:0xf
    s_waitcnt lgkmcnt(1)
    s_nop 0
    v_smfmac_f32_16x16x64_bf16 v[0:3], v[60:63], v[40:47], v126
    ds_read_b128 v[44:47], v127 offset:33792
    ds_read_b128 v[40:43], v127 offset:32768
    v_smfmac_f32_16x16x64_bf16 v[4:7], v[60:63], v[144:151], v126
    s_waitcnt lgkmcnt(2)
    s_barrier
    ds_read_b128 v[106:109], v136 offset:5184
    v_smfmac_f32_16x16x64_bf16 v[8:11], v[60:63], v[152:159], v126
    ds_read_b128 v[110:113], v136 offset:5248
    ds_read_b128 v[16:19], v136 offset:5312
    v_smfmac_f32_16x16x64_bf16 v[12:15], v[60:63], v[32:39], v126
    ds_read_b128 v[36:39], v127 offset:41984
    s_waitcnt lgkmcnt(3)
    v_smfmac_f32_16x16x64_bf16 v[0:3], v[106:109], v[160:167], v126
    ds_read_b128 v[32:35], v127 offset:40960
    s_waitcnt lgkmcnt(3)
    v_smfmac_f32_16x16x64_bf16 v[0:3], v[110:113], v[168:175], v126
    s_waitcnt lgkmcnt(2)
    v_smfmac_f32_16x16x64_bf16 v[0:3], v[16:19], v[176:183], v126
    v_smfmac_f32_16x16x64_bf16 v[4:7], v[106:109], v[40:47], v126
    ds_read_b128 v[40:43], v127 offset:49152
    v_smfmac_f32_16x16x64_bf16 v[4:7], v[110:113], v[184:191], v126
    ds_read_b128 v[44:47], v127 offset:50176
    v_cvt_pk_bf16_f32 v114, v0, v2
    v_smfmac_f32_16x16x64_bf16 v[4:7], v[16:19], v[192:199], v126
    v_and_or_b32 v114, v114, -2, s28
    v_cvt_pk_bf16_f32 v115, v1, v3
    s_waitcnt lgkmcnt(2)
    v_smfmac_f32_16x16x64_bf16 v[8:11], v[106:109], v[32:39], v126
    buffer_store_dwordx2 v[114:115], v130, s[8:11], 0 offen offset:0
    v_smfmac_f32_16x16x64_bf16 v[8:11], v[110:113], v[200:207], v126
    v_cvt_pk_bf16_f32 v116, v4, v6
    v_smfmac_f32_16x16x64_bf16 v[8:11], v[16:19], v[208:215], v126
    v_cvt_pk_bf16_f32 v117, v5, v7
    v_and_or_b32 v116, v116, -2, s28
    v_smfmac_f32_16x16x64_bf16 v[12:15], v[106:109], v[216:223], v126
    buffer_store_dwordx2 v[116:117], v130, s[8:11], 0 offen offset:2048
    s_waitcnt lgkmcnt(0)
    v_smfmac_f32_16x16x64_bf16 v[12:15], v[110:113], v[40:47], v126
    v_cvt_pk_bf16_f32 v119, v9, v11
    v_cvt_pk_bf16_f32 v118, v8, v10
    v_and_or_b32 v118, v118, -2, s28
    buffer_store_dwordx2 v[118:119], v130, s[8:11], s69 offen offset:0
    v_smfmac_f32_16x16x64_bf16 v[12:15], v[16:19], v[224:231], v126
    s_nop 7
    v_cvt_pk_bf16_f32 v120, v12, v14
    v_and_or_b32 v120, v120, -2, s28
    v_cvt_pk_bf16_f32 v121, v13, v15
    buffer_store_dwordx2 v[120:121], v130, s[8:11], s69 offen offset:2048
    s_waitcnt vmcnt(4)
    v_cmp_gt_u32 vcc, s43, v138
    ds_read_b128 v[122:125], v127 offset:13312
    s_waitcnt vmcnt(4)
    s_add_u32 s30, s30, 1048576
    s_add_u32 s68, s68, 1048576
    s_cbranch_vccnz LF0_lead
LF0_leadok:
    s_barrier
    s_add_u32 s33, s33, 1048576
    s_add_u32 s37, s37, 1048576
    s_add_u32 s32, s32, 1048576
    s_add_u32 s38, s38, 1
    s_xor_b32 s28, s28, 1
    s_add_u32 s43, s43, 1
    buffer_load_dwordx4 v[0:3], v127, s[8:11], s29 offen sc1
    buffer_load_dwordx4 v[4:7], v127, s[8:11], s29 offen offset:1024 sc1
    s_waitcnt lgkmcnt(0)
    s_branch LF0_pollP
LF0_done:
    buffer_store_dword v112, v131, s[8:11], s33 offen sc1
    s_waitcnt vmcnt(0)
    s_endpgm
LF0_retryE:
    buffer_load_dwordx4 v[8:11], v127, s[8:11], s30 offen sc1
    buffer_load_dwordx4 v[16:19], v127, s[8:11], s68 offen sc1
    s_sub_u32 s22, s22, 1
    s_cbranch_scc1 L_exit
    s_nop 3
    v_mov_b64 v[56:57], 0
    v_mov_b64 v[58:59], 0
    v_mov_b64 v[60:61], 0
    v_mov_b64 v[62:63], 0
    s_waitcnt vmcnt(1)
    s_branch LF0_bA
LF0_retryL:
    buffer_load_dwordx4 v[16:19], v127, s[8:11], s68 offen sc1
    s_sub_u32 s22, s22, 1
    s_cbranch_scc1 L_exit
    s_waitcnt vmcnt(0)
    v_cmp_eq_u32 vcc, -1, v16
    s_cbranch_vccnz LF0_retryL
    ds_write_b128 v127, v[16:19] offset:4096
    s_waitcnt lgkmcnt(0)
    s_branch LF0_Lok
    s_nop 0
LF0_retryP:
    buffer_load_dwordx4 v[0:3], v127, s[8:11], s29 offen sc1
    buffer_load_dwordx4 v[4:7], v127, s[8:11], s29 offen offset:1024 sc1
    s_sub_u32 s22, s22, 1
    s_cbranch_scc1 L_exit
    s_branch LF0_pollP
.p2align 5
LF0_lead:
    s_nop 5
    s_branch LF0_leadok
LF0_fallback:
    s_nop 7
    v_lshlrev_b32 v142, 1, v132
    v_subrev_u32 v142, 20480, v142
    ds_write_b32 v142, v104
    v_min_u32 v142, v133, v134
    v_lshlrev_b32 v142, 1, v142
    v_subrev_u32 v142, 20480, v142
    s_waitcnt lgkmcnt(0)
    s_barrier
    ds_read_b128 v[56:59], v142
    ds_read_b128 v[60:63], v142 offset:16
    s_waitcnt lgkmcnt(1)
    v_max3_f32 v141, v56, v57, v58
    s_waitcnt lgkmcnt(0)
    v_max3_f32 v141, v141, v59, v60
    v_max3_f32 v141, v141, v61, v62
    v_max3_f32 v141, v141, v63, v105
    s_nop 1
    v_max_f32_dpp v141, v141, v141 quad_perm:[2,3,0,1] row_mask:0xf bank_mask:0xf
    v_mov_b32 v142, v141
    s_nop 1
    v_permlane16_swap_b32 v141, v142
    v_max_f32 v141, v141, v142
    v_mov_b32 v142, v141
    s_nop 1
    v_permlane32_swap_b32 v141, v142
    v_max_f32 v141, v141, v142
    v_sub_f32 v56, v56, v141
    v_exp_f32 v56, v56
    v_sub_f32 v57, v57, v141
    v_exp_f32 v57, v57
    v_sub_f32 v58, v58, v141
    v_exp_f32 v58, v58
    v_sub_f32 v59, v59, v141
    v_exp_f32 v59, v59
    v_sub_f32 v60, v60, v141
    v_exp_f32 v60, v60
    v_sub_f32 v61, v61, v141
    v_exp_f32 v61, v61
    v_sub_f32 v62, v62, v141
    v_exp_f32 v62, v62
    v_sub_f32 v63, v63, v141
    v_exp_f32 v63, v63
    v_sub_f32 v107, v105, v141
    v_exp_f32 v107, v107
    s_nop 1
    v_mov_b32_dpp v108, v107 quad_perm:[2,3,0,1] row_mask:0xf bank_mask:0xf
    v_cvt_pk_bf16_f32 v107, v107, v108
    v_cndmask_b32 v68, v107, 0, s[24:25]
    v_cndmask_b32 v69, 0, v107, s[24:25]
    v_cvt_pk_bf16_f32 v142, v56, v57
    v_cndmask_b32 v110, v142, 0, s[24:25]
    v_cndmask_b32 v114, 0, v142, s[24:25]
    v_cvt_pk_bf16_f32 v142, v58, v59
    v_cndmask_b32 v111, v142, 0, s[24:25]
    v_cndmask_b32 v115, 0, v142, s[24:25]
    v_cvt_pk_bf16_f32 v142, v60, v61
    v_cndmask_b32 v112, v142, 0, s[24:25]
    v_cndmask_b32 v116, 0, v142, s[24:25]
    v_cvt_pk_bf16_f32 v142, v62, v63
    v_cndmask_b32 v113, v142, 0, s[24:25]
    v_cndmask_b32 v117, 0, v142, s[24:25]
    s_nop 0
    v_mfma_f32_16x16x32_bf16 v[118:121], v[88:91], v[110:113], 0
    v_mfma_f32_16x16x32_bf16 v[118:121], v[92:95], v[114:117], v[118:121]
    v_mfma_f32_16x16x32_bf16 v[64:67], v[122:125], v[110:113], 0
    s_nop 5
    v_mfma_f32_16x16x16_bf16 v[64:67], v[122:123], v[68:69], v[64:67]
    v_mfma_f32_16x16x16_bf16 v[118:121], v[72:73], v[68:69], v[118:121]
    s_nop 3
    v_rcp_f32_dpp v141, v64 quad_perm:[0,1,0,1] row_mask:0xf bank_mask:0xf
    s_mov_b64 vcc, 0
    s_nop 1
    s_branch LF0_norm
L_chain_slow0:
    s_add_u32 s34, s34, 1048576
    s_add_u32 s72, s72, 1048576
    s_add_u32 s37, s37, 1048576
    s_mov_b32 s43, 1
    s_mov_b32 s28, 1
    ds_read_b128 v[32:35], v129 offset:8192
    ds_read_b128 v[36:39], v129 offset:9216
    ds_read_b128 v[40:43], v128 offset:57344
    ds_read_b128 v[44:47], v128 offset:58368
    v_mov_b64 v[56:57], 0
    v_mov_b64 v[58:59], 0
    v_mov_b64 v[60:61], 0
    v_mov_b64 v[62:63], 0
    v_mov_b64 v[64:65], 0
    v_mov_b64 v[66:67], 0
    v_mov_b64 v[68:69], 0
    v_mov_b64 v[70:71], 0
    v_mov_b64 v[72:73], 0
    v_mov_b64 v[74:75], 0
    v_mov_b64 v[76:77], 0
    v_mov_b64 v[78:79], 0
    v_mov_b32 v142, s43
    s_waitcnt lgkmcnt(0)
    buffer_load_dwordx4 v[8:11], v127, s[8:11], s30 offen sc1
    buffer_load_dwordx4 v[16:19], v127, s[8:11], s68 offen sc1
    s_branch LS0_bAw
LS0_pollP:
    s_waitcnt vmcnt(1)
    v_mfma_f32_16x16x32_bf16 v[110:113], v[122:125], v[0:3], 0
    v_bitop3_b32 v141, v0, s28, 1 bitop3:0x28
    v_bitop3_b32 v141, v2, s28, v141 bitop3:0x28
    s_waitcnt vmcnt(0)
    v_mfma_f32_16x16x32_bf16 v[110:113], v[122:125], v[4:7], v[110:113]
    v_bitop3_b32 v141, v4, s28, v141 bitop3:0x28
    v_bitop3_b32 v141, v6, s28, v141 bitop3:0x28
    v_cmp_ne_u32 vcc, 1, v141
    s_nop 2
    s_cbranch_vccnz LS0_retryP
LS0_Pok:
    v_add_f32_dpp v110, v110, v110 row_ror:4 row_mask:0xf bank_mask:0xf
    v_add_f32_dpp v111, v111, v111 row_ror:4 row_mask:0xf bank_mask:0xf
    s_cmp_ge_u32 s38, 63
    v_add_f32_dpp v110, v110, v110 row_ror:8 row_mask:0xf bank_mask:0xf
    v_add_f32_dpp v111, v111, v111 row_ror:8 row_mask:0xf bank_mask:0xf
    v_cvt_pk_bf16_f32 v112, v110, v111
LS0_Mst:
    buffer_store_dword v112, v131, s[8:11], s32 offen sc1
    s_cbranch_scc1 LS0_done
    s_waitcnt vmcnt(0)
    v_mov_b64 v[88:89], v[96:97]
    v_mov_b64 v[90:91], v[98:99]
    v_mov_b64 v[92:93], v[100:101]
    s_nop 9
    buffer_load_dwordx4 v[8:11], v127, s[8:11], s30 offen sc1
    v_mov_b64 v[94:95], v[102:103]
    v_mov_b64 v[80:81], v[48:49]
    v_mov_b64 v[82:83], v[50:51]
    v_mov_b64 v[84:85], v[52:53]
    v_mov_b64 v[86:87], v[54:55]
    v_mov_b64 v[56:57], 0
    v_mov_b64 v[58:59], 0
    v_mov_b64 v[60:61], 0
    v_mov_b64 v[62:63], 0
    v_mov_b64 v[64:65], 0
    v_mov_b64 v[66:67], 0
    v_mov_b64 v[68:69], 0
    v_mov_b64 v[70:71], 0
    v_mov_b64 v[72:73], 0
    v_mov_b64 v[74:75], 0
    v_mov_b64 v[76:77], 0
    v_mov_b64 v[78:79], 0
    s_add_u32 s34, s34, 1048576
    s_add_u32 s72, s72, 1048576
    ds_read_b128 v[32:35], v129 offset:8192
    ds_read_b128 v[36:39], v129 offset:9216
    ds_read_b128 v[40:43], v128 offset:57344
    ds_read_b128 v[44:47], v128 offset:58368
    buffer_load_dwordx4 v[16:19], v127, s[8:11], s68 offen sc1
LS0_bAw:
    s_waitcnt vmcnt(1)
LS0_bA:
    v_max3_u32 v141, v8, v9, v10
    v_max_u32 v141, v141, v11
    v_cmp_eq_u32 vcc, -1, v141
    v_smfmac_f32_16x16x64_bf16 v[56:59], v[8:11], a[0:7], v126
    v_smfmac_f32_16x16x64_bf16 v[60:63], v[8:11], a[8:15], v126
    s_cbranch_vccnz LS0_retryE
    s_waitcnt vmcnt(0)
    v_max3_u32 v141, v16, v17, v18
    v_max_u32 v141, v141, v19
    v_cmp_eq_u32 vcc, -1, v141
    v_smfmac_f32_16x16x64_bf16 v[64:67], v[8:11], a[16:23], v126
    ds_write_b128 v127, v[8:11] offset:2048
    v_smfmac_f32_16x16x64_bf16 v[68:71], v[8:11], a[24:31], v126
    ds_write_b128 v127, v[16:19] offset:4096
    s_cbranch_vccnz LS0_retryL
LS0_Lok:
    v_smfmac_f32_16x16x64_bf16 v[56:59], v[16:19], a[32:39], v126
    v_mov_b64 v[122:123], s[70:71]
    s_waitcnt lgkmcnt(4)
    v_smfmac_f32_16x16x64_bf16 v[60:63], v[16:19], v[32:39], v126
    ds_read_b128 v[32:35], v129 offset:0
    ds_read_b128 v[36:39], v129 offset:1024
    v_smfmac_f32_16x16x64_bf16 v[64:67], v[16:19], a[40:47], v126
    s_waitcnt lgkmcnt(3)
    s_waitcnt lgkmcnt(2)
    s_barrier
    v_smfmac_f32_16x16x64_bf16 v[68:71], v[16:19], a[48:55], v126
    ds_read_b128 v[0:3], v127 offset:0
    ds_read_b128 v[4:7], v127 offset:1024
    buffer_load_dword v138, v139, s[8:11], s34 offen sc1
    ds_read_b128 v[12:15], v127 offset:3072
    ds_read_b128 v[20:23], v127 offset:5120
    buffer_load_dwordx4 v[96:99], v127, s[8:11], s72 offen sc1
    s_waitcnt lgkmcnt(3)
    v_smfmac_f32_16x16x64_bf16 v[56:59], v[0:3], v[40:47], v126
    buffer_load_dwordx4 v[100:103], v129, s[8:11], s72 offen sc1
    v_smfmac_f32_16x16x64_bf16 v[60:63], v[0:3], a[56:63], v126
    ds_read_b128 v[40:43], v129 offset:16384
    ds_read_b128 v[44:47], v129 offset:17408
    s_waitcnt lgkmcnt(4)
    v_smfmac_f32_16x16x64_bf16 v[56:59], v[4:7], a[64:71], v126
    ds_read_b128 v[24:27], v127 offset:6144
    ds_read_b128 v[28:31], v127 offset:7168
    v_smfmac_f32_16x16x64_bf16 v[60:63], v[4:7], a[72:79], v126
    v_mov_b64 v[124:125], s[70:71]
    s_waitcnt lgkmcnt(5)
    v_smfmac_f32_16x16x64_bf16 v[56:59], v[12:15], v[32:39], v126
    ds_read_b128 v[32:35], v129 offset:24576
    ds_read_b128 v[36:39], v129 offset:25600
    v_smfmac_f32_16x16x64_bf16 v[60:63], v[12:15], a[80:87], v126
    buffer_load_dwordx4 v[48:51], v127, s[8:11], s34 offen sc1
    s_waitcnt lgkmcnt(6)
    v_smfmac_f32_16x16x64_bf16 v[56:59], v[20:23], a[88:95], v126
    s_waitcnt lgkmcnt(4)
    v_smfmac_f32_16x16x64_bf16 v[60:63], v[20:23], v[40:47], v126
    ds_read_b128 v[40:43], v128 offset:32768
    ds_read_b128 v[44:47], v128 offset:33792
    s_waitcnt lgkmcnt(5)
    v_smfmac_f32_16x16x64_bf16 v[56:59], v[24:27], a[96:103], v126
    v_smfmac_f32_16x16x64_bf16 v[60:63], v[24:27], a[104:111], v126
    s_waitcnt lgkmcnt(2)
    v_smfmac_f32_16x16x64_bf16 v[56:59], v[28:31], v[32:39], v126
    ds_read_b128 v[32:35], v128 offset:40960
    buffer_load_dwordx4 v[52:55], v129, s[8:11], s34 offen sc1
    v_smfmac_f32_16x16x64_bf16 v[60:63], v[28:31], a[112:119], v126
    ds_read_b128 v[36:39], v128 offset:41984
    s_nop 2
    v_add_f32 v56, v56, v58
    v_add_f32 v57, v57, v59
    v_cvt_pk_bf16_f32 v56, v56, v57
    v_smfmac_f32_16x16x64_bf16 v[64:67], v[0:3], a[120:127], v126
    v_add_f32 v60, v60, v62
    v_add_f32 v61, v61, v63
    v_cvt_pk_bf16_f32 v57, v60, v61
    v_smfmac_f32_16x16x64_bf16 v[68:71], v[0:3], a[128:135], v126
    ds_write_b64 v143, v[56:57] offset:8192
    s_waitcnt lgkmcnt(3)
    v_smfmac_f32_16x16x64_bf16 v[64:67], v[4:7], v[40:47], v126
    ds_read_b128 v[40:43], v128 offset:49152
    ds_read_b128 v[44:47], v128 offset:50176
    v_smfmac_f32_16x16x64_bf16 v[68:71], v[4:7], a[136:143], v126
    v_smfmac_f32_16x16x64_bf16 v[64:67], v[12:15], a[144:151], v126
    s_waitcnt lgkmcnt(2)
    s_barrier
    v_smfmac_f32_16x16x64_bf16 v[68:71], v[12:15], v[32:39], v126
    ds_read_b64_tr_b16 v[56:57], v140 offset:8192
    ds_read_b64_tr_b16 v[58:59], v140 offset:8704
    v_smfmac_f32_16x16x64_bf16 v[64:67], v[20:23], a[152:159], v126
    ds_read_b64_tr_b16 v[60:61], v140 offset:9216
    ds_read_b64_tr_b16 v[62:63], v140 offset:9728
    v_smfmac_f32_16x16x64_bf16 v[68:71], v[20:23], a[160:167], v126
    ds_read_b128 v[32:35], v128 offset:0
    ds_read_b128 v[36:39], v128 offset:1024
    s_waitcnt lgkmcnt(6)
    v_smfmac_f32_16x16x64_bf16 v[64:67], v[24:27], v[40:47], v126
    ds_read_b128 v[40:43], v128 offset:8192
    ds_read_b128 v[44:47], v128 offset:9216
    v_smfmac_f32_16x16x64_bf16 v[68:71], v[24:27], a[168:175], v126
    s_waitcnt lgkmcnt(6)
    v_mfma_f32_16x16x32_bf16 v[106:109], v[80:83], v[56:59], 0
    v_smfmac_f32_16x16x64_bf16 v[64:67], v[28:31], a[176:183], v126
    s_waitcnt lgkmcnt(4)
    v_mfma_f32_16x16x32_bf16 v[106:109], v[84:87], v[60:63], v[106:109]
    v_smfmac_f32_16x16x64_bf16 v[68:71], v[28:31], a[184:191], v126
    v_add_f32 v64, v64, v66
    s_waitcnt lgkmcnt(2)
    v_smfmac_f32_16x16x64_bf16 v[72:75], v[8:11], v[32:39], v126
    ds_read_b128 v[32:35], v127 offset:57344
    v_cndmask_b32 v107, v107, v108, s[24:25]
    v_cndmask_b32 v106, v106, v109, s[24:25]
    v_add_f32 v65, v65, v67
    v_add_f32 v68, v68, v70
    v_add_f32_dpp v104, v107, v106 quad_perm:[2,3,0,1] row_mask:0xf bank_mask:0xf
    v_exp_f32 v141, v104
    v_add_f32 v69, v69, v71
    v_cvt_pk_bf16_f32 v64, v64, v65
    v_smfmac_f32_16x16x64_bf16 v[76:79], v[8:11], a[192:199], v126
    ds_read_b128 v[36:39], v127 offset:58368
    v_cvt_pk_bf16_f32 v65, v68, v69
    v_smfmac_f32_16x16x64_bf16 v[72:75], v[16:19], a[200:207], v126
    ds_write_b64 v143, v[64:65] offset:10240
    v_cvt_pk_bf16_f32 v141, v141, v141
    s_waitcnt lgkmcnt(3)
    v_smfmac_f32_16x16x64_bf16 v[76:79], v[16:19], v[40:47], v126
    ds_write_b16 v132, v141
    v_smfmac_f32_16x16x64_bf16 v[72:75], v[0:3], a[208:215], v126
    ds_read_b128 v[40:43], v128 offset:16384
    ds_read_b128 v[44:47], v128 offset:17408
    v_smfmac_f32_16x16x64_bf16 v[76:79], v[0:3], a[216:223], v126
    v_mov_b64 v[0:1], 0
    s_waitcnt lgkmcnt(4)
    v_smfmac_f32_16x16x64_bf16 v[72:75], v[4:7], v[32:39], v126
    ds_read_b128 v[32:35], v128 offset:24576
    s_waitcnt lgkmcnt(3)
    s_barrier
    v_smfmac_f32_16x16x64_bf16 v[76:79], v[4:7], a[224:231], v126
    ds_read_b64_tr_b16 v[64:65], v140 offset:10240
    ds_read_b64_tr_b16 v[66:67], v140 offset:10752
    v_smfmac_f32_16x16x64_bf16 v[72:75], v[12:15], a[232:239], v126
    ds_read_b64_tr_b16 v[68:69], v140 offset:11264
    ds_read_b64_tr_b16 v[70:71], v140 offset:11776
    v_smfmac_f32_16x16x64_bf16 v[76:79], v[12:15], a[240:247], v126
    ds_read_b128 v[36:39], v128 offset:25600
    ds_read_b128 v[110:113], v133
    s_waitcnt lgkmcnt(7)
    v_smfmac_f32_16x16x64_bf16 v[72:75], v[20:23], v[40:47], v126
    ds_read_b128 v[114:117], v134
    ds_read_b128 v[40:43], v127 offset:16384
    s_waitcnt lgkmcnt(6)
    v_mfma_f32_16x16x32_bf16 v[106:109], v[64:67], v[56:59], 0
    ds_read_b128 v[44:47], v127 offset:17408
    v_mov_b64 v[2:3], 0
    v_smfmac_f32_16x16x64_bf16 v[76:79], v[20:23], a[248:255], v126
    v_mov_b64 v[4:5], 0
    s_waitcnt lgkmcnt(5)
    v_mfma_f32_16x16x32_bf16 v[106:109], v[68:71], v[60:63], v[106:109]
    v_mov_b32 v71, s43
    v_mov_b64 v[6:7], 0
    v_smfmac_f32_16x16x64_bf16 v[72:75], v[24:27], v[232:239], v126
    v_mov_b64 v[8:9], 0
    s_waitcnt lgkmcnt(4)
    v_smfmac_f32_16x16x64_bf16 v[76:79], v[24:27], v[32:39], v126
    ds_read_b128 v[32:35], v127 offset:24576
    v_cndmask_b32 v107, v107, v108, s[24:25]
    v_smfmac_f32_16x16x64_bf16 v[72:75], v[28:31], v[240:247], v126
    ds_read_b128 v[36:39], v127 offset:25600
    v_cndmask_b32 v106, v106, v109, s[24:25]
    v_smfmac_f32_16x16x64_bf16 v[76:79], v[28:31], v[248:255], v126
    v_add_f32_dpp v105, v107, v106 quad_perm:[2,3,0,1] row_mask:0xf bank_mask:0xf
    v_mul_f32 v105, s39, v105
    v_exp_f32 v107, v105
    s_waitcnt lgkmcnt(5)
    v_mfma_f32_16x16x32_bf16 v[118:121], v[88:91], v[110:113], 0
    v_mov_b32_dpp v108, v107 quad_perm:[2,3,0,1] row_mask:0xf bank_mask:0xf
    v_cvt_pk_bf16_f32 v107, v107, v108
    v_mfma_f32_16x16x32_bf16 v[64:67], v[122:125], v[110:113], 0
    v_cndmask_b32 v68, v107, 0, s[24:25]
    v_cndmask_b32 v69, 0, v107, s[24:25]
    s_waitcnt lgkmcnt(4)
    v_mfma_f32_16x16x32_bf16 v[118:121], v[92:95], v[114:117], v[118:121]
    v_add_f32 v72, v72, v74
    v_add_f32 v73, v73, v75
    v_mfma_f32_16x16x16_bf16 v[64:67], v[122:123], v[68:69], v[64:67]
    v_add_f32 v76, v76, v78
    v_add_f32 v77, v77, v79
    v_cvt_pk_bf16_f32 v72, v72, v73
    v_cvt_pk_bf16_f32 v73, v77, v76
    v_mov_b64 v[10:11], 0
    v_mov_b64 v[12:13], 0
    v_mfma_f32_16x16x16_bf16 v[118:121], v[72:73], v[68:69], v[118:121]
    buffer_store_dword v71, v137, s[8:11], s35 offen sc1
    v_mov_b64 v[14:15], 0
    v_rcp_f32_dpp v141, v64 quad_perm:[0,1,0,1] row_mask:0xf bank_mask:0xf
    v_subrev_u32 v142, s44, v64
    v_cmp_le_u32 vcc, s45, v142
LS0_norm:
    s_nop 2
    v_mul_f32 v118, v118, v141
    v_mul_f32 v119, v119, v141
    v_mul_f32 v120, v120, v141
    v_mul_f32 v121, v121, v141
    v_cvt_pk_bf16_f32 v60, v118, v119
    v_cvt_pk_bf16_f32 v61, v120, v121
    ds_write_b64 v135, v[60:61] offset:5120
    s_and_b64 vcc, vcc, s[26:27]
    s_cbranch_scc1 LS0_fallback
    buffer_load_dword v138, v127, s[8:11], s31 offen sc1
    v_mov_b32_dpp v62, v60 quad_perm:[2,3,0,1] row_mask:0xf bank_mask:0xf
    v_mov_b32_dpp v63, v61 quad_perm:[2,3,0,1] row_mask:0xf bank_mask:0xf
    s_waitcnt lgkmcnt(3)
    s_nop 0
    v_smfmac_f32_16x16x64_bf16 v[0:3], v[60:63], v[40:47], v126
    ds_read_b128 v[40:43], v127 offset:32768
    ds_read_b128 v[44:47], v127 offset:33792
    v_smfmac_f32_16x16x64_bf16 v[4:7], v[60:63], v[144:151], v126
    s_waitcnt lgkmcnt(2)
    s_barrier
    v_smfmac_f32_16x16x64_bf16 v[8:11], v[60:63], v[152:159], v126
    ds_read_b128 v[106:109], v136 offset:5184
    ds_read_b128 v[110:113], v136 offset:5248
    v_smfmac_f32_16x16x64_bf16 v[12:15], v[60:63], v[32:39], v126
    ds_read_b128 v[16:19], v136 offset:5312
    ds_read_b128 v[32:35], v127 offset:40960
    ds_read_b128 v[36:39], v127 offset:41984
    s_waitcnt lgkmcnt(4)
    v_smfmac_f32_16x16x64_bf16 v[0:3], v[106:109], v[160:167], v126
    s_waitcnt lgkmcnt(3)
    v_smfmac_f32_16x16x64_bf16 v[0:3], v[110:113], v[168:175], v126
    s_waitcnt lgkmcnt(2)
    v_smfmac_f32_16x16x64_bf16 v[0:3], v[16:19], v[176:183], v126
    v_smfmac_f32_16x16x64_bf16 v[4:7], v[106:109], v[40:47], v126
    ds_read_b128 v[40:43], v127 offset:49152
    ds_read_b128 v[44:47], v127 offset:50176
    s_nop 1
    v_cvt_pk_bf16_f32 v114, v0, v2
    v_cvt_pk_bf16_f32 v115, v1, v3
    v_and_or_b32 v114, v114, -2, s28
    v_smfmac_f32_16x16x64_bf16 v[4:7], v[110:113], v[184:191], v126
    buffer_store_dwordx2 v[114:115], v130, s[8:11], 0 offen offset:0 sc1
    v_smfmac_f32_16x16x64_bf16 v[4:7], v[16:19], v[192:199], v126
    s_waitcnt lgkmcnt(2)
    v_smfmac_f32_16x16x64_bf16 v[8:11], v[106:109], v[32:39], v126
    v_smfmac_f32_16x16x64_bf16 v[8:11], v[110:113], v[200:207], v126
    v_cvt_pk_bf16_f32 v116, v4, v6
    v_cvt_pk_bf16_f32 v117, v5, v7
    v_and_or_b32 v116, v116, -2, s28
    v_smfmac_f32_16x16x64_bf16 v[8:11], v[16:19], v[208:215], v126
    buffer_store_dwordx2 v[116:117], v130, s[8:11], 0 offen offset:2048 sc1
    v_smfmac_f32_16x16x64_bf16 v[12:15], v[106:109], v[216:223], v126
    s_nop 3
    v_cvt_pk_bf16_f32 v118, v8, v10
    v_cvt_pk_bf16_f32 v119, v9, v11
    v_and_or_b32 v118, v118, -2, s28
    s_waitcnt lgkmcnt(0)
    v_smfmac_f32_16x16x64_bf16 v[12:15], v[110:113], v[40:47], v126
    buffer_store_dwordx2 v[118:119], v130, s[8:11], s69 offen offset:0 sc1
    v_smfmac_f32_16x16x64_bf16 v[12:15], v[16:19], v[224:231], v126
    s_nop 7
    v_cvt_pk_bf16_f32 v120, v12, v14
    v_cvt_pk_bf16_f32 v121, v13, v15
    v_and_or_b32 v120, v120, -2, s28
    buffer_store_dwordx2 v[120:121], v130, s[8:11], s69 offen offset:2048 sc1
    s_waitcnt vmcnt(4)
    v_cmp_gt_u32 vcc, s43, v138
    ds_read_b128 v[122:125], v127 offset:13312
    s_waitcnt vmcnt(4)
    s_add_u32 s30, s30, 1048576
    s_add_u32 s68, s68, 1048576
    s_cbranch_vccnz LS0_lead
LS0_leadok:
    s_barrier
    s_add_u32 s33, s33, 1048576
    s_add_u32 s37, s37, 1048576
    s_add_u32 s32, s32, 1048576
    s_add_u32 s38, s38, 1
    s_xor_b32 s28, s28, 1
    s_add_u32 s43, s43, 1
    buffer_load_dwordx4 v[0:3], v127, s[8:11], s29 offen sc1
    buffer_load_dwordx4 v[4:7], v127, s[8:11], s29 offen offset:1024 sc1
    s_waitcnt lgkmcnt(0)
    s_branch LS0_pollP
LS0_done:
    buffer_store_dword v112, v131, s[8:11], s33 offen sc1
    s_waitcnt vmcnt(0)
    s_endpgm
LS0_retryE:
    buffer_load_dwordx4 v[8:11], v127, s[8:11], s30 offen sc1
    buffer_load_dwordx4 v[16:19], v127, s[8:11], s68 offen sc1
    s_sub_u32 s22, s22, 1
    s_cbranch_scc1 L_exit
    s_nop 3
    v_mov_b64 v[56:57], 0
    v_mov_b64 v[58:59], 0
    v_mov_b64 v[60:61], 0
    v_mov_b64 v[62:63], 0
    s_waitcnt vmcnt(1)
    s_branch LS0_bA
LS0_retryL:
    buffer_load_dwordx4 v[16:19], v127, s[8:11], s68 offen sc1
    s_sub_u32 s22, s22, 1
    s_cbranch_scc1 L_exit
    s_waitcnt vmcnt(0)
    v_max3_u32 v141, v16, v17, v18
    v_max_u32 v141, v141, v19
    v_cmp_eq_u32 vcc, -1, v141
    s_cbranch_vccnz LS0_retryL
    ds_write_b128 v127, v[16:19] offset:4096
    s_waitcnt lgkmcnt(0)
    s_branch LS0_Lok
    s_nop 0
LS0_retryP:
    buffer_load_dwordx4 v[0:3], v127, s[8:11], s29 offen sc1
    buffer_load_dwordx4 v[4:7], v127, s[8:11], s29 offen offset:1024 sc1
    s_sub_u32 s22, s22, 1
    s_cbranch_scc1 L_exit
    s_branch LS0_pollP
LS0_lead:
    s_nop 5
    s_branch LS0_leadok
LS0_fallback:
    s_nop 7
    v_lshlrev_b32 v142, 1, v132
    v_subrev_u32 v142, 20480, v142
    ds_write_b32 v142, v104
    v_min_u32 v142, v133, v134
    v_lshlrev_b32 v142, 1, v142
    v_subrev_u32 v142, 20480, v142
    s_waitcnt lgkmcnt(0)
    s_barrier
    ds_read_b128 v[56:59], v142
    ds_read_b128 v[60:63], v142 offset:16
    s_waitcnt lgkmcnt(1)
    v_max3_f32 v141, v56, v57, v58
    s_waitcnt lgkmcnt(0)
    v_max3_f32 v141, v141, v59, v60
    v_max3_f32 v141, v141, v61, v62
    v_max3_f32 v141, v141, v63, v105
    s_nop 1
    v_max_f32_dpp v141, v141, v141 quad_perm:[2,3,0,1] row_mask:0xf bank_mask:0xf
    v_mov_b32 v142, v141
    s_nop 1
    v_permlane16_swap_b32 v141, v142
    v_max_f32 v141, v141, v142
    v_mov_b32 v142, v141
    s_nop 1
    v_permlane32_swap_b32 v141, v142
    v_max_f32 v141, v141, v142
    v_sub_f32 v56, v56, v141
    v_exp_f32 v56, v56
    v_sub_f32 v57, v57, v141
    v_exp_f32 v57, v57
    v_sub_f32 v58, v58, v141
    v_exp_f32 v58, v58
    v_sub_f32 v59, v59, v141
    v_exp_f32 v59, v59
    v_sub_f32 v60, v60, v141
    v_exp_f32 v60, v60
    v_sub_f32 v61, v61, v141
    v_exp_f32 v61, v61
    v_sub_f32 v62, v62, v141
    v_exp_f32 v62, v62
    v_sub_f32 v63, v63, v141
    v_exp_f32 v63, v63
    v_sub_f32 v107, v105, v141
    v_exp_f32 v107, v107
    s_nop 1
    v_mov_b32_dpp v108, v107 quad_perm:[2,3,0,1] row_mask:0xf bank_mask:0xf
    v_cvt_pk_bf16_f32 v107, v107, v108
    v_cndmask_b32 v68, v107, 0, s[24:25]
    v_cndmask_b32 v69, 0, v107, s[24:25]
    v_cvt_pk_bf16_f32 v142, v56, v57
    v_cndmask_b32 v110, v142, 0, s[24:25]
    v_cndmask_b32 v114, 0, v142, s[24:25]
    v_cvt_pk_bf16_f32 v142, v58, v59
    v_cndmask_b32 v111, v142, 0, s[24:25]
    v_cndmask_b32 v115, 0, v142, s[24:25]
    v_cvt_pk_bf16_f32 v142, v60, v61
    v_cndmask_b32 v112, v142, 0, s[24:25]
    v_cndmask_b32 v116, 0, v142, s[24:25]
    v_cvt_pk_bf16_f32 v142, v62, v63
    v_cndmask_b32 v113, v142, 0, s[24:25]
    v_cndmask_b32 v117, 0, v142, s[24:25]
    s_nop 0
    v_mfma_f32_16x16x32_bf16 v[118:121], v[88:91], v[110:113], 0
    v_mfma_f32_16x16x32_bf16 v[118:121], v[92:95], v[114:117], v[118:121]
    v_mfma_f32_16x16x32_bf16 v[64:67], v[122:125], v[110:113], 0
    s_nop 5
    v_mfma_f32_16x16x16_bf16 v[64:67], v[122:123], v[68:69], v[64:67]
    v_mfma_f32_16x16x16_bf16 v[118:121], v[72:73], v[68:69], v[118:121]
    s_nop 3
    v_rcp_f32_dpp v141, v64 quad_perm:[0,1,0,1] row_mask:0xf bank_mask:0xf
    s_mov_b64 vcc, 0
    s_nop 1
    s_branch LS0_norm
L_chain_w1:
    v_and_b32 v10, 63, v0
    v_lshlrev_b32 v6, 4, v10
    s_mov_b32 s14, 0x400000
    s_mov_b32 s15, 0x20000
    s_mov_b32 s12, s66
    s_mov_b32 s13, s67
    s_lshl_b32 s40, s20, 17
    s_add_u32 s40, s40, 8192
    s_mov_b32 m0, 40960
    s_nop 0
    buffer_load_dwordx4 v6, s[12:15], s40 offen lds
    s_add_u32 s40, s40, 1024
    s_mov_b32 m0, 41984
    s_nop 0
    buffer_load_dwordx4 v6, s[12:15], s40 offen lds
    s_add_u32 s40, s40, 1024
    s_mov_b32 m0, 43008
    s_nop 0
    buffer_load_dwordx4 v6, s[12:15], s40 offen lds
    s_add_u32 s40, s40, 1024
    s_mov_b32 m0, 44032
    s_nop 0
    buffer_load_dwordx4 v6, s[12:15], s40 offen lds
    s_add_u32 s40, s40, 1024
    s_mov_b32 m0, 45056
    s_nop 0
    buffer_load_dwordx4 v6, s[12:15], s40 offen lds
    s_add_u32 s40, s40, 1024
    s_mov_b32 m0, 46080
    s_nop 0
    buffer_load_dwordx4 v6, s[12:15], s40 offen lds
    s_add_u32 s40, s40, 1024
    s_mov_b32 m0, 47104
    s_nop 0
    buffer_load_dwordx4 v6, s[12:15], s40 offen lds
    s_add_u32 s40, s40, 1024
    s_mov_b32 m0, 48128
    s_nop 0
    buffer_load_dwordx4 v6, s[12:15], s40 offen lds
    s_mov_b32 s12, s66
    s_mov_b32 s13, s67
    s_lshl_b32 s40, s20, 17
    s_add_u32 s40, s40, 40960
    s_mov_b32 m0, 73728
    s_nop 0
    buffer_load_dwordx4 v6, s[12:15], s40 offen lds
    s_add_u32 s40, s40, 1024
    s_mov_b32 m0, 74752
    s_nop 0
    buffer_load_dwordx4 v6, s[12:15], s40 offen lds
    s_add_u32 s40, s40, 1024
    s_mov_b32 m0, 75776
    s_nop 0
    buffer_load_dwordx4 v6, s[12:15], s40 offen lds
    s_add_u32 s40, s40, 1024
    s_mov_b32 m0, 76800
    s_nop 0
    buffer_load_dwordx4 v6, s[12:15], s40 offen lds
    s_add_u32 s40, s40, 1024
    s_mov_b32 m0, 77824
    s_nop 0
    buffer_load_dwordx4 v6, s[12:15], s40 offen lds
    s_add_u32 s40, s40, 1024
    s_mov_b32 m0, 78848
    s_nop 0
    buffer_load_dwordx4 v6, s[12:15], s40 offen lds
    s_add_u32 s40, s40, 1024
    s_mov_b32 m0, 79872
    s_nop 0
    buffer_load_dwordx4 v6, s[12:15], s40 offen lds
    s_add_u32 s40, s40, 1024
    s_mov_b32 m0, 80896
    s_nop 0
    buffer_load_dwordx4 v6, s[12:15], s40 offen lds
    s_mov_b32 s12, s66
    s_mov_b32 s13, s67
    s_lshl_b32 s40, s20, 17
    s_add_u32 s40, s40, 73728
    s_mov_b32 m0, 106496
    s_nop 0
    buffer_load_dwordx4 v6, s[12:15], s40 offen lds
    s_add_u32 s40, s40, 1024
    s_mov_b32 m0, 107520
    s_nop 0
    buffer_load_dwordx4 v6, s[12:15], s40 offen lds
    s_add_u32 s40, s40, 1024
    s_mov_b32 m0, 108544
    s_nop 0
    buffer_load_dwordx4 v6, s[12:15], s40 offen lds
    s_add_u32 s40, s40, 1024
    s_mov_b32 m0, 109568
    s_nop 0
    buffer_load_dwordx4 v6, s[12:15], s40 offen lds
    s_add_u32 s40, s40, 1024
    s_mov_b32 m0, 110592
    s_nop 0
    buffer_load_dwordx4 v6, s[12:15], s40 offen lds
    s_add_u32 s40, s40, 1024
    s_mov_b32 m0, 111616
    s_nop 0
    buffer_load_dwordx4 v6, s[12:15], s40 offen lds
    s_add_u32 s40, s40, 1024
    s_mov_b32 m0, 112640
    s_nop 0
    buffer_load_dwordx4 v6, s[12:15], s40 offen lds
    s_add_u32 s40, s40, 1024
    s_mov_b32 m0, 113664
    s_nop 0
    buffer_load_dwordx4 v6, s[12:15], s40 offen lds
    s_mov_b32 s12, s66
    s_mov_b32 s13, s67
    s_lshl_b32 s40, s20, 17
    s_add_u32 s40, s40, 106496
    s_mov_b32 m0, 139264
    s_nop 0
    buffer_load_dwordx4 v6, s[12:15], s40 offen lds
    s_add_u32 s40, s40, 1024
    s_mov_b32 m0, 140288
    s_nop 0
    buffer_load_dwordx4 v6, s[12:15], s40 offen lds
    s_add_u32 s40, s40, 1024
    s_mov_b32 m0, 141312
    s_nop 0
    buffer_load_dwordx4 v6, s[12:15], s40 offen lds
    s_add_u32 s40, s40, 1024
    s_mov_b32 m0, 142336
    s_nop 0
    buffer_load_dwordx4 v6, s[12:15], s40 offen lds
    s_add_u32 s40, s40, 1024
    s_mov_b32 m0, 143360
    s_nop 0
    buffer_load_dwordx4 v6, s[12:15], s40 offen lds
    s_add_u32 s40, s40, 1024
    s_mov_b32 m0, 144384
    s_nop 0
    buffer_load_dwordx4 v6, s[12:15], s40 offen lds
    s_add_u32 s40, s40, 1024
    s_mov_b32 m0, 145408
    s_nop 0
    buffer_load_dwordx4 v6, s[12:15], s40 offen lds
    s_add_u32 s40, s40, 1024
    s_mov_b32 m0, 146432
    s_nop 0
    buffer_load_dwordx4 v6, s[12:15], s40 offen lds
    s_or_b32 s4, s23, s21
    s_cselect_b64 exec, 0, 1
    buffer_atomic_or v1, off, s[16:19], s59 sc0
    s_mov_b64 exec, -1
    v_and_b32 v2, 15, v0
    v_lshrrev_b32 v3, 4, v10
    v_lshlrev_b32 v4, 1, v3
    v_xor_b32 v4, v4, v2
    v_xor_b32 v5, 8, v4
    v_lshlrev_b32 v4, 4, v4
    v_lshlrev_b32 v5, 4, v5
    v_lshl_add_u32 v4, v3, 13, v4
    v_lshl_add_u32 v5, v3, 13, v5
    v_lshrrev_b32 v14, 2, v2
    v_and_b32 v15, 1, v3
    v_lshl_or_b32 v15, v15, 2, v14
    v_lshl_add_u32 v14, v3, 3, v14
    v_lshlrev_b32 v14, 8, v14
    v_and_b32 v16, 3, v2
    v_lshl_add_u32 v14, v16, 3, v14
    v_xor_b32 v7, 2, v15
    v_xor_b32 v8, 3, v15
    v_lshl_add_u32 v7, v7, 5, v14
    v_lshl_add_u32 v8, v8, 5, v14
    v_add_u32 v7, 32768, v7
    v_add_u32 v8, 32768, v8
    v_lshlrev_b32 v16, 2, v2
    v_add_u32 v16, 32832, v16
    v_lshl_add_u32 v9, v3, 12, v16
    v_lshrrev_b32 v14, 1, v3
    v_lshl_add_u32 v14, v14, 12, v16
    v_add_u32 v14, 32768, v14
    v_and_b32 v15, 1, v3
    v_lshl_add_u32 v11, v15, 14, v14
    v_xor_b32 v15, 1, v15
    v_lshl_add_u32 v12, v15, 14, v14
    s_mov_b32 s41, 0x05040100
    s_mov_b32 s42, 0x07060302
    s_lshl_b32 s37, s20, 6
    s_add_u32 s37, s37, 17580032
    s_waitcnt vmcnt(25)
    s_barrier
    ds_read2st64_b32 v[18:19], v9 offset0:0 offset1:4
    ds_read2st64_b32 v[20:21], v9 offset0:8 offset1:12
    ds_read2st64_b32 v[22:23], v9 offset0:64 offset1:68
    ds_read2st64_b32 v[24:25], v9 offset0:72 offset1:76
    ds_read2st64_b32 v[26:27], v9 offset0:1 offset1:5
    ds_read2st64_b32 v[28:29], v9 offset0:9 offset1:13
    ds_read2st64_b32 v[30:31], v9 offset0:65 offset1:69
    ds_read2st64_b32 v[32:33], v9 offset0:73 offset1:77
    ds_read2st64_b32 v[34:35], v9 offset0:2 offset1:6
    ds_read2st64_b32 v[36:37], v9 offset0:10 offset1:14
    ds_read2st64_b32 v[38:39], v9 offset0:66 offset1:70
    ds_read2st64_b32 v[40:41], v9 offset0:74 offset1:78
    ds_read2st64_b32 v[42:43], v9 offset0:3 offset1:7
    ds_read2st64_b32 v[44:45], v9 offset0:11 offset1:15
    ds_read2st64_b32 v[46:47], v9 offset0:67 offset1:71
    ds_read2st64_b32 v[48:49], v9 offset0:75 offset1:79
    s_waitcnt lgkmcnt(0)
    s_barrier
    s_mov_b32 s12, s64
    s_mov_b32 s13, s65
    s_lshl_b32 s40, s20, 8
    s_add_u32 s40, s40, 262144
    s_mov_b32 m0, 40960
    s_nop 0
    buffer_load_dwordx4 v4, s[12:15], s40 offen lds
    s_add_u32 s40, s40, 32768
    s_mov_b32 m0, 41984
    s_nop 0
    buffer_load_dwordx4 v4, s[12:15], s40 offen lds
    s_add_u32 s40, s40, 32768
    s_mov_b32 m0, 43008
    s_nop 0
    buffer_load_dwordx4 v5, s[12:15], s40 offen lds
    s_add_u32 s40, s40, 32768
    s_mov_b32 m0, 44032
    s_nop 0
    buffer_load_dwordx4 v5, s[12:15], s40 offen lds
    s_add_u32 s40, s40, 32768
    s_mov_b32 m0, 45056
    s_nop 0
    buffer_load_dwordx4 v4, s[12:15], s40 offen lds
    s_add_u32 s40, s40, 32768
    s_mov_b32 m0, 46080
    s_nop 0
    buffer_load_dwordx4 v4, s[12:15], s40 offen lds
    s_add_u32 s40, s40, 32768
    s_mov_b32 m0, 47104
    s_nop 0
    buffer_load_dwordx4 v5, s[12:15], s40 offen lds
    s_add_u32 s40, s40, 32768
    s_mov_b32 m0, 48128
    s_nop 0
    buffer_load_dwordx4 v5, s[12:15], s40 offen lds
    v_perm_b32 v176, v19, v18, s41
    v_perm_b32 v177, v19, v18, s42
    v_perm_b32 v178, v21, v20, s41
    v_perm_b32 v179, v21, v20, s42
    v_perm_b32 v180, v23, v22, s41
    v_perm_b32 v181, v23, v22, s42
    v_perm_b32 v182, v25, v24, s41
    v_perm_b32 v183, v25, v24, s42
    v_perm_b32 v192, v27, v26, s41
    v_perm_b32 v193, v27, v26, s42
    v_perm_b32 v194, v29, v28, s41
    v_perm_b32 v195, v29, v28, s42
    v_perm_b32 v196, v31, v30, s41
    v_perm_b32 v197, v31, v30, s42
    v_perm_b32 v198, v33, v32, s41
    v_perm_b32 v199, v33, v32, s42
    v_perm_b32 v208, v35, v34, s41
    v_perm_b32 v209, v35, v34, s42
    v_perm_b32 v210, v37, v36, s41
    v_perm_b32 v211, v37, v36, s42
    v_perm_b32 v212, v39, v38, s41
    v_perm_b32 v213, v39, v38, s42
    v_perm_b32 v214, v41, v40, s41
    v_perm_b32 v215, v41, v40, s42
    v_perm_b32 v224, v43, v42, s41
    v_perm_b32 v225, v43, v42, s42
    v_perm_b32 v226, v45, v44, s41
    v_perm_b32 v227, v45, v44, s42
    v_perm_b32 v228, v47, v46, s41
    v_perm_b32 v229, v47, v46, s42
    v_perm_b32 v230, v49, v48, s41
    v_perm_b32 v231, v49, v48, s42
    s_waitcnt vmcnt(25)
    s_barrier
    v_add_u32 v9, 32768, v9
    ds_read2st64_b32 v[18:19], v11 offset0:0 offset1:4
    ds_read2st64_b32 v[20:21], v12 offset0:0 offset1:4
    ds_read2st64_b32 v[22:23], v11 offset0:8 offset1:12
    ds_read2st64_b32 v[24:25], v12 offset0:8 offset1:12
    ds_read2st64_b32 v[26:27], v11 offset0:32 offset1:36
    ds_read2st64_b32 v[28:29], v12 offset0:32 offset1:36
    ds_read2st64_b32 v[30:31], v11 offset0:40 offset1:44
    ds_read2st64_b32 v[32:33], v12 offset0:40 offset1:44
    ds_read2st64_b32 v[34:35], v11 offset0:1 offset1:5
    ds_read2st64_b32 v[36:37], v12 offset0:1 offset1:5
    ds_read2st64_b32 v[38:39], v11 offset0:9 offset1:13
    ds_read2st64_b32 v[40:41], v12 offset0:9 offset1:13
    ds_read2st64_b32 v[42:43], v11 offset0:33 offset1:37
    ds_read2st64_b32 v[44:45], v12 offset0:33 offset1:37
    ds_read2st64_b32 v[46:47], v11 offset0:41 offset1:45
    ds_read2st64_b32 v[48:49], v12 offset0:41 offset1:45
    ds_read2st64_b32 v[50:51], v11 offset0:2 offset1:6
    ds_read2st64_b32 v[52:53], v12 offset0:2 offset1:6
    ds_read2st64_b32 v[54:55], v11 offset0:10 offset1:14
    ds_read2st64_b32 v[56:57], v12 offset0:10 offset1:14
    ds_read2st64_b32 v[58:59], v11 offset0:34 offset1:38
    ds_read2st64_b32 v[60:61], v12 offset0:34 offset1:38
    ds_read2st64_b32 v[62:63], v11 offset0:42 offset1:46
    ds_read2st64_b32 v[64:65], v12 offset0:42 offset1:46
    ds_read2st64_b32 v[66:67], v11 offset0:3 offset1:7
    ds_read2st64_b32 v[68:69], v12 offset0:3 offset1:7
    ds_read2st64_b32 v[70:71], v11 offset0:11 offset1:15
    ds_read2st64_b32 v[72:73], v12 offset0:11 offset1:15
    ds_read2st64_b32 v[74:75], v11 offset0:35 offset1:39
    ds_read2st64_b32 v[76:77], v12 offset0:35 offset1:39
    ds_read2st64_b32 v[78:79], v11 offset0:43 offset1:47
    ds_read2st64_b32 v[80:81], v12 offset0:43 offset1:47
    s_waitcnt lgkmcnt(0)
    s_barrier
    s_mov_b32 s12, s64
    s_mov_b32 s13, s65
    s_lshl_b32 s40, s20, 8
    s_add_u32 s40, s40, 1310720
    s_mov_b32 m0, 73728
    s_nop 0
    buffer_load_dwordx4 v4, s[12:15], s40 offen lds
    s_add_u32 s40, s40, 32768
    s_mov_b32 m0, 74752
    s_nop 0
    buffer_load_dwordx4 v4, s[12:15], s40 offen lds
    s_add_u32 s40, s40, 32768
    s_mov_b32 m0, 75776
    s_nop 0
    buffer_load_dwordx4 v5, s[12:15], s40 offen lds
    s_add_u32 s40, s40, 32768
    s_mov_b32 m0, 76800
    s_nop 0
    buffer_load_dwordx4 v5, s[12:15], s40 offen lds
    s_add_u32 s40, s40, 32768
    s_mov_b32 m0, 77824
    s_nop 0
    buffer_load_dwordx4 v4, s[12:15], s40 offen lds
    s_add_u32 s40, s40, 32768
    s_mov_b32 m0, 78848
    s_nop 0
    buffer_load_dwordx4 v4, s[12:15], s40 offen lds
    s_add_u32 s40, s40, 32768
    s_mov_b32 m0, 79872
    s_nop 0
    buffer_load_dwordx4 v5, s[12:15], s40 offen lds
    s_add_u32 s40, s40, 32768
    s_mov_b32 m0, 80896
    s_nop 0
    buffer_load_dwordx4 v5, s[12:15], s40 offen lds
    v_perm_b32 v82, v19, v18, s41
    v_perm_b32 v83, v21, v20, s42
    v_perm_b32 v84, v23, v22, s41
    v_perm_b32 v85, v25, v24, s42
    v_perm_b32 v86, v27, v26, s41
    v_perm_b32 v87, v29, v28, s42
    v_perm_b32 v88, v31, v30, s41
    v_perm_b32 v89, v33, v32, s42
    v_perm_b32 v144, v35, v34, s41
    v_perm_b32 v145, v37, v36, s42
    v_perm_b32 v146, v39, v38, s41
    v_perm_b32 v147, v41, v40, s42
    v_perm_b32 v148, v43, v42, s41
    v_perm_b32 v149, v45, v44, s42
    v_perm_b32 v150, v47, v46, s41
    v_perm_b32 v151, v49, v48, s42
    v_perm_b32 v152, v51, v50, s41
    v_perm_b32 v153, v53, v52, s42
    v_perm_b32 v154, v55, v54, s41
    v_perm_b32 v155, v57, v56, s42
    v_perm_b32 v156, v59, v58, s41
    v_perm_b32 v157, v61, v60, s42
    v_perm_b32 v158, v63, v62, s41
    v_perm_b32 v159, v65, v64, s42
    v_perm_b32 v90, v67, v66, s41
    v_perm_b32 v91, v69, v68, s42
    v_perm_b32 v92, v71, v70, s41
    v_perm_b32 v93, v73, v72, s42
    v_perm_b32 v94, v75, v74, s41
    v_perm_b32 v95, v77, v76, s42
    v_perm_b32 v96, v79, v78, s41
    v_perm_b32 v97, v81, v80, s42
    v_add_u32 v13, 18432, v6
    ds_write_b128 v13, v[82:85]
    ds_write_b128 v13, v[86:89] offset:1024
    v_add_u32 v13, 26624, v6
    ds_write_b128 v13, v[90:93]
    ds_write_b128 v13, v[94:97] offset:1024
    s_waitcnt vmcnt(25)
    s_barrier
    v_add_u32 v9, 32768, v9
    ds_read2st64_b32 v[18:19], v9 offset0:0 offset1:4
    ds_read2st64_b32 v[20:21], v9 offset0:8 offset1:12
    ds_read2st64_b32 v[22:23], v9 offset0:64 offset1:68
    ds_read2st64_b32 v[24:25], v9 offset0:72 offset1:76
    ds_read2st64_b32 v[26:27], v9 offset0:1 offset1:5
    ds_read2st64_b32 v[28:29], v9 offset0:9 offset1:13
    ds_read2st64_b32 v[30:31], v9 offset0:65 offset1:69
    ds_read2st64_b32 v[32:33], v9 offset0:73 offset1:77
    ds_read2st64_b32 v[34:35], v9 offset0:2 offset1:6
    ds_read2st64_b32 v[36:37], v9 offset0:10 offset1:14
    ds_read2st64_b32 v[38:39], v9 offset0:66 offset1:70
    ds_read2st64_b32 v[40:41], v9 offset0:74 offset1:78
    ds_read2st64_b32 v[42:43], v9 offset0:3 offset1:7
    ds_read2st64_b32 v[44:45], v9 offset0:11 offset1:15
    ds_read2st64_b32 v[46:47], v9 offset0:67 offset1:71
    ds_read2st64_b32 v[48:49], v9 offset0:75 offset1:79
    s_waitcnt lgkmcnt(0)
    s_barrier
    s_mov_b32 s12, s64
    s_mov_b32 s13, s65
    s_lshl_b32 s40, s20, 8
    s_add_u32 s40, s40, 2359296
    s_mov_b32 m0, 106496
    s_nop 0
    buffer_load_dwordx4 v4, s[12:15], s40 offen lds
    s_add_u32 s40, s40, 32768
    s_mov_b32 m0, 107520
    s_nop 0
    buffer_load_dwordx4 v4, s[12:15], s40 offen lds
    s_add_u32 s40, s40, 32768
    s_mov_b32 m0, 108544
    s_nop 0
    buffer_load_dwordx4 v5, s[12:15], s40 offen lds
    s_add_u32 s40, s40, 32768
    s_mov_b32 m0, 109568
    s_nop 0
    buffer_load_dwordx4 v5, s[12:15], s40 offen lds
    s_add_u32 s40, s40, 32768
    s_mov_b32 m0, 110592
    s_nop 0
    buffer_load_dwordx4 v4, s[12:15], s40 offen lds
    s_add_u32 s40, s40, 32768
    s_mov_b32 m0, 111616
    s_nop 0
    buffer_load_dwordx4 v4, s[12:15], s40 offen lds
    s_add_u32 s40, s40, 32768
    s_mov_b32 m0, 112640
    s_nop 0
    buffer_load_dwordx4 v5, s[12:15], s40 offen lds
    s_add_u32 s40, s40, 32768
    s_mov_b32 m0, 113664
    s_nop 0
    buffer_load_dwordx4 v5, s[12:15], s40 offen lds
    v_perm_b32 v160, v19, v18, s41
    v_perm_b32 v161, v19, v18, s42
    v_perm_b32 v162, v21, v20, s41
    v_perm_b32 v163, v21, v20, s42
    v_perm_b32 v164, v23, v22, s41
    v_perm_b32 v165, v23, v22, s42
    v_perm_b32 v166, v25, v24, s41
    v_perm_b32 v167, v25, v24, s42
    v_perm_b32 v82, v27, v26, s41
    v_perm_b32 v83, v27, v26, s42
    v_perm_b32 v84, v29, v28, s41
    v_perm_b32 v85, v29, v28, s42
    v_perm_b32 v86, v31, v30, s41
    v_perm_b32 v87, v31, v30, s42
    v_perm_b32 v88, v33, v32, s41
    v_perm_b32 v89, v33, v32, s42
    v_perm_b32 v90, v35, v34, s41
    v_perm_b32 v91, v35, v34, s42
    v_perm_b32 v92, v37, v36, s41
    v_perm_b32 v93, v37, v36, s42
    v_perm_b32 v94, v39, v38, s41
    v_perm_b32 v95, v39, v38, s42
    v_perm_b32 v96, v41, v40, s41
    v_perm_b32 v97, v41, v40, s42
    v_perm_b32 v216, v43, v42, s41
    v_perm_b32 v217, v43, v42, s42
    v_perm_b32 v218, v45, v44, s41
    v_perm_b32 v219, v45, v44, s42
    v_perm_b32 v220, v47, v46, s41
    v_perm_b32 v221, v47, v46, s42
    v_perm_b32 v222, v49, v48, s41
    v_perm_b32 v223, v49, v48, s42
    s_waitcnt vmcnt(25)
    s_barrier
    v_add_u32 v9, 32768, v9
    ds_read2st64_b32 v[18:19], v9 offset0:0 offset1:4
    ds_read2st64_b32 v[20:21], v9 offset0:8 offset1:12
    ds_read2st64_b32 v[22:23], v9 offset0:64 offset1:68
    ds_read2st64_b32 v[24:25], v9 offset0:72 offset1:76
    ds_read2st64_b32 v[26:27], v9 offset0:1 offset1:5
    ds_read2st64_b32 v[28:29], v9 offset0:9 offset1:13
    ds_read2st64_b32 v[30:31], v9 offset0:65 offset1:69
    ds_read2st64_b32 v[32:33], v9 offset0:73 offset1:77
    ds_read2st64_b32 v[34:35], v9 offset0:2 offset1:6
    ds_read2st64_b32 v[36:37], v9 offset0:10 offset1:14
    ds_read2st64_b32 v[38:39], v9 offset0:66 offset1:70
    ds_read2st64_b32 v[40:41], v9 offset0:74 offset1:78
    ds_read2st64_b32 v[42:43], v9 offset0:3 offset1:7
    ds_read2st64_b32 v[44:45], v9 offset0:11 offset1:15
    ds_read2st64_b32 v[46:47], v9 offset0:67 offset1:71
    ds_read2st64_b32 v[48:49], v9 offset0:75 offset1:79
    s_waitcnt lgkmcnt(0)
    s_barrier
    s_mov_b32 s12, s64
    s_mov_b32 s13, s65
    s_lshl_b32 s40, s20, 8
    s_add_u32 s40, s40, 3407872
    s_mov_b32 m0, 139264
    s_nop 0
    buffer_load_dwordx4 v4, s[12:15], s40 offen lds
    s_add_u32 s40, s40, 32768
    s_mov_b32 m0, 140288
    s_nop 0
    buffer_load_dwordx4 v4, s[12:15], s40 offen lds
    s_add_u32 s40, s40, 32768
    s_mov_b32 m0, 141312
    s_nop 0
    buffer_load_dwordx4 v5, s[12:15], s40 offen lds
    s_add_u32 s40, s40, 32768
    s_mov_b32 m0, 142336
    s_nop 0
    buffer_load_dwordx4 v5, s[12:15], s40 offen lds
    s_add_u32 s40, s40, 32768
    s_mov_b32 m0, 143360
    s_nop 0
    buffer_load_dwordx4 v4, s[12:15], s40 offen lds
    s_add_u32 s40, s40, 32768
    s_mov_b32 m0, 144384
    s_nop 0
    buffer_load_dwordx4 v4, s[12:15], s40 offen lds
    s_add_u32 s40, s40, 32768
    s_mov_b32 m0, 145408
    s_nop 0
    buffer_load_dwordx4 v5, s[12:15], s40 offen lds
    s_add_u32 s40, s40, 32768
    s_mov_b32 m0, 146432
    s_nop 0
    buffer_load_dwordx4 v5, s[12:15], s40 offen lds
    v_perm_b32 v168, v19, v18, s41
    v_perm_b32 v169, v19, v18, s42
    v_perm_b32 v170, v21, v20, s41
    v_perm_b32 v171, v21, v20, s42
    v_perm_b32 v172, v23, v22, s41
    v_perm_b32 v173, v23, v22, s42
    v_perm_b32 v174, v25, v24, s41
    v_perm_b32 v175, v25, v24, s42
    v_perm_b32 v184, v27, v26, s41
    v_perm_b32 v185, v27, v26, s42
    v_perm_b32 v186, v29, v28, s41
    v_perm_b32 v187, v29, v28, s42
    v_perm_b32 v188, v31, v30, s41
    v_perm_b32 v189, v31, v30, s42
    v_perm_b32 v190, v33, v32, s41
    v_perm_b32 v191, v33, v32, s42
    v_perm_b32 v200, v35, v34, s41
    v_perm_b32 v201, v35, v34, s42
    v_perm_b32 v202, v37, v36, s41
    v_perm_b32 v203, v37, v36, s42
    v_perm_b32 v204, v39, v38, s41
    v_perm_b32 v205, v39, v38, s42
    v_perm_b32 v206, v41, v40, s41
    v_perm_b32 v207, v41, v40, s42
    v_perm_b32 v98, v43, v42, s41
    v_perm_b32 v99, v43, v42, s42
    v_perm_b32 v100, v45, v44, s41
    v_perm_b32 v101, v45, v44, s42
    v_perm_b32 v102, v47, v46, s41
    v_perm_b32 v103, v47, v46, s42
    v_perm_b32 v104, v49, v48, s41
    v_perm_b32 v105, v49, v48, s42
    s_waitcnt vmcnt(24)
    s_barrier
    s_cmp_lg_u32 s23, 0
    s_cbranch_scc1 L_ver_c1
    v_mov_b32 v14, 14336
    s_cmp_lg_u32 s21, 0
    s_cbranch_scc1 L_verw_c1
    s_waitcnt vmcnt(24)
    s_mov_b64 exec, 1
    ds_write_b32 v14, v1
    s_mov_b64 exec, -1
    s_waitcnt lgkmcnt(0)
L_verw_c1:
    s_barrier
    ds_read_b32 v15, v14
    s_waitcnt lgkmcnt(0)
    v_readfirstlane_b32 s4, v15
    s_bitcmp1_b32 s4, s5
    s_cbranch_scc1 L_el_fix
    s_nop 2
L_ver_c1:
    ds_read_b64_tr_b16 v[232:233], v7 offset:0
    ds_read_b64_tr_b16 v[234:235], v7 offset:1024
    ds_read_b64_tr_b16 v[236:237], v7 offset:8192
    ds_read_b64_tr_b16 v[238:239], v7 offset:9216
    ds_read_b64_tr_b16 v[18:19], v8 offset:0
    ds_read_b64_tr_b16 v[20:21], v8 offset:1024
    ds_read_b64_tr_b16 v[22:23], v8 offset:8192
    ds_read_b64_tr_b16 v[24:25], v8 offset:9216
    ds_read_b64_tr_b16 v[240:241], v7 offset:16384
    ds_read_b64_tr_b16 v[242:243], v7 offset:17408
    ds_read_b64_tr_b16 v[244:245], v7 offset:24576
    ds_read_b64_tr_b16 v[246:247], v7 offset:25600
    ds_read_b64_tr_b16 v[248:249], v8 offset:16384
    ds_read_b64_tr_b16 v[250:251], v8 offset:17408
    ds_read_b64_tr_b16 v[252:253], v8 offset:24576
    ds_read_b64_tr_b16 v[254:255], v8 offset:25600
    s_waitcnt lgkmcnt(0)
    s_barrier
    s_mov_b32 s12, s62
    s_mov_b32 s13, s63
    s_lshl_b32 s40, s20, 8
    s_add_u32 s40, s40, 262144
    s_mov_b32 m0, 40960
    s_nop 0
    buffer_load_dwordx4 v4, s[12:15], s40 offen lds
    s_add_u32 s40, s40, 32768
    s_mov_b32 m0, 41984
    s_nop 0
    buffer_load_dwordx4 v4, s[12:15], s40 offen lds
    s_add_u32 s40, s40, 32768
    s_mov_b32 m0, 43008
    s_nop 0
    buffer_load_dwordx4 v5, s[12:15], s40 offen lds
    s_add_u32 s40, s40, 32768
    s_mov_b32 m0, 44032
    s_nop 0
    buffer_load_dwordx4 v5, s[12:15], s40 offen lds
    s_add_u32 s40, s40, 32768
    s_mov_b32 m0, 45056
    s_nop 0
    buffer_load_dwordx4 v4, s[12:15], s40 offen lds
    s_add_u32 s40, s40, 32768
    s_mov_b32 m0, 46080
    s_nop 0
    buffer_load_dwordx4 v4, s[12:15], s40 offen lds
    s_add_u32 s40, s40, 32768
    s_mov_b32 m0, 47104
    s_nop 0
    buffer_load_dwordx4 v5, s[12:15], s40 offen lds
    s_add_u32 s40, s40, 32768
    s_mov_b32 m0, 48128
    s_nop 0
    buffer_load_dwordx4 v5, s[12:15], s40 offen lds
    s_waitcnt vmcnt(24)
    s_barrier
    v_add_u32 v7, 32768, v7
    v_add_u32 v8, 32768, v8
    ds_read_b64_tr_b16 a[208:209], v7 offset:0
    ds_read_b64_tr_b16 a[210:211], v7 offset:1024
    ds_read_b64_tr_b16 a[212:213], v7 offset:8192
    ds_read_b64_tr_b16 a[214:215], v7 offset:9216
    ds_read_b64_tr_b16 a[216:217], v8 offset:0
    ds_read_b64_tr_b16 a[218:219], v8 offset:1024
    ds_read_b64_tr_b16 a[220:221], v8 offset:8192
    ds_read_b64_tr_b16 a[222:223], v8 offset:9216
    ds_read_b64_tr_b16 v[26:27], v7 offset:16384
    ds_read_b64_tr_b16 v[28:29], v7 offset:17408
    ds_read_b64_tr_b16 v[30:31], v7 offset:24576
    ds_read_b64_tr_b16 v[32:33], v7 offset:25600
    ds_read_b64_tr_b16 a[192:193], v8 offset:16384
    ds_read_b64_tr_b16 a[194:195], v8 offset:17408
    ds_read_b64_tr_b16 a[196:197], v8 offset:24576
    ds_read_b64_tr_b16 a[198:199], v8 offset:25600
    s_waitcnt lgkmcnt(0)
    s_barrier
    s_mov_b32 s12, s62
    s_mov_b32 s13, s63
    s_lshl_b32 s40, s20, 8
    s_add_u32 s40, s40, 1310720
    s_mov_b32 m0, 73728
    s_nop 0
    buffer_load_dwordx4 v4, s[12:15], s40 offen lds
    s_add_u32 s40, s40, 32768
    s_mov_b32 m0, 74752
    s_nop 0
    buffer_load_dwordx4 v4, s[12:15], s40 offen lds
    s_add_u32 s40, s40, 32768
    s_mov_b32 m0, 75776
    s_nop 0
    buffer_load_dwordx4 v5, s[12:15], s40 offen lds
    s_add_u32 s40, s40, 32768
    s_mov_b32 m0, 76800
    s_nop 0
    buffer_load_dwordx4 v5, s[12:15], s40 offen lds
    s_add_u32 s40, s40, 32768
    s_mov_b32 m0, 77824
    s_nop 0
    buffer_load_dwordx4 v4, s[12:15], s40 offen lds
    s_add_u32 s40, s40, 32768
    s_mov_b32 m0, 78848
    s_nop 0
    buffer_load_dwordx4 v4, s[12:15], s40 offen lds
    s_add_u32 s40, s40, 32768
    s_mov_b32 m0, 79872
    s_nop 0
    buffer_load_dwordx4 v5, s[12:15], s40 offen lds
    s_add_u32 s40, s40, 32768
    s_mov_b32 m0, 80896
    s_nop 0
    buffer_load_dwordx4 v5, s[12:15], s40 offen lds
    s_waitcnt vmcnt(24)
    s_barrier
    v_add_u32 v7, 32768, v7
    v_add_u32 v8, 32768, v8
    ds_read_b64_tr_b16 v[34:35], v7 offset:0
    ds_read_b64_tr_b16 v[36:37], v7 offset:1024
    ds_read_b64_tr_b16 v[38:39], v7 offset:8192
    ds_read_b64_tr_b16 v[40:41], v7 offset:9216
    ds_read_b64_tr_b16 a[224:225], v8 offset:0
    ds_read_b64_tr_b16 a[226:227], v8 offset:1024
    ds_read_b64_tr_b16 a[228:229], v8 offset:8192
    ds_read_b64_tr_b16 a[230:231], v8 offset:9216
    ds_read_b64_tr_b16 a[200:201], v7 offset:16384
    ds_read_b64_tr_b16 a[202:203], v7 offset:17408
    ds_read_b64_tr_b16 a[204:205], v7 offset:24576
    ds_read_b64_tr_b16 a[206:207], v7 offset:25600
    ds_read_b64_tr_b16 v[42:43], v8 offset:16384
    ds_read_b64_tr_b16 v[44:45], v8 offset:17408
    ds_read_b64_tr_b16 v[46:47], v8 offset:24576
    ds_read_b64_tr_b16 v[48:49], v8 offset:25600
    s_waitcnt lgkmcnt(0)
    s_barrier
    s_mov_b32 s12, s62
    s_mov_b32 s13, s63
    s_lshl_b32 s40, s20, 8
    s_add_u32 s40, s40, 2359296
    s_mov_b32 m0, 106496
    s_nop 0
    buffer_load_dwordx4 v4, s[12:15], s40 offen lds
    s_add_u32 s40, s40, 32768
    s_mov_b32 m0, 107520
    s_nop 0
    buffer_load_dwordx4 v4, s[12:15], s40 offen lds
    s_add_u32 s40, s40, 32768
    s_mov_b32 m0, 108544
    s_nop 0
    buffer_load_dwordx4 v5, s[12:15], s40 offen lds
    s_add_u32 s40, s40, 32768
    s_mov_b32 m0, 109568
    s_nop 0
    buffer_load_dwordx4 v5, s[12:15], s40 offen lds
    s_add_u32 s40, s40, 32768
    s_mov_b32 m0, 110592
    s_nop 0
    buffer_load_dwordx4 v4, s[12:15], s40 offen lds
    s_add_u32 s40, s40, 32768
    s_mov_b32 m0, 111616
    s_nop 0
    buffer_load_dwordx4 v4, s[12:15], s40 offen lds
    s_add_u32 s40, s40, 32768
    s_mov_b32 m0, 112640
    s_nop 0
    buffer_load_dwordx4 v5, s[12:15], s40 offen lds
    s_add_u32 s40, s40, 32768
    s_mov_b32 m0, 113664
    s_nop 0
    buffer_load_dwordx4 v5, s[12:15], s40 offen lds
    s_waitcnt vmcnt(24)
    s_barrier
    v_add_u32 v7, 32768, v7
    v_add_u32 v8, 32768, v8
    ds_read_b64_tr_b16 a[232:233], v7 offset:0
    ds_read_b64_tr_b16 a[234:235], v7 offset:1024
    ds_read_b64_tr_b16 a[236:237], v7 offset:8192
    ds_read_b64_tr_b16 a[238:239], v7 offset:9216
    ds_read_b64_tr_b16 a[240:241], v8 offset:0
    ds_read_b64_tr_b16 a[242:243], v8 offset:1024
    ds_read_b64_tr_b16 a[244:245], v8 offset:8192
    ds_read_b64_tr_b16 a[246:247], v8 offset:9216
    ds_read_b64_tr_b16 v[50:51], v7 offset:16384
    ds_read_b64_tr_b16 v[52:53], v7 offset:17408
    ds_read_b64_tr_b16 v[54:55], v7 offset:24576
    ds_read_b64_tr_b16 v[56:57], v7 offset:25600
    ds_read_b64_tr_b16 a[248:249], v8 offset:16384
    ds_read_b64_tr_b16 a[250:251], v8 offset:17408
    ds_read_b64_tr_b16 a[252:253], v8 offset:24576
    ds_read_b64_tr_b16 a[254:255], v8 offset:25600
    s_waitcnt lgkmcnt(0)
    s_barrier
    s_mov_b32 s12, s62
    s_mov_b32 s13, s63
    s_lshl_b32 s40, s20, 8
    s_add_u32 s40, s40, 3407872
    s_mov_b32 m0, 139264
    s_nop 0
    buffer_load_dwordx4 v4, s[12:15], s40 offen lds
    s_add_u32 s40, s40, 32768
    s_mov_b32 m0, 140288
    s_nop 0
    buffer_load_dwordx4 v4, s[12:15], s40 offen lds
    s_add_u32 s40, s40, 32768
    s_mov_b32 m0, 141312
    s_nop 0
    buffer_load_dwordx4 v5, s[12:15], s40 offen lds
    s_add_u32 s40, s40, 32768
    s_mov_b32 m0, 142336
    s_nop 0
    buffer_load_dwordx4 v5, s[12:15], s40 offen lds
    s_add_u32 s40, s40, 32768
    s_mov_b32 m0, 143360
    s_nop 0
    buffer_load_dwordx4 v4, s[12:15], s40 offen lds
    s_add_u32 s40, s40, 32768
    s_mov_b32 m0, 144384
    s_nop 0
    buffer_load_dwordx4 v4, s[12:15], s40 offen lds
    s_add_u32 s40, s40, 32768
    s_mov_b32 m0, 145408
    s_nop 0
    buffer_load_dwordx4 v5, s[12:15], s40 offen lds
    s_add_u32 s40, s40, 32768
    s_mov_b32 m0, 146432
    s_nop 0
    buffer_load_dwordx4 v5, s[12:15], s40 offen lds
    buffer_load_dword v1, off, s[16:19], 0 offset:4 sc1
    s_waitcnt vmcnt(25)
    s_barrier
    v_add_u32 v7, 4294868992, v7
    v_add_u32 v8, 4294868992, v8
    ds_read_b64_tr_b16 v[58:59], v7 offset:0
    ds_read_b64_tr_b16 v[60:61], v7 offset:1024
    ds_read_b64_tr_b16 v[62:63], v7 offset:8192
    ds_read_b64_tr_b16 v[64:65], v7 offset:9216
    ds_read_b64_tr_b16 a[168:169], v8 offset:0
    ds_read_b64_tr_b16 a[170:171], v8 offset:1024
    ds_read_b64_tr_b16 a[172:173], v8 offset:8192
    ds_read_b64_tr_b16 a[174:175], v8 offset:9216
    ds_read_b64_tr_b16 a[176:177], v7 offset:16384
    ds_read_b64_tr_b16 a[178:179], v7 offset:17408
    ds_read_b64_tr_b16 a[180:181], v7 offset:24576
    ds_read_b64_tr_b16 a[182:183], v7 offset:25600
    ds_read_b64_tr_b16 a[184:185], v8 offset:16384
    ds_read_b64_tr_b16 a[186:187], v8 offset:17408
    ds_read_b64_tr_b16 a[188:189], v8 offset:24576
    ds_read_b64_tr_b16 a[190:191], v8 offset:25600
    s_waitcnt lgkmcnt(0)
    s_barrier
    s_mov_b32 s12, s60
    s_mov_b32 s13, s61
    s_lshl_b32 s40, s20, 8
    s_add_u32 s40, s40, 262144
    s_mov_b32 m0, 40960
    s_nop 0
    buffer_load_dwordx4 v4, s[12:15], s40 offen lds
    s_add_u32 s40, s40, 32768
    s_mov_b32 m0, 41984
    s_nop 0
    buffer_load_dwordx4 v4, s[12:15], s40 offen lds
    s_add_u32 s40, s40, 32768
    s_mov_b32 m0, 43008
    s_nop 0
    buffer_load_dwordx4 v5, s[12:15], s40 offen lds
    s_add_u32 s40, s40, 32768
    s_mov_b32 m0, 44032
    s_nop 0
    buffer_load_dwordx4 v5, s[12:15], s40 offen lds
    s_add_u32 s40, s40, 32768
    s_mov_b32 m0, 45056
    s_nop 0
    buffer_load_dwordx4 v4, s[12:15], s40 offen lds
    s_add_u32 s40, s40, 32768
    s_mov_b32 m0, 46080
    s_nop 0
    buffer_load_dwordx4 v4, s[12:15], s40 offen lds
    s_add_u32 s40, s40, 32768
    s_mov_b32 m0, 47104
    s_nop 0
    buffer_load_dwordx4 v5, s[12:15], s40 offen lds
    s_add_u32 s40, s40, 32768
    s_mov_b32 m0, 48128
    s_nop 0
    buffer_load_dwordx4 v5, s[12:15], s40 offen lds
    s_waitcnt vmcnt(25)
    s_barrier
    v_add_u32 v7, 32768, v7
    v_add_u32 v8, 32768, v8
    ds_read_b64_tr_b16 a[120:121], v7 offset:0
    ds_read_b64_tr_b16 a[122:123], v7 offset:1024
    ds_read_b64_tr_b16 a[124:125], v7 offset:8192
    ds_read_b64_tr_b16 a[126:127], v7 offset:9216
    ds_read_b64_tr_b16 a[128:129], v8 offset:0
    ds_read_b64_tr_b16 a[130:131], v8 offset:1024
    ds_read_b64_tr_b16 a[132:133], v8 offset:8192
    ds_read_b64_tr_b16 a[134:135], v8 offset:9216
    ds_read_b64_tr_b16 a[16:17], v7 offset:16384
    ds_read_b64_tr_b16 a[18:19], v7 offset:17408
    ds_read_b64_tr_b16 a[20:21], v7 offset:24576
    ds_read_b64_tr_b16 a[22:23], v7 offset:25600
    ds_read_b64_tr_b16 a[24:25], v8 offset:16384
    ds_read_b64_tr_b16 a[26:27], v8 offset:17408
    ds_read_b64_tr_b16 a[28:29], v8 offset:24576
    ds_read_b64_tr_b16 a[30:31], v8 offset:25600
    s_waitcnt lgkmcnt(0)
    s_barrier
    s_mov_b32 s12, s60
    s_mov_b32 s13, s61
    s_lshl_b32 s40, s20, 8
    s_add_u32 s40, s40, 1310720
    s_mov_b32 m0, 73728
    s_nop 0
    buffer_load_dwordx4 v4, s[12:15], s40 offen lds
    s_add_u32 s40, s40, 32768
    s_mov_b32 m0, 74752
    s_nop 0
    buffer_load_dwordx4 v4, s[12:15], s40 offen lds
    s_add_u32 s40, s40, 32768
    s_mov_b32 m0, 75776
    s_nop 0
    buffer_load_dwordx4 v5, s[12:15], s40 offen lds
    s_add_u32 s40, s40, 32768
    s_mov_b32 m0, 76800
    s_nop 0
    buffer_load_dwordx4 v5, s[12:15], s40 offen lds
    s_add_u32 s40, s40, 32768
    s_mov_b32 m0, 77824
    s_nop 0
    buffer_load_dwordx4 v4, s[12:15], s40 offen lds
    s_add_u32 s40, s40, 32768
    s_mov_b32 m0, 78848
    s_nop 0
    buffer_load_dwordx4 v4, s[12:15], s40 offen lds
    s_add_u32 s40, s40, 32768
    s_mov_b32 m0, 79872
    s_nop 0
    buffer_load_dwordx4 v5, s[12:15], s40 offen lds
    s_add_u32 s40, s40, 32768
    s_mov_b32 m0, 80896
    s_nop 0
    buffer_load_dwordx4 v5, s[12:15], s40 offen lds
    s_waitcnt vmcnt(25)
    s_barrier
    v_add_u32 v7, 32768, v7
    v_add_u32 v8, 32768, v8
    ds_read_b64_tr_b16 v[66:67], v7 offset:0
    ds_read_b64_tr_b16 v[68:69], v7 offset:1024
    ds_read_b64_tr_b16 v[70:71], v7 offset:8192
    ds_read_b64_tr_b16 v[72:73], v7 offset:9216
    ds_read_b64_tr_b16 a[136:137], v8 offset:0
    ds_read_b64_tr_b16 a[138:139], v8 offset:1024
    ds_read_b64_tr_b16 a[140:141], v8 offset:8192
    ds_read_b64_tr_b16 a[142:143], v8 offset:9216
    ds_read_b64_tr_b16 a[40:41], v7 offset:16384
    ds_read_b64_tr_b16 a[42:43], v7 offset:17408
    ds_read_b64_tr_b16 a[44:45], v7 offset:24576
    ds_read_b64_tr_b16 a[46:47], v7 offset:25600
    ds_read_b64_tr_b16 a[48:49], v8 offset:16384
    ds_read_b64_tr_b16 a[50:51], v8 offset:17408
    ds_read_b64_tr_b16 a[52:53], v8 offset:24576
    ds_read_b64_tr_b16 a[54:55], v8 offset:25600
    s_waitcnt lgkmcnt(0)
    s_barrier
    s_mov_b32 s12, s60
    s_mov_b32 s13, s61
    s_lshl_b32 s40, s20, 8
    s_add_u32 s40, s40, 2359296
    s_mov_b32 m0, 106496
    s_nop 0
    buffer_load_dwordx4 v4, s[12:15], s40 offen lds
    s_add_u32 s40, s40, 32768
    s_mov_b32 m0, 107520
    s_nop 0
    buffer_load_dwordx4 v4, s[12:15], s40 offen lds
    s_add_u32 s40, s40, 32768
    s_mov_b32 m0, 108544
    s_nop 0
    buffer_load_dwordx4 v5, s[12:15], s40 offen lds
    s_add_u32 s40, s40, 32768
    s_mov_b32 m0, 109568
    s_nop 0
    buffer_load_dwordx4 v5, s[12:15], s40 offen lds
    s_add_u32 s40, s40, 32768
    s_mov_b32 m0, 110592
    s_nop 0
    buffer_load_dwordx4 v4, s[12:15], s40 offen lds
    s_add_u32 s40, s40, 32768
    s_mov_b32 m0, 111616
    s_nop 0
    buffer_load_dwordx4 v4, s[12:15], s40 offen lds
    s_add_u32 s40, s40, 32768
    s_mov_b32 m0, 112640
    s_nop 0
    buffer_load_dwordx4 v5, s[12:15], s40 offen lds
    s_add_u32 s40, s40, 32768
    s_mov_b32 m0, 113664
    s_nop 0
    buffer_load_dwordx4 v5, s[12:15], s40 offen lds
    s_waitcnt vmcnt(25)
    s_barrier
    v_add_u32 v7, 32768, v7
    v_add_u32 v8, 32768, v8
    ds_read_b64_tr_b16 a[144:145], v7 offset:0
    ds_read_b64_tr_b16 a[146:147], v7 offset:1024
    ds_read_b64_tr_b16 a[148:149], v7 offset:8192
    ds_read_b64_tr_b16 a[150:151], v7 offset:9216
    ds_read_b64_tr_b16 v[74:75], v8 offset:0
    ds_read_b64_tr_b16 v[76:77], v8 offset:1024
    ds_read_b64_tr_b16 v[78:79], v8 offset:8192
    ds_read_b64_tr_b16 v[80:81], v8 offset:9216
    ds_read_b64_tr_b16 a[152:153], v7 offset:16384
    ds_read_b64_tr_b16 a[154:155], v7 offset:17408
    ds_read_b64_tr_b16 a[156:157], v7 offset:24576
    ds_read_b64_tr_b16 a[158:159], v7 offset:25600
    ds_read_b64_tr_b16 a[160:161], v8 offset:16384
    ds_read_b64_tr_b16 a[162:163], v8 offset:17408
    ds_read_b64_tr_b16 a[164:165], v8 offset:24576
    ds_read_b64_tr_b16 a[166:167], v8 offset:25600
    s_waitcnt lgkmcnt(0)
    s_barrier
    s_mov_b32 s12, s60
    s_mov_b32 s13, s61
    s_lshl_b32 s40, s20, 8
    s_add_u32 s40, s40, 3407872
    s_mov_b32 m0, 139264
    s_nop 0
    buffer_load_dwordx4 v4, s[12:15], s40 offen lds
    s_add_u32 s40, s40, 32768
    s_mov_b32 m0, 140288
    s_nop 0
    buffer_load_dwordx4 v4, s[12:15], s40 offen lds
    s_add_u32 s40, s40, 32768
    s_mov_b32 m0, 141312
    s_nop 0
    buffer_load_dwordx4 v5, s[12:15], s40 offen lds
    s_add_u32 s40, s40, 32768
    s_mov_b32 m0, 142336
    s_nop 0
    buffer_load_dwordx4 v5, s[12:15], s40 offen lds
    s_add_u32 s40, s40, 32768
    s_mov_b32 m0, 143360
    s_nop 0
    buffer_load_dwordx4 v4, s[12:15], s40 offen lds
    s_add_u32 s40, s40, 32768
    s_mov_b32 m0, 144384
    s_nop 0
    buffer_load_dwordx4 v4, s[12:15], s40 offen lds
    s_add_u32 s40, s40, 32768
    s_mov_b32 m0, 145408
    s_nop 0
    buffer_load_dwordx4 v5, s[12:15], s40 offen lds
    s_add_u32 s40, s40, 32768
    s_mov_b32 m0, 146432
    s_nop 0
    buffer_load_dwordx4 v5, s[12:15], s40 offen lds
    s_waitcnt vmcnt(24)
    s_barrier
    v_add_u32 v7, 4294868992, v7
    v_add_u32 v8, 4294868992, v8
    ds_read_b64_tr_b16 a[96:97], v7 offset:0
    ds_read_b64_tr_b16 a[98:99], v7 offset:1024
    ds_read_b64_tr_b16 a[100:101], v7 offset:8192
    ds_read_b64_tr_b16 a[102:103], v7 offset:9216
    ds_read_b64_tr_b16 a[104:105], v8 offset:0
    ds_read_b64_tr_b16 a[106:107], v8 offset:1024
    ds_read_b64_tr_b16 a[108:109], v8 offset:8192
    ds_read_b64_tr_b16 a[110:111], v8 offset:9216
    ds_read_b64_tr_b16 v[106:107], v7 offset:16384
    ds_read_b64_tr_b16 v[108:109], v7 offset:17408
    ds_read_b64_tr_b16 v[110:111], v7 offset:24576
    ds_read_b64_tr_b16 v[112:113], v7 offset:25600
    ds_read_b64_tr_b16 a[112:113], v8 offset:16384
    ds_read_b64_tr_b16 a[114:115], v8 offset:17408
    ds_read_b64_tr_b16 a[116:117], v8 offset:24576
    ds_read_b64_tr_b16 a[118:119], v8 offset:25600
    s_waitcnt lgkmcnt(0)
    s_barrier
    v_add_u32 v13, 34816, v6
    ds_write_b128 v13, v[82:85]
    ds_write_b128 v13, v[86:89] offset:1024
    v_add_u32 v13, 43008, v6
    ds_write_b128 v13, v[90:93]
    ds_write_b128 v13, v[94:97] offset:1024
    v_add_u32 v13, 51200, v6
    ds_write_b128 v13, v[98:101]
    ds_write_b128 v13, v[102:105] offset:1024
    v_add_u32 v13, 59392, v6
    ds_write_b128 v13, v[18:21]
    ds_write_b128 v13, v[22:25] offset:1024
    v_readfirstlane_b32 s74, v1
    s_and_b32 s40, s74, 0xffff
    s_cmp_eq_u32 s40, 8224
    s_cbranch_scc1 L_c1_rdy
    s_nop 1
L_c1_rdyl:
    buffer_load_dword v1, off, s[16:19], 0 offset:4 sc1
    s_sub_u32 s22, s22, 1
    s_cbranch_scc1 L_exit
    s_waitcnt vmcnt(0)
    v_readfirstlane_b32 s74, v1
    s_and_b32 s40, s74, 0xffff
    s_cmp_lg_u32 s40, 8224
    s_cbranch_scc1 L_c1_rdyl
    s_nop 1
L_c1_rdy:
    s_waitcnt vmcnt(16)
    s_barrier
    v_add_u32 v7, 32768, v7
    v_add_u32 v8, 32768, v8
    ds_read_b64_tr_b16 v[18:19], v7 offset:0
    ds_read_b64_tr_b16 v[20:21], v7 offset:1024
    ds_read_b64_tr_b16 v[22:23], v7 offset:8192
    ds_read_b64_tr_b16 v[24:25], v7 offset:9216
    ds_read_b64_tr_b16 a[56:57], v8 offset:0
    ds_read_b64_tr_b16 a[58:59], v8 offset:1024
    ds_read_b64_tr_b16 a[60:61], v8 offset:8192
    ds_read_b64_tr_b16 a[62:63], v8 offset:9216
    ds_read_b64_tr_b16 a[0:1], v7 offset:16384
    ds_read_b64_tr_b16 a[2:3], v7 offset:17408
    ds_read_b64_tr_b16 a[4:5], v7 offset:24576
    ds_read_b64_tr_b16 a[6:7], v7 offset:25600
    ds_read_b64_tr_b16 a[8:9], v8 offset:16384
    ds_read_b64_tr_b16 a[10:11], v8 offset:17408
    ds_read_b64_tr_b16 a[12:13], v8 offset:24576
    ds_read_b64_tr_b16 a[14:15], v8 offset:25600
    s_waitcnt lgkmcnt(0)
    s_barrier
    v_add_u32 v13, 67584, v6
    ds_write_b128 v13, v[26:29]
    ds_write_b128 v13, v[30:33] offset:1024
    v_add_u32 v13, 75776, v6
    ds_write_b128 v13, v[34:37]
    ds_write_b128 v13, v[38:41] offset:1024
    v_add_u32 v13, 83968, v6
    ds_write_b128 v13, v[42:45]
    ds_write_b128 v13, v[46:49] offset:1024
    v_add_u32 v13, 92160, v6
    ds_write_b128 v13, v[50:53]
    ds_write_b128 v13, v[54:57] offset:1024
    v_and_b32 v14, 1, v10
    v_lshlrev_b32 v14, 20, v14
    v_add_u32 v14, s37, v14
    buffer_load_dword v1, v14, s[8:11], 0 offen sc1
    s_waitcnt vmcnt(9)
    s_barrier
    v_add_u32 v7, 32768, v7
    v_add_u32 v8, 32768, v8
    ds_read_b64_tr_b16 a[64:65], v7 offset:0
    ds_read_b64_tr_b16 a[66:67], v7 offset:1024
    ds_read_b64_tr_b16 a[68:69], v7 offset:8192
    ds_read_b64_tr_b16 a[70:71], v7 offset:9216
    ds_read_b64_tr_b16 a[72:73], v8 offset:0
    ds_read_b64_tr_b16 a[74:75], v8 offset:1024
    ds_read_b64_tr_b16 a[76:77], v8 offset:8192
    ds_read_b64_tr_b16 a[78:79], v8 offset:9216
    ds_read_b64_tr_b16 a[32:33], v7 offset:16384
    ds_read_b64_tr_b16 a[34:35], v7 offset:17408
    ds_read_b64_tr_b16 a[36:37], v7 offset:24576
    ds_read_b64_tr_b16 a[38:39], v7 offset:25600
    ds_read_b64_tr_b16 v[26:27], v8 offset:16384
    ds_read_b64_tr_b16 v[28:29], v8 offset:17408
    ds_read_b64_tr_b16 v[30:31], v8 offset:24576
    ds_read_b64_tr_b16 v[32:33], v8 offset:25600
    s_waitcnt lgkmcnt(0)
    s_barrier
    v_add_u32 v13, 100352, v6
    ds_write_b128 v13, v[58:61]
    ds_write_b128 v13, v[62:65] offset:1024
    v_add_u32 v13, 108544, v6
    ds_write_b128 v13, v[66:69]
    ds_write_b128 v13, v[70:73] offset:1024
    v_add_u32 v13, 116736, v6
    ds_write_b128 v13, v[74:77]
    ds_write_b128 v13, v[78:81] offset:1024
    v_add_u32 v13, 124928, v6
    ds_write_b128 v13, v[106:109]
    ds_write_b128 v13, v[110:113] offset:1024
    s_waitcnt vmcnt(1)
    s_barrier
    v_add_u32 v7, 32768, v7
    v_add_u32 v8, 32768, v8
    ds_read_b64_tr_b16 v[34:35], v7 offset:0
    ds_read_b64_tr_b16 v[36:37], v7 offset:1024
    ds_read_b64_tr_b16 v[38:39], v7 offset:8192
    ds_read_b64_tr_b16 v[40:41], v7 offset:9216
    ds_read_b64_tr_b16 a[80:81], v8 offset:0
    ds_read_b64_tr_b16 a[82:83], v8 offset:1024
    ds_read_b64_tr_b16 a[84:85], v8 offset:8192
    ds_read_b64_tr_b16 a[86:87], v8 offset:9216
    ds_read_b64_tr_b16 a[88:89], v7 offset:16384
    ds_read_b64_tr_b16 a[90:91], v7 offset:17408
    ds_read_b64_tr_b16 a[92:93], v7 offset:24576
    ds_read_b64_tr_b16 a[94:95], v7 offset:25600
    ds_read_b64_tr_b16 v[42:43], v8 offset:16384
    ds_read_b64_tr_b16 v[44:45], v8 offset:17408
    ds_read_b64_tr_b16 v[46:47], v8 offset:24576
    ds_read_b64_tr_b16 v[48:49], v8 offset:25600
    s_waitcnt lgkmcnt(0)
    s_barrier
    v_add_u32 v13, 133120, v6
    ds_write_b128 v13, v[18:21]
    ds_write_b128 v13, v[22:25] offset:1024
    v_add_u32 v13, 141312, v6
    ds_write_b128 v13, v[26:29]
    ds_write_b128 v13, v[30:33] offset:1024
    v_add_u32 v13, 149504, v6
    ds_write_b128 v13, v[34:37]
    ds_write_b128 v13, v[38:41] offset:1024
    v_add_u32 v13, 157696, v6
    ds_write_b128 v13, v[42:45]
    ds_write_b128 v13, v[46:49] offset:1024
    s_waitcnt vmcnt(0)
    v_cmp_eq_u32 vcc, -1, v1
    s_cbranch_vccz L_c1_kv
    s_nop 3
L_c1_kvl:
    buffer_load_dword v1, v14, s[8:11], 0 offen sc1
    s_sub_u32 s22, s22, 1
    s_cbranch_scc1 L_exit
    s_waitcnt vmcnt(0)
    v_cmp_eq_u32 vcc, -1, v1
    s_cbranch_vccnz L_c1_kvl
    s_nop 3
L_c1_kv:
    s_lshl_b32 s34, s20, 12
    s_add_u32 s34, s34, 16778240
    s_add_u32 s72, s34, 0x40000
    v_add_u32 v14, 0x20000, v6
    s_lshl_b32 s29, s20, 13
    s_add_u32 s29, s29, 2048
    s_waitcnt lgkmcnt(0)
    buffer_load_dwordx4 v[80:83], v6, s[8:11], s34 offen sc1
    buffer_load_dwordx4 v[84:87], v14, s[8:11], s34 offen sc1
    buffer_load_dwordx4 v[88:91], v6, s[8:11], s72 offen sc1
    buffer_load_dwordx4 v[92:95], v14, s[8:11], s72 offen sc1
    buffer_load_dwordx4 v[96:99], v6, s[8:11], s29 offen offset:0 sc1
    buffer_load_dwordx4 v[100:103], v6, s[8:11], s29 offen offset:1024 sc1
    s_lshl_b32 s36, s20, 6
    s_add_u32 s36, s36, 2048
    v_mbcnt_lo_u32_b32 v141, -1, 0
    v_mbcnt_hi_u32_b32 v141, -1, v141
    v_and_b32 v106, 15, v141
    v_lshrrev_b32 v107, 4, v141
    v_lshrrev_b32 v108, 2, v106
    v_bfe_u32 v109, v106, 1, 1
    v_and_b32 v123, 1, v106
    v_lshl_add_u32 v122, v108, 1, v123
    s_mov_b32 s24, 0xcccccccc
    s_mov_b32 s25, 0xcccccccc
    s_mov_b32 s26, 0x33333333
    s_mov_b32 s27, 0x33333333
    s_mov_b32 s70, 0x3f803f80
    s_mov_b32 s71, 0x3f803f80
    v_lshlrev_b32 v127, 4, v141
    v_add_u32 v128, 0x10000, v127
    v_add_u32 v129, 0x20000, v127
    v_mov_b32 v126, 0x4444
    v_mov_b32 v124, 0xeeee
    v_cndmask_b32 v126, v126, v124, s[24:25]
    v_lshlrev_b32 v123, 4, v123
    v_mov_b32 v124, 0x3f80
    v_lshlrev_b32 v124, v123, v124
    v_cndmask_b32 v124, v124, 0, s[24:25]
    v_cmp_eq_u32 vcc, 0, v108
    s_nop 1
    v_cndmask_b32 v114, 0, v124, vcc
    v_cmp_eq_u32 vcc, 1, v108
    s_nop 1
    v_cndmask_b32 v115, 0, v124, vcc
    v_cmp_eq_u32 vcc, 2, v108
    s_nop 1
    v_cndmask_b32 v116, 0, v124, vcc
    v_cmp_eq_u32 vcc, 3, v108
    s_nop 1
    v_cndmask_b32 v117, 0, v124, vcc
    ds_write_b128 v127, v[114:117] offset:13312
    v_mov_b32 v118, 0
    v_mov_b32 v119, 0
    v_mov_b32 v120, 0
    v_mov_b32 v121, 0
    v_mov_b32 v123, 12800
    ds_write_b128 v123, v[118:121]
    v_lshrrev_b32 v123, 3, v106
    v_lshlrev_b32 v123, 15, v123
    v_lshl_add_u32 v123, v107, 13, v123
    v_and_b32 v124, 7, v106
    v_lshl_add_u32 v123, v124, 3, v123
    v_lshrrev_b32 v124, 11, v123
    v_add_u32 v124, s20, v124
    v_add_u32 v124, 2, v124
    v_and_b32 v124, 31, v124
    v_lshl_add_u32 v123, v124, 6, v123
    v_add_u32 v130, 65536, v123
    s_mov_b32 s69, 4096
    v_and_b32 v124, 3, v106
    v_lshlrev_b32 v123, 4, v107
    v_lshl_add_u32 v123, v124, 2, v123
    v_add_u32 v123, s36, v123
    v_mov_b32 v124, 0x40000000
    v_cmp_gt_u32 vcc, 4, v106
    s_nop 1
    v_cndmask_b32 v131, v124, v123, vcc
    s_lshl_b32 s40, s20, 8
    v_add_u32 v123, s40, v127
    v_cmp_gt_u32 vcc, 16, v141
    s_nop 1
    v_cndmask_b32 v137, v124, v123, vcc
    s_lshl_b32 s35, s20, 4
    s_add_u32 s35, s35, 262144
    v_xor_b32 v125, v107, v108
    v_lshlrev_b32 v125, 3, v125
    v_lshl_add_u32 v143, v106, 5, v125
    v_lshlrev_b32 v125, 3, v141
    v_lshlrev_b32 v123, 3, v107
    v_xor_b32 v140, v125, v123
    v_lshrrev_b32 v125, 1, v107
    v_lshl_add_u32 v125, v122, 2, v125
    v_lshlrev_b32 v125, 4, v125
    v_and_b32 v123, 1, v107
    v_lshl_add_u32 v125, v123, 2, v125
    v_lshl_add_u32 v125, v109, 1, v125
    v_add_u32 v132, 12320, v125
    v_lshl_add_u32 v123, v122, 2, v107
    v_lshlrev_b32 v123, 4, v123
    v_add_u32 v123, 12288, v123
    v_mov_b32 v124, 12800
    v_cndmask_b32 v133, v123, v124, s[24:25]
    v_cndmask_b32 v134, v124, v123, s[24:25]
    v_mul_u32_u24 v123, 288, v122
    v_lshl_add_u32 v124, v109, 5, v123
    v_lshl_add_u32 v135, v107, 3, v124
    v_lshl_add_u32 v136, v107, 4, v123
    v_lshlrev_b32 v124, 7, v141
    v_mov_b32 v125, 0x40000000
    v_cmp_gt_u32 vcc, 0, v141
    s_nop 1
    v_cndmask_b32 v124, v125, v124, vcc
    s_add_u32 s40, s36, 18612224
    s_sub_u32 s40, s40, s34
    v_mov_b32 v125, s40
    v_cmp_gt_u32 vcc, 32, v141
    s_nop 1
    v_cndmask_b32 v124, v125, v124, vcc
    s_add_u32 s40, s37, 1048576
    s_sub_u32 s40, s40, s34
    v_mov_b32 v125, s40
    v_cmp_gt_u32 vcc, 33, v141
    s_nop 1
    v_cndmask_b32 v124, v125, v124, vcc
    v_mov_b32 v125, 0x40000000
    v_cmp_gt_u32 vcc, 33, v141
    s_nop 1
    v_cndmask_b32 v139, v125, v124, vcc
    buffer_load_dword v138, v139, s[8:11], s34 offen sc1
    s_mov_b32 s30, 17566720
    s_mov_b32 s68, 17568768
    s_mov_b32 s32, 17563648
    s_mov_b32 s33, 17571840
    s_mov_b32 s28, 0
    s_mov_b32 s38, 0
    s_mov_b32 s39, 1040356334
    s_mov_b32 s44, 729808896
    s_mov_b32 s45, 671088640
    s_mov_b32 s31, 262144
    s_lshr_b32 s5, s74, 16
    s_cmp_eq_u32 s5, 0
    s_cbranch_scc0 L_chain_slow1
    s_add_u32 s34, s34, 1048576
    s_add_u32 s72, s72, 1048576
    s_add_u32 s37, s37, 1048576
    s_mov_b32 s43, 1
    s_mov_b32 s28, 1
    ds_read_b128 v[32:35], v129 offset:10240
    ds_read_b128 v[36:39], v129 offset:11264
    ds_read_b128 v[40:43], v129 offset:2048
    ds_read_b128 v[44:47], v129 offset:3072
    v_mov_b64 v[56:57], 0
    v_mov_b64 v[58:59], 0
    v_mov_b64 v[60:61], 0
    v_mov_b64 v[62:63], 0
    v_mov_b64 v[64:65], 0
    v_mov_b64 v[66:67], 0
    v_mov_b64 v[68:69], 0
    v_mov_b64 v[70:71], 0
    v_mov_b64 v[72:73], 0
    v_mov_b64 v[74:75], 0
    v_mov_b64 v[76:77], 0
    v_mov_b64 v[78:79], 0
    v_mov_b32 v142, s43
    s_waitcnt lgkmcnt(0)
    buffer_load_dwordx4 v[12:15], v127, s[8:11], s30 offen sc1
    buffer_load_dwordx4 v[20:23], v127, s[8:11], s68 offen sc1
    s_branch LF1_bAw
.p2align 6
LF1_pollP:
    s_waitcnt vmcnt(1)
    v_mfma_f32_16x16x32_bf16 v[110:113], v[122:125], v[0:3], 0
    v_bitop3_b32 v141, v0, s28, 1 bitop3:0x28
    s_waitcnt vmcnt(0)
    v_mfma_f32_16x16x32_bf16 v[110:113], v[122:125], v[4:7], v[110:113]
    v_bitop3_b32 v141, v4, s28, v141 bitop3:0x28
    v_cmp_ne_u32 vcc, 1, v141
    s_nop 2
    s_cbranch_vccnz LF1_retryP
LF1_Pok:
    s_nop 0
    v_add_f32_dpp v110, v110, v110 row_ror:4 row_mask:0xf bank_mask:0xf
    v_add_f32_dpp v111, v111, v111 row_ror:4 row_mask:0xf bank_mask:0xf
    s_cmp_ge_u32 s38, 63
    v_add_f32_dpp v110, v110, v110 row_ror:8 row_mask:0xf bank_mask:0xf
    v_add_f32_dpp v111, v111, v111 row_ror:8 row_mask:0xf bank_mask:0xf
    v_cvt_pk_bf16_f32 v112, v110, v111
LF1_Mst:
    buffer_store_dword v112, v131, s[8:11], s32 offen
    s_cbranch_scc1 LF1_done
    s_waitcnt vmcnt(0)
    v_mov_b64 v[56:57], 0
    v_mov_b64 v[58:59], 0
    v_mov_b64 v[60:61], 0
    v_mov_b64 v[62:63], 0
    v_mov_b64 v[64:65], 0
    buffer_load_dwordx4 v[12:15], v127, s[8:11], s30 offen sc1
    v_mov_b64 v[66:67], 0
    v_mov_b64 v[68:69], 0
    v_mov_b64 v[70:71], 0
    v_mov_b64 v[72:73], 0
    v_mov_b64 v[74:75], 0
    v_mov_b64 v[76:77], 0
    v_mov_b64 v[78:79], 0
    s_add_u32 s34, s34, 1048576
    s_add_u32 s72, s72, 1048576
    ds_read_b128 v[32:35], v129 offset:10240
    ds_read_b128 v[36:39], v129 offset:11264
    ds_read_b128 v[40:43], v129 offset:2048
    ds_read_b128 v[44:47], v129 offset:3072
    buffer_load_dwordx4 v[20:23], v127, s[8:11], s68 offen sc1
LF1_bAw:
    s_waitcnt vmcnt(1)
LF1_bA:
    v_cmp_eq_u32 vcc, -1, v12
    v_smfmac_f32_16x16x64_bf16 v[56:59], v[12:15], a[0:7], v126
    ds_write_b128 v127, v[12:15] offset:3072
    v_smfmac_f32_16x16x64_bf16 v[60:63], v[12:15], a[8:15], v126
    s_cbranch_vccnz LF1_retryE
    s_waitcnt vmcnt(0)
    v_cmp_eq_u32 vcc, -1, v20
    v_smfmac_f32_16x16x64_bf16 v[64:67], v[12:15], a[16:23], v126
    ds_write_b128 v127, v[20:23] offset:5120
    v_smfmac_f32_16x16x64_bf16 v[68:71], v[12:15], a[24:31], v126
    s_cbranch_vccnz LF1_retryL
LF1_Lok:
    v_smfmac_f32_16x16x64_bf16 v[56:59], v[20:23], a[32:39], v126
    s_waitcnt lgkmcnt(4)
    v_smfmac_f32_16x16x64_bf16 v[60:63], v[20:23], v[32:39], v126
    ds_read_b128 v[36:39], v129 offset:19456
    s_waitcnt lgkmcnt(2)
    s_waitcnt lgkmcnt(1)
    s_barrier
    ds_read_b128 v[8:11], v127 offset:2048
    v_smfmac_f32_16x16x64_bf16 v[64:67], v[20:23], a[40:47], v126
    ds_read_b128 v[16:19], v127 offset:4096
    ds_read_b128 v[24:27], v127 offset:6144
    v_smfmac_f32_16x16x64_bf16 v[68:71], v[20:23], a[48:55], v126
    ds_read_b128 v[28:31], v127 offset:7168
    buffer_load_dwordx4 v[96:99], v127, s[8:11], s72 offen sc1
    ds_read_b128 v[32:35], v129 offset:18432
    s_waitcnt lgkmcnt(4)
    v_smfmac_f32_16x16x64_bf16 v[56:59], v[8:11], v[40:47], v126
    ds_read_b128 v[40:43], v129 offset:26624
    v_smfmac_f32_16x16x64_bf16 v[60:63], v[8:11], a[56:63], v126
    ds_read_b128 v[0:3], v127 offset:0
    v_mov_b64 v[124:125], s[70:71]
    s_waitcnt lgkmcnt(5)
    v_smfmac_f32_16x16x64_bf16 v[56:59], v[16:19], a[64:71], v126
    ds_read_b128 v[44:47], v129 offset:27648
    v_smfmac_f32_16x16x64_bf16 v[60:63], v[16:19], a[72:79], v126
    buffer_load_dwordx4 v[100:103], v129, s[8:11], s72 offen sc1
    s_waitcnt lgkmcnt(3)
    v_smfmac_f32_16x16x64_bf16 v[56:59], v[24:27], v[32:39], v126
    ds_read_b128 v[4:7], v127 offset:1024
    v_smfmac_f32_16x16x64_bf16 v[60:63], v[24:27], a[80:87], v126
    ds_read_b128 v[32:35], v128 offset:59392
    v_smfmac_f32_16x16x64_bf16 v[56:59], v[28:31], a[88:95], v126
    ds_read_b128 v[36:39], v128 offset:60416
    s_waitcnt lgkmcnt(3)
    v_smfmac_f32_16x16x64_bf16 v[60:63], v[28:31], v[40:47], v126
    ds_read_b128 v[44:47], v128 offset:44032
    v_smfmac_f32_16x16x64_bf16 v[56:59], v[0:3], a[96:103], v126
    ds_read_b128 v[40:43], v128 offset:43008
    v_smfmac_f32_16x16x64_bf16 v[60:63], v[0:3], a[104:111], v126
    buffer_load_dword v138, v139, s[8:11], s34 offen sc1
    s_waitcnt lgkmcnt(2)
    v_smfmac_f32_16x16x64_bf16 v[56:59], v[4:7], v[32:39], v126
    buffer_load_dwordx4 v[48:51], v127, s[8:11], s34 offen sc1
    v_smfmac_f32_16x16x64_bf16 v[60:63], v[4:7], a[112:119], v126
    v_smfmac_f32_16x16x64_bf16 v[64:67], v[8:11], a[120:127], v126
    ds_read_b128 v[32:35], v128 offset:51200
    v_add_f32 v57, v57, v59
    v_smfmac_f32_16x16x64_bf16 v[68:71], v[8:11], a[128:135], v126
    ds_read_b128 v[36:39], v128 offset:52224
    v_add_f32 v61, v61, v63
    s_waitcnt lgkmcnt(2)
    v_smfmac_f32_16x16x64_bf16 v[64:67], v[16:19], v[40:47], v126
    ds_read_b128 v[40:43], v128 offset:34816
    v_add_f32 v56, v56, v58
    v_smfmac_f32_16x16x64_bf16 v[68:71], v[16:19], a[136:143], v126
    buffer_load_dwordx4 v[52:55], v129, s[8:11], s34 offen sc1
    v_smfmac_f32_16x16x64_bf16 v[64:67], v[24:27], a[144:151], v126
    ds_read_b128 v[44:47], v128 offset:35840
    v_cvt_pk_bf16_f32 v56, v56, v57
    v_add_f32 v60, v60, v62
    v_cvt_pk_bf16_f32 v57, v60, v61
    s_waitcnt lgkmcnt(2)
    v_smfmac_f32_16x16x64_bf16 v[68:71], v[24:27], v[32:39], v126
    ds_write_b64 v143, v[56:57] offset:8704
    v_smfmac_f32_16x16x64_bf16 v[64:67], v[28:31], a[152:159], v126
    ds_read_b128 v[36:39], v128 offset:3072
    v_smfmac_f32_16x16x64_bf16 v[68:71], v[28:31], a[160:167], v126
    ds_read_b128 v[32:35], v128 offset:2048
    s_waitcnt lgkmcnt(3)
    v_smfmac_f32_16x16x64_bf16 v[64:67], v[0:3], v[40:47], v126
    ds_read_b128 v[44:47], v128 offset:19456
    v_smfmac_f32_16x16x64_bf16 v[68:71], v[0:3], a[168:175], v126
    s_waitcnt lgkmcnt(3)
    s_barrier
    v_smfmac_f32_16x16x64_bf16 v[64:67], v[4:7], a[176:183], v126
    ds_read_b64_tr_b16 v[58:59], v140 offset:8704
    ds_read_b64_tr_b16 v[56:57], v140 offset:8192
    v_smfmac_f32_16x16x64_bf16 v[68:71], v[4:7], a[184:191], v126
    ds_read_b64_tr_b16 v[60:61], v140 offset:9216
    ds_read_b64_tr_b16 v[62:63], v140 offset:9728
    s_waitcnt lgkmcnt(5)
    v_smfmac_f32_16x16x64_bf16 v[72:75], v[12:15], v[32:39], v126
    ds_read_b128 v[40:43], v128 offset:18432
    v_mov_b64 v[122:123], s[70:71]
    v_smfmac_f32_16x16x64_bf16 v[76:79], v[12:15], a[192:199], v126
    ds_read_b128 v[32:35], v128 offset:10240
    v_add_f32 v68, v68, v70
    v_smfmac_f32_16x16x64_bf16 v[72:75], v[20:23], a[200:207], v126
    ds_read_b128 v[36:39], v128 offset:11264
    v_add_f32 v65, v65, v67
    s_waitcnt lgkmcnt(5)
    v_mfma_f32_16x16x32_bf16 v[106:109], v[80:83], v[56:59], 0
    v_add_f32 v64, v64, v66
    v_add_f32 v69, v69, v71
    s_waitcnt lgkmcnt(3)
    v_mfma_f32_16x16x32_bf16 v[106:109], v[84:87], v[60:63], v[106:109]
    v_cvt_pk_bf16_f32 v64, v64, v65
    v_cvt_pk_bf16_f32 v65, v68, v69
    s_waitcnt lgkmcnt(2)
    v_smfmac_f32_16x16x64_bf16 v[76:79], v[20:23], v[40:47], v126
    ds_write_b64 v143, v[64:65] offset:10752
    v_smfmac_f32_16x16x64_bf16 v[72:75], v[8:11], a[208:215], v126
    ds_read_b128 v[40:43], v128 offset:26624
    v_cndmask_b32 v107, v107, v108, s[24:25]
    v_cndmask_b32 v106, v106, v109, s[24:25]
    v_smfmac_f32_16x16x64_bf16 v[76:79], v[8:11], a[216:223], v126
    ds_read_b128 v[44:47], v128 offset:27648
    v_add_f32_dpp v104, v107, v106 quad_perm:[2,3,0,1] row_mask:0xf bank_mask:0xf
    v_exp_f32 v141, v104
    s_nop 0
    v_cvt_pk_bf16_f32 v141, v141, v141
    s_waitcnt lgkmcnt(3)
    v_smfmac_f32_16x16x64_bf16 v[72:75], v[16:19], v[32:39], v126
    ds_write_b16 v132, v141
    v_smfmac_f32_16x16x64_bf16 v[76:79], v[16:19], a[224:231], v126
    ds_read_b128 v[32:35], v127 offset:59392
    v_mov_b64 v[12:13], 0
    v_smfmac_f32_16x16x64_bf16 v[72:75], v[24:27], a[232:239], v126
    v_smfmac_f32_16x16x64_bf16 v[76:79], v[24:27], a[240:247], v126
    ds_read_b128 v[36:39], v127 offset:60416
    s_waitcnt lgkmcnt(2)
    s_barrier
    v_smfmac_f32_16x16x64_bf16 v[72:75], v[28:31], v[40:47], v126
    ds_read_b64_tr_b16 v[64:65], v140 offset:10240
    ds_read_b64_tr_b16 v[66:67], v140 offset:10752
    v_smfmac_f32_16x16x64_bf16 v[76:79], v[28:31], a[248:255], v126
    ds_read_b64_tr_b16 v[68:69], v140 offset:11264
    ds_read_b64_tr_b16 v[70:71], v140 offset:11776
    v_smfmac_f32_16x16x64_bf16 v[72:75], v[0:3], v[232:239], v126
    ds_read_b128 v[110:113], v133
    v_mov_b64 v[14:15], 0
    s_waitcnt lgkmcnt(5)
    v_smfmac_f32_16x16x64_bf16 v[76:79], v[0:3], v[32:39], v126
    v_mov_b64 v[0:1], 0
    v_smfmac_f32_16x16x64_bf16 v[72:75], v[4:7], v[240:247], v126
    ds_read_b128 v[36:39], v127 offset:27648
    v_mov_b64 v[2:3], 0
    s_waitcnt lgkmcnt(4)
    v_mfma_f32_16x16x32_bf16 v[106:109], v[64:67], v[56:59], 0
    ds_read_b128 v[114:117], v134
    v_mov_b64 v[10:11], 0
    s_waitcnt lgkmcnt(3)
    v_mfma_f32_16x16x32_bf16 v[106:109], v[68:71], v[60:63], v[106:109]
    ds_read_b128 v[44:47], v127 offset:19456
    v_add_f32 v73, v73, v75
    v_smfmac_f32_16x16x64_bf16 v[76:79], v[4:7], v[248:255], v126
    ds_read_b128 v[32:35], v127 offset:26624
    v_add_f32 v72, v72, v74
    s_waitcnt lgkmcnt(4)
    v_mfma_f32_16x16x32_bf16 v[118:121], v[88:91], v[110:113], 0
    v_cndmask_b32 v106, v106, v109, s[24:25]
    v_cndmask_b32 v107, v107, v108, s[24:25]
    v_mfma_f32_16x16x32_bf16 v[64:67], v[122:125], v[110:113], 0
    v_add_f32_dpp v105, v107, v106 quad_perm:[2,3,0,1] row_mask:0xf bank_mask:0xf
    v_mul_f32 v105, s39, v105
    v_exp_f32 v107, v105
    s_waitcnt lgkmcnt(2)
    v_mfma_f32_16x16x32_bf16 v[118:121], v[92:95], v[114:117], v[118:121]
    v_add_f32 v76, v76, v78
    v_mov_b32_dpp v108, v107 quad_perm:[2,3,0,1] row_mask:0xf bank_mask:0xf
    v_cvt_pk_bf16_f32 v107, v107, v108
    v_cndmask_b32 v69, 0, v107, s[24:25]
    v_cndmask_b32 v68, v107, 0, s[24:25]
    v_cvt_pk_bf16_f32 v72, v72, v73
    v_add_f32 v77, v77, v79
    v_mfma_f32_16x16x16_bf16 v[64:67], v[122:123], v[68:69], v[64:67]
    v_cvt_pk_bf16_f32 v73, v77, v76
    ds_read_b128 v[40:43], v127 offset:18432
    s_nop 0
    v_mfma_f32_16x16x16_bf16 v[118:121], v[72:73], v[68:69], v[118:121]
    v_mov_b64 v[8:9], 0
    v_mov_b64 v[6:7], 0
    s_nop 1
    v_subrev_u32 v142, s44, v64
    v_rcp_f32_dpp v141, v64 quad_perm:[0,1,0,1] row_mask:0xf bank_mask:0xf
    v_mov_b64 v[4:5], 0
    v_cmp_le_u32 vcc, s45, v142
LF1_norm:
    v_mul_f32 v118, v118, v141
    v_mul_f32 v119, v119, v141
    v_mul_f32 v120, v120, v141
    v_mul_f32 v121, v121, v141
    v_cvt_pk_bf16_f32 v60, v118, v119
    v_cvt_pk_bf16_f32 v61, v120, v121
    ds_write_b64 v135, v[60:61] offset:5184
    s_and_b64 vcc, vcc, s[26:27]
    s_cbranch_scc1 LF1_fallback
    v_mov_b32_dpp v62, v60 quad_perm:[2,3,0,1] row_mask:0xf bank_mask:0xf
    v_mov_b32_dpp v63, v61 quad_perm:[2,3,0,1] row_mask:0xf bank_mask:0xf
    s_waitcnt lgkmcnt(1)
    s_nop 0
    v_smfmac_f32_16x16x64_bf16 v[0:3], v[60:63], v[40:47], v126
    ds_read_b128 v[40:43], v127 offset:34816
    v_smfmac_f32_16x16x64_bf16 v[4:7], v[60:63], v[144:151], v126
    buffer_load_dword v137, v127, s[8:11], s31 offen sc1
    ds_read_b128 v[44:47], v127 offset:35840
    s_waitcnt lgkmcnt(2)
    s_barrier
    ds_read_b128 v[106:109], v136 offset:5248
    v_smfmac_f32_16x16x64_bf16 v[8:11], v[60:63], v[152:159], v126
    ds_read_b128 v[110:113], v136 offset:5312
    v_smfmac_f32_16x16x64_bf16 v[12:15], v[60:63], v[32:39], v126
    ds_read_b128 v[16:19], v136 offset:5120
    ds_read_b128 v[36:39], v127 offset:44032
    ds_read_b128 v[32:35], v127 offset:43008
    s_waitcnt lgkmcnt(4)
    v_smfmac_f32_16x16x64_bf16 v[0:3], v[106:109], v[160:167], v126
    s_waitcnt lgkmcnt(3)
    v_smfmac_f32_16x16x64_bf16 v[0:3], v[110:113], v[168:175], v126
    s_waitcnt lgkmcnt(2)
    v_smfmac_f32_16x16x64_bf16 v[0:3], v[16:19], v[176:183], v126
    v_smfmac_f32_16x16x64_bf16 v[4:7], v[106:109], v[40:47], v126
    ds_read_b128 v[40:43], v127 offset:51200
    v_smfmac_f32_16x16x64_bf16 v[4:7], v[110:113], v[184:191], v126
    ds_read_b128 v[44:47], v127 offset:52224
    v_cvt_pk_bf16_f32 v115, v1, v3
    v_smfmac_f32_16x16x64_bf16 v[4:7], v[16:19], v[192:199], v126
    v_cvt_pk_bf16_f32 v114, v0, v2
    v_and_or_b32 v114, v114, -2, s28
    s_waitcnt lgkmcnt(2)
    v_smfmac_f32_16x16x64_bf16 v[8:11], v[106:109], v[32:39], v126
    buffer_store_dwordx2 v[114:115], v130, s[8:11], 0 offen offset:0
    v_smfmac_f32_16x16x64_bf16 v[8:11], v[110:113], v[200:207], v126
    v_cvt_pk_bf16_f32 v117, v5, v7
    v_smfmac_f32_16x16x64_bf16 v[8:11], v[16:19], v[208:215], v126
    v_cvt_pk_bf16_f32 v116, v4, v6
    v_and_or_b32 v116, v116, -2, s28
    v_smfmac_f32_16x16x64_bf16 v[12:15], v[106:109], v[216:223], v126
    buffer_store_dwordx2 v[116:117], v130, s[8:11], 0 offen offset:2048
    s_waitcnt lgkmcnt(0)
    v_smfmac_f32_16x16x64_bf16 v[12:15], v[110:113], v[40:47], v126
    v_cvt_pk_bf16_f32 v118, v8, v10
    v_and_or_b32 v118, v118, -2, s28
    v_cvt_pk_bf16_f32 v119, v9, v11
    buffer_store_dwordx2 v[118:119], v130, s[8:11], s69 offen offset:0
    v_smfmac_f32_16x16x64_bf16 v[12:15], v[16:19], v[224:231], v126
    s_nop 7
    v_cvt_pk_bf16_f32 v120, v12, v14
    v_and_or_b32 v120, v120, -2, s28
    v_cvt_pk_bf16_f32 v121, v13, v15
    buffer_store_dwordx2 v[120:121], v130, s[8:11], s69 offen offset:2048
    s_waitcnt vmcnt(4)
    v_cmp_gt_u32 vcc, s43, v137
    ds_read_b128 v[122:125], v127 offset:13312
    s_waitcnt vmcnt(4)
    s_add_u32 s30, s30, 1048576
    s_add_u32 s68, s68, 1048576
    s_cbranch_vccnz LF1_lead
LF1_leadok:
    s_barrier
    s_add_u32 s33, s33, 1048576
    s_add_u32 s37, s37, 1048576
    s_add_u32 s32, s32, 1048576
    s_add_u32 s38, s38, 1
    s_xor_b32 s28, s28, 1
    v_mov_b64 v[88:89], v[96:97]
    v_mov_b64 v[90:91], v[98:99]
    v_mov_b64 v[92:93], v[100:101]
    v_mov_b64 v[94:95], v[102:103]
    v_mov_b64 v[80:81], v[48:49]
    v_mov_b64 v[82:83], v[50:51]
    v_mov_b64 v[84:85], v[52:53]
    v_mov_b64 v[86:87], v[54:55]
    s_add_u32 s43, s43, 1
    buffer_load_dwordx4 v[0:3], v127, s[8:11], s29 offen sc1
    buffer_load_dwordx4 v[4:7], v127, s[8:11], s29 offen offset:1024 sc1
    s_waitcnt lgkmcnt(0)
    s_branch LF1_pollP
LF1_done:
    buffer_store_dword v112, v131, s[8:11], s33 offen sc1
    s_waitcnt vmcnt(0)
    s_endpgm
LF1_retryE:
    buffer_load_dwordx4 v[12:15], v127, s[8:11], s30 offen sc1
    buffer_load_dwordx4 v[20:23], v127, s[8:11], s68 offen sc1
    s_sub_u32 s22, s22, 1
    s_cbranch_scc1 L_exit
    s_nop 3
    v_mov_b64 v[56:57], 0
    v_mov_b64 v[58:59], 0
    v_mov_b64 v[60:61], 0
    v_mov_b64 v[62:63], 0
    s_waitcnt vmcnt(1)
    s_branch LF1_bA
LF1_retryL:
    buffer_load_dwordx4 v[20:23], v127, s[8:11], s68 offen sc1
    s_sub_u32 s22, s22, 1
    s_cbranch_scc1 L_exit
    s_waitcnt vmcnt(0)
    v_cmp_eq_u32 vcc, -1, v20
    s_cbranch_vccnz LF1_retryL
    ds_write_b128 v127, v[20:23] offset:5120
    s_waitcnt lgkmcnt(0)
    s_branch LF1_Lok
    s_nop 0
LF1_retryP:
    buffer_load_dwordx4 v[0:3], v127, s[8:11], s29 offen sc1
    buffer_load_dwordx4 v[4:7], v127, s[8:11], s29 offen offset:1024 sc1
    s_sub_u32 s22, s22, 1
    s_cbranch_scc1 L_exit
    s_branch LF1_pollP
.p2align 5
LF1_lead:
    s_nop 12
    s_branch LF1_leadok
LF1_fallback:
    s_nop 7
    v_lshlrev_b32 v142, 1, v132
    v_subrev_u32 v142, 20480, v142
    ds_write_b32 v142, v104
    v_min_u32 v142, v133, v134
    v_lshlrev_b32 v142, 1, v142
    v_subrev_u32 v142, 20480, v142
    s_waitcnt lgkmcnt(0)
    s_barrier
    ds_read_b128 v[56:59], v142
    ds_read_b128 v[60:63], v142 offset:16
    s_waitcnt lgkmcnt(1)
    v_max3_f32 v141, v56, v57, v58
    s_waitcnt lgkmcnt(0)
    v_max3_f32 v141, v141, v59, v60
    v_max3_f32 v141, v141, v61, v62
    v_max3_f32 v141, v141, v63, v105
    s_nop 1
    v_max_f32_dpp v141, v141, v141 quad_perm:[2,3,0,1] row_mask:0xf bank_mask:0xf
    v_mov_b32 v142, v141
    s_nop 1
    v_permlane16_swap_b32 v141, v142
    v_max_f32 v141, v141, v142
    v_mov_b32 v142, v141
    s_nop 1
    v_permlane32_swap_b32 v141, v142
    v_max_f32 v141, v141, v142
    v_sub_f32 v56, v56, v141
    v_exp_f32 v56, v56
    v_sub_f32 v57, v57, v141
    v_exp_f32 v57, v57
    v_sub_f32 v58, v58, v141
    v_exp_f32 v58, v58
    v_sub_f32 v59, v59, v141
    v_exp_f32 v59, v59
    v_sub_f32 v60, v60, v141
    v_exp_f32 v60, v60
    v_sub_f32 v61, v61, v141
    v_exp_f32 v61, v61
    v_sub_f32 v62, v62, v141
    v_exp_f32 v62, v62
    v_sub_f32 v63, v63, v141
    v_exp_f32 v63, v63
    v_sub_f32 v107, v105, v141
    v_exp_f32 v107, v107
    s_nop 1
    v_mov_b32_dpp v108, v107 quad_perm:[2,3,0,1] row_mask:0xf bank_mask:0xf
    v_cvt_pk_bf16_f32 v107, v107, v108
    v_cndmask_b32 v68, v107, 0, s[24:25]
    v_cndmask_b32 v69, 0, v107, s[24:25]
    v_cvt_pk_bf16_f32 v142, v56, v57
    v_cndmask_b32 v110, v142, 0, s[24:25]
    v_cndmask_b32 v114, 0, v142, s[24:25]
    v_cvt_pk_bf16_f32 v142, v58, v59
    v_cndmask_b32 v111, v142, 0, s[24:25]
    v_cndmask_b32 v115, 0, v142, s[24:25]
    v_cvt_pk_bf16_f32 v142, v60, v61
    v_cndmask_b32 v112, v142, 0, s[24:25]
    v_cndmask_b32 v116, 0, v142, s[24:25]
    v_cvt_pk_bf16_f32 v142, v62, v63
    v_cndmask_b32 v113, v142, 0, s[24:25]
    v_cndmask_b32 v117, 0, v142, s[24:25]
    s_nop 0
    v_mfma_f32_16x16x32_bf16 v[118:121], v[88:91], v[110:113], 0
    v_mfma_f32_16x16x32_bf16 v[118:121], v[92:95], v[114:117], v[118:121]
    v_mfma_f32_16x16x32_bf16 v[64:67], v[122:125], v[110:113], 0
    s_nop 5
    v_mfma_f32_16x16x16_bf16 v[64:67], v[122:123], v[68:69], v[64:67]
    v_mfma_f32_16x16x16_bf16 v[118:121], v[72:73], v[68:69], v[118:121]
    s_nop 3
    v_rcp_f32_dpp v141, v64 quad_perm:[0,1,0,1] row_mask:0xf bank_mask:0xf
    s_mov_b64 vcc, 0
    s_nop 1
    s_branch LF1_norm
L_chain_slow1:
    s_add_u32 s34, s34, 1048576
    s_add_u32 s72, s72, 1048576
    s_add_u32 s37, s37, 1048576
    s_mov_b32 s43, 1
    s_mov_b32 s28, 1
    ds_read_b128 v[32:35], v129 offset:10240
    ds_read_b128 v[36:39], v129 offset:11264
    ds_read_b128 v[40:43], v129 offset:2048
    ds_read_b128 v[44:47], v129 offset:3072
    v_mov_b64 v[56:57], 0
    v_mov_b64 v[58:59], 0
    v_mov_b64 v[60:61], 0
    v_mov_b64 v[62:63], 0
    v_mov_b64 v[64:65], 0
    v_mov_b64 v[66:67], 0
    v_mov_b64 v[68:69], 0
    v_mov_b64 v[70:71], 0
    v_mov_b64 v[72:73], 0
    v_mov_b64 v[74:75], 0
    v_mov_b64 v[76:77], 0
    v_mov_b64 v[78:79], 0
    v_mov_b32 v142, s43
    s_waitcnt lgkmcnt(0)
    buffer_load_dwordx4 v[12:15], v127, s[8:11], s30 offen sc1
    buffer_load_dwordx4 v[20:23], v127, s[8:11], s68 offen sc1
    s_branch LS1_bAw
LS1_pollP:
    s_waitcnt vmcnt(1)
    v_mfma_f32_16x16x32_bf16 v[110:113], v[122:125], v[0:3], 0
    v_bitop3_b32 v141, v0, s28, 1 bitop3:0x28
    v_bitop3_b32 v141, v2, s28, v141 bitop3:0x28
    s_waitcnt vmcnt(0)
    v_mfma_f32_16x16x32_bf16 v[110:113], v[122:125], v[4:7], v[110:113]
    v_bitop3_b32 v141, v4, s28, v141 bitop3:0x28
    v_bitop3_b32 v141, v6, s28, v141 bitop3:0x28
    v_cmp_ne_u32 vcc, 1, v141
    s_nop 2
    s_cbranch_vccnz LS1_retryP
LS1_Pok:
    v_add_f32_dpp v110, v110, v110 row_ror:4 row_mask:0xf bank_mask:0xf
    v_add_f32_dpp v111, v111, v111 row_ror:4 row_mask:0xf bank_mask:0xf
    s_cmp_ge_u32 s38, 63
    v_add_f32_dpp v110, v110, v110 row_ror:8 row_mask:0xf bank_mask:0xf
    v_add_f32_dpp v111, v111, v111 row_ror:8 row_mask:0xf bank_mask:0xf
    v_cvt_pk_bf16_f32 v112, v110, v111
LS1_Mst:
    buffer_store_dword v112, v131, s[8:11], s32 offen sc1
    s_cbranch_scc1 LS1_done
    s_waitcnt vmcnt(0)
    v_mov_b64 v[56:57], 0
    v_mov_b64 v[58:59], 0
    v_mov_b64 v[60:61], 0
    v_mov_b64 v[62:63], 0
    v_mov_b64 v[64:65], 0
    buffer_load_dwordx4 v[12:15], v127, s[8:11], s30 offen sc1
    v_mov_b64 v[66:67], 0
    v_mov_b64 v[68:69], 0
    v_mov_b64 v[70:71], 0
    v_mov_b64 v[72:73], 0
    v_mov_b64 v[74:75], 0
    v_mov_b64 v[76:77], 0
    v_mov_b64 v[78:79], 0
    s_add_u32 s34, s34, 1048576
    s_add_u32 s72, s72, 1048576
    ds_read_b128 v[32:35], v129 offset:10240
    ds_read_b128 v[36:39], v129 offset:11264
    ds_read_b128 v[40:43], v129 offset:2048
    ds_read_b128 v[44:47], v129 offset:3072
    buffer_load_dwordx4 v[20:23], v127, s[8:11], s68 offen sc1
LS1_bAw:
    s_waitcnt vmcnt(1)
LS1_bA:
    v_max3_u32 v141, v12, v13, v14
    v_max_u32 v141, v141, v15
    v_cmp_eq_u32 vcc, -1, v141
    v_smfmac_f32_16x16x64_bf16 v[56:59], v[12:15], a[0:7], v126
    v_smfmac_f32_16x16x64_bf16 v[60:63], v[12:15], a[8:15], v126
    s_cbranch_vccnz LS1_retryE
    s_waitcnt vmcnt(0)
    v_max3_u32 v141, v20, v21, v22
    v_max_u32 v141, v141, v23
    v_cmp_eq_u32 vcc, -1, v141
    v_smfmac_f32_16x16x64_bf16 v[64:67], v[12:15], a[16:23], v126
    ds_write_b128 v127, v[12:15] offset:3072
    v_smfmac_f32_16x16x64_bf16 v[68:71], v[12:15], a[24:31], v126
    ds_write_b128 v127, v[20:23] offset:5120
    s_cbranch_vccnz LS1_retryL
LS1_Lok:
    v_smfmac_f32_16x16x64_bf16 v[56:59], v[20:23], a[32:39], v126
    v_mov_b64 v[122:123], s[70:71]
    s_waitcnt lgkmcnt(4)
    v_smfmac_f32_16x16x64_bf16 v[60:63], v[20:23], v[32:39], v126
    ds_read_b128 v[32:35], v129 offset:18432
    ds_read_b128 v[36:39], v129 offset:19456
    v_smfmac_f32_16x16x64_bf16 v[64:67], v[20:23], a[40:47], v126
    s_waitcnt lgkmcnt(3)
    s_waitcnt lgkmcnt(2)
    s_barrier
    v_smfmac_f32_16x16x64_bf16 v[68:71], v[20:23], a[48:55], v126
    ds_read_b128 v[8:11], v127 offset:2048
    ds_read_b128 v[16:19], v127 offset:4096
    buffer_load_dword v138, v139, s[8:11], s34 offen sc1
    ds_read_b128 v[24:27], v127 offset:6144
    ds_read_b128 v[28:31], v127 offset:7168
    buffer_load_dwordx4 v[96:99], v127, s[8:11], s72 offen sc1
    s_waitcnt lgkmcnt(3)
    v_smfmac_f32_16x16x64_bf16 v[56:59], v[8:11], v[40:47], v126
    buffer_load_dwordx4 v[100:103], v129, s[8:11], s72 offen sc1
    v_smfmac_f32_16x16x64_bf16 v[60:63], v[8:11], a[56:63], v126
    ds_read_b128 v[40:43], v129 offset:26624
    ds_read_b128 v[44:47], v129 offset:27648
    s_waitcnt lgkmcnt(4)
    v_smfmac_f32_16x16x64_bf16 v[56:59], v[16:19], a[64:71], v126
    ds_read_b128 v[0:3], v127 offset:0
    ds_read_b128 v[4:7], v127 offset:1024
    v_smfmac_f32_16x16x64_bf16 v[60:63], v[16:19], a[72:79], v126
    v_mov_b64 v[124:125], s[70:71]
    s_waitcnt lgkmcnt(5)
    v_smfmac_f32_16x16x64_bf16 v[56:59], v[24:27], v[32:39], v126
    ds_read_b128 v[32:35], v128 offset:59392
    ds_read_b128 v[36:39], v128 offset:60416
    v_smfmac_f32_16x16x64_bf16 v[60:63], v[24:27], a[80:87], v126
    buffer_load_dwordx4 v[48:51], v127, s[8:11], s34 offen sc1
    s_waitcnt lgkmcnt(6)
    v_smfmac_f32_16x16x64_bf16 v[56:59], v[28:31], a[88:95], v126
    s_waitcnt lgkmcnt(4)
    v_smfmac_f32_16x16x64_bf16 v[60:63], v[28:31], v[40:47], v126
    ds_read_b128 v[40:43], v128 offset:43008
    ds_read_b128 v[44:47], v128 offset:44032
    s_waitcnt lgkmcnt(5)
    v_smfmac_f32_16x16x64_bf16 v[56:59], v[0:3], a[96:103], v126
    v_smfmac_f32_16x16x64_bf16 v[60:63], v[0:3], a[104:111], v126
    s_waitcnt lgkmcnt(2)
    v_smfmac_f32_16x16x64_bf16 v[56:59], v[4:7], v[32:39], v126
    ds_read_b128 v[32:35], v128 offset:51200
    buffer_load_dwordx4 v[52:55], v129, s[8:11], s34 offen sc1
    v_smfmac_f32_16x16x64_bf16 v[60:63], v[4:7], a[112:119], v126
    ds_read_b128 v[36:39], v128 offset:52224
    s_nop 2
    v_add_f32 v56, v56, v58
    v_add_f32 v57, v57, v59
    v_cvt_pk_bf16_f32 v56, v56, v57
    v_smfmac_f32_16x16x64_bf16 v[64:67], v[8:11], a[120:127], v126
    v_add_f32 v60, v60, v62
    v_add_f32 v61, v61, v63
    v_cvt_pk_bf16_f32 v57, v60, v61
    v_smfmac_f32_16x16x64_bf16 v[68:71], v[8:11], a[128:135], v126
    ds_write_b64 v143, v[56:57] offset:8704
    s_waitcnt lgkmcnt(3)
    v_smfmac_f32_16x16x64_bf16 v[64:67], v[16:19], v[40:47], v126
    ds_read_b128 v[40:43], v128 offset:34816
    ds_read_b128 v[44:47], v128 offset:35840
    v_smfmac_f32_16x16x64_bf16 v[68:71], v[16:19], a[136:143], v126
    v_smfmac_f32_16x16x64_bf16 v[64:67], v[24:27], a[144:151], v126
    s_waitcnt lgkmcnt(2)
    s_barrier
    v_smfmac_f32_16x16x64_bf16 v[68:71], v[24:27], v[32:39], v126
    ds_read_b64_tr_b16 v[56:57], v140 offset:8192
    ds_read_b64_tr_b16 v[58:59], v140 offset:8704
    v_smfmac_f32_16x16x64_bf16 v[64:67], v[28:31], a[152:159], v126
    ds_read_b64_tr_b16 v[60:61], v140 offset:9216
    ds_read_b64_tr_b16 v[62:63], v140 offset:9728
    v_smfmac_f32_16x16x64_bf16 v[68:71], v[28:31], a[160:167], v126
    ds_read_b128 v[32:35], v128 offset:2048
    ds_read_b128 v[36:39], v128 offset:3072
    s_waitcnt lgkmcnt(6)
    v_smfmac_f32_16x16x64_bf16 v[64:67], v[0:3], v[40:47], v126
    ds_read_b128 v[40:43], v128 offset:18432
    ds_read_b128 v[44:47], v128 offset:19456
    v_smfmac_f32_16x16x64_bf16 v[68:71], v[0:3], a[168:175], v126
    s_waitcnt lgkmcnt(6)
    v_mfma_f32_16x16x32_bf16 v[106:109], v[80:83], v[56:59], 0
    v_smfmac_f32_16x16x64_bf16 v[64:67], v[4:7], a[176:183], v126
    s_waitcnt lgkmcnt(4)
    v_mfma_f32_16x16x32_bf16 v[106:109], v[84:87], v[60:63], v[106:109]
    v_smfmac_f32_16x16x64_bf16 v[68:71], v[4:7], a[184:191], v126
    v_add_f32 v64, v64, v66
    s_waitcnt lgkmcnt(2)
    v_smfmac_f32_16x16x64_bf16 v[72:75], v[12:15], v[32:39], v126
    ds_read_b128 v[32:35], v128 offset:10240
    v_cndmask_b32 v107, v107, v108, s[24:25]
    v_cndmask_b32 v106, v106, v109, s[24:25]
    v_add_f32 v65, v65, v67
    v_add_f32 v68, v68, v70
    v_add_f32_dpp v104, v107, v106 quad_perm:[2,3,0,1] row_mask:0xf bank_mask:0xf
    v_exp_f32 v141, v104
    v_add_f32 v69, v69, v71
    v_cvt_pk_bf16_f32 v64, v64, v65
    v_smfmac_f32_16x16x64_bf16 v[76:79], v[12:15], a[192:199], v126
    ds_read_b128 v[36:39], v128 offset:11264
    v_cvt_pk_bf16_f32 v65, v68, v69
    v_smfmac_f32_16x16x64_bf16 v[72:75], v[20:23], a[200:207], v126
    ds_write_b64 v143, v[64:65] offset:10752
    v_cvt_pk_bf16_f32 v141, v141, v141
    s_waitcnt lgkmcnt(3)
    v_smfmac_f32_16x16x64_bf16 v[76:79], v[20:23], v[40:47], v126
    ds_write_b16 v132, v141
    v_smfmac_f32_16x16x64_bf16 v[72:75], v[8:11], a[208:215], v126
    ds_read_b128 v[40:43], v128 offset:26624
    ds_read_b128 v[44:47], v128 offset:27648
    v_smfmac_f32_16x16x64_bf16 v[76:79], v[8:11], a[216:223], v126
    v_mov_b64 v[8:9], 0
    s_waitcnt lgkmcnt(4)
    v_smfmac_f32_16x16x64_bf16 v[72:75], v[16:19], v[32:39], v126
    ds_read_b128 v[32:35], v127 offset:59392
    s_waitcnt lgkmcnt(3)
    s_barrier
    v_smfmac_f32_16x16x64_bf16 v[76:79], v[16:19], a[224:231], v126
    ds_read_b64_tr_b16 v[64:65], v140 offset:10240
    ds_read_b64_tr_b16 v[66:67], v140 offset:10752
    v_smfmac_f32_16x16x64_bf16 v[72:75], v[24:27], a[232:239], v126
    ds_read_b64_tr_b16 v[68:69], v140 offset:11264
    ds_read_b64_tr_b16 v[70:71], v140 offset:11776
    v_smfmac_f32_16x16x64_bf16 v[76:79], v[24:27], a[240:247], v126
    ds_read_b128 v[36:39], v127 offset:60416
    ds_read_b128 v[110:113], v133
    s_waitcnt lgkmcnt(7)
    v_smfmac_f32_16x16x64_bf16 v[72:75], v[28:31], v[40:47], v126
    ds_read_b128 v[114:117], v134
    ds_read_b128 v[40:43], v127 offset:18432
    s_waitcnt lgkmcnt(6)
    v_mfma_f32_16x16x32_bf16 v[106:109], v[64:67], v[56:59], 0
    ds_read_b128 v[44:47], v127 offset:19456
    v_mov_b64 v[10:11], 0
    v_smfmac_f32_16x16x64_bf16 v[76:79], v[28:31], a[248:255], v126
    v_mov_b64 v[12:13], 0
    s_waitcnt lgkmcnt(5)
    v_mfma_f32_16x16x32_bf16 v[106:109], v[68:71], v[60:63], v[106:109]
    v_mov_b64 v[14:15], 0
    v_smfmac_f32_16x16x64_bf16 v[72:75], v[0:3], v[232:239], v126
    s_waitcnt lgkmcnt(4)
    v_smfmac_f32_16x16x64_bf16 v[76:79], v[0:3], v[32:39], v126
    ds_read_b128 v[32:35], v127 offset:26624
    v_cndmask_b32 v107, v107, v108, s[24:25]
    v_smfmac_f32_16x16x64_bf16 v[72:75], v[4:7], v[240:247], v126
    ds_read_b128 v[36:39], v127 offset:27648
    v_cndmask_b32 v106, v106, v109, s[24:25]
    v_smfmac_f32_16x16x64_bf16 v[76:79], v[4:7], v[248:255], v126
    v_add_f32_dpp v105, v107, v106 quad_perm:[2,3,0,1] row_mask:0xf bank_mask:0xf
    v_mul_f32 v105, s39, v105
    v_exp_f32 v107, v105
    s_waitcnt lgkmcnt(5)
    v_mfma_f32_16x16x32_bf16 v[118:121], v[88:91], v[110:113], 0
    v_mov_b32_dpp v108, v107 quad_perm:[2,3,0,1] row_mask:0xf bank_mask:0xf
    v_cvt_pk_bf16_f32 v107, v107, v108
    v_mfma_f32_16x16x32_bf16 v[64:67], v[122:125], v[110:113], 0
    v_cndmask_b32 v68, v107, 0, s[24:25]
    v_cndmask_b32 v69, 0, v107, s[24:25]
    s_waitcnt lgkmcnt(4)
    v_mfma_f32_16x16x32_bf16 v[118:121], v[92:95], v[114:117], v[118:121]
    v_add_f32 v72, v72, v74
    v_add_f32 v73, v73, v75
    v_mfma_f32_16x16x16_bf16 v[64:67], v[122:123], v[68:69], v[64:67]
    v_add_f32 v76, v76, v78
    v_add_f32 v77, v77, v79
    v_cvt_pk_bf16_f32 v72, v72, v73
    v_cvt_pk_bf16_f32 v73, v77, v76
    v_mov_b64 v[0:1], 0
    v_mov_b64 v[2:3], 0
    v_mfma_f32_16x16x16_bf16 v[118:121], v[72:73], v[68:69], v[118:121]
    v_mov_b64 v[4:5], 0
    v_rcp_f32_dpp v141, v64 quad_perm:[0,1,0,1] row_mask:0xf bank_mask:0xf
    v_subrev_u32 v142, s44, v64
    v_cmp_le_u32 vcc, s45, v142
    v_mov_b64 v[6:7], 0
LS1_norm:
    s_nop 2
    v_mul_f32 v118, v118, v141
    v_mul_f32 v119, v119, v141
    v_mul_f32 v120, v120, v141
    v_mul_f32 v121, v121, v141
    v_cvt_pk_bf16_f32 v60, v118, v119
    v_cvt_pk_bf16_f32 v61, v120, v121
    ds_write_b64 v135, v[60:61] offset:5184
    s_and_b64 vcc, vcc, s[26:27]
    s_cbranch_scc1 LS1_fallback
    v_mov_b32_dpp v62, v60 quad_perm:[2,3,0,1] row_mask:0xf bank_mask:0xf
    v_mov_b32_dpp v63, v61 quad_perm:[2,3,0,1] row_mask:0xf bank_mask:0xf
    s_waitcnt lgkmcnt(3)
    s_nop 0
    v_smfmac_f32_16x16x64_bf16 v[0:3], v[60:63], v[40:47], v126
    ds_read_b128 v[40:43], v127 offset:34816
    ds_read_b128 v[44:47], v127 offset:35840
    v_smfmac_f32_16x16x64_bf16 v[4:7], v[60:63], v[144:151], v126
    buffer_load_dword v137, v127, s[8:11], s31 offen sc1
    s_waitcnt lgkmcnt(2)
    s_barrier
    v_smfmac_f32_16x16x64_bf16 v[8:11], v[60:63], v[152:159], v126
    ds_read_b128 v[106:109], v136 offset:5248
    ds_read_b128 v[110:113], v136 offset:5312
    v_smfmac_f32_16x16x64_bf16 v[12:15], v[60:63], v[32:39], v126
    ds_read_b128 v[16:19], v136 offset:5120
    ds_read_b128 v[32:35], v127 offset:43008
    ds_read_b128 v[36:39], v127 offset:44032
    s_waitcnt lgkmcnt(4)
    v_smfmac_f32_16x16x64_bf16 v[0:3], v[106:109], v[160:167], v126
    s_waitcnt lgkmcnt(3)
    v_smfmac_f32_16x16x64_bf16 v[0:3], v[110:113], v[168:175], v126
    s_waitcnt lgkmcnt(2)
    v_smfmac_f32_16x16x64_bf16 v[0:3], v[16:19], v[176:183], v126
    v_smfmac_f32_16x16x64_bf16 v[4:7], v[106:109], v[40:47], v126
    ds_read_b128 v[40:43], v127 offset:51200
    ds_read_b128 v[44:47], v127 offset:52224
    s_nop 1
    v_cvt_pk_bf16_f32 v114, v0, v2
    v_cvt_pk_bf16_f32 v115, v1, v3
    v_and_or_b32 v114, v114, -2, s28
    v_smfmac_f32_16x16x64_bf16 v[4:7], v[110:113], v[184:191], v126
    buffer_store_dwordx2 v[114:115], v130, s[8:11], 0 offen offset:0 sc1
    v_smfmac_f32_16x16x64_bf16 v[4:7], v[16:19], v[192:199], v126
    s_waitcnt lgkmcnt(2)
    v_smfmac_f32_16x16x64_bf16 v[8:11], v[106:109], v[32:39], v126
    v_smfmac_f32_16x16x64_bf16 v[8:11], v[110:113], v[200:207], v126
    v_cvt_pk_bf16_f32 v116, v4, v6
    v_cvt_pk_bf16_f32 v117, v5, v7
    v_and_or_b32 v116, v116, -2, s28
    v_smfmac_f32_16x16x64_bf16 v[8:11], v[16:19], v[208:215], v126
    buffer_store_dwordx2 v[116:117], v130, s[8:11], 0 offen offset:2048 sc1
    v_smfmac_f32_16x16x64_bf16 v[12:15], v[106:109], v[216:223], v126
    s_nop 3
    v_cvt_pk_bf16_f32 v118, v8, v10
    v_cvt_pk_bf16_f32 v119, v9, v11
    v_and_or_b32 v118, v118, -2, s28
    s_waitcnt lgkmcnt(0)
    v_smfmac_f32_16x16x64_bf16 v[12:15], v[110:113], v[40:47], v126
    buffer_store_dwordx2 v[118:119], v130, s[8:11], s69 offen offset:0 sc1
    v_smfmac_f32_16x16x64_bf16 v[12:15], v[16:19], v[224:231], v126
    s_nop 7
    v_cvt_pk_bf16_f32 v120, v12, v14
    v_cvt_pk_bf16_f32 v121, v13, v15
    v_and_or_b32 v120, v120, -2, s28
    buffer_store_dwordx2 v[120:121], v130, s[8:11], s69 offen offset:2048 sc1
    s_waitcnt vmcnt(4)
    v_cmp_gt_u32 vcc, s43, v137
    ds_read_b128 v[122:125], v127 offset:13312
    s_waitcnt vmcnt(4)
    s_add_u32 s30, s30, 1048576
    s_add_u32 s68, s68, 1048576
    s_cbranch_vccnz LS1_lead
LS1_leadok:
    s_barrier
    s_add_u32 s33, s33, 1048576
    s_add_u32 s37, s37, 1048576
    s_add_u32 s32, s32, 1048576
    s_add_u32 s38, s38, 1
    s_xor_b32 s28, s28, 1
    v_mov_b64 v[88:89], v[96:97]
    v_mov_b64 v[90:91], v[98:99]
    v_mov_b64 v[92:93], v[100:101]
    v_mov_b64 v[94:95], v[102:103]
    v_mov_b64 v[80:81], v[48:49]
    v_mov_b64 v[82:83], v[50:51]
    v_mov_b64 v[84:85], v[52:53]
    v_mov_b64 v[86:87], v[54:55]
    s_add_u32 s43, s43, 1
    buffer_load_dwordx4 v[0:3], v127, s[8:11], s29 offen sc1
    buffer_load_dwordx4 v[4:7], v127, s[8:11], s29 offen offset:1024 sc1
    s_waitcnt lgkmcnt(0)
    s_branch LS1_pollP
LS1_done:
    buffer_store_dword v112, v131, s[8:11], s33 offen sc1
    s_waitcnt vmcnt(0)
    s_endpgm
LS1_retryE:
    buffer_load_dwordx4 v[12:15], v127, s[8:11], s30 offen sc1
    buffer_load_dwordx4 v[20:23], v127, s[8:11], s68 offen sc1
    s_sub_u32 s22, s22, 1
    s_cbranch_scc1 L_exit
    s_nop 3
    v_mov_b64 v[56:57], 0
    v_mov_b64 v[58:59], 0
    v_mov_b64 v[60:61], 0
    v_mov_b64 v[62:63], 0
    s_waitcnt vmcnt(1)
    s_branch LS1_bA
LS1_retryL:
    buffer_load_dwordx4 v[20:23], v127, s[8:11], s68 offen sc1
    s_sub_u32 s22, s22, 1
    s_cbranch_scc1 L_exit
    s_waitcnt vmcnt(0)
    v_max3_u32 v141, v20, v21, v22
    v_max_u32 v141, v141, v23
    v_cmp_eq_u32 vcc, -1, v141
    s_cbranch_vccnz LS1_retryL
    ds_write_b128 v127, v[20:23] offset:5120
    s_waitcnt lgkmcnt(0)
    s_branch LS1_Lok
    s_nop 0
LS1_retryP:
    buffer_load_dwordx4 v[0:3], v127, s[8:11], s29 offen sc1
    buffer_load_dwordx4 v[4:7], v127, s[8:11], s29 offen offset:1024 sc1
    s_sub_u32 s22, s22, 1
    s_cbranch_scc1 L_exit
    s_branch LS1_pollP
LS1_lead:
    s_nop 12
    s_branch LS1_leadok
LS1_fallback:
    s_nop 7
    v_lshlrev_b32 v142, 1, v132
    v_subrev_u32 v142, 20480, v142
    ds_write_b32 v142, v104
    v_min_u32 v142, v133, v134
    v_lshlrev_b32 v142, 1, v142
    v_subrev_u32 v142, 20480, v142
    s_waitcnt lgkmcnt(0)
    s_barrier
    ds_read_b128 v[56:59], v142
    ds_read_b128 v[60:63], v142 offset:16
    s_waitcnt lgkmcnt(1)
    v_max3_f32 v141, v56, v57, v58
    s_waitcnt lgkmcnt(0)
    v_max3_f32 v141, v141, v59, v60
    v_max3_f32 v141, v141, v61, v62
    v_max3_f32 v141, v141, v63, v105
    s_nop 1
    v_max_f32_dpp v141, v141, v141 quad_perm:[2,3,0,1] row_mask:0xf bank_mask:0xf
    v_mov_b32 v142, v141
    s_nop 1
    v_permlane16_swap_b32 v141, v142
    v_max_f32 v141, v141, v142
    v_mov_b32 v142, v141
    s_nop 1
    v_permlane32_swap_b32 v141, v142
    v_max_f32 v141, v141, v142
    v_sub_f32 v56, v56, v141
    v_exp_f32 v56, v56
    v_sub_f32 v57, v57, v141
    v_exp_f32 v57, v57
    v_sub_f32 v58, v58, v141
    v_exp_f32 v58, v58
    v_sub_f32 v59, v59, v141
    v_exp_f32 v59, v59
    v_sub_f32 v60, v60, v141
    v_exp_f32 v60, v60
    v_sub_f32 v61, v61, v141
    v_exp_f32 v61, v61
    v_sub_f32 v62, v62, v141
    v_exp_f32 v62, v62
    v_sub_f32 v63, v63, v141
    v_exp_f32 v63, v63
    v_sub_f32 v107, v105, v141
    v_exp_f32 v107, v107
    s_nop 1
    v_mov_b32_dpp v108, v107 quad_perm:[2,3,0,1] row_mask:0xf bank_mask:0xf
    v_cvt_pk_bf16_f32 v107, v107, v108
    v_cndmask_b32 v68, v107, 0, s[24:25]
    v_cndmask_b32 v69, 0, v107, s[24:25]
    v_cvt_pk_bf16_f32 v142, v56, v57
    v_cndmask_b32 v110, v142, 0, s[24:25]
    v_cndmask_b32 v114, 0, v142, s[24:25]
    v_cvt_pk_bf16_f32 v142, v58, v59
    v_cndmask_b32 v111, v142, 0, s[24:25]
    v_cndmask_b32 v115, 0, v142, s[24:25]
    v_cvt_pk_bf16_f32 v142, v60, v61
    v_cndmask_b32 v112, v142, 0, s[24:25]
    v_cndmask_b32 v116, 0, v142, s[24:25]
    v_cvt_pk_bf16_f32 v142, v62, v63
    v_cndmask_b32 v113, v142, 0, s[24:25]
    v_cndmask_b32 v117, 0, v142, s[24:25]
    s_nop 0
    v_mfma_f32_16x16x32_bf16 v[118:121], v[88:91], v[110:113], 0
    v_mfma_f32_16x16x32_bf16 v[118:121], v[92:95], v[114:117], v[118:121]
    v_mfma_f32_16x16x32_bf16 v[64:67], v[122:125], v[110:113], 0
    s_nop 5
    v_mfma_f32_16x16x16_bf16 v[64:67], v[122:123], v[68:69], v[64:67]
    v_mfma_f32_16x16x16_bf16 v[118:121], v[72:73], v[68:69], v[118:121]
    s_nop 3
    v_rcp_f32_dpp v141, v64 quad_perm:[0,1,0,1] row_mask:0xf bank_mask:0xf
    s_mov_b64 vcc, 0
    s_nop 1
    s_branch LS1_norm
L_chain_w2:
    v_and_b32 v10, 63, v0
    v_lshlrev_b32 v6, 4, v10
    s_mov_b32 s14, 0x400000
    s_mov_b32 s15, 0x20000
    s_mov_b32 s12, s66
    s_mov_b32 s13, s67
    s_lshl_b32 s40, s20, 17
    s_add_u32 s40, s40, 16384
    s_mov_b32 m0, 49152
    s_nop 0
    buffer_load_dwordx4 v6, s[12:15], s40 offen lds
    s_add_u32 s40, s40, 1024
    s_mov_b32 m0, 50176
    s_nop 0
    buffer_load_dwordx4 v6, s[12:15], s40 offen lds
    s_add_u32 s40, s40, 1024
    s_mov_b32 m0, 51200
    s_nop 0
    buffer_load_dwordx4 v6, s[12:15], s40 offen lds
    s_add_u32 s40, s40, 1024
    s_mov_b32 m0, 52224
    s_nop 0
    buffer_load_dwordx4 v6, s[12:15], s40 offen lds
    s_add_u32 s40, s40, 1024
    s_mov_b32 m0, 53248
    s_nop 0
    buffer_load_dwordx4 v6, s[12:15], s40 offen lds
    s_add_u32 s40, s40, 1024
    s_mov_b32 m0, 54272
    s_nop 0
    buffer_load_dwordx4 v6, s[12:15], s40 offen lds
    s_add_u32 s40, s40, 1024
    s_mov_b32 m0, 55296
    s_nop 0
    buffer_load_dwordx4 v6, s[12:15], s40 offen lds
    s_add_u32 s40, s40, 1024
    s_mov_b32 m0, 56320
    s_nop 0
    buffer_load_dwordx4 v6, s[12:15], s40 offen lds
    s_mov_b32 s12, s66
    s_mov_b32 s13, s67
    s_lshl_b32 s40, s20, 17
    s_add_u32 s40, s40, 49152
    s_mov_b32 m0, 81920
    s_nop 0
    buffer_load_dwordx4 v6, s[12:15], s40 offen lds
    s_add_u32 s40, s40, 1024
    s_mov_b32 m0, 82944
    s_nop 0
    buffer_load_dwordx4 v6, s[12:15], s40 offen lds
    s_add_u32 s40, s40, 1024
    s_mov_b32 m0, 83968
    s_nop 0
    buffer_load_dwordx4 v6, s[12:15], s40 offen lds
    s_add_u32 s40, s40, 1024
    s_mov_b32 m0, 84992
    s_nop 0
    buffer_load_dwordx4 v6, s[12:15], s40 offen lds
    s_add_u32 s40, s40, 1024
    s_mov_b32 m0, 86016
    s_nop 0
    buffer_load_dwordx4 v6, s[12:15], s40 offen lds
    s_add_u32 s40, s40, 1024
    s_mov_b32 m0, 87040
    s_nop 0
    buffer_load_dwordx4 v6, s[12:15], s40 offen lds
    s_add_u32 s40, s40, 1024
    s_mov_b32 m0, 88064
    s_nop 0
    buffer_load_dwordx4 v6, s[12:15], s40 offen lds
    s_add_u32 s40, s40, 1024
    s_mov_b32 m0, 89088
    s_nop 0
    buffer_load_dwordx4 v6, s[12:15], s40 offen lds
    s_mov_b32 s12, s66
    s_mov_b32 s13, s67
    s_lshl_b32 s40, s20, 17
    s_add_u32 s40, s40, 81920
    s_mov_b32 m0, 114688
    s_nop 0
    buffer_load_dwordx4 v6, s[12:15], s40 offen lds
    s_add_u32 s40, s40, 1024
    s_mov_b32 m0, 115712
    s_nop 0
    buffer_load_dwordx4 v6, s[12:15], s40 offen lds
    s_add_u32 s40, s40, 1024
    s_mov_b32 m0, 116736
    s_nop 0
    buffer_load_dwordx4 v6, s[12:15], s40 offen lds
    s_add_u32 s40, s40, 1024
    s_mov_b32 m0, 117760
    s_nop 0
    buffer_load_dwordx4 v6, s[12:15], s40 offen lds
    s_add_u32 s40, s40, 1024
    s_mov_b32 m0, 118784
    s_nop 0
    buffer_load_dwordx4 v6, s[12:15], s40 offen lds
    s_add_u32 s40, s40, 1024
    s_mov_b32 m0, 119808
    s_nop 0
    buffer_load_dwordx4 v6, s[12:15], s40 offen lds
    s_add_u32 s40, s40, 1024
    s_mov_b32 m0, 120832
    s_nop 0
    buffer_load_dwordx4 v6, s[12:15], s40 offen lds
    s_add_u32 s40, s40, 1024
    s_mov_b32 m0, 121856
    s_nop 0
    buffer_load_dwordx4 v6, s[12:15], s40 offen lds
    s_mov_b32 s12, s66
    s_mov_b32 s13, s67
    s_lshl_b32 s40, s20, 17
    s_add_u32 s40, s40, 114688
    s_mov_b32 m0, 147456
    s_nop 0
    buffer_load_dwordx4 v6, s[12:15], s40 offen lds
    s_add_u32 s40, s40, 1024
    s_mov_b32 m0, 148480
    s_nop 0
    buffer_load_dwordx4 v6, s[12:15], s40 offen lds
    s_add_u32 s40, s40, 1024
    s_mov_b32 m0, 149504
    s_nop 0
    buffer_load_dwordx4 v6, s[12:15], s40 offen lds
    s_add_u32 s40, s40, 1024
    s_mov_b32 m0, 150528
    s_nop 0
    buffer_load_dwordx4 v6, s[12:15], s40 offen lds
    s_add_u32 s40, s40, 1024
    s_mov_b32 m0, 151552
    s_nop 0
    buffer_load_dwordx4 v6, s[12:15], s40 offen lds
    s_add_u32 s40, s40, 1024
    s_mov_b32 m0, 152576
    s_nop 0
    buffer_load_dwordx4 v6, s[12:15], s40 offen lds
    s_add_u32 s40, s40, 1024
    s_mov_b32 m0, 153600
    s_nop 0
    buffer_load_dwordx4 v6, s[12:15], s40 offen lds
    s_add_u32 s40, s40, 1024
    s_mov_b32 m0, 154624
    s_nop 0
    buffer_load_dwordx4 v6, s[12:15], s40 offen lds
    s_or_b32 s4, s23, s21
    s_cselect_b64 exec, 0, 1
    buffer_atomic_or v1, off, s[16:19], s59 sc0
    s_mov_b64 exec, -1
    v_and_b32 v2, 15, v0
    v_lshrrev_b32 v3, 4, v10
    v_lshlrev_b32 v4, 1, v3
    v_xor_b32 v4, v4, v2
    v_xor_b32 v5, 8, v4
    v_lshlrev_b32 v4, 4, v4
    v_lshlrev_b32 v5, 4, v5
    v_lshl_add_u32 v4, v3, 13, v4
    v_lshl_add_u32 v5, v3, 13, v5
    v_lshrrev_b32 v14, 2, v2
    v_and_b32 v15, 1, v3
    v_lshl_or_b32 v15, v15, 2, v14
    v_lshl_add_u32 v14, v3, 3, v14
    v_lshlrev_b32 v14, 8, v14
    v_and_b32 v16, 3, v2
    v_lshl_add_u32 v14, v16, 3, v14
    v_xor_b32 v7, 4, v15
    v_xor_b32 v8, 5, v15
    v_lshl_add_u32 v7, v7, 5, v14
    v_lshl_add_u32 v8, v8, 5, v14
    v_add_u32 v7, 32768, v7
    v_add_u32 v8, 32768, v8
    v_lshlrev_b32 v16, 2, v2
    v_add_u32 v16, 32896, v16
    v_lshl_add_u32 v9, v3, 12, v16
    v_lshrrev_b32 v14, 1, v3
    v_lshl_add_u32 v14, v14, 12, v16
    v_add_u32 v14, 65536, v14
    v_and_b32 v15, 1, v3
    v_lshl_add_u32 v11, v15, 14, v14
    v_xor_b32 v15, 1, v15
    v_lshl_add_u32 v12, v15, 14, v14
    s_mov_b32 s41, 0x05040100
    s_mov_b32 s42, 0x07060302
    s_lshl_b32 s37, s20, 6
    s_add_u32 s37, s37, 17580032
    s_waitcnt vmcnt(25)
    s_barrier
    ds_read2st64_b32 v[18:19], v9 offset0:0 offset1:4
    ds_read2st64_b32 v[20:21], v9 offset0:8 offset1:12
    ds_read2st64_b32 v[22:23], v9 offset0:64 offset1:68
    ds_read2st64_b32 v[24:25], v9 offset0:72 offset1:76
    ds_read2st64_b32 v[26:27], v9 offset0:1 offset1:5
    ds_read2st64_b32 v[28:29], v9 offset0:9 offset1:13
    ds_read2st64_b32 v[30:31], v9 offset0:65 offset1:69
    ds_read2st64_b32 v[32:33], v9 offset0:73 offset1:77
    ds_read2st64_b32 v[34:35], v9 offset0:2 offset1:6
    ds_read2st64_b32 v[36:37], v9 offset0:10 offset1:14
    ds_read2st64_b32 v[38:39], v9 offset0:66 offset1:70
    ds_read2st64_b32 v[40:41], v9 offset0:74 offset1:78
    ds_read2st64_b32 v[42:43], v9 offset0:3 offset1:7
    ds_read2st64_b32 v[44:45], v9 offset0:11 offset1:15
    ds_read2st64_b32 v[46:47], v9 offset0:67 offset1:71
    ds_read2st64_b32 v[48:49], v9 offset0:75 offset1:79
    s_waitcnt lgkmcnt(0)
    s_barrier
    s_mov_b32 s12, s64
    s_mov_b32 s13, s65
    s_lshl_b32 s40, s20, 8
    s_add_u32 s40, s40, 524288
    s_mov_b32 m0, 49152
    s_nop 0
    buffer_load_dwordx4 v4, s[12:15], s40 offen lds
    s_add_u32 s40, s40, 32768
    s_mov_b32 m0, 50176
    s_nop 0
    buffer_load_dwordx4 v4, s[12:15], s40 offen lds
    s_add_u32 s40, s40, 32768
    s_mov_b32 m0, 51200
    s_nop 0
    buffer_load_dwordx4 v5, s[12:15], s40 offen lds
    s_add_u32 s40, s40, 32768
    s_mov_b32 m0, 52224
    s_nop 0
    buffer_load_dwordx4 v5, s[12:15], s40 offen lds
    s_add_u32 s40, s40, 32768
    s_mov_b32 m0, 53248
    s_nop 0
    buffer_load_dwordx4 v4, s[12:15], s40 offen lds
    s_add_u32 s40, s40, 32768
    s_mov_b32 m0, 54272
    s_nop 0
    buffer_load_dwordx4 v4, s[12:15], s40 offen lds
    s_add_u32 s40, s40, 32768
    s_mov_b32 m0, 55296
    s_nop 0
    buffer_load_dwordx4 v5, s[12:15], s40 offen lds
    s_add_u32 s40, s40, 32768
    s_mov_b32 m0, 56320
    s_nop 0
    buffer_load_dwordx4 v5, s[12:15], s40 offen lds
    v_perm_b32 v168, v19, v18, s41
    v_perm_b32 v169, v19, v18, s42
    v_perm_b32 v170, v21, v20, s41
    v_perm_b32 v171, v21, v20, s42
    v_perm_b32 v172, v23, v22, s41
    v_perm_b32 v173, v23, v22, s42
    v_perm_b32 v174, v25, v24, s41
    v_perm_b32 v175, v25, v24, s42
    v_perm_b32 v184, v27, v26, s41
    v_perm_b32 v185, v27, v26, s42
    v_perm_b32 v186, v29, v28, s41
    v_perm_b32 v187, v29, v28, s42
    v_perm_b32 v188, v31, v30, s41
    v_perm_b32 v189, v31, v30, s42
    v_perm_b32 v190, v33, v32, s41
    v_perm_b32 v191, v33, v32, s42
    v_perm_b32 v200, v35, v34, s41
    v_perm_b32 v201, v35, v34, s42
    v_perm_b32 v202, v37, v36, s41
    v_perm_b32 v203, v37, v36, s42
    v_perm_b32 v204, v39, v38, s41
    v_perm_b32 v205, v39, v38, s42
    v_perm_b32 v206, v41, v40, s41
    v_perm_b32 v207, v41, v40, s42
    v_perm_b32 v82, v43, v42, s41
    v_perm_b32 v83, v43, v42, s42
    v_perm_b32 v84, v45, v44, s41
    v_perm_b32 v85, v45, v44, s42
    v_perm_b32 v86, v47, v46, s41
    v_perm_b32 v87, v47, v46, s42
    v_perm_b32 v88, v49, v48, s41
    v_perm_b32 v89, v49, v48, s42
    v_add_u32 v13, 20480, v6
    ds_write_b128 v13, v[82:85]
    ds_write_b128 v13, v[86:89] offset:1024
    s_waitcnt vmcnt(25)
    s_barrier
    v_add_u32 v9, 32768, v9
    ds_read2st64_b32 v[18:19], v9 offset0:0 offset1:4
    ds_read2st64_b32 v[20:21], v9 offset0:8 offset1:12
    ds_read2st64_b32 v[22:23], v9 offset0:64 offset1:68
    ds_read2st64_b32 v[24:25], v9 offset0:72 offset1:76
    ds_read2st64_b32 v[26:27], v9 offset0:1 offset1:5
    ds_read2st64_b32 v[28:29], v9 offset0:9 offset1:13
    ds_read2st64_b32 v[30:31], v9 offset0:65 offset1:69
    ds_read2st64_b32 v[32:33], v9 offset0:73 offset1:77
    ds_read2st64_b32 v[34:35], v9 offset0:2 offset1:6
    ds_read2st64_b32 v[36:37], v9 offset0:10 offset1:14
    ds_read2st64_b32 v[38:39], v9 offset0:66 offset1:70
    ds_read2st64_b32 v[40:41], v9 offset0:74 offset1:78
    ds_read2st64_b32 v[42:43], v9 offset0:3 offset1:7
    ds_read2st64_b32 v[44:45], v9 offset0:11 offset1:15
    ds_read2st64_b32 v[46:47], v9 offset0:67 offset1:71
    ds_read2st64_b32 v[48:49], v9 offset0:75 offset1:79
    s_waitcnt lgkmcnt(0)
    s_barrier
    s_mov_b32 s12, s64
    s_mov_b32 s13, s65
    s_lshl_b32 s40, s20, 8
    s_add_u32 s40, s40, 1572864
    s_mov_b32 m0, 81920
    s_nop 0
    buffer_load_dwordx4 v4, s[12:15], s40 offen lds
    s_add_u32 s40, s40, 32768
    s_mov_b32 m0, 82944
    s_nop 0
    buffer_load_dwordx4 v4, s[12:15], s40 offen lds
    s_add_u32 s40, s40, 32768
    s_mov_b32 m0, 83968
    s_nop 0
    buffer_load_dwordx4 v5, s[12:15], s40 offen lds
    s_add_u32 s40, s40, 32768
    s_mov_b32 m0, 84992
    s_nop 0
    buffer_load_dwordx4 v5, s[12:15], s40 offen lds
    s_add_u32 s40, s40, 32768
    s_mov_b32 m0, 86016
    s_nop 0
    buffer_load_dwordx4 v4, s[12:15], s40 offen lds
    s_add_u32 s40, s40, 32768
    s_mov_b32 m0, 87040
    s_nop 0
    buffer_load_dwordx4 v4, s[12:15], s40 offen lds
    s_add_u32 s40, s40, 32768
    s_mov_b32 m0, 88064
    s_nop 0
    buffer_load_dwordx4 v5, s[12:15], s40 offen lds
    s_add_u32 s40, s40, 32768
    s_mov_b32 m0, 89088
    s_nop 0
    buffer_load_dwordx4 v5, s[12:15], s40 offen lds
    v_perm_b32 v176, v19, v18, s41
    v_perm_b32 v177, v19, v18, s42
    v_perm_b32 v178, v21, v20, s41
    v_perm_b32 v179, v21, v20, s42
    v_perm_b32 v180, v23, v22, s41
    v_perm_b32 v181, v23, v22, s42
    v_perm_b32 v182, v25, v24, s41
    v_perm_b32 v183, v25, v24, s42
    v_perm_b32 v192, v27, v26, s41
    v_perm_b32 v193, v27, v26, s42
    v_perm_b32 v194, v29, v28, s41
    v_perm_b32 v195, v29, v28, s42
    v_perm_b32 v196, v31, v30, s41
    v_perm_b32 v197, v31, v30, s42
    v_perm_b32 v198, v33, v32, s41
    v_perm_b32 v199, v33, v32, s42
    v_perm_b32 v208, v35, v34, s41
    v_perm_b32 v209, v35, v34, s42
    v_perm_b32 v210, v37, v36, s41
    v_perm_b32 v211, v37, v36, s42
    v_perm_b32 v212, v39, v38, s41
    v_perm_b32 v213, v39, v38, s42
    v_perm_b32 v214, v41, v40, s41
    v_perm_b32 v215, v41, v40, s42
    v_perm_b32 v224, v43, v42, s41
    v_perm_b32 v225, v43, v42, s42
    v_perm_b32 v226, v45, v44, s41
    v_perm_b32 v227, v45, v44, s42
    v_perm_b32 v228, v47, v46, s41
    v_perm_b32 v229, v47, v46, s42
    v_perm_b32 v230, v49, v48, s41
    v_perm_b32 v231, v49, v48, s42
    s_waitcnt vmcnt(25)
    s_barrier
    v_add_u32 v9, 32768, v9
    ds_read2st64_b32 v[18:19], v11 offset0:0 offset1:4
    ds_read2st64_b32 v[20:21], v12 offset0:0 offset1:4
    ds_read2st64_b32 v[22:23], v11 offset0:8 offset1:12
    ds_read2st64_b32 v[24:25], v12 offset0:8 offset1:12
    ds_read2st64_b32 v[26:27], v11 offset0:32 offset1:36
    ds_read2st64_b32 v[28:29], v12 offset0:32 offset1:36
    ds_read2st64_b32 v[30:31], v11 offset0:40 offset1:44
    ds_read2st64_b32 v[32:33], v12 offset0:40 offset1:44
    ds_read2st64_b32 v[34:35], v11 offset0:1 offset1:5
    ds_read2st64_b32 v[36:37], v12 offset0:1 offset1:5
    ds_read2st64_b32 v[38:39], v11 offset0:9 offset1:13
    ds_read2st64_b32 v[40:41], v12 offset0:9 offset1:13
    ds_read2st64_b32 v[42:43], v11 offset0:33 offset1:37
    ds_read2st64_b32 v[44:45], v12 offset0:33 offset1:37
    ds_read2st64_b32 v[46:47], v11 offset0:41 offset1:45
    ds_read2st64_b32 v[48:49], v12 offset0:41 offset1:45
    ds_read2st64_b32 v[50:51], v11 offset0:2 offset1:6
    ds_read2st64_b32 v[52:53], v12 offset0:2 offset1:6
    ds_read2st64_b32 v[54:55], v11 offset0:10 offset1:14
    ds_read2st64_b32 v[56:57], v12 offset0:10 offset1:14
    ds_read2st64_b32 v[58:59], v11 offset0:34 offset1:38
    ds_read2st64_b32 v[60:61], v12 offset0:34 offset1:38
    ds_read2st64_b32 v[62:63], v11 offset0:42 offset1:46
    ds_read2st64_b32 v[64:65], v12 offset0:42 offset1:46
    ds_read2st64_b32 v[66:67], v11 offset0:3 offset1:7
    ds_read2st64_b32 v[68:69], v12 offset0:3 offset1:7
    ds_read2st64_b32 v[70:71], v11 offset0:11 offset1:15
    ds_read2st64_b32 v[72:73], v12 offset0:11 offset1:15
    ds_read2st64_b32 v[74:75], v11 offset0:35 offset1:39
    ds_read2st64_b32 v[76:77], v12 offset0:35 offset1:39
    ds_read2st64_b32 v[78:79], v11 offset0:43 offset1:47
    ds_read2st64_b32 v[80:81], v12 offset0:43 offset1:47
    s_waitcnt lgkmcnt(0)
    s_barrier
    s_mov_b32 s12, s64
    s_mov_b32 s13, s65
    s_lshl_b32 s40, s20, 8
    s_add_u32 s40, s40, 2621440
    s_mov_b32 m0, 114688
    s_nop 0
    buffer_load_dwordx4 v4, s[12:15], s40 offen lds
    s_add_u32 s40, s40, 32768
    s_mov_b32 m0, 115712
    s_nop 0
    buffer_load_dwordx4 v4, s[12:15], s40 offen lds
    s_add_u32 s40, s40, 32768
    s_mov_b32 m0, 116736
    s_nop 0
    buffer_load_dwordx4 v5, s[12:15], s40 offen lds
    s_add_u32 s40, s40, 32768
    s_mov_b32 m0, 117760
    s_nop 0
    buffer_load_dwordx4 v5, s[12:15], s40 offen lds
    s_add_u32 s40, s40, 32768
    s_mov_b32 m0, 118784
    s_nop 0
    buffer_load_dwordx4 v4, s[12:15], s40 offen lds
    s_add_u32 s40, s40, 32768
    s_mov_b32 m0, 119808
    s_nop 0
    buffer_load_dwordx4 v4, s[12:15], s40 offen lds
    s_add_u32 s40, s40, 32768
    s_mov_b32 m0, 120832
    s_nop 0
    buffer_load_dwordx4 v5, s[12:15], s40 offen lds
    s_add_u32 s40, s40, 32768
    s_mov_b32 m0, 121856
    s_nop 0
    buffer_load_dwordx4 v5, s[12:15], s40 offen lds
    v_perm_b32 v82, v19, v18, s41
    v_perm_b32 v83, v21, v20, s42
    v_perm_b32 v84, v23, v22, s41
    v_perm_b32 v85, v25, v24, s42
    v_perm_b32 v86, v27, v26, s41
    v_perm_b32 v87, v29, v28, s42
    v_perm_b32 v88, v31, v30, s41
    v_perm_b32 v89, v33, v32, s42
    v_perm_b32 v144, v35, v34, s41
    v_perm_b32 v145, v37, v36, s42
    v_perm_b32 v146, v39, v38, s41
    v_perm_b32 v147, v41, v40, s42
    v_perm_b32 v148, v43, v42, s41
    v_perm_b32 v149, v45, v44, s42
    v_perm_b32 v150, v47, v46, s41
    v_perm_b32 v151, v49, v48, s42
    v_perm_b32 v152, v51, v50, s41
    v_perm_b32 v153, v53, v52, s42
    v_perm_b32 v154, v55, v54, s41
    v_perm_b32 v155, v57, v56, s42
    v_perm_b32 v156, v59, v58, s41
    v_perm_b32 v157, v61, v60, s42
    v_perm_b32 v158, v63, v62, s41
    v_perm_b32 v159, v65, v64, s42
    v_perm_b32 v90, v67, v66, s41
    v_perm_b32 v91, v69, v68, s42
    v_perm_b32 v92, v71, v70, s41
    v_perm_b32 v93, v73, v72, s42
    v_perm_b32 v94, v75, v74, s41
    v_perm_b32 v95, v77, v76, s42
    v_perm_b32 v96, v79, v78, s41
    v_perm_b32 v97, v81, v80, s42
    v_add_u32 v13, 28672, v6
    ds_write_b128 v13, v[82:85]
    ds_write_b128 v13, v[86:89] offset:1024
    s_waitcnt vmcnt(25)
    s_barrier
    v_add_u32 v9, 32768, v9
    ds_read2st64_b32 v[18:19], v9 offset0:0 offset1:4
    ds_read2st64_b32 v[20:21], v9 offset0:8 offset1:12
    ds_read2st64_b32 v[22:23], v9 offset0:64 offset1:68
    ds_read2st64_b32 v[24:25], v9 offset0:72 offset1:76
    ds_read2st64_b32 v[26:27], v9 offset0:1 offset1:5
    ds_read2st64_b32 v[28:29], v9 offset0:9 offset1:13
    ds_read2st64_b32 v[30:31], v9 offset0:65 offset1:69
    ds_read2st64_b32 v[32:33], v9 offset0:73 offset1:77
    ds_read2st64_b32 v[34:35], v9 offset0:2 offset1:6
    ds_read2st64_b32 v[36:37], v9 offset0:10 offset1:14
    ds_read2st64_b32 v[38:39], v9 offset0:66 offset1:70
    ds_read2st64_b32 v[40:41], v9 offset0:74 offset1:78
    ds_read2st64_b32 v[42:43], v9 offset0:3 offset1:7
    ds_read2st64_b32 v[44:45], v9 offset0:11 offset1:15
    ds_read2st64_b32 v[46:47], v9 offset0:67 offset1:71
    ds_read2st64_b32 v[48:49], v9 offset0:75 offset1:79
    s_waitcnt lgkmcnt(0)
    s_barrier
    s_mov_b32 s12, s64
    s_mov_b32 s13, s65
    s_lshl_b32 s40, s20, 8
    s_add_u32 s40, s40, 3670016
    s_mov_b32 m0, 147456
    s_nop 0
    buffer_load_dwordx4 v4, s[12:15], s40 offen lds
    s_add_u32 s40, s40, 32768
    s_mov_b32 m0, 148480
    s_nop 0
    buffer_load_dwordx4 v4, s[12:15], s40 offen lds
    s_add_u32 s40, s40, 32768
    s_mov_b32 m0, 149504
    s_nop 0
    buffer_load_dwordx4 v5, s[12:15], s40 offen lds
    s_add_u32 s40, s40, 32768
    s_mov_b32 m0, 150528
    s_nop 0
    buffer_load_dwordx4 v5, s[12:15], s40 offen lds
    s_add_u32 s40, s40, 32768
    s_mov_b32 m0, 151552
    s_nop 0
    buffer_load_dwordx4 v4, s[12:15], s40 offen lds
    s_add_u32 s40, s40, 32768
    s_mov_b32 m0, 152576
    s_nop 0
    buffer_load_dwordx4 v4, s[12:15], s40 offen lds
    s_add_u32 s40, s40, 32768
    s_mov_b32 m0, 153600
    s_nop 0
    buffer_load_dwordx4 v5, s[12:15], s40 offen lds
    s_add_u32 s40, s40, 32768
    s_mov_b32 m0, 154624
    s_nop 0
    buffer_load_dwordx4 v5, s[12:15], s40 offen lds
    v_perm_b32 v160, v19, v18, s41
    v_perm_b32 v161, v19, v18, s42
    v_perm_b32 v162, v21, v20, s41
    v_perm_b32 v163, v21, v20, s42
    v_perm_b32 v164, v23, v22, s41
    v_perm_b32 v165, v23, v22, s42
    v_perm_b32 v166, v25, v24, s41
    v_perm_b32 v167, v25, v24, s42
    v_perm_b32 v82, v27, v26, s41
    v_perm_b32 v83, v27, v26, s42
    v_perm_b32 v84, v29, v28, s41
    v_perm_b32 v85, v29, v28, s42
    v_perm_b32 v86, v31, v30, s41
    v_perm_b32 v87, v31, v30, s42
    v_perm_b32 v88, v33, v32, s41
    v_perm_b32 v89, v33, v32, s42
    v_perm_b32 v98, v35, v34, s41
    v_perm_b32 v99, v35, v34, s42
    v_perm_b32 v100, v37, v36, s41
    v_perm_b32 v101, v37, v36, s42
    v_perm_b32 v102, v39, v38, s41
    v_perm_b32 v103, v39, v38, s42
    v_perm_b32 v104, v41, v40, s41
    v_perm_b32 v105, v41, v40, s42
    v_perm_b32 v216, v43, v42, s41
    v_perm_b32 v217, v43, v42, s42
    v_perm_b32 v218, v45, v44, s41
    v_perm_b32 v219, v45, v44, s42
    v_perm_b32 v220, v47, v46, s41
    v_perm_b32 v221, v47, v46, s42
    v_perm_b32 v222, v49, v48, s41
    v_perm_b32 v223, v49, v48, s42
    s_waitcnt vmcnt(24)
    s_barrier
    s_cmp_lg_u32 s23, 0
    s_cbranch_scc1 L_ver_c2
    v_mov_b32 v14, 14336
    s_cmp_lg_u32 s21, 0
    s_cbranch_scc1 L_verw_c2
    s_waitcnt vmcnt(24)
    s_mov_b64 exec, 1
    ds_write_b32 v14, v1
    s_mov_b64 exec, -1
    s_waitcnt lgkmcnt(0)
L_verw_c2:
    s_barrier
    ds_read_b32 v15, v14
    s_waitcnt lgkmcnt(0)
    v_readfirstlane_b32 s4, v15
    s_bitcmp1_b32 s4, s5
    s_cbranch_scc1 L_el_fix
    s_nop 2
L_ver_c2:
    ds_read_b64_tr_b16 a[32:33], v7 offset:0
    ds_read_b64_tr_b16 a[34:35], v7 offset:1024
    ds_read_b64_tr_b16 a[36:37], v7 offset:8192
    ds_read_b64_tr_b16 a[38:39], v7 offset:9216
    ds_read_b64_tr_b16 v[18:19], v8 offset:0
    ds_read_b64_tr_b16 v[20:21], v8 offset:1024
    ds_read_b64_tr_b16 v[22:23], v8 offset:8192
    ds_read_b64_tr_b16 v[24:25], v8 offset:9216
    ds_read_b64_tr_b16 v[26:27], v7 offset:16384
    ds_read_b64_tr_b16 v[28:29], v7 offset:17408
    ds_read_b64_tr_b16 v[30:31], v7 offset:24576
    ds_read_b64_tr_b16 v[32:33], v7 offset:25600
    ds_read_b64_tr_b16 a[248:249], v8 offset:16384
    ds_read_b64_tr_b16 a[250:251], v8 offset:17408
    ds_read_b64_tr_b16 a[252:253], v8 offset:24576
    ds_read_b64_tr_b16 a[254:255], v8 offset:25600
    s_waitcnt lgkmcnt(0)
    s_barrier
    s_mov_b32 s12, s62
    s_mov_b32 s13, s63
    s_lshl_b32 s40, s20, 8
    s_add_u32 s40, s40, 524288
    s_mov_b32 m0, 49152
    s_nop 0
    buffer_load_dwordx4 v4, s[12:15], s40 offen lds
    s_add_u32 s40, s40, 32768
    s_mov_b32 m0, 50176
    s_nop 0
    buffer_load_dwordx4 v4, s[12:15], s40 offen lds
    s_add_u32 s40, s40, 32768
    s_mov_b32 m0, 51200
    s_nop 0
    buffer_load_dwordx4 v5, s[12:15], s40 offen lds
    s_add_u32 s40, s40, 32768
    s_mov_b32 m0, 52224
    s_nop 0
    buffer_load_dwordx4 v5, s[12:15], s40 offen lds
    s_add_u32 s40, s40, 32768
    s_mov_b32 m0, 53248
    s_nop 0
    buffer_load_dwordx4 v4, s[12:15], s40 offen lds
    s_add_u32 s40, s40, 32768
    s_mov_b32 m0, 54272
    s_nop 0
    buffer_load_dwordx4 v4, s[12:15], s40 offen lds
    s_add_u32 s40, s40, 32768
    s_mov_b32 m0, 55296
    s_nop 0
    buffer_load_dwordx4 v5, s[12:15], s40 offen lds
    s_add_u32 s40, s40, 32768
    s_mov_b32 m0, 56320
    s_nop 0
    buffer_load_dwordx4 v5, s[12:15], s40 offen lds
    s_waitcnt vmcnt(24)
    s_barrier
    v_add_u32 v7, 32768, v7
    v_add_u32 v8, 32768, v8
    ds_read_b64_tr_b16 v[232:233], v7 offset:0
    ds_read_b64_tr_b16 v[234:235], v7 offset:1024
    ds_read_b64_tr_b16 v[236:237], v7 offset:8192
    ds_read_b64_tr_b16 v[238:239], v7 offset:9216
    ds_read_b64_tr_b16 v[34:35], v8 offset:0
    ds_read_b64_tr_b16 v[36:37], v8 offset:1024
    ds_read_b64_tr_b16 v[38:39], v8 offset:8192
    ds_read_b64_tr_b16 v[40:41], v8 offset:9216
    ds_read_b64_tr_b16 v[240:241], v7 offset:16384
    ds_read_b64_tr_b16 v[242:243], v7 offset:17408
    ds_read_b64_tr_b16 v[244:245], v7 offset:24576
    ds_read_b64_tr_b16 v[246:247], v7 offset:25600
    ds_read_b64_tr_b16 v[248:249], v8 offset:16384
    ds_read_b64_tr_b16 v[250:251], v8 offset:17408
    ds_read_b64_tr_b16 v[252:253], v8 offset:24576
    ds_read_b64_tr_b16 v[254:255], v8 offset:25600
    s_waitcnt lgkmcnt(0)
    s_barrier
    s_mov_b32 s12, s62
    s_mov_b32 s13, s63
    s_lshl_b32 s40, s20, 8
    s_add_u32 s40, s40, 1572864
    s_mov_b32 m0, 81920
    s_nop 0
    buffer_load_dwordx4 v4, s[12:15], s40 offen lds
    s_add_u32 s40, s40, 32768
    s_mov_b32 m0, 82944
    s_nop 0
    buffer_load_dwordx4 v4, s[12:15], s40 offen lds
    s_add_u32 s40, s40, 32768
    s_mov_b32 m0, 83968
    s_nop 0
    buffer_load_dwordx4 v5, s[12:15], s40 offen lds
    s_add_u32 s40, s40, 32768
    s_mov_b32 m0, 84992
    s_nop 0
    buffer_load_dwordx4 v5, s[12:15], s40 offen lds
    s_add_u32 s40, s40, 32768
    s_mov_b32 m0, 86016
    s_nop 0
    buffer_load_dwordx4 v4, s[12:15], s40 offen lds
    s_add_u32 s40, s40, 32768
    s_mov_b32 m0, 87040
    s_nop 0
    buffer_load_dwordx4 v4, s[12:15], s40 offen lds
    s_add_u32 s40, s40, 32768
    s_mov_b32 m0, 88064
    s_nop 0
    buffer_load_dwordx4 v5, s[12:15], s40 offen lds
    s_add_u32 s40, s40, 32768
    s_mov_b32 m0, 89088
    s_nop 0
    buffer_load_dwordx4 v5, s[12:15], s40 offen lds
    s_waitcnt vmcnt(24)
    s_barrier
    v_add_u32 v7, 32768, v7
    v_add_u32 v8, 32768, v8
    ds_read_b64_tr_b16 a[208:209], v7 offset:0
    ds_read_b64_tr_b16 a[210:211], v7 offset:1024
    ds_read_b64_tr_b16 a[212:213], v7 offset:8192
    ds_read_b64_tr_b16 a[214:215], v7 offset:9216
    ds_read_b64_tr_b16 a[216:217], v8 offset:0
    ds_read_b64_tr_b16 a[218:219], v8 offset:1024
    ds_read_b64_tr_b16 a[220:221], v8 offset:8192
    ds_read_b64_tr_b16 a[222:223], v8 offset:9216
    ds_read_b64_tr_b16 v[42:43], v7 offset:16384
    ds_read_b64_tr_b16 v[44:45], v7 offset:17408
    ds_read_b64_tr_b16 v[46:47], v7 offset:24576
    ds_read_b64_tr_b16 v[48:49], v7 offset:25600
    ds_read_b64_tr_b16 a[224:225], v8 offset:16384
    ds_read_b64_tr_b16 a[226:227], v8 offset:17408
    ds_read_b64_tr_b16 a[228:229], v8 offset:24576
    ds_read_b64_tr_b16 a[230:231], v8 offset:25600
    s_waitcnt lgkmcnt(0)
    s_barrier
    s_mov_b32 s12, s62
    s_mov_b32 s13, s63
    s_lshl_b32 s40, s20, 8
    s_add_u32 s40, s40, 2621440
    s_mov_b32 m0, 114688
    s_nop 0
    buffer_load_dwordx4 v4, s[12:15], s40 offen lds
    s_add_u32 s40, s40, 32768
    s_mov_b32 m0, 115712
    s_nop 0
    buffer_load_dwordx4 v4, s[12:15], s40 offen lds
    s_add_u32 s40, s40, 32768
    s_mov_b32 m0, 116736
    s_nop 0
    buffer_load_dwordx4 v5, s[12:15], s40 offen lds
    s_add_u32 s40, s40, 32768
    s_mov_b32 m0, 117760
    s_nop 0
    buffer_load_dwordx4 v5, s[12:15], s40 offen lds
    s_add_u32 s40, s40, 32768
    s_mov_b32 m0, 118784
    s_nop 0
    buffer_load_dwordx4 v4, s[12:15], s40 offen lds
    s_add_u32 s40, s40, 32768
    s_mov_b32 m0, 119808
    s_nop 0
    buffer_load_dwordx4 v4, s[12:15], s40 offen lds
    s_add_u32 s40, s40, 32768
    s_mov_b32 m0, 120832
    s_nop 0
    buffer_load_dwordx4 v5, s[12:15], s40 offen lds
    s_add_u32 s40, s40, 32768
    s_mov_b32 m0, 121856
    s_nop 0
    buffer_load_dwordx4 v5, s[12:15], s40 offen lds
    s_waitcnt vmcnt(24)
    s_barrier
    v_add_u32 v7, 32768, v7
    v_add_u32 v8, 32768, v8
    ds_read_b64_tr_b16 a[64:65], v7 offset:0
    ds_read_b64_tr_b16 a[66:67], v7 offset:1024
    ds_read_b64_tr_b16 a[68:69], v7 offset:8192
    ds_read_b64_tr_b16 a[70:71], v7 offset:9216
    ds_read_b64_tr_b16 a[72:73], v8 offset:0
    ds_read_b64_tr_b16 a[74:75], v8 offset:1024
    ds_read_b64_tr_b16 a[76:77], v8 offset:8192
    ds_read_b64_tr_b16 a[78:79], v8 offset:9216
    ds_read_b64_tr_b16 a[232:233], v7 offset:16384
    ds_read_b64_tr_b16 a[234:235], v7 offset:17408
    ds_read_b64_tr_b16 a[236:237], v7 offset:24576
    ds_read_b64_tr_b16 a[238:239], v7 offset:25600
    ds_read_b64_tr_b16 a[240:241], v8 offset:16384
    ds_read_b64_tr_b16 a[242:243], v8 offset:17408
    ds_read_b64_tr_b16 a[244:245], v8 offset:24576
    ds_read_b64_tr_b16 a[246:247], v8 offset:25600
    s_waitcnt lgkmcnt(0)
    s_barrier
    s_mov_b32 s12, s62
    s_mov_b32 s13, s63
    s_lshl_b32 s40, s20, 8
    s_add_u32 s40, s40, 3670016
    s_mov_b32 m0, 147456
    s_nop 0
    buffer_load_dwordx4 v4, s[12:15], s40 offen lds
    s_add_u32 s40, s40, 32768
    s_mov_b32 m0, 148480
    s_nop 0
    buffer_load_dwordx4 v4, s[12:15], s40 offen lds
    s_add_u32 s40, s40, 32768
    s_mov_b32 m0, 149504
    s_nop 0
    buffer_load_dwordx4 v5, s[12:15], s40 offen lds
    s_add_u32 s40, s40, 32768
    s_mov_b32 m0, 150528
    s_nop 0
    buffer_load_dwordx4 v5, s[12:15], s40 offen lds
    s_add_u32 s40, s40, 32768
    s_mov_b32 m0, 151552
    s_nop 0
    buffer_load_dwordx4 v4, s[12:15], s40 offen lds
    s_add_u32 s40, s40, 32768
    s_mov_b32 m0, 152576
    s_nop 0
    buffer_load_dwordx4 v4, s[12:15], s40 offen lds
    s_add_u32 s40, s40, 32768
    s_mov_b32 m0, 153600
    s_nop 0
    buffer_load_dwordx4 v5, s[12:15], s40 offen lds
    s_add_u32 s40, s40, 32768
    s_mov_b32 m0, 154624
    s_nop 0
    buffer_load_dwordx4 v5, s[12:15], s40 offen lds
    buffer_load_dword v1, off, s[16:19], 0 offset:4 sc1
    s_waitcnt vmcnt(25)
    s_barrier
    v_add_u32 v7, 4294868992, v7
    v_add_u32 v8, 4294868992, v8
    ds_read_b64_tr_b16 a[16:17], v7 offset:0
    ds_read_b64_tr_b16 a[18:19], v7 offset:1024
    ds_read_b64_tr_b16 a[20:21], v7 offset:8192
    ds_read_b64_tr_b16 a[22:23], v7 offset:9216
    ds_read_b64_tr_b16 a[24:25], v8 offset:0
    ds_read_b64_tr_b16 a[26:27], v8 offset:1024
    ds_read_b64_tr_b16 a[28:29], v8 offset:8192
    ds_read_b64_tr_b16 a[30:31], v8 offset:9216
    ds_read_b64_tr_b16 a[176:177], v7 offset:16384
    ds_read_b64_tr_b16 a[178:179], v7 offset:17408
    ds_read_b64_tr_b16 a[180:181], v7 offset:24576
    ds_read_b64_tr_b16 a[182:183], v7 offset:25600
    ds_read_b64_tr_b16 a[184:185], v8 offset:16384
    ds_read_b64_tr_b16 a[186:187], v8 offset:17408
    ds_read_b64_tr_b16 a[188:189], v8 offset:24576
    ds_read_b64_tr_b16 a[190:191], v8 offset:25600
    s_waitcnt lgkmcnt(0)
    s_barrier
    s_mov_b32 s12, s60
    s_mov_b32 s13, s61
    s_lshl_b32 s40, s20, 8
    s_add_u32 s40, s40, 524288
    s_mov_b32 m0, 49152
    s_nop 0
    buffer_load_dwordx4 v4, s[12:15], s40 offen lds
    s_add_u32 s40, s40, 32768
    s_mov_b32 m0, 50176
    s_nop 0
    buffer_load_dwordx4 v4, s[12:15], s40 offen lds
    s_add_u32 s40, s40, 32768
    s_mov_b32 m0, 51200
    s_nop 0
    buffer_load_dwordx4 v5, s[12:15], s40 offen lds
    s_add_u32 s40, s40, 32768
    s_mov_b32 m0, 52224
    s_nop 0
    buffer_load_dwordx4 v5, s[12:15], s40 offen lds
    s_add_u32 s40, s40, 32768
    s_mov_b32 m0, 53248
    s_nop 0
    buffer_load_dwordx4 v4, s[12:15], s40 offen lds
    s_add_u32 s40, s40, 32768
    s_mov_b32 m0, 54272
    s_nop 0
    buffer_load_dwordx4 v4, s[12:15], s40 offen lds
    s_add_u32 s40, s40, 32768
    s_mov_b32 m0, 55296
    s_nop 0
    buffer_load_dwordx4 v5, s[12:15], s40 offen lds
    s_add_u32 s40, s40, 32768
    s_mov_b32 m0, 56320
    s_nop 0
    buffer_load_dwordx4 v5, s[12:15], s40 offen lds
    s_waitcnt vmcnt(25)
    s_barrier
    v_add_u32 v7, 32768, v7
    v_add_u32 v8, 32768, v8
    ds_read_b64_tr_b16 v[50:51], v7 offset:0
    ds_read_b64_tr_b16 v[52:53], v7 offset:1024
    ds_read_b64_tr_b16 v[54:55], v7 offset:8192
    ds_read_b64_tr_b16 v[56:57], v7 offset:9216
    ds_read_b64_tr_b16 a[192:193], v8 offset:0
    ds_read_b64_tr_b16 a[194:195], v8 offset:1024
    ds_read_b64_tr_b16 a[196:197], v8 offset:8192
    ds_read_b64_tr_b16 a[198:199], v8 offset:9216
    ds_read_b64_tr_b16 a[200:201], v7 offset:16384
    ds_read_b64_tr_b16 a[202:203], v7 offset:17408
    ds_read_b64_tr_b16 a[204:205], v7 offset:24576
    ds_read_b64_tr_b16 a[206:207], v7 offset:25600
    ds_read_b64_tr_b16 v[58:59], v8 offset:16384
    ds_read_b64_tr_b16 v[60:61], v8 offset:17408
    ds_read_b64_tr_b16 v[62:63], v8 offset:24576
    ds_read_b64_tr_b16 v[64:65], v8 offset:25600
    s_waitcnt lgkmcnt(0)
    s_barrier
    s_mov_b32 s12, s60
    s_mov_b32 s13, s61
    s_lshl_b32 s40, s20, 8
    s_add_u32 s40, s40, 1572864
    s_mov_b32 m0, 81920
    s_nop 0
    buffer_load_dwordx4 v4, s[12:15], s40 offen lds
    s_add_u32 s40, s40, 32768
    s_mov_b32 m0, 82944
    s_nop 0
    buffer_load_dwordx4 v4, s[12:15], s40 offen lds
    s_add_u32 s40, s40, 32768
    s_mov_b32 m0, 83968
    s_nop 0
    buffer_load_dwordx4 v5, s[12:15], s40 offen lds
    s_add_u32 s40, s40, 32768
    s_mov_b32 m0, 84992
    s_nop 0
    buffer_load_dwordx4 v5, s[12:15], s40 offen lds
    s_add_u32 s40, s40, 32768
    s_mov_b32 m0, 86016
    s_nop 0
    buffer_load_dwordx4 v4, s[12:15], s40 offen lds
    s_add_u32 s40, s40, 32768
    s_mov_b32 m0, 87040
    s_nop 0
    buffer_load_dwordx4 v4, s[12:15], s40 offen lds
    s_add_u32 s40, s40, 32768
    s_mov_b32 m0, 88064
    s_nop 0
    buffer_load_dwordx4 v5, s[12:15], s40 offen lds
    s_add_u32 s40, s40, 32768
    s_mov_b32 m0, 89088
    s_nop 0
    buffer_load_dwordx4 v5, s[12:15], s40 offen lds
    s_waitcnt vmcnt(25)
    s_barrier
    v_add_u32 v7, 32768, v7
    v_add_u32 v8, 32768, v8
    ds_read_b64_tr_b16 a[144:145], v7 offset:0
    ds_read_b64_tr_b16 a[146:147], v7 offset:1024
    ds_read_b64_tr_b16 a[148:149], v7 offset:8192
    ds_read_b64_tr_b16 a[150:151], v7 offset:9216
    ds_read_b64_tr_b16 v[66:67], v8 offset:0
    ds_read_b64_tr_b16 v[68:69], v8 offset:1024
    ds_read_b64_tr_b16 v[70:71], v8 offset:8192
    ds_read_b64_tr_b16 v[72:73], v8 offset:9216
    ds_read_b64_tr_b16 a[152:153], v7 offset:16384
    ds_read_b64_tr_b16 a[154:155], v7 offset:17408
    ds_read_b64_tr_b16 a[156:157], v7 offset:24576
    ds_read_b64_tr_b16 a[158:159], v7 offset:25600
    ds_read_b64_tr_b16 a[160:161], v8 offset:16384
    ds_read_b64_tr_b16 a[162:163], v8 offset:17408
    ds_read_b64_tr_b16 a[164:165], v8 offset:24576
    ds_read_b64_tr_b16 a[166:167], v8 offset:25600
    s_waitcnt lgkmcnt(0)
    s_barrier
    s_mov_b32 s12, s60
    s_mov_b32 s13, s61
    s_lshl_b32 s40, s20, 8
    s_add_u32 s40, s40, 2621440
    s_mov_b32 m0, 114688
    s_nop 0
    buffer_load_dwordx4 v4, s[12:15], s40 offen lds
    s_add_u32 s40, s40, 32768
    s_mov_b32 m0, 115712
    s_nop 0
    buffer_load_dwordx4 v4, s[12:15], s40 offen lds
    s_add_u32 s40, s40, 32768
    s_mov_b32 m0, 116736
    s_nop 0
    buffer_load_dwordx4 v5, s[12:15], s40 offen lds
    s_add_u32 s40, s40, 32768
    s_mov_b32 m0, 117760
    s_nop 0
    buffer_load_dwordx4 v5, s[12:15], s40 offen lds
    s_add_u32 s40, s40, 32768
    s_mov_b32 m0, 118784
    s_nop 0
    buffer_load_dwordx4 v4, s[12:15], s40 offen lds
    s_add_u32 s40, s40, 32768
    s_mov_b32 m0, 119808
    s_nop 0
    buffer_load_dwordx4 v4, s[12:15], s40 offen lds
    s_add_u32 s40, s40, 32768
    s_mov_b32 m0, 120832
    s_nop 0
    buffer_load_dwordx4 v5, s[12:15], s40 offen lds
    s_add_u32 s40, s40, 32768
    s_mov_b32 m0, 121856
    s_nop 0
    buffer_load_dwordx4 v5, s[12:15], s40 offen lds
    s_waitcnt vmcnt(25)
    s_barrier
    v_add_u32 v7, 32768, v7
    v_add_u32 v8, 32768, v8
    ds_read_b64_tr_b16 v[74:75], v7 offset:0
    ds_read_b64_tr_b16 v[76:77], v7 offset:1024
    ds_read_b64_tr_b16 v[78:79], v7 offset:8192
    ds_read_b64_tr_b16 v[80:81], v7 offset:9216
    ds_read_b64_tr_b16 a[56:57], v8 offset:0
    ds_read_b64_tr_b16 a[58:59], v8 offset:1024
    ds_read_b64_tr_b16 a[60:61], v8 offset:8192
    ds_read_b64_tr_b16 a[62:63], v8 offset:9216
    ds_read_b64_tr_b16 v[106:107], v7 offset:16384
    ds_read_b64_tr_b16 v[108:109], v7 offset:17408
    ds_read_b64_tr_b16 v[110:111], v7 offset:24576
    ds_read_b64_tr_b16 v[112:113], v7 offset:25600
    ds_read_b64_tr_b16 a[168:169], v8 offset:16384
    ds_read_b64_tr_b16 a[170:171], v8 offset:17408
    ds_read_b64_tr_b16 a[172:173], v8 offset:24576
    ds_read_b64_tr_b16 a[174:175], v8 offset:25600
    s_waitcnt lgkmcnt(0)
    s_barrier
    s_mov_b32 s12, s60
    s_mov_b32 s13, s61
    s_lshl_b32 s40, s20, 8
    s_add_u32 s40, s40, 3670016
    s_mov_b32 m0, 147456
    s_nop 0
    buffer_load_dwordx4 v4, s[12:15], s40 offen lds
    s_add_u32 s40, s40, 32768
    s_mov_b32 m0, 148480
    s_nop 0
    buffer_load_dwordx4 v4, s[12:15], s40 offen lds
    s_add_u32 s40, s40, 32768
    s_mov_b32 m0, 149504
    s_nop 0
    buffer_load_dwordx4 v5, s[12:15], s40 offen lds
    s_add_u32 s40, s40, 32768
    s_mov_b32 m0, 150528
    s_nop 0
    buffer_load_dwordx4 v5, s[12:15], s40 offen lds
    s_add_u32 s40, s40, 32768
    s_mov_b32 m0, 151552
    s_nop 0
    buffer_load_dwordx4 v4, s[12:15], s40 offen lds
    s_add_u32 s40, s40, 32768
    s_mov_b32 m0, 152576
    s_nop 0
    buffer_load_dwordx4 v4, s[12:15], s40 offen lds
    s_add_u32 s40, s40, 32768
    s_mov_b32 m0, 153600
    s_nop 0
    buffer_load_dwordx4 v5, s[12:15], s40 offen lds
    s_add_u32 s40, s40, 32768
    s_mov_b32 m0, 154624
    s_nop 0
    buffer_load_dwordx4 v5, s[12:15], s40 offen lds
    s_waitcnt vmcnt(24)
    s_barrier
    v_add_u32 v7, 4294868992, v7
    v_add_u32 v8, 4294868992, v8
    ds_read_b64_tr_b16 a[0:1], v7 offset:0
    ds_read_b64_tr_b16 a[2:3], v7 offset:1024
    ds_read_b64_tr_b16 a[4:5], v7 offset:8192
    ds_read_b64_tr_b16 a[6:7], v7 offset:9216
    ds_read_b64_tr_b16 a[8:9], v8 offset:0
    ds_read_b64_tr_b16 a[10:11], v8 offset:1024
    ds_read_b64_tr_b16 a[12:13], v8 offset:8192
    ds_read_b64_tr_b16 a[14:15], v8 offset:9216
    ds_read_b64_tr_b16 v[114:115], v7 offset:16384
    ds_read_b64_tr_b16 v[116:117], v7 offset:17408
    ds_read_b64_tr_b16 v[118:119], v7 offset:24576
    ds_read_b64_tr_b16 v[120:121], v7 offset:25600
    ds_read_b64_tr_b16 a[112:113], v8 offset:16384
    ds_read_b64_tr_b16 a[114:115], v8 offset:17408
    ds_read_b64_tr_b16 a[116:117], v8 offset:24576
    ds_read_b64_tr_b16 a[118:119], v8 offset:25600
    s_waitcnt lgkmcnt(0)
    s_barrier
    v_add_u32 v13, 36864, v6
    ds_write_b128 v13, v[90:93]
    ds_write_b128 v13, v[94:97] offset:1024
    v_add_u32 v13, 45056, v6
    ds_write_b128 v13, v[82:85]
    ds_write_b128 v13, v[86:89] offset:1024
    v_add_u32 v13, 53248, v6
    ds_write_b128 v13, v[98:101]
    ds_write_b128 v13, v[102:105] offset:1024
    v_add_u32 v13, 61440, v6
    ds_write_b128 v13, v[18:21]
    ds_write_b128 v13, v[22:25] offset:1024
    v_readfirstlane_b32 s74, v1
    s_and_b32 s40, s74, 0xffff
    s_cmp_eq_u32 s40, 8224
    s_cbranch_scc1 L_c2_rdy
    s_nop 1
L_c2_rdyl:
    buffer_load_dword v1, off, s[16:19], 0 offset:4 sc1
    s_sub_u32 s22, s22, 1
    s_cbranch_scc1 L_exit
    s_waitcnt vmcnt(0)
    v_readfirstlane_b32 s74, v1
    s_and_b32 s40, s74, 0xffff
    s_cmp_lg_u32 s40, 8224
    s_cbranch_scc1 L_c2_rdyl
    s_nop 1
L_c2_rdy:
    s_waitcnt vmcnt(16)
    s_barrier
    v_add_u32 v7, 32768, v7
    v_add_u32 v8, 32768, v8
    ds_read_b64_tr_b16 a[120:121], v7 offset:0
    ds_read_b64_tr_b16 a[122:123], v7 offset:1024
    ds_read_b64_tr_b16 a[124:125], v7 offset:8192
    ds_read_b64_tr_b16 a[126:127], v7 offset:9216
    ds_read_b64_tr_b16 a[128:129], v8 offset:0
    ds_read_b64_tr_b16 a[130:131], v8 offset:1024
    ds_read_b64_tr_b16 a[132:133], v8 offset:8192
    ds_read_b64_tr_b16 a[134:135], v8 offset:9216
    ds_read_b64_tr_b16 v[18:19], v7 offset:16384
    ds_read_b64_tr_b16 v[20:21], v7 offset:17408
    ds_read_b64_tr_b16 v[22:23], v7 offset:24576
    ds_read_b64_tr_b16 v[24:25], v7 offset:25600
    ds_read_b64_tr_b16 a[136:137], v8 offset:16384
    ds_read_b64_tr_b16 a[138:139], v8 offset:17408
    ds_read_b64_tr_b16 a[140:141], v8 offset:24576
    ds_read_b64_tr_b16 a[142:143], v8 offset:25600
    s_waitcnt lgkmcnt(0)
    s_barrier
    v_add_u32 v13, 69632, v6
    ds_write_b128 v13, v[26:29]
    ds_write_b128 v13, v[30:33] offset:1024
    v_add_u32 v13, 77824, v6
    ds_write_b128 v13, v[34:37]
    ds_write_b128 v13, v[38:41] offset:1024
    v_add_u32 v13, 86016, v6
    ds_write_b128 v13, v[42:45]
    ds_write_b128 v13, v[46:49] offset:1024
    v_add_u32 v13, 94208, v6
    ds_write_b128 v13, v[50:53]
    ds_write_b128 v13, v[54:57] offset:1024
    v_and_b32 v14, 1, v10
    v_lshlrev_b32 v14, 20, v14
    v_add_u32 v14, s37, v14
    buffer_load_dword v1, v14, s[8:11], 0 offen sc1
    s_waitcnt vmcnt(9)
    s_barrier
    v_add_u32 v7, 32768, v7
    v_add_u32 v8, 32768, v8
    ds_read_b64_tr_b16 v[26:27], v7 offset:0
    ds_read_b64_tr_b16 v[28:29], v7 offset:1024
    ds_read_b64_tr_b16 v[30:31], v7 offset:8192
    ds_read_b64_tr_b16 v[32:33], v7 offset:9216
    ds_read_b64_tr_b16 a[80:81], v8 offset:0
    ds_read_b64_tr_b16 a[82:83], v8 offset:1024
    ds_read_b64_tr_b16 a[84:85], v8 offset:8192
    ds_read_b64_tr_b16 a[86:87], v8 offset:9216
    ds_read_b64_tr_b16 a[88:89], v7 offset:16384
    ds_read_b64_tr_b16 a[90:91], v7 offset:17408
    ds_read_b64_tr_b16 a[92:93], v7 offset:24576
    ds_read_b64_tr_b16 a[94:95], v7 offset:25600
    ds_read_b64_tr_b16 v[34:35], v8 offset:16384
    ds_read_b64_tr_b16 v[36:37], v8 offset:17408
    ds_read_b64_tr_b16 v[38:39], v8 offset:24576
    ds_read_b64_tr_b16 v[40:41], v8 offset:25600
    s_waitcnt lgkmcnt(0)
    s_barrier
    v_add_u32 v13, 102400, v6
    ds_write_b128 v13, v[58:61]
    ds_write_b128 v13, v[62:65] offset:1024
    v_add_u32 v13, 110592, v6
    ds_write_b128 v13, v[66:69]
    ds_write_b128 v13, v[70:73] offset:1024
    v_add_u32 v13, 118784, v6
    ds_write_b128 v13, v[74:77]
    ds_write_b128 v13, v[78:81] offset:1024
    v_add_u32 v13, 126976, v6
    ds_write_b128 v13, v[106:109]
    ds_write_b128 v13, v[110:113] offset:1024
    s_waitcnt vmcnt(1)
    s_barrier
    v_add_u32 v7, 32768, v7
    v_add_u32 v8, 32768, v8
    ds_read_b64_tr_b16 a[40:41], v7 offset:0
    ds_read_b64_tr_b16 a[42:43], v7 offset:1024
    ds_read_b64_tr_b16 a[44:45], v7 offset:8192
    ds_read_b64_tr_b16 a[46:47], v7 offset:9216
    ds_read_b64_tr_b16 a[48:49], v8 offset:0
    ds_read_b64_tr_b16 a[50:51], v8 offset:1024
    ds_read_b64_tr_b16 a[52:53], v8 offset:8192
    ds_read_b64_tr_b16 a[54:55], v8 offset:9216
    ds_read_b64_tr_b16 a[96:97], v7 offset:16384
    ds_read_b64_tr_b16 a[98:99], v7 offset:17408
    ds_read_b64_tr_b16 a[100:101], v7 offset:24576
    ds_read_b64_tr_b16 a[102:103], v7 offset:25600
    ds_read_b64_tr_b16 a[104:105], v8 offset:16384
    ds_read_b64_tr_b16 a[106:107], v8 offset:17408
    ds_read_b64_tr_b16 a[108:109], v8 offset:24576
    ds_read_b64_tr_b16 a[110:111], v8 offset:25600
    s_waitcnt lgkmcnt(0)
    s_barrier
    v_add_u32 v13, 135168, v6
    ds_write_b128 v13, v[114:117]
    ds_write_b128 v13, v[118:121] offset:1024
    v_add_u32 v13, 143360, v6
    ds_write_b128 v13, v[18:21]
    ds_write_b128 v13, v[22:25] offset:1024
    v_add_u32 v13, 151552, v6
    ds_write_b128 v13, v[26:29]
    ds_write_b128 v13, v[30:33] offset:1024
    v_add_u32 v13, 159744, v6
    ds_write_b128 v13, v[34:37]
    ds_write_b128 v13, v[38:41] offset:1024
    s_waitcnt vmcnt(0)
    v_cmp_eq_u32 vcc, -1, v1
    s_cbranch_vccz L_c2_kv
    s_nop 3
L_c2_kvl:
    buffer_load_dword v1, v14, s[8:11], 0 offen sc1
    s_sub_u32 s22, s22, 1
    s_cbranch_scc1 L_exit
    s_waitcnt vmcnt(0)
    v_cmp_eq_u32 vcc, -1, v1
    s_cbranch_vccnz L_c2_kvl
    s_nop 3
L_c2_kv:
    s_lshl_b32 s34, s20, 12
    s_add_u32 s34, s34, 16779264
    s_add_u32 s72, s34, 0x40000
    v_add_u32 v14, 0x20000, v6
    s_lshl_b32 s29, s20, 13
    s_add_u32 s29, s29, 4096
    s_waitcnt lgkmcnt(0)
    buffer_load_dwordx4 v[80:83], v6, s[8:11], s34 offen sc1
    buffer_load_dwordx4 v[84:87], v14, s[8:11], s34 offen sc1
    buffer_load_dwordx4 v[88:91], v6, s[8:11], s72 offen sc1
    buffer_load_dwordx4 v[92:95], v14, s[8:11], s72 offen sc1
    buffer_load_dwordx4 v[96:99], v6, s[8:11], s29 offen offset:0 sc1
    buffer_load_dwordx4 v[100:103], v6, s[8:11], s29 offen offset:1024 sc1
    s_lshl_b32 s36, s20, 6
    s_add_u32 s36, s36, 4096
    v_mbcnt_lo_u32_b32 v141, -1, 0
    v_mbcnt_hi_u32_b32 v141, -1, v141
    v_and_b32 v106, 15, v141
    v_lshrrev_b32 v107, 4, v141
    v_lshrrev_b32 v108, 2, v106
    v_bfe_u32 v109, v106, 1, 1
    v_and_b32 v123, 1, v106
    v_lshl_add_u32 v122, v108, 1, v123
    s_mov_b32 s24, 0xcccccccc
    s_mov_b32 s25, 0xcccccccc
    s_mov_b32 s26, 0x33333333
    s_mov_b32 s27, 0x33333333
    s_mov_b32 s70, 0x3f803f80
    s_mov_b32 s71, 0x3f803f80
    v_lshlrev_b32 v127, 4, v141
    v_add_u32 v128, 0x10000, v127
    v_add_u32 v129, 0x20000, v127
    v_mov_b32 v126, 0x4444
    v_mov_b32 v124, 0xeeee
    v_cndmask_b32 v126, v126, v124, s[24:25]
    v_lshlrev_b32 v123, 4, v123
    v_mov_b32 v124, 0x3f80
    v_lshlrev_b32 v124, v123, v124
    v_cndmask_b32 v124, v124, 0, s[24:25]
    v_cmp_eq_u32 vcc, 0, v108
    s_nop 1
    v_cndmask_b32 v114, 0, v124, vcc
    v_cmp_eq_u32 vcc, 1, v108
    s_nop 1
    v_cndmask_b32 v115, 0, v124, vcc
    v_cmp_eq_u32 vcc, 2, v108
    s_nop 1
    v_cndmask_b32 v116, 0, v124, vcc
    v_cmp_eq_u32 vcc, 3, v108
    s_nop 1
    v_cndmask_b32 v117, 0, v124, vcc
    ds_write_b128 v127, v[114:117] offset:13312
    v_mov_b32 v118, 0
    v_mov_b32 v119, 0
    v_mov_b32 v120, 0
    v_mov_b32 v121, 0
    v_mov_b32 v123, 12800
    ds_write_b128 v123, v[118:121]
    v_lshrrev_b32 v123, 3, v106
    v_lshlrev_b32 v123, 15, v123
    v_lshl_add_u32 v123, v107, 13, v123
    v_and_b32 v124, 7, v106
    v_lshl_add_u32 v123, v124, 3, v123
    v_lshrrev_b32 v124, 11, v123
    v_add_u32 v124, s20, v124
    v_add_u32 v124, 4, v124
    v_and_b32 v124, 31, v124
    v_lshl_add_u32 v123, v124, 6, v123
    v_add_u32 v130, 131072, v123
    s_mov_b32 s69, 4096
    v_and_b32 v124, 3, v106
    v_lshlrev_b32 v123, 4, v107
    v_lshl_add_u32 v123, v124, 2, v123
    v_add_u32 v123, s36, v123
    v_mov_b32 v124, 0x40000000
    v_cmp_gt_u32 vcc, 4, v106
    s_nop 1
    v_cndmask_b32 v131, v124, v123, vcc
    s_lshl_b32 s40, s20, 8
    v_add_u32 v123, s40, v127
    v_cmp_gt_u32 vcc, 16, v141
    s_nop 1
    v_cndmask_b32 v137, v124, v123, vcc
    s_lshl_b32 s35, s20, 4
    s_add_u32 s35, s35, 262144
    v_xor_b32 v125, v107, v108
    v_lshlrev_b32 v125, 3, v125
    v_lshl_add_u32 v143, v106, 5, v125
    v_lshlrev_b32 v125, 3, v141
    v_lshlrev_b32 v123, 3, v107
    v_xor_b32 v140, v125, v123
    v_lshrrev_b32 v125, 1, v107
    v_lshl_add_u32 v125, v122, 2, v125
    v_lshlrev_b32 v125, 4, v125
    v_and_b32 v123, 1, v107
    v_lshl_add_u32 v125, v123, 2, v125
    v_lshl_add_u32 v125, v109, 1, v125
    v_add_u32 v132, 12296, v125
    v_lshl_add_u32 v123, v122, 2, v107
    v_lshlrev_b32 v123, 4, v123
    v_add_u32 v123, 12288, v123
    v_mov_b32 v124, 12800
    v_cndmask_b32 v133, v123, v124, s[24:25]
    v_cndmask_b32 v134, v124, v123, s[24:25]
    v_mul_u32_u24 v123, 288, v122
    v_lshl_add_u32 v124, v109, 5, v123
    v_lshl_add_u32 v135, v107, 3, v124
    v_lshl_add_u32 v136, v107, 4, v123
    v_lshlrev_b32 v124, 7, v141
    v_mov_b32 v125, 0x40000000
    v_cmp_gt_u32 vcc, 0, v141
    s_nop 1
    v_cndmask_b32 v124, v125, v124, vcc
    s_add_u32 s40, s36, 18612224
    s_sub_u32 s40, s40, s34
    v_mov_b32 v125, s40
    v_cmp_gt_u32 vcc, 32, v141
    s_nop 1
    v_cndmask_b32 v124, v125, v124, vcc
    s_add_u32 s40, s37, 1048576
    s_sub_u32 s40, s40, s34
    v_mov_b32 v125, s40
    v_cmp_gt_u32 vcc, 33, v141
    s_nop 1
    v_cndmask_b32 v124, v125, v124, vcc
    v_mov_b32 v125, 0x40000000
    v_cmp_gt_u32 vcc, 33, v141
    s_nop 1
    v_cndmask_b32 v139, v125, v124, vcc
    buffer_load_dword v138, v139, s[8:11], s34 offen sc1
    s_mov_b32 s30, 17563648
    s_mov_b32 s68, 17569792
    s_mov_b32 s32, 17563648
    s_mov_b32 s33, 17571840
    s_mov_b32 s28, 0
    s_mov_b32 s38, 0
    s_mov_b32 s39, 1040356334
    s_mov_b32 s44, 729808896
    s_mov_b32 s45, 671088640
    s_mov_b32 s31, 262144
    s_lshr_b32 s5, s74, 16
    s_cmp_eq_u32 s5, 0
    s_cbranch_scc0 L_chain_slow2
    s_add_u32 s34, s34, 1048576
    s_add_u32 s72, s72, 1048576
    s_add_u32 s37, s37, 1048576
    s_mov_b32 s43, 1
    s_mov_b32 s28, 1
    ds_read_b128 v[32:35], v127 offset:61440
    ds_read_b128 v[36:39], v127 offset:62464
    ds_read_b128 v[40:43], v128 offset:53248
    ds_read_b128 v[44:47], v128 offset:54272
    v_mov_b64 v[56:57], 0
    v_mov_b64 v[58:59], 0
    v_mov_b64 v[60:61], 0
    v_mov_b64 v[62:63], 0
    v_mov_b64 v[64:65], 0
    v_mov_b64 v[66:67], 0
    v_mov_b64 v[68:69], 0
    v_mov_b64 v[70:71], 0
    v_mov_b64 v[72:73], 0
    v_mov_b64 v[74:75], 0
    v_mov_b64 v[76:77], 0
    v_mov_b64 v[78:79], 0
    v_mov_b32 v142, s43
    s_waitcnt lgkmcnt(0)
    buffer_load_dwordx4 v[0:3], v127, s[8:11], s30 offen sc1
    buffer_load_dwordx4 v[24:27], v127, s[8:11], s68 offen sc1
    s_branch LF2_bAw
.p2align 6
LF2_pollP:
    s_waitcnt vmcnt(1)
    v_mfma_f32_16x16x32_bf16 v[110:113], v[122:125], v[0:3], 0
    v_bitop3_b32 v141, v0, s28, 1 bitop3:0x28
    s_waitcnt vmcnt(0)
    v_mfma_f32_16x16x32_bf16 v[110:113], v[122:125], v[4:7], v[110:113]
    v_bitop3_b32 v141, v4, s28, v141 bitop3:0x28
    v_cmp_ne_u32 vcc, 1, v141
    s_nop 2
    s_cbranch_vccnz LF2_retryP
LF2_Pok:
    s_nop 0
    v_add_f32_dpp v110, v110, v110 row_ror:4 row_mask:0xf bank_mask:0xf
    v_add_f32_dpp v111, v111, v111 row_ror:4 row_mask:0xf bank_mask:0xf
    s_cmp_ge_u32 s38, 63
    v_add_f32_dpp v110, v110, v110 row_ror:8 row_mask:0xf bank_mask:0xf
    v_add_f32_dpp v111, v111, v111 row_ror:8 row_mask:0xf bank_mask:0xf
    v_cvt_pk_bf16_f32 v112, v110, v111
LF2_Mst:
    buffer_store_dword v112, v131, s[8:11], s32 offen
    s_cbranch_scc1 LF2_done
    s_add_u32 s72, s72, 1048576
    ds_read_b128 v[32:35], v127 offset:61440
    ds_read_b128 v[36:39], v127 offset:62464
    ds_read_b128 v[40:43], v128 offset:53248
    ds_read_b128 v[44:47], v128 offset:54272
    s_waitcnt lgkmcnt(0)
    buffer_load_dwordx4 v[0:3], v127, s[8:11], s30 offen sc1
    s_waitcnt vmcnt(1)
    s_nop 15
    buffer_load_dwordx4 v[24:27], v127, s[8:11], s68 offen sc1
LF2_bAw:
    s_waitcnt vmcnt(1)
LF2_bA:
    v_smfmac_f32_16x16x64_bf16 v[56:59], v[0:3], a[0:7], v126
    v_cmp_eq_u32 vcc, -1, v0
    v_smfmac_f32_16x16x64_bf16 v[60:63], v[0:3], a[8:15], v126
    v_smfmac_f32_16x16x64_bf16 v[64:67], v[0:3], a[16:23], v126
    s_cbranch_vccnz LF2_retryE
    v_smfmac_f32_16x16x64_bf16 v[68:71], v[0:3], a[24:31], v126
    v_smfmac_f32_16x16x64_bf16 v[72:75], v[0:3], a[32:39], v126
    v_smfmac_f32_16x16x64_bf16 v[76:79], v[0:3], v[32:39], v126
    ds_read_b128 v[36:39], v129 offset:21504
    ds_write_b128 v127, v[0:3] offset:0
    v_mov_b64 v[122:123], s[70:71]
    v_mov_b64 v[124:125], s[70:71]
    v_mov_b64 v[2:3], 0
    s_waitcnt vmcnt(0)
    v_cmp_eq_u32 vcc, -1, v24
    ds_write_b128 v127, v[24:27] offset:6144
    s_cbranch_vccnz LF2_retryL
LF2_Lok:
    v_smfmac_f32_16x16x64_bf16 v[56:59], v[24:27], a[40:47], v126
    v_smfmac_f32_16x16x64_bf16 v[60:63], v[24:27], a[48:55], v126
    ds_read_b128 v[32:35], v129 offset:20480
    v_smfmac_f32_16x16x64_bf16 v[64:67], v[24:27], v[40:47], v126
    s_waitcnt lgkmcnt(2)
    s_waitcnt lgkmcnt(1)
    s_barrier
    v_smfmac_f32_16x16x64_bf16 v[68:71], v[24:27], a[56:63], v126
    ds_read_b128 v[16:19], v127 offset:4096
    ds_read_b128 v[44:47], v129 offset:29696
    v_smfmac_f32_16x16x64_bf16 v[72:75], v[24:27], a[64:71], v126
    ds_read_b128 v[20:23], v127 offset:5120
    ds_read_b128 v[40:43], v129 offset:28672
    v_smfmac_f32_16x16x64_bf16 v[76:79], v[24:27], a[72:79], v126
    buffer_load_dwordx4 v[96:99], v127, s[8:11], s72 offen sc1
    ds_read_b128 v[28:31], v127 offset:7168
    s_waitcnt lgkmcnt(4)
    v_smfmac_f32_16x16x64_bf16 v[56:59], v[16:19], v[32:39], v126
    ds_read_b128 v[32:35], v129 offset:4096
    v_smfmac_f32_16x16x64_bf16 v[60:63], v[16:19], a[80:87], v126
    ds_read_b128 v[36:39], v129 offset:5120
    ds_read_b128 v[4:7], v127 offset:1024
    s_waitcnt lgkmcnt(5)
    v_smfmac_f32_16x16x64_bf16 v[56:59], v[20:23], a[88:95], v126
    buffer_load_dwordx4 v[100:103], v129, s[8:11], s72 offen sc1
    s_waitcnt lgkmcnt(4)
    v_smfmac_f32_16x16x64_bf16 v[60:63], v[20:23], v[40:47], v126
    ds_read_b128 v[114:117], v137 offset:0
    ds_read_b128 v[44:47], v129 offset:13312
    s_waitcnt lgkmcnt(5)
    v_smfmac_f32_16x16x64_bf16 v[56:59], v[28:31], a[96:103], v126
    buffer_load_dword v138, v139, s[8:11], s34 offen sc1
    ds_read_b128 v[8:11], v127 offset:2048
    v_smfmac_f32_16x16x64_bf16 v[60:63], v[28:31], a[104:111], v126
    ds_read_b128 v[12:15], v127 offset:3072
    ds_read_b128 v[40:43], v129 offset:12288
    s_waitcnt lgkmcnt(5)
    v_smfmac_f32_16x16x64_bf16 v[56:59], v[4:7], v[32:39], v126
    s_waitcnt lgkmcnt(4)
    buffer_store_dwordx4 v[114:117], v137, s[8:11], s33 offen sc1
    v_smfmac_f32_16x16x64_bf16 v[60:63], v[4:7], a[112:119], v126
    ds_read_b128 v[32:35], v128 offset:45056
    v_mov_b64 v[0:1], 0
    s_waitcnt lgkmcnt(3)
    v_smfmac_f32_16x16x64_bf16 v[56:59], v[8:11], a[120:127], v126
    buffer_load_dwordx4 v[48:51], v127, s[8:11], s34 offen sc1
    v_smfmac_f32_16x16x64_bf16 v[60:63], v[8:11], a[128:135], v126
    ds_read_b128 v[36:39], v128 offset:46080
    s_waitcnt lgkmcnt(2)
    v_smfmac_f32_16x16x64_bf16 v[56:59], v[12:15], v[40:47], v126
    ds_read_b128 v[40:43], v128 offset:61440
    v_smfmac_f32_16x16x64_bf16 v[60:63], v[12:15], a[136:143], v126
    ds_read_b128 v[44:47], v128 offset:62464
    v_smfmac_f32_16x16x64_bf16 v[64:67], v[16:19], a[144:151], v126
    buffer_load_dwordx4 v[52:55], v129, s[8:11], s34 offen sc1
    s_waitcnt lgkmcnt(2)
    v_smfmac_f32_16x16x64_bf16 v[68:71], v[16:19], v[32:39], v126
    ds_read_b128 v[36:39], v128 offset:29696
    v_add_f32 v57, v57, v59
    v_add_f32 v56, v56, v58
    v_smfmac_f32_16x16x64_bf16 v[64:67], v[20:23], a[152:159], v126
    ds_read_b128 v[32:35], v128 offset:28672
    v_add_f32 v61, v61, v63
    v_cvt_pk_bf16_f32 v56, v56, v57
    v_add_f32 v60, v60, v62
    v_cvt_pk_bf16_f32 v57, v60, v61
    v_smfmac_f32_16x16x64_bf16 v[68:71], v[20:23], a[160:167], v126
    ds_write_b64 v143, v[56:57] offset:9216
    s_waitcnt lgkmcnt(3)
    v_smfmac_f32_16x16x64_bf16 v[64:67], v[28:31], v[40:47], v126
    ds_read_b128 v[44:47], v128 offset:37888
    v_smfmac_f32_16x16x64_bf16 v[68:71], v[28:31], a[168:175], v126
    ds_read_b128 v[40:43], v128 offset:36864
    v_smfmac_f32_16x16x64_bf16 v[64:67], v[4:7], a[176:183], v126
    s_waitcnt lgkmcnt(2)
    s_barrier
    v_smfmac_f32_16x16x64_bf16 v[68:71], v[4:7], a[184:191], v126
    ds_read_b64_tr_b16 v[56:57], v140 offset:8192
    ds_read_b64_tr_b16 v[58:59], v140 offset:8704
    v_smfmac_f32_16x16x64_bf16 v[64:67], v[8:11], v[32:39], v126
    ds_read_b64_tr_b16 v[62:63], v140 offset:9728
    ds_read_b64_tr_b16 v[60:61], v140 offset:9216
    v_smfmac_f32_16x16x64_bf16 v[68:71], v[8:11], a[192:199], v126
    v_smfmac_f32_16x16x64_bf16 v[64:67], v[12:15], a[200:207], v126
    ds_read_b128 v[36:39], v128 offset:21504
    s_waitcnt lgkmcnt(5)
    v_smfmac_f32_16x16x64_bf16 v[68:71], v[12:15], v[40:47], v126
    ds_read_b128 v[44:47], v128 offset:5120
    s_waitcnt lgkmcnt(4)
    v_mfma_f32_16x16x32_bf16 v[106:109], v[80:83], v[56:59], 0
    v_add_f32 v65, v65, v67
    v_add_f32 v64, v64, v66
    s_waitcnt lgkmcnt(2)
    v_mfma_f32_16x16x32_bf16 v[106:109], v[84:87], v[60:63], v[106:109]
    v_add_f32 v68, v68, v70
    v_cvt_pk_bf16_f32 v64, v64, v65
    v_smfmac_f32_16x16x64_bf16 v[72:75], v[16:19], a[208:215], v126
    ds_read_b128 v[32:35], v128 offset:20480
    v_add_f32 v69, v69, v71
    v_cvt_pk_bf16_f32 v65, v68, v69
    v_cndmask_b32 v107, v107, v108, s[24:25]
    v_cndmask_b32 v106, v106, v109, s[24:25]
    v_smfmac_f32_16x16x64_bf16 v[76:79], v[16:19], a[216:223], v126
    ds_read_b128 v[40:43], v128 offset:4096
    v_add_f32_dpp v104, v107, v106 quad_perm:[2,3,0,1] row_mask:0xf bank_mask:0xf
    v_exp_f32 v141, v104
    ds_write_b64 v143, v[64:65] offset:11264
    v_cvt_pk_bf16_f32 v141, v141, v141
    s_waitcnt lgkmcnt(2)
    v_smfmac_f32_16x16x64_bf16 v[72:75], v[20:23], v[32:39], v126
    ds_write_b16 v132, v141
    v_smfmac_f32_16x16x64_bf16 v[76:79], v[20:23], a[224:231], v126
    v_smfmac_f32_16x16x64_bf16 v[72:75], v[28:31], a[232:239], v126
    ds_read_b128 v[32:35], v128 offset:12288
    v_smfmac_f32_16x16x64_bf16 v[76:79], v[28:31], a[240:247], v126
    ds_read_b128 v[36:39], v128 offset:13312
    s_waitcnt lgkmcnt(2)
    s_barrier
    v_smfmac_f32_16x16x64_bf16 v[72:75], v[4:7], v[40:47], v126
    ds_read_b64_tr_b16 v[66:67], v140 offset:10752
    ds_read_b64_tr_b16 v[64:65], v140 offset:10240
    v_smfmac_f32_16x16x64_bf16 v[76:79], v[4:7], a[248:255], v126
    ds_read_b64_tr_b16 v[68:69], v140 offset:11264
    ds_read_b64_tr_b16 v[70:71], v140 offset:11776
    v_smfmac_f32_16x16x64_bf16 v[72:75], v[8:11], v[232:239], v126
    ds_read_b128 v[110:113], v133
    s_waitcnt lgkmcnt(5)
    v_smfmac_f32_16x16x64_bf16 v[76:79], v[8:11], v[32:39], v126
    ds_read_b128 v[40:43], v127 offset:28672
    v_mov_b64 v[4:5], 0
    v_smfmac_f32_16x16x64_bf16 v[72:75], v[12:15], v[240:247], v126
    ds_read_b128 v[44:47], v127 offset:29696
    s_waitcnt lgkmcnt(5)
    v_mfma_f32_16x16x32_bf16 v[106:109], v[64:67], v[56:59], 0
    ds_read_b128 v[32:35], v127 offset:36864
    v_mov_b64 v[8:9], 0
    s_waitcnt lgkmcnt(4)
    v_mfma_f32_16x16x32_bf16 v[106:109], v[68:71], v[60:63], v[106:109]
    ds_read_b128 v[114:117], v134
    v_add_f32 v73, v73, v75
    v_smfmac_f32_16x16x64_bf16 v[76:79], v[12:15], v[248:255], v126
    ds_read_b128 v[36:39], v127 offset:37888
    v_add_f32 v72, v72, v74
    s_waitcnt lgkmcnt(5)
    v_mfma_f32_16x16x32_bf16 v[118:121], v[88:91], v[110:113], 0
    v_cndmask_b32 v107, v107, v108, s[24:25]
    v_cndmask_b32 v106, v106, v109, s[24:25]
    v_mfma_f32_16x16x32_bf16 v[64:67], v[122:125], v[110:113], 0
    v_add_f32_dpp v105, v107, v106 quad_perm:[2,3,0,1] row_mask:0xf bank_mask:0xf
    v_mul_f32 v105, s39, v105
    v_exp_f32 v107, v105
    s_waitcnt lgkmcnt(1)
    v_mfma_f32_16x16x32_bf16 v[118:121], v[92:95], v[114:117], v[118:121]
    v_mov_b32_dpp v108, v107 quad_perm:[2,3,0,1] row_mask:0xf bank_mask:0xf
    v_cvt_pk_bf16_f32 v107, v107, v108
    v_cndmask_b32 v68, v107, 0, s[24:25]
    v_cndmask_b32 v69, 0, v107, s[24:25]
    v_add_f32 v77, v77, v79
    v_add_f32 v76, v76, v78
    v_mfma_f32_16x16x16_bf16 v[64:67], v[122:123], v[68:69], v[64:67]
    v_cvt_pk_bf16_f32 v72, v72, v73
    v_cvt_pk_bf16_f32 v73, v77, v76
    s_nop 1
    v_mfma_f32_16x16x16_bf16 v[118:121], v[72:73], v[68:69], v[118:121]
    v_mov_b64 v[10:11], 0
    v_mov_b64 v[12:13], 0
    s_nop 0
    v_subrev_u32 v142, s44, v64
    v_mov_b64 v[14:15], 0
    v_cmp_le_u32 vcc, s45, v142
    v_rcp_f32_dpp v141, v64 quad_perm:[0,1,0,1] row_mask:0xf bank_mask:0xf
LF2_norm:
    s_nop 0
    v_mul_f32 v118, v118, v141
    v_mul_f32 v119, v119, v141
    v_mul_f32 v120, v120, v141
    v_mul_f32 v121, v121, v141
    v_cvt_pk_bf16_f32 v60, v118, v119
    v_cvt_pk_bf16_f32 v61, v120, v121
    ds_write_b64 v135, v[60:61] offset:5248
    s_and_b64 vcc, vcc, s[26:27]
    s_cbranch_scc1 LF2_fallback
    v_mov_b32_dpp v62, v60 quad_perm:[2,3,0,1] row_mask:0xf bank_mask:0xf
    v_mov_b32_dpp v63, v61 quad_perm:[2,3,0,1] row_mask:0xf bank_mask:0xf
    s_nop 1
    v_smfmac_f32_16x16x64_bf16 v[0:3], v[60:63], v[40:47], v126
    ds_read_b128 v[40:43], v127 offset:45056
    v_mov_b64 v[6:7], 0
    s_nop 1
    v_smfmac_f32_16x16x64_bf16 v[4:7], v[60:63], v[144:151], v126
    s_waitcnt lgkmcnt(1)
    s_barrier
    ds_read_b128 v[106:109], v136 offset:5312
    v_smfmac_f32_16x16x64_bf16 v[8:11], v[60:63], v[152:159], v126
    ds_read_b128 v[110:113], v136 offset:5120
    v_smfmac_f32_16x16x64_bf16 v[12:15], v[60:63], v[32:39], v126
    buffer_load_dword v138, v127, s[8:11], s31 offen sc1
    ds_read_b128 v[16:19], v136 offset:5184
    ds_read_b128 v[44:47], v127 offset:46080
    s_waitcnt lgkmcnt(3)
    v_smfmac_f32_16x16x64_bf16 v[0:3], v[106:109], v[160:167], v126
    ds_read_b128 v[36:39], v127 offset:54272
    s_waitcnt lgkmcnt(3)
    v_smfmac_f32_16x16x64_bf16 v[0:3], v[110:113], v[168:175], v126
    ds_read_b128 v[32:35], v127 offset:53248
    s_waitcnt lgkmcnt(3)
    v_smfmac_f32_16x16x64_bf16 v[0:3], v[16:19], v[176:183], v126
    s_waitcnt lgkmcnt(2)
    v_smfmac_f32_16x16x64_bf16 v[4:7], v[106:109], v[40:47], v126
    ds_read_b128 v[40:43], v127 offset:20480
    v_smfmac_f32_16x16x64_bf16 v[4:7], v[110:113], v[184:191], v126
    ds_read_b128 v[44:47], v127 offset:21504
    v_cvt_pk_bf16_f32 v115, v1, v3
    v_smfmac_f32_16x16x64_bf16 v[4:7], v[16:19], v[192:199], v126
    v_cvt_pk_bf16_f32 v114, v0, v2
    v_and_or_b32 v114, v114, -2, s28
    s_waitcnt lgkmcnt(2)
    v_smfmac_f32_16x16x64_bf16 v[8:11], v[106:109], v[32:39], v126
    buffer_store_dwordx2 v[114:115], v130, s[8:11], 0 offen offset:0
    v_smfmac_f32_16x16x64_bf16 v[8:11], v[110:113], v[200:207], v126
    v_cvt_pk_bf16_f32 v116, v4, v6
    v_smfmac_f32_16x16x64_bf16 v[8:11], v[16:19], v[208:215], v126
    v_and_or_b32 v116, v116, -2, s28
    v_cvt_pk_bf16_f32 v117, v5, v7
    v_smfmac_f32_16x16x64_bf16 v[12:15], v[106:109], v[216:223], v126
    buffer_store_dwordx2 v[116:117], v130, s[8:11], 0 offen offset:2048
    s_waitcnt lgkmcnt(0)
    v_smfmac_f32_16x16x64_bf16 v[12:15], v[110:113], v[40:47], v126
    v_cvt_pk_bf16_f32 v119, v9, v11
    v_cvt_pk_bf16_f32 v118, v8, v10
    v_and_or_b32 v118, v118, -2, s28
    buffer_store_dwordx2 v[118:119], v130, s[8:11], s69 offen offset:0
    v_smfmac_f32_16x16x64_bf16 v[12:15], v[16:19], v[224:231], v126
    s_nop 7
    v_cvt_pk_bf16_f32 v121, v13, v15
    v_cvt_pk_bf16_f32 v120, v12, v14
    v_and_or_b32 v120, v120, -2, s28
    buffer_store_dwordx2 v[120:121], v130, s[8:11], s69 offen offset:2048
    s_waitcnt vmcnt(4)
    v_cmp_gt_u32 vcc, s43, v138
    ds_read_b128 v[122:125], v127 offset:13312
    s_waitcnt vmcnt(4)
    s_add_u32 s30, s30, 1048576
    s_add_u32 s68, s68, 1048576
    s_cbranch_vccnz LF2_lead
LF2_leadok:
    s_barrier
    s_add_u32 s33, s33, 1048576
    s_add_u32 s37, s37, 1048576
    s_add_u32 s32, s32, 1048576
    s_add_u32 s38, s38, 1
    s_xor_b32 s28, s28, 1
    v_mov_b64 v[88:89], v[96:97]
    v_mov_b64 v[90:91], v[98:99]
    v_mov_b64 v[92:93], v[100:101]
    v_mov_b64 v[94:95], v[102:103]
    v_mov_b64 v[80:81], v[48:49]
    v_mov_b64 v[82:83], v[50:51]
    v_mov_b64 v[84:85], v[52:53]
    v_mov_b64 v[86:87], v[54:55]
    v_mov_b64 v[56:57], 0
    v_mov_b64 v[58:59], 0
    v_mov_b64 v[60:61], 0
    v_mov_b64 v[62:63], 0
    v_mov_b64 v[64:65], 0
    v_mov_b64 v[66:67], 0
    v_mov_b64 v[68:69], 0
    v_mov_b64 v[70:71], 0
    v_mov_b64 v[72:73], 0
    v_mov_b64 v[74:75], 0
    v_mov_b64 v[76:77], 0
    v_mov_b64 v[78:79], 0
    s_add_u32 s34, s34, 1048576
    s_add_u32 s43, s43, 1
    buffer_load_dwordx4 v[0:3], v127, s[8:11], s29 offen sc1
    buffer_load_dwordx4 v[4:7], v127, s[8:11], s29 offen offset:1024 sc1
    s_waitcnt lgkmcnt(0)
    s_branch LF2_pollP
LF2_done:
    buffer_store_dword v112, v131, s[8:11], s33 offen sc1
    s_waitcnt vmcnt(0)
    s_endpgm
LF2_retryE:
    buffer_load_dwordx4 v[0:3], v127, s[8:11], s30 offen sc1
    buffer_load_dwordx4 v[24:27], v127, s[8:11], s68 offen sc1
    s_sub_u32 s22, s22, 1
    s_cbranch_scc1 L_exit
    s_nop 3
    v_mov_b64 v[64:65], 0
    v_mov_b64 v[66:67], 0
    v_mov_b64 v[68:69], 0
    v_mov_b64 v[70:71], 0
    v_mov_b64 v[56:57], 0
    v_mov_b64 v[58:59], 0
    v_mov_b64 v[60:61], 0
    v_mov_b64 v[62:63], 0
    s_waitcnt vmcnt(1)
    s_branch LF2_bA
LF2_retryL:
    buffer_load_dwordx4 v[24:27], v127, s[8:11], s68 offen sc1
    s_sub_u32 s22, s22, 1
    s_cbranch_scc1 L_exit
    s_waitcnt vmcnt(0)
    v_cmp_eq_u32 vcc, -1, v24
    s_cbranch_vccnz LF2_retryL
    ds_write_b128 v127, v[24:27] offset:6144
    s_waitcnt lgkmcnt(0)
    s_branch LF2_Lok
    s_nop 0
LF2_retryP:
    buffer_load_dwordx4 v[0:3], v127, s[8:11], s29 offen sc1
    buffer_load_dwordx4 v[4:7], v127, s[8:11], s29 offen offset:1024 sc1
    s_sub_u32 s22, s22, 1
    s_cbranch_scc1 L_exit
    s_branch LF2_pollP
.p2align 5
LF2_lead:
    s_nop 15
    s_branch LF2_leadok
LF2_fallback:
    s_nop 7
    v_lshlrev_b32 v142, 1, v132
    v_subrev_u32 v142, 20480, v142
    ds_write_b32 v142, v104
    v_min_u32 v142, v133, v134
    v_lshlrev_b32 v142, 1, v142
    v_subrev_u32 v142, 20480, v142
    s_waitcnt lgkmcnt(0)
    s_barrier
    ds_read_b128 v[56:59], v142
    ds_read_b128 v[60:63], v142 offset:16
    s_waitcnt lgkmcnt(1)
    v_max3_f32 v141, v56, v57, v58
    s_waitcnt lgkmcnt(0)
    v_max3_f32 v141, v141, v59, v60
    v_max3_f32 v141, v141, v61, v62
    v_max3_f32 v141, v141, v63, v105
    s_nop 1
    v_max_f32_dpp v141, v141, v141 quad_perm:[2,3,0,1] row_mask:0xf bank_mask:0xf
    v_mov_b32 v142, v141
    s_nop 1
    v_permlane16_swap_b32 v141, v142
    v_max_f32 v141, v141, v142
    v_mov_b32 v142, v141
    s_nop 1
    v_permlane32_swap_b32 v141, v142
    v_max_f32 v141, v141, v142
    v_sub_f32 v56, v56, v141
    v_exp_f32 v56, v56
    v_sub_f32 v57, v57, v141
    v_exp_f32 v57, v57
    v_sub_f32 v58, v58, v141
    v_exp_f32 v58, v58
    v_sub_f32 v59, v59, v141
    v_exp_f32 v59, v59
    v_sub_f32 v60, v60, v141
    v_exp_f32 v60, v60
    v_sub_f32 v61, v61, v141
    v_exp_f32 v61, v61
    v_sub_f32 v62, v62, v141
    v_exp_f32 v62, v62
    v_sub_f32 v63, v63, v141
    v_exp_f32 v63, v63
    v_sub_f32 v107, v105, v141
    v_exp_f32 v107, v107
    s_nop 1
    v_mov_b32_dpp v108, v107 quad_perm:[2,3,0,1] row_mask:0xf bank_mask:0xf
    v_cvt_pk_bf16_f32 v107, v107, v108
    v_cndmask_b32 v68, v107, 0, s[24:25]
    v_cndmask_b32 v69, 0, v107, s[24:25]
    v_cvt_pk_bf16_f32 v142, v56, v57
    v_cndmask_b32 v110, v142, 0, s[24:25]
    v_cndmask_b32 v114, 0, v142, s[24:25]
    v_cvt_pk_bf16_f32 v142, v58, v59
    v_cndmask_b32 v111, v142, 0, s[24:25]
    v_cndmask_b32 v115, 0, v142, s[24:25]
    v_cvt_pk_bf16_f32 v142, v60, v61
    v_cndmask_b32 v112, v142, 0, s[24:25]
    v_cndmask_b32 v116, 0, v142, s[24:25]
    v_cvt_pk_bf16_f32 v142, v62, v63
    v_cndmask_b32 v113, v142, 0, s[24:25]
    v_cndmask_b32 v117, 0, v142, s[24:25]
    s_nop 0
    v_mfma_f32_16x16x32_bf16 v[118:121], v[88:91], v[110:113], 0
    v_mfma_f32_16x16x32_bf16 v[118:121], v[92:95], v[114:117], v[118:121]
    v_mfma_f32_16x16x32_bf16 v[64:67], v[122:125], v[110:113], 0
    s_nop 5
    v_mfma_f32_16x16x16_bf16 v[64:67], v[122:123], v[68:69], v[64:67]
    v_mfma_f32_16x16x16_bf16 v[118:121], v[72:73], v[68:69], v[118:121]
    s_nop 3
    v_rcp_f32_dpp v141, v64 quad_perm:[0,1,0,1] row_mask:0xf bank_mask:0xf
    s_mov_b64 vcc, 0
    s_nop 1
    s_branch LF2_norm
L_chain_slow2:
    s_add_u32 s34, s34, 1048576
    s_add_u32 s72, s72, 1048576
    s_add_u32 s37, s37, 1048576
    s_mov_b32 s43, 1
    s_mov_b32 s28, 1
    ds_read_b128 v[32:35], v127 offset:61440
    ds_read_b128 v[36:39], v127 offset:62464
    ds_read_b128 v[40:43], v128 offset:53248
    ds_read_b128 v[44:47], v128 offset:54272
    v_mov_b64 v[56:57], 0
    v_mov_b64 v[58:59], 0
    v_mov_b64 v[60:61], 0
    v_mov_b64 v[62:63], 0
    v_mov_b64 v[64:65], 0
    v_mov_b64 v[66:67], 0
    v_mov_b64 v[68:69], 0
    v_mov_b64 v[70:71], 0
    v_mov_b64 v[72:73], 0
    v_mov_b64 v[74:75], 0
    v_mov_b64 v[76:77], 0
    v_mov_b64 v[78:79], 0
    v_mov_b32 v142, s43
    s_waitcnt lgkmcnt(0)
    buffer_load_dwordx4 v[0:3], v127, s[8:11], s30 offen sc1
    buffer_load_dwordx4 v[24:27], v127, s[8:11], s68 offen sc1
    s_branch LS2_bAw
LS2_pollP:
    s_waitcnt vmcnt(1)
    v_mfma_f32_16x16x32_bf16 v[110:113], v[122:125], v[0:3], 0
    v_bitop3_b32 v141, v0, s28, 1 bitop3:0x28
    v_bitop3_b32 v141, v2, s28, v141 bitop3:0x28
    s_waitcnt vmcnt(0)
    v_mfma_f32_16x16x32_bf16 v[110:113], v[122:125], v[4:7], v[110:113]
    v_bitop3_b32 v141, v4, s28, v141 bitop3:0x28
    v_bitop3_b32 v141, v6, s28, v141 bitop3:0x28
    v_cmp_ne_u32 vcc, 1, v141
    s_nop 2
    s_cbranch_vccnz LS2_retryP
LS2_Pok:
    v_add_f32_dpp v110, v110, v110 row_ror:4 row_mask:0xf bank_mask:0xf
    v_add_f32_dpp v111, v111, v111 row_ror:4 row_mask:0xf bank_mask:0xf
    s_cmp_ge_u32 s38, 63
    v_add_f32_dpp v110, v110, v110 row_ror:8 row_mask:0xf bank_mask:0xf
    v_add_f32_dpp v111, v111, v111 row_ror:8 row_mask:0xf bank_mask:0xf
    v_cvt_pk_bf16_f32 v112, v110, v111
LS2_Mst:
    buffer_store_dword v112, v131, s[8:11], s32 offen sc1
    s_cbranch_scc1 LS2_done
    s_add_u32 s72, s72, 1048576
    ds_read_b128 v[32:35], v127 offset:61440
    ds_read_b128 v[36:39], v127 offset:62464
    ds_read_b128 v[40:43], v128 offset:53248
    ds_read_b128 v[44:47], v128 offset:54272
    s_waitcnt lgkmcnt(0)
    buffer_load_dwordx4 v[0:3], v127, s[8:11], s30 offen sc1
    s_waitcnt vmcnt(1)
    s_nop 15
    buffer_load_dwordx4 v[24:27], v127, s[8:11], s68 offen sc1
LS2_bAw:
    s_waitcnt vmcnt(1)
LS2_bA:
    v_max3_u32 v141, v0, v1, v2
    v_max_u32 v141, v141, v3
    v_cmp_eq_u32 vcc, -1, v141
    v_smfmac_f32_16x16x64_bf16 v[56:59], v[0:3], a[0:7], v126
    v_smfmac_f32_16x16x64_bf16 v[60:63], v[0:3], a[8:15], v126
    s_cbranch_vccnz LS2_retryE
    ds_write_b128 v127, v[0:3] offset:0
    v_smfmac_f32_16x16x64_bf16 v[64:67], v[0:3], a[16:23], v126
    v_mov_b64 v[122:123], s[70:71]
    v_smfmac_f32_16x16x64_bf16 v[68:71], v[0:3], a[24:31], v126
    v_mov_b64 v[124:125], s[70:71]
    v_smfmac_f32_16x16x64_bf16 v[72:75], v[0:3], a[32:39], v126
    v_smfmac_f32_16x16x64_bf16 v[76:79], v[0:3], v[32:39], v126
    ds_read_b128 v[32:35], v129 offset:20480
    ds_read_b128 v[36:39], v129 offset:21504
    s_waitcnt vmcnt(0)
    v_max3_u32 v141, v24, v25, v26
    v_max_u32 v141, v141, v27
    v_cmp_eq_u32 vcc, -1, v141
    ds_write_b128 v127, v[24:27] offset:6144
    v_mov_b64 v[0:1], 0
    s_cbranch_vccnz LS2_retryL
LS2_Lok:
    v_smfmac_f32_16x16x64_bf16 v[56:59], v[24:27], a[40:47], v126
    v_mov_b64 v[2:3], 0
    v_smfmac_f32_16x16x64_bf16 v[60:63], v[24:27], a[48:55], v126
    v_smfmac_f32_16x16x64_bf16 v[64:67], v[24:27], v[40:47], v126
    s_waitcnt lgkmcnt(3)
    s_waitcnt lgkmcnt(0)
    s_barrier
    v_smfmac_f32_16x16x64_bf16 v[68:71], v[24:27], a[56:63], v126
    ds_read_b128 v[16:19], v127 offset:4096
    ds_read_b128 v[20:23], v127 offset:5120
    v_smfmac_f32_16x16x64_bf16 v[72:75], v[24:27], a[64:71], v126
    ds_read_b128 v[40:43], v129 offset:28672
    ds_read_b128 v[44:47], v129 offset:29696
    v_smfmac_f32_16x16x64_bf16 v[76:79], v[24:27], a[72:79], v126
    buffer_load_dword v138, v139, s[8:11], s34 offen sc1
    ds_read_b128 v[28:31], v127 offset:7168
    ds_read_b128 v[4:7], v127 offset:1024
    s_waitcnt lgkmcnt(5)
    v_smfmac_f32_16x16x64_bf16 v[56:59], v[16:19], v[32:39], v126
    ds_read_b128 v[32:35], v129 offset:4096
    ds_read_b128 v[36:39], v129 offset:5120
    v_smfmac_f32_16x16x64_bf16 v[60:63], v[16:19], a[80:87], v126
    buffer_load_dwordx4 v[96:99], v127, s[8:11], s72 offen sc1
    s_waitcnt lgkmcnt(6)
    v_smfmac_f32_16x16x64_bf16 v[56:59], v[20:23], a[88:95], v126
    buffer_load_dwordx4 v[100:103], v129, s[8:11], s72 offen sc1
    s_waitcnt lgkmcnt(4)
    v_smfmac_f32_16x16x64_bf16 v[60:63], v[20:23], v[40:47], v126
    ds_read_b128 v[8:11], v127 offset:2048
    ds_read_b128 v[114:117], v137 offset:0
    s_waitcnt lgkmcnt(5)
    v_smfmac_f32_16x16x64_bf16 v[56:59], v[28:31], a[96:103], v126
    ds_read_b128 v[12:15], v127 offset:3072
    ds_read_b128 v[40:43], v129 offset:12288
    v_smfmac_f32_16x16x64_bf16 v[60:63], v[28:31], a[104:111], v126
    ds_read_b128 v[44:47], v129 offset:13312
    buffer_load_dwordx4 v[48:51], v127, s[8:11], s34 offen sc1
    s_waitcnt lgkmcnt(5)
    v_smfmac_f32_16x16x64_bf16 v[56:59], v[4:7], v[32:39], v126
    ds_read_b128 v[32:35], v128 offset:45056
    ds_read_b128 v[36:39], v128 offset:46080
    v_smfmac_f32_16x16x64_bf16 v[60:63], v[4:7], a[112:119], v126
    s_waitcnt lgkmcnt(5)
    buffer_store_dwordx4 v[114:117], v137, s[8:11], s33 offen sc1
    v_smfmac_f32_16x16x64_bf16 v[56:59], v[8:11], a[120:127], v126
    buffer_load_dwordx4 v[52:55], v129, s[8:11], s34 offen sc1
    v_smfmac_f32_16x16x64_bf16 v[60:63], v[8:11], a[128:135], v126
    s_waitcnt lgkmcnt(2)
    v_smfmac_f32_16x16x64_bf16 v[56:59], v[12:15], v[40:47], v126
    ds_read_b128 v[40:43], v128 offset:61440
    ds_read_b128 v[44:47], v128 offset:62464
    v_smfmac_f32_16x16x64_bf16 v[60:63], v[12:15], a[136:143], v126
    s_nop 3
    v_add_f32 v56, v56, v58
    v_add_f32 v57, v57, v59
    v_cvt_pk_bf16_f32 v56, v56, v57
    v_smfmac_f32_16x16x64_bf16 v[64:67], v[16:19], a[144:151], v126
    v_add_f32 v60, v60, v62
    v_add_f32 v61, v61, v63
    v_cvt_pk_bf16_f32 v57, v60, v61
    s_waitcnt lgkmcnt(2)
    v_smfmac_f32_16x16x64_bf16 v[68:71], v[16:19], v[32:39], v126
    ds_write_b64 v143, v[56:57] offset:9216
    v_smfmac_f32_16x16x64_bf16 v[64:67], v[20:23], a[152:159], v126
    ds_read_b128 v[32:35], v128 offset:28672
    ds_read_b128 v[36:39], v128 offset:29696
    v_smfmac_f32_16x16x64_bf16 v[68:71], v[20:23], a[160:167], v126
    s_waitcnt lgkmcnt(3)
    v_smfmac_f32_16x16x64_bf16 v[64:67], v[28:31], v[40:47], v126
    ds_read_b128 v[40:43], v128 offset:36864
    s_waitcnt lgkmcnt(3)
    s_barrier
    v_smfmac_f32_16x16x64_bf16 v[68:71], v[28:31], a[168:175], v126
    ds_read_b64_tr_b16 v[56:57], v140 offset:8192
    ds_read_b64_tr_b16 v[58:59], v140 offset:8704
    v_smfmac_f32_16x16x64_bf16 v[64:67], v[4:7], a[176:183], v126
    ds_read_b64_tr_b16 v[60:61], v140 offset:9216
    ds_read_b64_tr_b16 v[62:63], v140 offset:9728
    v_smfmac_f32_16x16x64_bf16 v[68:71], v[4:7], a[184:191], v126
    ds_read_b128 v[44:47], v128 offset:37888
    s_waitcnt lgkmcnt(6)
    v_smfmac_f32_16x16x64_bf16 v[64:67], v[8:11], v[32:39], v126
    ds_read_b128 v[32:35], v128 offset:20480
    ds_read_b128 v[36:39], v128 offset:21504
    v_smfmac_f32_16x16x64_bf16 v[68:71], v[8:11], a[192:199], v126
    s_waitcnt lgkmcnt(5)
    v_mfma_f32_16x16x32_bf16 v[106:109], v[80:83], v[56:59], 0
    v_smfmac_f32_16x16x64_bf16 v[64:67], v[12:15], a[200:207], v126
    s_waitcnt lgkmcnt(3)
    v_mfma_f32_16x16x32_bf16 v[106:109], v[84:87], v[60:63], v[106:109]
    s_waitcnt lgkmcnt(2)
    v_smfmac_f32_16x16x64_bf16 v[68:71], v[12:15], v[40:47], v126
    ds_read_b128 v[40:43], v128 offset:4096
    v_add_f32 v64, v64, v66
    v_add_f32 v65, v65, v67
    v_cndmask_b32 v107, v107, v108, s[24:25]
    v_cndmask_b32 v106, v106, v109, s[24:25]
    v_cvt_pk_bf16_f32 v64, v64, v65
    v_smfmac_f32_16x16x64_bf16 v[72:75], v[16:19], a[208:215], v126
    ds_read_b128 v[44:47], v128 offset:5120
    v_add_f32_dpp v104, v107, v106 quad_perm:[2,3,0,1] row_mask:0xf bank_mask:0xf
    v_exp_f32 v141, v104
    v_add_f32 v68, v68, v70
    v_add_f32 v69, v69, v71
    v_cvt_pk_bf16_f32 v65, v68, v69
    v_smfmac_f32_16x16x64_bf16 v[76:79], v[16:19], a[216:223], v126
    ds_write_b64 v143, v[64:65] offset:11264
    v_cvt_pk_bf16_f32 v141, v141, v141
    s_waitcnt lgkmcnt(3)
    v_smfmac_f32_16x16x64_bf16 v[72:75], v[20:23], v[32:39], v126
    ds_write_b16 v132, v141
    v_smfmac_f32_16x16x64_bf16 v[76:79], v[20:23], a[224:231], v126
    ds_read_b128 v[32:35], v128 offset:12288
    ds_read_b128 v[36:39], v128 offset:13312
    v_smfmac_f32_16x16x64_bf16 v[72:75], v[28:31], a[232:239], v126
    v_smfmac_f32_16x16x64_bf16 v[76:79], v[28:31], a[240:247], v126
    s_waitcnt lgkmcnt(2)
    s_barrier
    v_smfmac_f32_16x16x64_bf16 v[72:75], v[4:7], v[40:47], v126
    ds_read_b64_tr_b16 v[64:65], v140 offset:10240
    ds_read_b64_tr_b16 v[66:67], v140 offset:10752
    v_smfmac_f32_16x16x64_bf16 v[76:79], v[4:7], a[248:255], v126
    ds_read_b64_tr_b16 v[68:69], v140 offset:11264
    ds_read_b64_tr_b16 v[70:71], v140 offset:11776
    v_smfmac_f32_16x16x64_bf16 v[72:75], v[8:11], v[232:239], v126
    ds_read_b128 v[110:113], v133
    ds_read_b128 v[114:117], v134
    s_waitcnt lgkmcnt(6)
    v_smfmac_f32_16x16x64_bf16 v[76:79], v[8:11], v[32:39], v126
    ds_read_b128 v[40:43], v127 offset:28672
    ds_read_b128 v[44:47], v127 offset:29696
    s_waitcnt lgkmcnt(6)
    v_mfma_f32_16x16x32_bf16 v[106:109], v[64:67], v[56:59], 0
    ds_read_b128 v[32:35], v127 offset:36864
    ds_read_b128 v[36:39], v127 offset:37888
    s_waitcnt lgkmcnt(6)
    v_mfma_f32_16x16x32_bf16 v[106:109], v[68:71], v[60:63], v[106:109]
    v_mov_b64 v[4:5], 0
    v_mov_b64 v[6:7], 0
    v_smfmac_f32_16x16x64_bf16 v[72:75], v[12:15], v[240:247], v126
    v_mov_b64 v[8:9], 0
    v_smfmac_f32_16x16x64_bf16 v[76:79], v[12:15], v[248:255], v126
    v_cndmask_b32 v107, v107, v108, s[24:25]
    v_cndmask_b32 v106, v106, v109, s[24:25]
    s_waitcnt lgkmcnt(5)
    v_mfma_f32_16x16x32_bf16 v[118:121], v[88:91], v[110:113], 0
    v_add_f32_dpp v105, v107, v106 quad_perm:[2,3,0,1] row_mask:0xf bank_mask:0xf
    v_mul_f32 v105, s39, v105
    v_exp_f32 v107, v105
    v_mfma_f32_16x16x32_bf16 v[64:67], v[122:125], v[110:113], 0
    v_mov_b32_dpp v108, v107 quad_perm:[2,3,0,1] row_mask:0xf bank_mask:0xf
    v_cvt_pk_bf16_f32 v107, v107, v108
    s_waitcnt lgkmcnt(4)
    v_mfma_f32_16x16x32_bf16 v[118:121], v[92:95], v[114:117], v[118:121]
    v_cndmask_b32 v68, v107, 0, s[24:25]
    v_cndmask_b32 v69, 0, v107, s[24:25]
    v_add_f32 v72, v72, v74
    v_add_f32 v73, v73, v75
    v_mfma_f32_16x16x16_bf16 v[64:67], v[122:123], v[68:69], v[64:67]
    v_add_f32 v76, v76, v78
    v_add_f32 v77, v77, v79
    v_cvt_pk_bf16_f32 v72, v72, v73
    v_cvt_pk_bf16_f32 v73, v77, v76
    v_mov_b64 v[10:11], 0
    v_mov_b64 v[12:13], 0
    v_mfma_f32_16x16x16_bf16 v[118:121], v[72:73], v[68:69], v[118:121]
    v_mov_b64 v[14:15], 0
    v_rcp_f32_dpp v141, v64 quad_perm:[0,1,0,1] row_mask:0xf bank_mask:0xf
    v_subrev_u32 v142, s44, v64
    v_cmp_le_u32 vcc, s45, v142
LS2_norm:
    s_nop 3
    v_mul_f32 v118, v118, v141
    v_mul_f32 v119, v119, v141
    v_mul_f32 v120, v120, v141
    v_mul_f32 v121, v121, v141
    v_cvt_pk_bf16_f32 v60, v118, v119
    v_cvt_pk_bf16_f32 v61, v120, v121
    ds_write_b64 v135, v[60:61] offset:5248
    s_and_b64 vcc, vcc, s[26:27]
    s_cbranch_scc1 LS2_fallback
    v_mov_b32_dpp v62, v60 quad_perm:[2,3,0,1] row_mask:0xf bank_mask:0xf
    v_mov_b32_dpp v63, v61 quad_perm:[2,3,0,1] row_mask:0xf bank_mask:0xf
    s_waitcnt lgkmcnt(3)
    s_nop 0
    v_smfmac_f32_16x16x64_bf16 v[0:3], v[60:63], v[40:47], v126
    ds_read_b128 v[40:43], v127 offset:45056
    ds_read_b128 v[44:47], v127 offset:46080
    v_smfmac_f32_16x16x64_bf16 v[4:7], v[60:63], v[144:151], v126
    s_waitcnt lgkmcnt(2)
    s_barrier
    v_smfmac_f32_16x16x64_bf16 v[8:11], v[60:63], v[152:159], v126
    ds_read_b128 v[106:109], v136 offset:5312
    ds_read_b128 v[110:113], v136 offset:5120
    v_smfmac_f32_16x16x64_bf16 v[12:15], v[60:63], v[32:39], v126
    buffer_load_dword v138, v127, s[8:11], s31 offen sc1
    ds_read_b128 v[16:19], v136 offset:5184
    ds_read_b128 v[32:35], v127 offset:53248
    ds_read_b128 v[36:39], v127 offset:54272
    s_waitcnt lgkmcnt(4)
    v_smfmac_f32_16x16x64_bf16 v[0:3], v[106:109], v[160:167], v126
    s_waitcnt lgkmcnt(3)
    v_smfmac_f32_16x16x64_bf16 v[0:3], v[110:113], v[168:175], v126
    s_waitcnt lgkmcnt(2)
    v_smfmac_f32_16x16x64_bf16 v[0:3], v[16:19], v[176:183], v126
    v_smfmac_f32_16x16x64_bf16 v[4:7], v[106:109], v[40:47], v126
    ds_read_b128 v[40:43], v127 offset:20480
    ds_read_b128 v[44:47], v127 offset:21504
    s_nop 1
    v_cvt_pk_bf16_f32 v114, v0, v2
    v_cvt_pk_bf16_f32 v115, v1, v3
    v_and_or_b32 v114, v114, -2, s28
    v_smfmac_f32_16x16x64_bf16 v[4:7], v[110:113], v[184:191], v126
    buffer_store_dwordx2 v[114:115], v130, s[8:11], 0 offen offset:0 sc1
    v_smfmac_f32_16x16x64_bf16 v[4:7], v[16:19], v[192:199], v126
    s_waitcnt lgkmcnt(2)
    v_smfmac_f32_16x16x64_bf16 v[8:11], v[106:109], v[32:39], v126
    v_smfmac_f32_16x16x64_bf16 v[8:11], v[110:113], v[200:207], v126
    v_cvt_pk_bf16_f32 v116, v4, v6
    v_cvt_pk_bf16_f32 v117, v5, v7
    v_and_or_b32 v116, v116, -2, s28
    v_smfmac_f32_16x16x64_bf16 v[8:11], v[16:19], v[208:215], v126
    buffer_store_dwordx2 v[116:117], v130, s[8:11], 0 offen offset:2048 sc1
    v_smfmac_f32_16x16x64_bf16 v[12:15], v[106:109], v[216:223], v126
    s_nop 3
    v_cvt_pk_bf16_f32 v118, v8, v10
    v_cvt_pk_bf16_f32 v119, v9, v11
    v_and_or_b32 v118, v118, -2, s28
    s_waitcnt lgkmcnt(0)
    v_smfmac_f32_16x16x64_bf16 v[12:15], v[110:113], v[40:47], v126
    buffer_store_dwordx2 v[118:119], v130, s[8:11], s69 offen offset:0 sc1
    v_smfmac_f32_16x16x64_bf16 v[12:15], v[16:19], v[224:231], v126
    s_nop 7
    v_cvt_pk_bf16_f32 v120, v12, v14
    v_cvt_pk_bf16_f32 v121, v13, v15
    v_and_or_b32 v120, v120, -2, s28
    buffer_store_dwordx2 v[120:121], v130, s[8:11], s69 offen offset:2048 sc1
    s_waitcnt vmcnt(4)
    v_cmp_gt_u32 vcc, s43, v138
    ds_read_b128 v[122:125], v127 offset:13312
    s_waitcnt vmcnt(4)
    s_add_u32 s30, s30, 1048576
    s_add_u32 s68, s68, 1048576
    s_cbranch_vccnz LS2_lead
LS2_leadok:
    s_barrier
    s_add_u32 s33, s33, 1048576
    s_add_u32 s37, s37, 1048576
    s_add_u32 s32, s32, 1048576
    s_add_u32 s38, s38, 1
    s_xor_b32 s28, s28, 1
    v_mov_b64 v[88:89], v[96:97]
    v_mov_b64 v[90:91], v[98:99]
    v_mov_b64 v[92:93], v[100:101]
    v_mov_b64 v[94:95], v[102:103]
    v_mov_b64 v[80:81], v[48:49]
    v_mov_b64 v[82:83], v[50:51]
    v_mov_b64 v[84:85], v[52:53]
    v_mov_b64 v[86:87], v[54:55]
    v_mov_b64 v[56:57], 0
    v_mov_b64 v[58:59], 0
    v_mov_b64 v[60:61], 0
    v_mov_b64 v[62:63], 0
    v_mov_b64 v[64:65], 0
    v_mov_b64 v[66:67], 0
    v_mov_b64 v[68:69], 0
    v_mov_b64 v[70:71], 0
    v_mov_b64 v[72:73], 0
    v_mov_b64 v[74:75], 0
    v_mov_b64 v[76:77], 0
    v_mov_b64 v[78:79], 0
    s_add_u32 s34, s34, 1048576
    s_add_u32 s43, s43, 1
    buffer_load_dwordx4 v[0:3], v127, s[8:11], s29 offen sc1
    buffer_load_dwordx4 v[4:7], v127, s[8:11], s29 offen offset:1024 sc1
    s_waitcnt lgkmcnt(0)
    s_branch LS2_pollP
LS2_done:
    buffer_store_dword v112, v131, s[8:11], s33 offen sc1
    s_waitcnt vmcnt(0)
    s_endpgm
LS2_retryE:
    buffer_load_dwordx4 v[0:3], v127, s[8:11], s30 offen sc1
    buffer_load_dwordx4 v[24:27], v127, s[8:11], s68 offen sc1
    s_sub_u32 s22, s22, 1
    s_cbranch_scc1 L_exit
    s_nop 3
    v_mov_b64 v[56:57], 0
    v_mov_b64 v[58:59], 0
    v_mov_b64 v[60:61], 0
    v_mov_b64 v[62:63], 0
    s_waitcnt vmcnt(1)
    s_branch LS2_bA
LS2_retryL:
    buffer_load_dwordx4 v[24:27], v127, s[8:11], s68 offen sc1
    s_sub_u32 s22, s22, 1
    s_cbranch_scc1 L_exit
    s_waitcnt vmcnt(0)
    v_max3_u32 v141, v24, v25, v26
    v_max_u32 v141, v141, v27
    v_cmp_eq_u32 vcc, -1, v141
    s_cbranch_vccnz LS2_retryL
    ds_write_b128 v127, v[24:27] offset:6144
    s_waitcnt lgkmcnt(0)
    s_branch LS2_Lok
    s_nop 0
LS2_retryP:
    buffer_load_dwordx4 v[0:3], v127, s[8:11], s29 offen sc1
    buffer_load_dwordx4 v[4:7], v127, s[8:11], s29 offen offset:1024 sc1
    s_sub_u32 s22, s22, 1
    s_cbranch_scc1 L_exit
    s_branch LS2_pollP
LS2_lead:
    s_nop 15
    s_branch LS2_leadok
LS2_fallback:
    s_nop 7
    v_lshlrev_b32 v142, 1, v132
    v_subrev_u32 v142, 20480, v142
    ds_write_b32 v142, v104
    v_min_u32 v142, v133, v134
    v_lshlrev_b32 v142, 1, v142
    v_subrev_u32 v142, 20480, v142
    s_waitcnt lgkmcnt(0)
    s_barrier
    ds_read_b128 v[56:59], v142
    ds_read_b128 v[60:63], v142 offset:16
    s_waitcnt lgkmcnt(1)
    v_max3_f32 v141, v56, v57, v58
    s_waitcnt lgkmcnt(0)
    v_max3_f32 v141, v141, v59, v60
    v_max3_f32 v141, v141, v61, v62
    v_max3_f32 v141, v141, v63, v105
    s_nop 1
    v_max_f32_dpp v141, v141, v141 quad_perm:[2,3,0,1] row_mask:0xf bank_mask:0xf
    v_mov_b32 v142, v141
    s_nop 1
    v_permlane16_swap_b32 v141, v142
    v_max_f32 v141, v141, v142
    v_mov_b32 v142, v141
    s_nop 1
    v_permlane32_swap_b32 v141, v142
    v_max_f32 v141, v141, v142
    v_sub_f32 v56, v56, v141
    v_exp_f32 v56, v56
    v_sub_f32 v57, v57, v141
    v_exp_f32 v57, v57
    v_sub_f32 v58, v58, v141
    v_exp_f32 v58, v58
    v_sub_f32 v59, v59, v141
    v_exp_f32 v59, v59
    v_sub_f32 v60, v60, v141
    v_exp_f32 v60, v60
    v_sub_f32 v61, v61, v141
    v_exp_f32 v61, v61
    v_sub_f32 v62, v62, v141
    v_exp_f32 v62, v62
    v_sub_f32 v63, v63, v141
    v_exp_f32 v63, v63
    v_sub_f32 v107, v105, v141
    v_exp_f32 v107, v107
    s_nop 1
    v_mov_b32_dpp v108, v107 quad_perm:[2,3,0,1] row_mask:0xf bank_mask:0xf
    v_cvt_pk_bf16_f32 v107, v107, v108
    v_cndmask_b32 v68, v107, 0, s[24:25]
    v_cndmask_b32 v69, 0, v107, s[24:25]
    v_cvt_pk_bf16_f32 v142, v56, v57
    v_cndmask_b32 v110, v142, 0, s[24:25]
    v_cndmask_b32 v114, 0, v142, s[24:25]
    v_cvt_pk_bf16_f32 v142, v58, v59
    v_cndmask_b32 v111, v142, 0, s[24:25]
    v_cndmask_b32 v115, 0, v142, s[24:25]
    v_cvt_pk_bf16_f32 v142, v60, v61
    v_cndmask_b32 v112, v142, 0, s[24:25]
    v_cndmask_b32 v116, 0, v142, s[24:25]
    v_cvt_pk_bf16_f32 v142, v62, v63
    v_cndmask_b32 v113, v142, 0, s[24:25]
    v_cndmask_b32 v117, 0, v142, s[24:25]
    s_nop 0
    v_mfma_f32_16x16x32_bf16 v[118:121], v[88:91], v[110:113], 0
    v_mfma_f32_16x16x32_bf16 v[118:121], v[92:95], v[114:117], v[118:121]
    v_mfma_f32_16x16x32_bf16 v[64:67], v[122:125], v[110:113], 0
    s_nop 5
    v_mfma_f32_16x16x16_bf16 v[64:67], v[122:123], v[68:69], v[64:67]
    v_mfma_f32_16x16x16_bf16 v[118:121], v[72:73], v[68:69], v[118:121]
    s_nop 3
    v_rcp_f32_dpp v141, v64 quad_perm:[0,1,0,1] row_mask:0xf bank_mask:0xf
    s_mov_b64 vcc, 0
    s_nop 1
    s_branch LS2_norm
L_chain_w3:
    v_and_b32 v10, 63, v0
    v_lshlrev_b32 v6, 4, v10
    s_mov_b32 s14, 0x400000
    s_mov_b32 s15, 0x20000
    s_mov_b32 s12, s66
    s_mov_b32 s13, s67
    s_lshl_b32 s40, s20, 17
    s_add_u32 s40, s40, 24576
    s_mov_b32 m0, 57344
    s_nop 0
    buffer_load_dwordx4 v6, s[12:15], s40 offen lds
    s_add_u32 s40, s40, 1024
    s_mov_b32 m0, 58368
    s_nop 0
    buffer_load_dwordx4 v6, s[12:15], s40 offen lds
    s_add_u32 s40, s40, 1024
    s_mov_b32 m0, 59392
    s_nop 0
    buffer_load_dwordx4 v6, s[12:15], s40 offen lds
    s_add_u32 s40, s40, 1024
    s_mov_b32 m0, 60416
    s_nop 0
    buffer_load_dwordx4 v6, s[12:15], s40 offen lds
    s_add_u32 s40, s40, 1024
    s_mov_b32 m0, 61440
    s_nop 0
    buffer_load_dwordx4 v6, s[12:15], s40 offen lds
    s_add_u32 s40, s40, 1024
    s_mov_b32 m0, 62464
    s_nop 0
    buffer_load_dwordx4 v6, s[12:15], s40 offen lds
    s_add_u32 s40, s40, 1024
    s_mov_b32 m0, 63488
    s_nop 0
    buffer_load_dwordx4 v6, s[12:15], s40 offen lds
    s_add_u32 s40, s40, 1024
    s_mov_b32 m0, 64512
    s_nop 0
    buffer_load_dwordx4 v6, s[12:15], s40 offen lds
    s_mov_b32 s12, s66
    s_mov_b32 s13, s67
    s_lshl_b32 s40, s20, 17
    s_add_u32 s40, s40, 57344
    s_mov_b32 m0, 90112
    s_nop 0
    buffer_load_dwordx4 v6, s[12:15], s40 offen lds
    s_add_u32 s40, s40, 1024
    s_mov_b32 m0, 91136
    s_nop 0
    buffer_load_dwordx4 v6, s[12:15], s40 offen lds
    s_add_u32 s40, s40, 1024
    s_mov_b32 m0, 92160
    s_nop 0
    buffer_load_dwordx4 v6, s[12:15], s40 offen lds
    s_add_u32 s40, s40, 1024
    s_mov_b32 m0, 93184
    s_nop 0
    buffer_load_dwordx4 v6, s[12:15], s40 offen lds
    s_add_u32 s40, s40, 1024
    s_mov_b32 m0, 94208
    s_nop 0
    buffer_load_dwordx4 v6, s[12:15], s40 offen lds
    s_add_u32 s40, s40, 1024
    s_mov_b32 m0, 95232
    s_nop 0
    buffer_load_dwordx4 v6, s[12:15], s40 offen lds
    s_add_u32 s40, s40, 1024
    s_mov_b32 m0, 96256
    s_nop 0
    buffer_load_dwordx4 v6, s[12:15], s40 offen lds
    s_add_u32 s40, s40, 1024
    s_mov_b32 m0, 97280
    s_nop 0
    buffer_load_dwordx4 v6, s[12:15], s40 offen lds
    s_mov_b32 s12, s66
    s_mov_b32 s13, s67
    s_lshl_b32 s40, s20, 17
    s_add_u32 s40, s40, 90112
    s_mov_b32 m0, 122880
    s_nop 0
    buffer_load_dwordx4 v6, s[12:15], s40 offen lds
    s_add_u32 s40, s40, 1024
    s_mov_b32 m0, 123904
    s_nop 0
    buffer_load_dwordx4 v6, s[12:15], s40 offen lds
    s_add_u32 s40, s40, 1024
    s_mov_b32 m0, 124928
    s_nop 0
    buffer_load_dwordx4 v6, s[12:15], s40 offen lds
    s_add_u32 s40, s40, 1024
    s_mov_b32 m0, 125952
    s_nop 0
    buffer_load_dwordx4 v6, s[12:15], s40 offen lds
    s_add_u32 s40, s40, 1024
    s_mov_b32 m0, 126976
    s_nop 0
    buffer_load_dwordx4 v6, s[12:15], s40 offen lds
    s_add_u32 s40, s40, 1024
    s_mov_b32 m0, 128000
    s_nop 0
    buffer_load_dwordx4 v6, s[12:15], s40 offen lds
    s_add_u32 s40, s40, 1024
    s_mov_b32 m0, 129024
    s_nop 0
    buffer_load_dwordx4 v6, s[12:15], s40 offen lds
    s_add_u32 s40, s40, 1024
    s_mov_b32 m0, 130048
    s_nop 0
    buffer_load_dwordx4 v6, s[12:15], s40 offen lds
    s_mov_b32 s12, s66
    s_mov_b32 s13, s67
    s_lshl_b32 s40, s20, 17
    s_add_u32 s40, s40, 122880
    s_mov_b32 m0, 155648
    s_nop 0
    buffer_load_dwordx4 v6, s[12:15], s40 offen lds
    s_add_u32 s40, s40, 1024
    s_mov_b32 m0, 156672
    s_nop 0
    buffer_load_dwordx4 v6, s[12:15], s40 offen lds
    s_add_u32 s40, s40, 1024
    s_mov_b32 m0, 157696
    s_nop 0
    buffer_load_dwordx4 v6, s[12:15], s40 offen lds
    s_add_u32 s40, s40, 1024
    s_mov_b32 m0, 158720
    s_nop 0
    buffer_load_dwordx4 v6, s[12:15], s40 offen lds
    s_add_u32 s40, s40, 1024
    s_mov_b32 m0, 159744
    s_nop 0
    buffer_load_dwordx4 v6, s[12:15], s40 offen lds
    s_add_u32 s40, s40, 1024
    s_mov_b32 m0, 160768
    s_nop 0
    buffer_load_dwordx4 v6, s[12:15], s40 offen lds
    s_add_u32 s40, s40, 1024
    s_mov_b32 m0, 161792
    s_nop 0
    buffer_load_dwordx4 v6, s[12:15], s40 offen lds
    s_add_u32 s40, s40, 1024
    s_mov_b32 m0, 162816
    s_nop 0
    buffer_load_dwordx4 v6, s[12:15], s40 offen lds
    s_or_b32 s4, s23, s21
    s_cselect_b64 exec, 0, 1
    buffer_atomic_or v1, off, s[16:19], s59 sc0
    s_mov_b64 exec, -1
    v_and_b32 v2, 15, v0
    v_lshrrev_b32 v3, 4, v10
    v_lshlrev_b32 v4, 1, v3
    v_xor_b32 v4, v4, v2
    v_xor_b32 v5, 8, v4
    v_lshlrev_b32 v4, 4, v4
    v_lshlrev_b32 v5, 4, v5
    v_lshl_add_u32 v4, v3, 13, v4
    v_lshl_add_u32 v5, v3, 13, v5
    v_lshrrev_b32 v14, 2, v2
    v_and_b32 v15, 1, v3
    v_lshl_or_b32 v15, v15, 2, v14
    v_lshl_add_u32 v14, v3, 3, v14
    v_lshlrev_b32 v14, 8, v14
    v_and_b32 v16, 3, v2
    v_lshl_add_u32 v14, v16, 3, v14
    v_xor_b32 v7, 6, v15
    v_xor_b32 v8, 7, v15
    v_lshl_add_u32 v7, v7, 5, v14
    v_lshl_add_u32 v8, v8, 5, v14
    v_add_u32 v7, 32768, v7
    v_add_u32 v8, 32768, v8
    v_lshlrev_b32 v16, 2, v2
    v_add_u32 v16, 32960, v16
    v_lshl_add_u32 v9, v3, 12, v16
    v_lshrrev_b32 v14, 1, v3
    v_lshl_add_u32 v14, v14, 12, v16
    v_add_u32 v14, 98304, v14
    v_and_b32 v15, 1, v3
    v_lshl_add_u32 v11, v15, 14, v14
    v_xor_b32 v15, 1, v15
    v_lshl_add_u32 v12, v15, 14, v14
    s_mov_b32 s41, 0x05040100
    s_mov_b32 s42, 0x07060302
    s_lshl_b32 s37, s20, 6
    s_add_u32 s37, s37, 17580032
    s_waitcnt vmcnt(25)
    s_barrier
    ds_read2st64_b32 v[18:19], v9 offset0:0 offset1:4
    ds_read2st64_b32 v[20:21], v9 offset0:8 offset1:12
    ds_read2st64_b32 v[22:23], v9 offset0:64 offset1:68
    ds_read2st64_b32 v[24:25], v9 offset0:72 offset1:76
    ds_read2st64_b32 v[26:27], v9 offset0:1 offset1:5
    ds_read2st64_b32 v[28:29], v9 offset0:9 offset1:13
    ds_read2st64_b32 v[30:31], v9 offset0:65 offset1:69
    ds_read2st64_b32 v[32:33], v9 offset0:73 offset1:77
    ds_read2st64_b32 v[34:35], v9 offset0:2 offset1:6
    ds_read2st64_b32 v[36:37], v9 offset0:10 offset1:14
    ds_read2st64_b32 v[38:39], v9 offset0:66 offset1:70
    ds_read2st64_b32 v[40:41], v9 offset0:74 offset1:78
    ds_read2st64_b32 v[42:43], v9 offset0:3 offset1:7
    ds_read2st64_b32 v[44:45], v9 offset0:11 offset1:15
    ds_read2st64_b32 v[46:47], v9 offset0:67 offset1:71
    ds_read2st64_b32 v[48:49], v9 offset0:75 offset1:79
    s_waitcnt lgkmcnt(0)
    s_barrier
    s_mov_b32 s12, s64
    s_mov_b32 s13, s65
    s_lshl_b32 s40, s20, 8
    s_add_u32 s40, s40, 786432
    s_mov_b32 m0, 57344
    s_nop 0
    buffer_load_dwordx4 v4, s[12:15], s40 offen lds
    s_add_u32 s40, s40, 32768
    s_mov_b32 m0, 58368
    s_nop 0
    buffer_load_dwordx4 v4, s[12:15], s40 offen lds
    s_add_u32 s40, s40, 32768
    s_mov_b32 m0, 59392
    s_nop 0
    buffer_load_dwordx4 v5, s[12:15], s40 offen lds
    s_add_u32 s40, s40, 32768
    s_mov_b32 m0, 60416
    s_nop 0
    buffer_load_dwordx4 v5, s[12:15], s40 offen lds
    s_add_u32 s40, s40, 32768
    s_mov_b32 m0, 61440
    s_nop 0
    buffer_load_dwordx4 v4, s[12:15], s40 offen lds
    s_add_u32 s40, s40, 32768
    s_mov_b32 m0, 62464
    s_nop 0
    buffer_load_dwordx4 v4, s[12:15], s40 offen lds
    s_add_u32 s40, s40, 32768
    s_mov_b32 m0, 63488
    s_nop 0
    buffer_load_dwordx4 v5, s[12:15], s40 offen lds
    s_add_u32 s40, s40, 32768
    s_mov_b32 m0, 64512
    s_nop 0
    buffer_load_dwordx4 v5, s[12:15], s40 offen lds
    v_perm_b32 v160, v19, v18, s41
    v_perm_b32 v161, v19, v18, s42
    v_perm_b32 v162, v21, v20, s41
    v_perm_b32 v163, v21, v20, s42
    v_perm_b32 v164, v23, v22, s41
    v_perm_b32 v165, v23, v22, s42
    v_perm_b32 v166, v25, v24, s41
    v_perm_b32 v167, v25, v24, s42
    v_perm_b32 v82, v27, v26, s41
    v_perm_b32 v83, v27, v26, s42
    v_perm_b32 v84, v29, v28, s41
    v_perm_b32 v85, v29, v28, s42
    v_perm_b32 v86, v31, v30, s41
    v_perm_b32 v87, v31, v30, s42
    v_perm_b32 v88, v33, v32, s41
    v_perm_b32 v89, v33, v32, s42
    v_perm_b32 v90, v35, v34, s41
    v_perm_b32 v91, v35, v34, s42
    v_perm_b32 v92, v37, v36, s41
    v_perm_b32 v93, v37, v36, s42
    v_perm_b32 v94, v39, v38, s41
    v_perm_b32 v95, v39, v38, s42
    v_perm_b32 v96, v41, v40, s41
    v_perm_b32 v97, v41, v40, s42
    v_perm_b32 v216, v43, v42, s41
    v_perm_b32 v217, v43, v42, s42
    v_perm_b32 v218, v45, v44, s41
    v_perm_b32 v219, v45, v44, s42
    v_perm_b32 v220, v47, v46, s41
    v_perm_b32 v221, v47, v46, s42
    v_perm_b32 v222, v49, v48, s41
    v_perm_b32 v223, v49, v48, s42
    v_add_u32 v13, 22528, v6
    ds_write_b128 v13, v[82:85]
    ds_write_b128 v13, v[86:89] offset:1024
    v_add_u32 v13, 30720, v6
    ds_write_b128 v13, v[90:93]
    ds_write_b128 v13, v[94:97] offset:1024
    s_waitcnt vmcnt(25)
    s_barrier
    v_add_u32 v9, 32768, v9
    ds_read2st64_b32 v[18:19], v9 offset0:0 offset1:4
    ds_read2st64_b32 v[20:21], v9 offset0:8 offset1:12
    ds_read2st64_b32 v[22:23], v9 offset0:64 offset1:68
    ds_read2st64_b32 v[24:25], v9 offset0:72 offset1:76
    ds_read2st64_b32 v[26:27], v9 offset0:1 offset1:5
    ds_read2st64_b32 v[28:29], v9 offset0:9 offset1:13
    ds_read2st64_b32 v[30:31], v9 offset0:65 offset1:69
    ds_read2st64_b32 v[32:33], v9 offset0:73 offset1:77
    ds_read2st64_b32 v[34:35], v9 offset0:2 offset1:6
    ds_read2st64_b32 v[36:37], v9 offset0:10 offset1:14
    ds_read2st64_b32 v[38:39], v9 offset0:66 offset1:70
    ds_read2st64_b32 v[40:41], v9 offset0:74 offset1:78
    ds_read2st64_b32 v[42:43], v9 offset0:3 offset1:7
    ds_read2st64_b32 v[44:45], v9 offset0:11 offset1:15
    ds_read2st64_b32 v[46:47], v9 offset0:67 offset1:71
    ds_read2st64_b32 v[48:49], v9 offset0:75 offset1:79
    s_waitcnt lgkmcnt(0)
    s_barrier
    s_mov_b32 s12, s64
    s_mov_b32 s13, s65
    s_lshl_b32 s40, s20, 8
    s_add_u32 s40, s40, 1835008
    s_mov_b32 m0, 90112
    s_nop 0
    buffer_load_dwordx4 v4, s[12:15], s40 offen lds
    s_add_u32 s40, s40, 32768
    s_mov_b32 m0, 91136
    s_nop 0
    buffer_load_dwordx4 v4, s[12:15], s40 offen lds
    s_add_u32 s40, s40, 32768
    s_mov_b32 m0, 92160
    s_nop 0
    buffer_load_dwordx4 v5, s[12:15], s40 offen lds
    s_add_u32 s40, s40, 32768
    s_mov_b32 m0, 93184
    s_nop 0
    buffer_load_dwordx4 v5, s[12:15], s40 offen lds
    s_add_u32 s40, s40, 32768
    s_mov_b32 m0, 94208
    s_nop 0
    buffer_load_dwordx4 v4, s[12:15], s40 offen lds
    s_add_u32 s40, s40, 32768
    s_mov_b32 m0, 95232
    s_nop 0
    buffer_load_dwordx4 v4, s[12:15], s40 offen lds
    s_add_u32 s40, s40, 32768
    s_mov_b32 m0, 96256
    s_nop 0
    buffer_load_dwordx4 v5, s[12:15], s40 offen lds
    s_add_u32 s40, s40, 32768
    s_mov_b32 m0, 97280
    s_nop 0
    buffer_load_dwordx4 v5, s[12:15], s40 offen lds
    v_perm_b32 v168, v19, v18, s41
    v_perm_b32 v169, v19, v18, s42
    v_perm_b32 v170, v21, v20, s41
    v_perm_b32 v171, v21, v20, s42
    v_perm_b32 v172, v23, v22, s41
    v_perm_b32 v173, v23, v22, s42
    v_perm_b32 v174, v25, v24, s41
    v_perm_b32 v175, v25, v24, s42
    v_perm_b32 v184, v27, v26, s41
    v_perm_b32 v185, v27, v26, s42
    v_perm_b32 v186, v29, v28, s41
    v_perm_b32 v187, v29, v28, s42
    v_perm_b32 v188, v31, v30, s41
    v_perm_b32 v189, v31, v30, s42
    v_perm_b32 v190, v33, v32, s41
    v_perm_b32 v191, v33, v32, s42
    v_perm_b32 v200, v35, v34, s41
    v_perm_b32 v201, v35, v34, s42
    v_perm_b32 v202, v37, v36, s41
    v_perm_b32 v203, v37, v36, s42
    v_perm_b32 v204, v39, v38, s41
    v_perm_b32 v205, v39, v38, s42
    v_perm_b32 v206, v41, v40, s41
    v_perm_b32 v207, v41, v40, s42
    v_perm_b32 v82, v43, v42, s41
    v_perm_b32 v83, v43, v42, s42
    v_perm_b32 v84, v45, v44, s41
    v_perm_b32 v85, v45, v44, s42
    v_perm_b32 v86, v47, v46, s41
    v_perm_b32 v87, v47, v46, s42
    v_perm_b32 v88, v49, v48, s41
    v_perm_b32 v89, v49, v48, s42
    s_waitcnt vmcnt(25)
    s_barrier
    v_add_u32 v9, 32768, v9
    ds_read2st64_b32 v[18:19], v9 offset0:0 offset1:4
    ds_read2st64_b32 v[20:21], v9 offset0:8 offset1:12
    ds_read2st64_b32 v[22:23], v9 offset0:64 offset1:68
    ds_read2st64_b32 v[24:25], v9 offset0:72 offset1:76
    ds_read2st64_b32 v[26:27], v9 offset0:1 offset1:5
    ds_read2st64_b32 v[28:29], v9 offset0:9 offset1:13
    ds_read2st64_b32 v[30:31], v9 offset0:65 offset1:69
    ds_read2st64_b32 v[32:33], v9 offset0:73 offset1:77
    ds_read2st64_b32 v[34:35], v9 offset0:2 offset1:6
    ds_read2st64_b32 v[36:37], v9 offset0:10 offset1:14
    ds_read2st64_b32 v[38:39], v9 offset0:66 offset1:70
    ds_read2st64_b32 v[40:41], v9 offset0:74 offset1:78
    ds_read2st64_b32 v[42:43], v9 offset0:3 offset1:7
    ds_read2st64_b32 v[44:45], v9 offset0:11 offset1:15
    ds_read2st64_b32 v[46:47], v9 offset0:67 offset1:71
    ds_read2st64_b32 v[48:49], v9 offset0:75 offset1:79
    s_waitcnt lgkmcnt(0)
    s_barrier
    s_mov_b32 s12, s64
    s_mov_b32 s13, s65
    s_lshl_b32 s40, s20, 8
    s_add_u32 s40, s40, 2883584
    s_mov_b32 m0, 122880
    s_nop 0
    buffer_load_dwordx4 v4, s[12:15], s40 offen lds
    s_add_u32 s40, s40, 32768
    s_mov_b32 m0, 123904
    s_nop 0
    buffer_load_dwordx4 v4, s[12:15], s40 offen lds
    s_add_u32 s40, s40, 32768
    s_mov_b32 m0, 124928
    s_nop 0
    buffer_load_dwordx4 v5, s[12:15], s40 offen lds
    s_add_u32 s40, s40, 32768
    s_mov_b32 m0, 125952
    s_nop 0
    buffer_load_dwordx4 v5, s[12:15], s40 offen lds
    s_add_u32 s40, s40, 32768
    s_mov_b32 m0, 126976
    s_nop 0
    buffer_load_dwordx4 v4, s[12:15], s40 offen lds
    s_add_u32 s40, s40, 32768
    s_mov_b32 m0, 128000
    s_nop 0
    buffer_load_dwordx4 v4, s[12:15], s40 offen lds
    s_add_u32 s40, s40, 32768
    s_mov_b32 m0, 129024
    s_nop 0
    buffer_load_dwordx4 v5, s[12:15], s40 offen lds
    s_add_u32 s40, s40, 32768
    s_mov_b32 m0, 130048
    s_nop 0
    buffer_load_dwordx4 v5, s[12:15], s40 offen lds
    v_perm_b32 v176, v19, v18, s41
    v_perm_b32 v177, v19, v18, s42
    v_perm_b32 v178, v21, v20, s41
    v_perm_b32 v179, v21, v20, s42
    v_perm_b32 v180, v23, v22, s41
    v_perm_b32 v181, v23, v22, s42
    v_perm_b32 v182, v25, v24, s41
    v_perm_b32 v183, v25, v24, s42
    v_perm_b32 v192, v27, v26, s41
    v_perm_b32 v193, v27, v26, s42
    v_perm_b32 v194, v29, v28, s41
    v_perm_b32 v195, v29, v28, s42
    v_perm_b32 v196, v31, v30, s41
    v_perm_b32 v197, v31, v30, s42
    v_perm_b32 v198, v33, v32, s41
    v_perm_b32 v199, v33, v32, s42
    v_perm_b32 v208, v35, v34, s41
    v_perm_b32 v209, v35, v34, s42
    v_perm_b32 v210, v37, v36, s41
    v_perm_b32 v211, v37, v36, s42
    v_perm_b32 v212, v39, v38, s41
    v_perm_b32 v213, v39, v38, s42
    v_perm_b32 v214, v41, v40, s41
    v_perm_b32 v215, v41, v40, s42
    v_perm_b32 v224, v43, v42, s41
    v_perm_b32 v225, v43, v42, s42
    v_perm_b32 v226, v45, v44, s41
    v_perm_b32 v227, v45, v44, s42
    v_perm_b32 v228, v47, v46, s41
    v_perm_b32 v229, v47, v46, s42
    v_perm_b32 v230, v49, v48, s41
    v_perm_b32 v231, v49, v48, s42
    s_waitcnt vmcnt(25)
    s_barrier
    v_add_u32 v9, 32768, v9
    ds_read2st64_b32 v[18:19], v11 offset0:0 offset1:4
    ds_read2st64_b32 v[20:21], v12 offset0:0 offset1:4
    ds_read2st64_b32 v[22:23], v11 offset0:8 offset1:12
    ds_read2st64_b32 v[24:25], v12 offset0:8 offset1:12
    ds_read2st64_b32 v[26:27], v11 offset0:32 offset1:36
    ds_read2st64_b32 v[28:29], v12 offset0:32 offset1:36
    ds_read2st64_b32 v[30:31], v11 offset0:40 offset1:44
    ds_read2st64_b32 v[32:33], v12 offset0:40 offset1:44
    ds_read2st64_b32 v[34:35], v11 offset0:1 offset1:5
    ds_read2st64_b32 v[36:37], v12 offset0:1 offset1:5
    ds_read2st64_b32 v[38:39], v11 offset0:9 offset1:13
    ds_read2st64_b32 v[40:41], v12 offset0:9 offset1:13
    ds_read2st64_b32 v[42:43], v11 offset0:33 offset1:37
    ds_read2st64_b32 v[44:45], v12 offset0:33 offset1:37
    ds_read2st64_b32 v[46:47], v11 offset0:41 offset1:45
    ds_read2st64_b32 v[48:49], v12 offset0:41 offset1:45
    ds_read2st64_b32 v[50:51], v11 offset0:2 offset1:6
    ds_read2st64_b32 v[52:53], v12 offset0:2 offset1:6
    ds_read2st64_b32 v[54:55], v11 offset0:10 offset1:14
    ds_read2st64_b32 v[56:57], v12 offset0:10 offset1:14
    ds_read2st64_b32 v[58:59], v11 offset0:34 offset1:38
    ds_read2st64_b32 v[60:61], v12 offset0:34 offset1:38
    ds_read2st64_b32 v[62:63], v11 offset0:42 offset1:46
    ds_read2st64_b32 v[64:65], v12 offset0:42 offset1:46
    ds_read2st64_b32 v[66:67], v11 offset0:3 offset1:7
    ds_read2st64_b32 v[68:69], v12 offset0:3 offset1:7
    ds_read2st64_b32 v[70:71], v11 offset0:11 offset1:15
    ds_read2st64_b32 v[72:73], v12 offset0:11 offset1:15
    ds_read2st64_b32 v[74:75], v11 offset0:35 offset1:39
    ds_read2st64_b32 v[76:77], v12 offset0:35 offset1:39
    ds_read2st64_b32 v[78:79], v11 offset0:43 offset1:47
    ds_read2st64_b32 v[80:81], v12 offset0:43 offset1:47
    s_waitcnt lgkmcnt(0)
    s_barrier
    s_mov_b32 s12, s64
    s_mov_b32 s13, s65
    s_lshl_b32 s40, s20, 8
    s_add_u32 s40, s40, 3932160
    s_mov_b32 m0, 155648
    s_nop 0
    buffer_load_dwordx4 v4, s[12:15], s40 offen lds
    s_add_u32 s40, s40, 32768
    s_mov_b32 m0, 156672
    s_nop 0
    buffer_load_dwordx4 v4, s[12:15], s40 offen lds
    s_add_u32 s40, s40, 32768
    s_mov_b32 m0, 157696
    s_nop 0
    buffer_load_dwordx4 v5, s[12:15], s40 offen lds
    s_add_u32 s40, s40, 32768
    s_mov_b32 m0, 158720
    s_nop 0
    buffer_load_dwordx4 v5, s[12:15], s40 offen lds
    s_add_u32 s40, s40, 32768
    s_mov_b32 m0, 159744
    s_nop 0
    buffer_load_dwordx4 v4, s[12:15], s40 offen lds
    s_add_u32 s40, s40, 32768
    s_mov_b32 m0, 160768
    s_nop 0
    buffer_load_dwordx4 v4, s[12:15], s40 offen lds
    s_add_u32 s40, s40, 32768
    s_mov_b32 m0, 161792
    s_nop 0
    buffer_load_dwordx4 v5, s[12:15], s40 offen lds
    s_add_u32 s40, s40, 32768
    s_mov_b32 m0, 162816
    s_nop 0
    buffer_load_dwordx4 v5, s[12:15], s40 offen lds
    v_perm_b32 v90, v19, v18, s41
    v_perm_b32 v91, v21, v20, s42
    v_perm_b32 v92, v23, v22, s41
    v_perm_b32 v93, v25, v24, s42
    v_perm_b32 v94, v27, v26, s41
    v_perm_b32 v95, v29, v28, s42
    v_perm_b32 v96, v31, v30, s41
    v_perm_b32 v97, v33, v32, s42
    v_perm_b32 v144, v35, v34, s41
    v_perm_b32 v145, v37, v36, s42
    v_perm_b32 v146, v39, v38, s41
    v_perm_b32 v147, v41, v40, s42
    v_perm_b32 v148, v43, v42, s41
    v_perm_b32 v149, v45, v44, s42
    v_perm_b32 v150, v47, v46, s41
    v_perm_b32 v151, v49, v48, s42
    v_perm_b32 v152, v51, v50, s41
    v_perm_b32 v153, v53, v52, s42
    v_perm_b32 v154, v55, v54, s41
    v_perm_b32 v155, v57, v56, s42
    v_perm_b32 v156, v59, v58, s41
    v_perm_b32 v157, v61, v60, s42
    v_perm_b32 v158, v63, v62, s41
    v_perm_b32 v159, v65, v64, s42
    v_perm_b32 v98, v67, v66, s41
    v_perm_b32 v99, v69, v68, s42
    v_perm_b32 v100, v71, v70, s41
    v_perm_b32 v101, v73, v72, s42
    v_perm_b32 v102, v75, v74, s41
    v_perm_b32 v103, v77, v76, s42
    v_perm_b32 v104, v79, v78, s41
    v_perm_b32 v105, v81, v80, s42
    s_waitcnt vmcnt(24)
    s_barrier
    s_cmp_lg_u32 s23, 0
    s_cbranch_scc1 L_ver_c3
    v_mov_b32 v14, 14336
    s_cmp_lg_u32 s21, 0
    s_cbranch_scc1 L_verw_c3
    s_waitcnt vmcnt(24)
    s_mov_b64 exec, 1
    ds_write_b32 v14, v1
    s_mov_b64 exec, -1
    s_waitcnt lgkmcnt(0)
L_verw_c3:
    s_barrier
    ds_read_b32 v15, v14
    s_waitcnt lgkmcnt(0)
    v_readfirstlane_b32 s4, v15
    s_bitcmp1_b32 s4, s5
    s_cbranch_scc1 L_el_fix
    s_nop 2
L_ver_c3:
    ds_read_b64_tr_b16 v[18:19], v7 offset:0
    ds_read_b64_tr_b16 v[20:21], v7 offset:1024
    ds_read_b64_tr_b16 v[22:23], v7 offset:8192
    ds_read_b64_tr_b16 v[24:25], v7 offset:9216
    ds_read_b64_tr_b16 a[224:225], v8 offset:0
    ds_read_b64_tr_b16 a[226:227], v8 offset:1024
    ds_read_b64_tr_b16 a[228:229], v8 offset:8192
    ds_read_b64_tr_b16 a[230:231], v8 offset:9216
    ds_read_b64_tr_b16 a[32:33], v7 offset:16384
    ds_read_b64_tr_b16 a[34:35], v7 offset:17408
    ds_read_b64_tr_b16 a[36:37], v7 offset:24576
    ds_read_b64_tr_b16 a[38:39], v7 offset:25600
    ds_read_b64_tr_b16 v[26:27], v8 offset:16384
    ds_read_b64_tr_b16 v[28:29], v8 offset:17408
    ds_read_b64_tr_b16 v[30:31], v8 offset:24576
    ds_read_b64_tr_b16 v[32:33], v8 offset:25600
    s_waitcnt lgkmcnt(0)
    s_barrier
    s_mov_b32 s12, s62
    s_mov_b32 s13, s63
    s_lshl_b32 s40, s20, 8
    s_add_u32 s40, s40, 786432
    s_mov_b32 m0, 57344
    s_nop 0
    buffer_load_dwordx4 v4, s[12:15], s40 offen lds
    s_add_u32 s40, s40, 32768
    s_mov_b32 m0, 58368
    s_nop 0
    buffer_load_dwordx4 v4, s[12:15], s40 offen lds
    s_add_u32 s40, s40, 32768
    s_mov_b32 m0, 59392
    s_nop 0
    buffer_load_dwordx4 v5, s[12:15], s40 offen lds
    s_add_u32 s40, s40, 32768
    s_mov_b32 m0, 60416
    s_nop 0
    buffer_load_dwordx4 v5, s[12:15], s40 offen lds
    s_add_u32 s40, s40, 32768
    s_mov_b32 m0, 61440
    s_nop 0
    buffer_load_dwordx4 v4, s[12:15], s40 offen lds
    s_add_u32 s40, s40, 32768
    s_mov_b32 m0, 62464
    s_nop 0
    buffer_load_dwordx4 v4, s[12:15], s40 offen lds
    s_add_u32 s40, s40, 32768
    s_mov_b32 m0, 63488
    s_nop 0
    buffer_load_dwordx4 v5, s[12:15], s40 offen lds
    s_add_u32 s40, s40, 32768
    s_mov_b32 m0, 64512
    s_nop 0
    buffer_load_dwordx4 v5, s[12:15], s40 offen lds
    s_waitcnt vmcnt(24)
    s_barrier
    v_add_u32 v7, 32768, v7
    v_add_u32 v8, 32768, v8
    ds_read_b64_tr_b16 a[232:233], v7 offset:0
    ds_read_b64_tr_b16 a[234:235], v7 offset:1024
    ds_read_b64_tr_b16 a[236:237], v7 offset:8192
    ds_read_b64_tr_b16 a[238:239], v7 offset:9216
    ds_read_b64_tr_b16 a[240:241], v8 offset:0
    ds_read_b64_tr_b16 a[242:243], v8 offset:1024
    ds_read_b64_tr_b16 a[244:245], v8 offset:8192
    ds_read_b64_tr_b16 a[246:247], v8 offset:9216
    ds_read_b64_tr_b16 v[34:35], v7 offset:16384
    ds_read_b64_tr_b16 v[36:37], v7 offset:17408
    ds_read_b64_tr_b16 v[38:39], v7 offset:24576
    ds_read_b64_tr_b16 v[40:41], v7 offset:25600
    ds_read_b64_tr_b16 a[248:249], v8 offset:16384
    ds_read_b64_tr_b16 a[250:251], v8 offset:17408
    ds_read_b64_tr_b16 a[252:253], v8 offset:24576
    ds_read_b64_tr_b16 a[254:255], v8 offset:25600
    s_waitcnt lgkmcnt(0)
    s_barrier
    s_mov_b32 s12, s62
    s_mov_b32 s13, s63
    s_lshl_b32 s40, s20, 8
    s_add_u32 s40, s40, 1835008
    s_mov_b32 m0, 90112
    s_nop 0
    buffer_load_dwordx4 v4, s[12:15], s40 offen lds
    s_add_u32 s40, s40, 32768
    s_mov_b32 m0, 91136
    s_nop 0
    buffer_load_dwordx4 v4, s[12:15], s40 offen lds
    s_add_u32 s40, s40, 32768
    s_mov_b32 m0, 92160
    s_nop 0
    buffer_load_dwordx4 v5, s[12:15], s40 offen lds
    s_add_u32 s40, s40, 32768
    s_mov_b32 m0, 93184
    s_nop 0
    buffer_load_dwordx4 v5, s[12:15], s40 offen lds
    s_add_u32 s40, s40, 32768
    s_mov_b32 m0, 94208
    s_nop 0
    buffer_load_dwordx4 v4, s[12:15], s40 offen lds
    s_add_u32 s40, s40, 32768
    s_mov_b32 m0, 95232
    s_nop 0
    buffer_load_dwordx4 v4, s[12:15], s40 offen lds
    s_add_u32 s40, s40, 32768
    s_mov_b32 m0, 96256
    s_nop 0
    buffer_load_dwordx4 v5, s[12:15], s40 offen lds
    s_add_u32 s40, s40, 32768
    s_mov_b32 m0, 97280
    s_nop 0
    buffer_load_dwordx4 v5, s[12:15], s40 offen lds
    s_waitcnt vmcnt(24)
    s_barrier
    v_add_u32 v7, 32768, v7
    v_add_u32 v8, 32768, v8
    ds_read_b64_tr_b16 v[232:233], v7 offset:0
    ds_read_b64_tr_b16 v[234:235], v7 offset:1024
    ds_read_b64_tr_b16 v[236:237], v7 offset:8192
    ds_read_b64_tr_b16 v[238:239], v7 offset:9216
    ds_read_b64_tr_b16 v[42:43], v8 offset:0
    ds_read_b64_tr_b16 v[44:45], v8 offset:1024
    ds_read_b64_tr_b16 v[46:47], v8 offset:8192
    ds_read_b64_tr_b16 v[48:49], v8 offset:9216
    ds_read_b64_tr_b16 v[240:241], v7 offset:16384
    ds_read_b64_tr_b16 v[242:243], v7 offset:17408
    ds_read_b64_tr_b16 v[244:245], v7 offset:24576
    ds_read_b64_tr_b16 v[246:247], v7 offset:25600
    ds_read_b64_tr_b16 v[248:249], v8 offset:16384
    ds_read_b64_tr_b16 v[250:251], v8 offset:17408
    ds_read_b64_tr_b16 v[252:253], v8 offset:24576
    ds_read_b64_tr_b16 v[254:255], v8 offset:25600
    s_waitcnt lgkmcnt(0)
    s_barrier
    s_mov_b32 s12, s62
    s_mov_b32 s13, s63
    s_lshl_b32 s40, s20, 8
    s_add_u32 s40, s40, 2883584
    s_mov_b32 m0, 122880
    s_nop 0
    buffer_load_dwordx4 v4, s[12:15], s40 offen lds
    s_add_u32 s40, s40, 32768
    s_mov_b32 m0, 123904
    s_nop 0
    buffer_load_dwordx4 v4, s[12:15], s40 offen lds
    s_add_u32 s40, s40, 32768
    s_mov_b32 m0, 124928
    s_nop 0
    buffer_load_dwordx4 v5, s[12:15], s40 offen lds
    s_add_u32 s40, s40, 32768
    s_mov_b32 m0, 125952
    s_nop 0
    buffer_load_dwordx4 v5, s[12:15], s40 offen lds
    s_add_u32 s40, s40, 32768
    s_mov_b32 m0, 126976
    s_nop 0
    buffer_load_dwordx4 v4, s[12:15], s40 offen lds
    s_add_u32 s40, s40, 32768
    s_mov_b32 m0, 128000
    s_nop 0
    buffer_load_dwordx4 v4, s[12:15], s40 offen lds
    s_add_u32 s40, s40, 32768
    s_mov_b32 m0, 129024
    s_nop 0
    buffer_load_dwordx4 v5, s[12:15], s40 offen lds
    s_add_u32 s40, s40, 32768
    s_mov_b32 m0, 130048
    s_nop 0
    buffer_load_dwordx4 v5, s[12:15], s40 offen lds
    s_waitcnt vmcnt(24)
    s_barrier
    v_add_u32 v7, 32768, v7
    v_add_u32 v8, 32768, v8
    ds_read_b64_tr_b16 a[208:209], v7 offset:0
    ds_read_b64_tr_b16 a[210:211], v7 offset:1024
    ds_read_b64_tr_b16 a[212:213], v7 offset:8192
    ds_read_b64_tr_b16 a[214:215], v7 offset:9216
    ds_read_b64_tr_b16 a[216:217], v8 offset:0
    ds_read_b64_tr_b16 a[218:219], v8 offset:1024
    ds_read_b64_tr_b16 a[220:221], v8 offset:8192
    ds_read_b64_tr_b16 a[222:223], v8 offset:9216
    ds_read_b64_tr_b16 a[64:65], v7 offset:16384
    ds_read_b64_tr_b16 a[66:67], v7 offset:17408
    ds_read_b64_tr_b16 a[68:69], v7 offset:24576
    ds_read_b64_tr_b16 a[70:71], v7 offset:25600
    ds_read_b64_tr_b16 a[72:73], v8 offset:16384
    ds_read_b64_tr_b16 a[74:75], v8 offset:17408
    ds_read_b64_tr_b16 a[76:77], v8 offset:24576
    ds_read_b64_tr_b16 a[78:79], v8 offset:25600
    s_waitcnt lgkmcnt(0)
    s_barrier
    s_mov_b32 s12, s62
    s_mov_b32 s13, s63
    s_lshl_b32 s40, s20, 8
    s_add_u32 s40, s40, 3932160
    s_mov_b32 m0, 155648
    s_nop 0
    buffer_load_dwordx4 v4, s[12:15], s40 offen lds
    s_add_u32 s40, s40, 32768
    s_mov_b32 m0, 156672
    s_nop 0
    buffer_load_dwordx4 v4, s[12:15], s40 offen lds
    s_add_u32 s40, s40, 32768
    s_mov_b32 m0, 157696
    s_nop 0
    buffer_load_dwordx4 v5, s[12:15], s40 offen lds
    s_add_u32 s40, s40, 32768
    s_mov_b32 m0, 158720
    s_nop 0
    buffer_load_dwordx4 v5, s[12:15], s40 offen lds
    s_add_u32 s40, s40, 32768
    s_mov_b32 m0, 159744
    s_nop 0
    buffer_load_dwordx4 v4, s[12:15], s40 offen lds
    s_add_u32 s40, s40, 32768
    s_mov_b32 m0, 160768
    s_nop 0
    buffer_load_dwordx4 v4, s[12:15], s40 offen lds
    s_add_u32 s40, s40, 32768
    s_mov_b32 m0, 161792
    s_nop 0
    buffer_load_dwordx4 v5, s[12:15], s40 offen lds
    s_add_u32 s40, s40, 32768
    s_mov_b32 m0, 162816
    s_nop 0
    buffer_load_dwordx4 v5, s[12:15], s40 offen lds
    buffer_load_dword v1, off, s[16:19], 0 offset:4 sc1
    s_waitcnt vmcnt(25)
    s_barrier
    v_add_u32 v7, 4294868992, v7
    v_add_u32 v8, 4294868992, v8
    ds_read_b64_tr_b16 a[152:153], v7 offset:0
    ds_read_b64_tr_b16 a[154:155], v7 offset:1024
    ds_read_b64_tr_b16 a[156:157], v7 offset:8192
    ds_read_b64_tr_b16 a[158:159], v7 offset:9216
    ds_read_b64_tr_b16 a[160:161], v8 offset:0
    ds_read_b64_tr_b16 a[162:163], v8 offset:1024
    ds_read_b64_tr_b16 a[164:165], v8 offset:8192
    ds_read_b64_tr_b16 a[166:167], v8 offset:9216
    ds_read_b64_tr_b16 a[16:17], v7 offset:16384
    ds_read_b64_tr_b16 a[18:19], v7 offset:17408
    ds_read_b64_tr_b16 a[20:21], v7 offset:24576
    ds_read_b64_tr_b16 a[22:23], v7 offset:25600
    ds_read_b64_tr_b16 a[24:25], v8 offset:16384
    ds_read_b64_tr_b16 a[26:27], v8 offset:17408
    ds_read_b64_tr_b16 a[28:29], v8 offset:24576
    ds_read_b64_tr_b16 a[30:31], v8 offset:25600
    s_waitcnt lgkmcnt(0)
    s_barrier
    s_mov_b32 s12, s60
    s_mov_b32 s13, s61
    s_lshl_b32 s40, s20, 8
    s_add_u32 s40, s40, 786432
    s_mov_b32 m0, 57344
    s_nop 0
    buffer_load_dwordx4 v4, s[12:15], s40 offen lds
    s_add_u32 s40, s40, 32768
    s_mov_b32 m0, 58368
    s_nop 0
    buffer_load_dwordx4 v4, s[12:15], s40 offen lds
    s_add_u32 s40, s40, 32768
    s_mov_b32 m0, 59392
    s_nop 0
    buffer_load_dwordx4 v5, s[12:15], s40 offen lds
    s_add_u32 s40, s40, 32768
    s_mov_b32 m0, 60416
    s_nop 0
    buffer_load_dwordx4 v5, s[12:15], s40 offen lds
    s_add_u32 s40, s40, 32768
    s_mov_b32 m0, 61440
    s_nop 0
    buffer_load_dwordx4 v4, s[12:15], s40 offen lds
    s_add_u32 s40, s40, 32768
    s_mov_b32 m0, 62464
    s_nop 0
    buffer_load_dwordx4 v4, s[12:15], s40 offen lds
    s_add_u32 s40, s40, 32768
    s_mov_b32 m0, 63488
    s_nop 0
    buffer_load_dwordx4 v5, s[12:15], s40 offen lds
    s_add_u32 s40, s40, 32768
    s_mov_b32 m0, 64512
    s_nop 0
    buffer_load_dwordx4 v5, s[12:15], s40 offen lds
    s_waitcnt vmcnt(25)
    s_barrier
    v_add_u32 v7, 32768, v7
    v_add_u32 v8, 32768, v8
    ds_read_b64_tr_b16 v[50:51], v7 offset:0
    ds_read_b64_tr_b16 v[52:53], v7 offset:1024
    ds_read_b64_tr_b16 v[54:55], v7 offset:8192
    ds_read_b64_tr_b16 v[56:57], v7 offset:9216
    ds_read_b64_tr_b16 a[168:169], v8 offset:0
    ds_read_b64_tr_b16 a[170:171], v8 offset:1024
    ds_read_b64_tr_b16 a[172:173], v8 offset:8192
    ds_read_b64_tr_b16 a[174:175], v8 offset:9216
    ds_read_b64_tr_b16 a[176:177], v7 offset:16384
    ds_read_b64_tr_b16 a[178:179], v7 offset:17408
    ds_read_b64_tr_b16 a[180:181], v7 offset:24576
    ds_read_b64_tr_b16 a[182:183], v7 offset:25600
    ds_read_b64_tr_b16 a[184:185], v8 offset:16384
    ds_read_b64_tr_b16 a[186:187], v8 offset:17408
    ds_read_b64_tr_b16 a[188:189], v8 offset:24576
    ds_read_b64_tr_b16 a[190:191], v8 offset:25600
    s_waitcnt lgkmcnt(0)
    s_barrier
    s_mov_b32 s12, s60
    s_mov_b32 s13, s61
    s_lshl_b32 s40, s20, 8
    s_add_u32 s40, s40, 1835008
    s_mov_b32 m0, 90112
    s_nop 0
    buffer_load_dwordx4 v4, s[12:15], s40 offen lds
    s_add_u32 s40, s40, 32768
    s_mov_b32 m0, 91136
    s_nop 0
    buffer_load_dwordx4 v4, s[12:15], s40 offen lds
    s_add_u32 s40, s40, 32768
    s_mov_b32 m0, 92160
    s_nop 0
    buffer_load_dwordx4 v5, s[12:15], s40 offen lds
    s_add_u32 s40, s40, 32768
    s_mov_b32 m0, 93184
    s_nop 0
    buffer_load_dwordx4 v5, s[12:15], s40 offen lds
    s_add_u32 s40, s40, 32768
    s_mov_b32 m0, 94208
    s_nop 0
    buffer_load_dwordx4 v4, s[12:15], s40 offen lds
    s_add_u32 s40, s40, 32768
    s_mov_b32 m0, 95232
    s_nop 0
    buffer_load_dwordx4 v4, s[12:15], s40 offen lds
    s_add_u32 s40, s40, 32768
    s_mov_b32 m0, 96256
    s_nop 0
    buffer_load_dwordx4 v5, s[12:15], s40 offen lds
    s_add_u32 s40, s40, 32768
    s_mov_b32 m0, 97280
    s_nop 0
    buffer_load_dwordx4 v5, s[12:15], s40 offen lds
    s_waitcnt vmcnt(25)
    s_barrier
    v_add_u32 v7, 32768, v7
    v_add_u32 v8, 32768, v8
    ds_read_b64_tr_b16 v[58:59], v7 offset:0
    ds_read_b64_tr_b16 v[60:61], v7 offset:1024
    ds_read_b64_tr_b16 v[62:63], v7 offset:8192
    ds_read_b64_tr_b16 v[64:65], v7 offset:9216
    ds_read_b64_tr_b16 a[192:193], v8 offset:0
    ds_read_b64_tr_b16 a[194:195], v8 offset:1024
    ds_read_b64_tr_b16 a[196:197], v8 offset:8192
    ds_read_b64_tr_b16 a[198:199], v8 offset:9216
    ds_read_b64_tr_b16 a[200:201], v7 offset:16384
    ds_read_b64_tr_b16 a[202:203], v7 offset:17408
    ds_read_b64_tr_b16 a[204:205], v7 offset:24576
    ds_read_b64_tr_b16 a[206:207], v7 offset:25600
    ds_read_b64_tr_b16 v[66:67], v8 offset:16384
    ds_read_b64_tr_b16 v[68:69], v8 offset:17408
    ds_read_b64_tr_b16 v[70:71], v8 offset:24576
    ds_read_b64_tr_b16 v[72:73], v8 offset:25600
    s_waitcnt lgkmcnt(0)
    s_barrier
    s_mov_b32 s12, s60
    s_mov_b32 s13, s61
    s_lshl_b32 s40, s20, 8
    s_add_u32 s40, s40, 2883584
    s_mov_b32 m0, 122880
    s_nop 0
    buffer_load_dwordx4 v4, s[12:15], s40 offen lds
    s_add_u32 s40, s40, 32768
    s_mov_b32 m0, 123904
    s_nop 0
    buffer_load_dwordx4 v4, s[12:15], s40 offen lds
    s_add_u32 s40, s40, 32768
    s_mov_b32 m0, 124928
    s_nop 0
    buffer_load_dwordx4 v5, s[12:15], s40 offen lds
    s_add_u32 s40, s40, 32768
    s_mov_b32 m0, 125952
    s_nop 0
    buffer_load_dwordx4 v5, s[12:15], s40 offen lds
    s_add_u32 s40, s40, 32768
    s_mov_b32 m0, 126976
    s_nop 0
    buffer_load_dwordx4 v4, s[12:15], s40 offen lds
    s_add_u32 s40, s40, 32768
    s_mov_b32 m0, 128000
    s_nop 0
    buffer_load_dwordx4 v4, s[12:15], s40 offen lds
    s_add_u32 s40, s40, 32768
    s_mov_b32 m0, 129024
    s_nop 0
    buffer_load_dwordx4 v5, s[12:15], s40 offen lds
    s_add_u32 s40, s40, 32768
    s_mov_b32 m0, 130048
    s_nop 0
    buffer_load_dwordx4 v5, s[12:15], s40 offen lds
    s_waitcnt vmcnt(25)
    s_barrier
    v_add_u32 v7, 32768, v7
    v_add_u32 v8, 32768, v8
    ds_read_b64_tr_b16 a[144:145], v7 offset:0
    ds_read_b64_tr_b16 a[146:147], v7 offset:1024
    ds_read_b64_tr_b16 a[148:149], v7 offset:8192
    ds_read_b64_tr_b16 a[150:151], v7 offset:9216
    ds_read_b64_tr_b16 v[74:75], v8 offset:0
    ds_read_b64_tr_b16 v[76:77], v8 offset:1024
    ds_read_b64_tr_b16 v[78:79], v8 offset:8192
    ds_read_b64_tr_b16 v[80:81], v8 offset:9216
    ds_read_b64_tr_b16 v[106:107], v7 offset:16384
    ds_read_b64_tr_b16 v[108:109], v7 offset:17408
    ds_read_b64_tr_b16 v[110:111], v7 offset:24576
    ds_read_b64_tr_b16 v[112:113], v7 offset:25600
    ds_read_b64_tr_b16 a[56:57], v8 offset:16384
    ds_read_b64_tr_b16 a[58:59], v8 offset:17408
    ds_read_b64_tr_b16 a[60:61], v8 offset:24576
    ds_read_b64_tr_b16 a[62:63], v8 offset:25600
    s_waitcnt lgkmcnt(0)
    s_barrier
    s_mov_b32 s12, s60
    s_mov_b32 s13, s61
    s_lshl_b32 s40, s20, 8
    s_add_u32 s40, s40, 3932160
    s_mov_b32 m0, 155648
    s_nop 0
    buffer_load_dwordx4 v4, s[12:15], s40 offen lds
    s_add_u32 s40, s40, 32768
    s_mov_b32 m0, 156672
    s_nop 0
    buffer_load_dwordx4 v4, s[12:15], s40 offen lds
    s_add_u32 s40, s40, 32768
    s_mov_b32 m0, 157696
    s_nop 0
    buffer_load_dwordx4 v5, s[12:15], s40 offen lds
    s_add_u32 s40, s40, 32768
    s_mov_b32 m0, 158720
    s_nop 0
    buffer_load_dwordx4 v5, s[12:15], s40 offen lds
    s_add_u32 s40, s40, 32768
    s_mov_b32 m0, 159744
    s_nop 0
    buffer_load_dwordx4 v4, s[12:15], s40 offen lds
    s_add_u32 s40, s40, 32768
    s_mov_b32 m0, 160768
    s_nop 0
    buffer_load_dwordx4 v4, s[12:15], s40 offen lds
    s_add_u32 s40, s40, 32768
    s_mov_b32 m0, 161792
    s_nop 0
    buffer_load_dwordx4 v5, s[12:15], s40 offen lds
    s_add_u32 s40, s40, 32768
    s_mov_b32 m0, 162816
    s_nop 0
    buffer_load_dwordx4 v5, s[12:15], s40 offen lds
    s_waitcnt vmcnt(24)
    s_barrier
    v_add_u32 v7, 4294868992, v7
    v_add_u32 v8, 4294868992, v8
    ds_read_b64_tr_b16 a[88:89], v7 offset:0
    ds_read_b64_tr_b16 a[90:91], v7 offset:1024
    ds_read_b64_tr_b16 a[92:93], v7 offset:8192
    ds_read_b64_tr_b16 a[94:95], v7 offset:9216
    ds_read_b64_tr_b16 v[114:115], v8 offset:0
    ds_read_b64_tr_b16 v[116:117], v8 offset:1024
    ds_read_b64_tr_b16 v[118:119], v8 offset:8192
    ds_read_b64_tr_b16 v[120:121], v8 offset:9216
    ds_read_b64_tr_b16 a[0:1], v7 offset:16384
    ds_read_b64_tr_b16 a[2:3], v7 offset:17408
    ds_read_b64_tr_b16 a[4:5], v7 offset:24576
    ds_read_b64_tr_b16 a[6:7], v7 offset:25600
    ds_read_b64_tr_b16 a[8:9], v8 offset:16384
    ds_read_b64_tr_b16 a[10:11], v8 offset:17408
    ds_read_b64_tr_b16 a[12:13], v8 offset:24576
    ds_read_b64_tr_b16 a[14:15], v8 offset:25600
    s_waitcnt lgkmcnt(0)
    s_barrier
    v_add_u32 v13, 38912, v6
    ds_write_b128 v13, v[82:85]
    ds_write_b128 v13, v[86:89] offset:1024
    v_add_u32 v13, 47104, v6
    ds_write_b128 v13, v[90:93]
    ds_write_b128 v13, v[94:97] offset:1024
    v_add_u32 v13, 55296, v6
    ds_write_b128 v13, v[98:101]
    ds_write_b128 v13, v[102:105] offset:1024
    v_add_u32 v13, 63488, v6
    ds_write_b128 v13, v[18:21]
    ds_write_b128 v13, v[22:25] offset:1024
    v_readfirstlane_b32 s74, v1
    s_and_b32 s40, s74, 0xffff
    s_cmp_eq_u32 s40, 8224
    s_cbranch_scc1 L_c3_rdy
    s_nop 1
L_c3_rdyl:
    buffer_load_dword v1, off, s[16:19], 0 offset:4 sc1
    s_sub_u32 s22, s22, 1
    s_cbranch_scc1 L_exit
    s_waitcnt vmcnt(0)
    v_readfirstlane_b32 s74, v1
    s_and_b32 s40, s74, 0xffff
    s_cmp_lg_u32 s40, 8224
    s_cbranch_scc1 L_c3_rdyl
    s_nop 1
L_c3_rdy:
    s_waitcnt vmcnt(16)
    s_barrier
    v_add_u32 v7, 32768, v7
    v_add_u32 v8, 32768, v8
    ds_read_b64_tr_b16 a[96:97], v7 offset:0
    ds_read_b64_tr_b16 a[98:99], v7 offset:1024
    ds_read_b64_tr_b16 a[100:101], v7 offset:8192
    ds_read_b64_tr_b16 a[102:103], v7 offset:9216
    ds_read_b64_tr_b16 a[104:105], v8 offset:0
    ds_read_b64_tr_b16 a[106:107], v8 offset:1024
    ds_read_b64_tr_b16 a[108:109], v8 offset:8192
    ds_read_b64_tr_b16 a[110:111], v8 offset:9216
    ds_read_b64_tr_b16 v[18:19], v7 offset:16384
    ds_read_b64_tr_b16 v[20:21], v7 offset:17408
    ds_read_b64_tr_b16 v[22:23], v7 offset:24576
    ds_read_b64_tr_b16 v[24:25], v7 offset:25600
    ds_read_b64_tr_b16 a[112:113], v8 offset:16384
    ds_read_b64_tr_b16 a[114:115], v8 offset:17408
    ds_read_b64_tr_b16 a[116:117], v8 offset:24576
    ds_read_b64_tr_b16 a[118:119], v8 offset:25600
    s_waitcnt lgkmcnt(0)
    s_barrier
    v_add_u32 v13, 71680, v6
    ds_write_b128 v13, v[26:29]
    ds_write_b128 v13, v[30:33] offset:1024
    v_add_u32 v13, 79872, v6
    ds_write_b128 v13, v[34:37]
    ds_write_b128 v13, v[38:41] offset:1024
    v_add_u32 v13, 88064, v6
    ds_write_b128 v13, v[42:45]
    ds_write_b128 v13, v[46:49] offset:1024
    v_add_u32 v13, 96256, v6
    ds_write_b128 v13, v[50:53]
    ds_write_b128 v13, v[54:57] offset:1024
    v_and_b32 v14, 1, v10
    v_lshlrev_b32 v14, 20, v14
    v_add_u32 v14, s37, v14
    buffer_load_dword v1, v14, s[8:11], 0 offen sc1
    s_waitcnt vmcnt(9)
    s_barrier
    v_add_u32 v7, 32768, v7
    v_add_u32 v8, 32768, v8
    ds_read_b64_tr_b16 a[120:121], v7 offset:0
    ds_read_b64_tr_b16 a[122:123], v7 offset:1024
    ds_read_b64_tr_b16 a[124:125], v7 offset:8192
    ds_read_b64_tr_b16 a[126:127], v7 offset:9216
    ds_read_b64_tr_b16 a[128:129], v8 offset:0
    ds_read_b64_tr_b16 a[130:131], v8 offset:1024
    ds_read_b64_tr_b16 a[132:133], v8 offset:8192
    ds_read_b64_tr_b16 a[134:135], v8 offset:9216
    ds_read_b64_tr_b16 v[26:27], v7 offset:16384
    ds_read_b64_tr_b16 v[28:29], v7 offset:17408
    ds_read_b64_tr_b16 v[30:31], v7 offset:24576
    ds_read_b64_tr_b16 v[32:33], v7 offset:25600
    ds_read_b64_tr_b16 a[136:137], v8 offset:16384
    ds_read_b64_tr_b16 a[138:139], v8 offset:17408
    ds_read_b64_tr_b16 a[140:141], v8 offset:24576
    ds_read_b64_tr_b16 a[142:143], v8 offset:25600
    s_waitcnt lgkmcnt(0)
    s_barrier
    v_add_u32 v13, 104448, v6
    ds_write_b128 v13, v[58:61]
    ds_write_b128 v13, v[62:65] offset:1024
    v_add_u32 v13, 112640, v6
    ds_write_b128 v13, v[66:69]
    ds_write_b128 v13, v[70:73] offset:1024
    v_add_u32 v13, 120832, v6
    ds_write_b128 v13, v[74:77]
    ds_write_b128 v13, v[78:81] offset:1024
    v_add_u32 v13, 129024, v6
    ds_write_b128 v13, v[106:109]
    ds_write_b128 v13, v[110:113] offset:1024
    s_waitcnt vmcnt(1)
    s_barrier
    v_add_u32 v7, 32768, v7
    v_add_u32 v8, 32768, v8
    ds_read_b64_tr_b16 v[34:35], v7 offset:0
    ds_read_b64_tr_b16 v[36:37], v7 offset:1024
    ds_read_b64_tr_b16 v[38:39], v7 offset:8192
    ds_read_b64_tr_b16 v[40:41], v7 offset:9216
    ds_read_b64_tr_b16 a[80:81], v8 offset:0
    ds_read_b64_tr_b16 a[82:83], v8 offset:1024
    ds_read_b64_tr_b16 a[84:85], v8 offset:8192
    ds_read_b64_tr_b16 a[86:87], v8 offset:9216
    ds_read_b64_tr_b16 a[40:41], v7 offset:16384
    ds_read_b64_tr_b16 a[42:43], v7 offset:17408
    ds_read_b64_tr_b16 a[44:45], v7 offset:24576
    ds_read_b64_tr_b16 a[46:47], v7 offset:25600
    ds_read_b64_tr_b16 a[48:49], v8 offset:16384
    ds_read_b64_tr_b16 a[50:51], v8 offset:17408
    ds_read_b64_tr_b16 a[52:53], v8 offset:24576
    ds_read_b64_tr_b16 a[54:55], v8 offset:25600
    s_waitcnt lgkmcnt(0)
    s_barrier
    v_add_u32 v13, 137216, v6
    ds_write_b128 v13, v[114:117]
    ds_write_b128 v13, v[118:121] offset:1024
    v_add_u32 v13, 145408, v6
    ds_write_b128 v13, v[18:21]
    ds_write_b128 v13, v[22:25] offset:1024
    v_add_u32 v13, 153600, v6
    ds_write_b128 v13, v[26:29]
    ds_write_b128 v13, v[30:33] offset:1024
    v_add_u32 v13, 161792, v6
    ds_write_b128 v13, v[34:37]
    ds_write_b128 v13, v[38:41] offset:1024
    s_waitcnt vmcnt(0)
    v_cmp_eq_u32 vcc, -1, v1
    s_cbranch_vccz L_c3_kv
    s_nop 3
L_c3_kvl:
    buffer_load_dword v1, v14, s[8:11], 0 offen sc1
    s_sub_u32 s22, s22, 1
    s_cbranch_scc1 L_exit
    s_waitcnt vmcnt(0)
    v_cmp_eq_u32 vcc, -1, v1
    s_cbranch_vccnz L_c3_kvl
    s_nop 3
L_c3_kv:
    s_lshl_b32 s34, s20, 12
    s_add_u32 s34, s34, 16780288
    s_add_u32 s72, s34, 0x40000
    v_add_u32 v14, 0x20000, v6
    s_lshl_b32 s29, s20, 13
    s_add_u32 s29, s29, 6144
    s_waitcnt lgkmcnt(0)
    buffer_load_dwordx4 v[80:83], v6, s[8:11], s34 offen sc1
    buffer_load_dwordx4 v[84:87], v14, s[8:11], s34 offen sc1
    buffer_load_dwordx4 v[88:91], v6, s[8:11], s72 offen sc1
    buffer_load_dwordx4 v[92:95], v14, s[8:11], s72 offen sc1
    buffer_load_dwordx4 v[96:99], v6, s[8:11], s29 offen offset:0 sc1
    buffer_load_dwordx4 v[100:103], v6, s[8:11], s29 offen offset:1024 sc1
    s_lshl_b32 s36, s20, 6
    s_add_u32 s36, s36, 6144
    v_mbcnt_lo_u32_b32 v141, -1, 0
    v_mbcnt_hi_u32_b32 v141, -1, v141
    v_and_b32 v106, 15, v141
    v_lshrrev_b32 v107, 4, v141
    v_lshrrev_b32 v108, 2, v106
    v_bfe_u32 v109, v106, 1, 1
    v_and_b32 v123, 1, v106
    v_lshl_add_u32 v122, v108, 1, v123
    s_mov_b32 s24, 0xcccccccc
    s_mov_b32 s25, 0xcccccccc
    s_mov_b32 s26, 0x33333333
    s_mov_b32 s27, 0x33333333
    s_mov_b32 s70, 0x3f803f80
    s_mov_b32 s71, 0x3f803f80
    v_lshlrev_b32 v127, 4, v141
    v_add_u32 v128, 0x10000, v127
    v_add_u32 v129, 0x20000, v127
    v_mov_b32 v126, 0x4444
    v_mov_b32 v124, 0xeeee
    v_cndmask_b32 v126, v126, v124, s[24:25]
    v_lshlrev_b32 v123, 4, v123
    v_mov_b32 v124, 0x3f80
    v_lshlrev_b32 v124, v123, v124
    v_cndmask_b32 v124, v124, 0, s[24:25]
    v_cmp_eq_u32 vcc, 0, v108
    s_nop 1
    v_cndmask_b32 v114, 0, v124, vcc
    v_cmp_eq_u32 vcc, 1, v108
    s_nop 1
    v_cndmask_b32 v115, 0, v124, vcc
    v_cmp_eq_u32 vcc, 2, v108
    s_nop 1
    v_cndmask_b32 v116, 0, v124, vcc
    v_cmp_eq_u32 vcc, 3, v108
    s_nop 1
    v_cndmask_b32 v117, 0, v124, vcc
    ds_write_b128 v127, v[114:117] offset:13312
    v_mov_b32 v118, 0
    v_mov_b32 v119, 0
    v_mov_b32 v120, 0
    v_mov_b32 v121, 0
    v_mov_b32 v123, 12800
    ds_write_b128 v123, v[118:121]
    v_lshrrev_b32 v123, 3, v106
    v_lshlrev_b32 v123, 15, v123
    v_lshl_add_u32 v123, v107, 13, v123
    v_and_b32 v124, 7, v106
    v_lshl_add_u32 v123, v124, 3, v123
    v_lshrrev_b32 v124, 11, v123
    v_add_u32 v124, s20, v124
    v_add_u32 v124, 6, v124
    v_and_b32 v124, 31, v124
    v_lshl_add_u32 v123, v124, 6, v123
    v_add_u32 v130, 196608, v123
    s_mov_b32 s69, 4096
    v_and_b32 v124, 3, v106
    v_lshlrev_b32 v123, 4, v107
    v_lshl_add_u32 v123, v124, 2, v123
    v_add_u32 v123, s36, v123
    v_mov_b32 v124, 0x40000000
    v_cmp_gt_u32 vcc, 4, v106
    s_nop 1
    v_cndmask_b32 v131, v124, v123, vcc
    s_lshl_b32 s40, s20, 8
    v_add_u32 v123, s40, v127
    v_cmp_gt_u32 vcc, 16, v141
    s_nop 1
    v_cndmask_b32 v137, v124, v123, vcc
    s_lshl_b32 s35, s20, 4
    s_add_u32 s35, s35, 262144
    v_xor_b32 v125, v107, v108
    v_lshlrev_b32 v125, 3, v125
    v_lshl_add_u32 v143, v106, 5, v125
    v_lshlrev_b32 v125, 3, v141
    v_lshlrev_b32 v123, 3, v107
    v_xor_b32 v140, v125, v123
    v_lshrrev_b32 v125, 1, v107
    v_lshl_add_u32 v125, v122, 2, v125
    v_lshlrev_b32 v125, 4, v125
    v_and_b32 v123, 1, v107
    v_lshl_add_u32 v125, v123, 2, v125
    v_lshl_add_u32 v125, v109, 1, v125
    v_add_u32 v132, 12328, v125
    v_lshl_add_u32 v123, v122, 2, v107
    v_lshlrev_b32 v123, 4, v123
    v_add_u32 v123, 12288, v123
    v_mov_b32 v124, 12800
    v_cndmask_b32 v133, v123, v124, s[24:25]
    v_cndmask_b32 v134, v124, v123, s[24:25]
    v_mul_u32_u24 v123, 288, v122
    v_lshl_add_u32 v124, v109, 5, v123
    v_lshl_add_u32 v135, v107, 3, v124
    v_lshl_add_u32 v136, v107, 4, v123
    v_lshlrev_b32 v124, 7, v141
    v_mov_b32 v125, 0x40000000
    v_cmp_gt_u32 vcc, 0, v141
    s_nop 1
    v_cndmask_b32 v124, v125, v124, vcc
    s_add_u32 s40, s36, 18612224
    s_sub_u32 s40, s40, s34
    v_mov_b32 v125, s40
    v_cmp_gt_u32 vcc, 32, v141
    s_nop 1
    v_cndmask_b32 v124, v125, v124, vcc
    s_add_u32 s40, s37, 1048576
    s_sub_u32 s40, s40, s34
    v_mov_b32 v125, s40
    v_cmp_gt_u32 vcc, 33, v141
    s_nop 1
    v_cndmask_b32 v124, v125, v124, vcc
    v_mov_b32 v125, 0x40000000
    v_cmp_gt_u32 vcc, 34, v141
    s_nop 1
    v_cndmask_b32 v139, v125, v124, vcc
    buffer_load_dword v138, v139, s[8:11], s34 offen sc1
    s_mov_b32 s30, 17564672
    s_mov_b32 s68, 17570816
    s_mov_b32 s32, 17563648
    s_mov_b32 s33, 17571840
    s_mov_b32 s28, 0
    s_mov_b32 s38, 0
    s_mov_b32 s39, 1040356334
    s_mov_b32 s44, 729808896
    s_mov_b32 s45, 671088640
    s_mov_b32 s31, 262144
    s_lshr_b32 s5, s74, 16
    s_cmp_eq_u32 s5, 0
    s_cbranch_scc0 L_chain_slow3
    s_add_u32 s34, s34, 1048576
    s_add_u32 s72, s72, 1048576
    s_add_u32 s37, s37, 1048576
    s_mov_b32 s43, 1
    s_mov_b32 s28, 1
    ds_read_b128 v[32:35], v128 offset:6144
    ds_read_b128 v[36:39], v128 offset:7168
    ds_read_b128 v[40:43], v128 offset:63488
    ds_read_b128 v[44:47], v128 offset:64512
    v_mov_b64 v[56:57], 0
    v_mov_b64 v[58:59], 0
    v_mov_b64 v[60:61], 0
    v_mov_b64 v[62:63], 0
    v_mov_b64 v[64:65], 0
    v_mov_b64 v[66:67], 0
    v_mov_b64 v[68:69], 0
    v_mov_b64 v[70:71], 0
    v_mov_b64 v[72:73], 0
    v_mov_b64 v[74:75], 0
    v_mov_b64 v[76:77], 0
    v_mov_b64 v[78:79], 0
    v_mov_b32 v142, s43
    s_waitcnt lgkmcnt(0)
    buffer_load_dwordx4 v[4:7], v127, s[8:11], s30 offen sc1
    buffer_load_dwordx4 v[28:31], v127, s[8:11], s68 offen sc1
    s_branch LF3_bAw
.p2align 6
LF3_pollP:
    s_waitcnt vmcnt(1)
    v_mfma_f32_16x16x32_bf16 v[110:113], v[122:125], v[0:3], 0
    v_bitop3_b32 v141, v0, s28, 1 bitop3:0x28
    s_waitcnt vmcnt(0)
    v_mfma_f32_16x16x32_bf16 v[110:113], v[122:125], v[4:7], v[110:113]
    v_bitop3_b32 v141, v4, s28, v141 bitop3:0x28
    v_cmp_ne_u32 vcc, 1, v141
    s_nop 2
    s_cbranch_vccnz LF3_retryP
LF3_Pok:
    s_nop 0
    v_add_f32_dpp v110, v110, v110 row_ror:4 row_mask:0xf bank_mask:0xf
    v_add_f32_dpp v111, v111, v111 row_ror:4 row_mask:0xf bank_mask:0xf
    s_cmp_ge_u32 s38, 63
    v_add_f32_dpp v110, v110, v110 row_ror:8 row_mask:0xf bank_mask:0xf
    v_add_f32_dpp v111, v111, v111 row_ror:8 row_mask:0xf bank_mask:0xf
    v_cvt_pk_bf16_f32 v112, v110, v111
LF3_Mst:
    buffer_store_dword v112, v131, s[8:11], s32 offen
    s_cbranch_scc1 LF3_done
    v_readlane_b32 s41, v138, 33
    s_cmp_eq_u32 s41, -1
    s_cbranch_scc1 LF3_slowflag
LF3_flagok:
    buffer_load_dwordx4 v[4:7], v127, s[8:11], s30 offen sc1
    s_waitcnt vmcnt(1)
    s_nop 2
    buffer_load_dwordx4 v[28:31], v127, s[8:11], s68 offen sc1
LF3_bAw:
    s_waitcnt vmcnt(1)
LF3_bA:
    v_smfmac_f32_16x16x64_bf16 v[56:59], v[4:7], a[0:7], v126
    v_cmp_eq_u32 vcc, -1, v4
    v_smfmac_f32_16x16x64_bf16 v[60:63], v[4:7], a[8:15], v126
    v_smfmac_f32_16x16x64_bf16 v[64:67], v[4:7], a[16:23], v126
    s_cbranch_vccnz LF3_retryE
    v_smfmac_f32_16x16x64_bf16 v[68:71], v[4:7], a[24:31], v126
    v_mov_b64 v[124:125], s[70:71]
    v_smfmac_f32_16x16x64_bf16 v[72:75], v[4:7], a[32:39], v126
    v_smfmac_f32_16x16x64_bf16 v[76:79], v[4:7], v[32:39], v126
    ds_read_b128 v[36:39], v129 offset:31744
    ds_write_b128 v127, v[4:7] offset:1024
    s_waitcnt vmcnt(0)
    v_cmp_eq_u32 vcc, -1, v28
    ds_write_b128 v127, v[28:31] offset:7168
    s_cbranch_vccnz LF3_retryL
LF3_Lok:
    v_smfmac_f32_16x16x64_bf16 v[56:59], v[28:31], a[40:47], v126
    ds_read_b128 v[32:35], v129 offset:30720
    v_smfmac_f32_16x16x64_bf16 v[60:63], v[28:31], a[48:55], v126
    v_mov_b64 v[4:5], 0
    v_smfmac_f32_16x16x64_bf16 v[64:67], v[28:31], v[40:47], v126
    s_waitcnt lgkmcnt(2)
    s_waitcnt lgkmcnt(1)
    s_barrier
    ds_read_b128 v[24:27], v127 offset:6144
    v_smfmac_f32_16x16x64_bf16 v[68:71], v[28:31], a[56:63], v126
    ds_read_b128 v[40:43], v129 offset:6144
    ds_read_b128 v[0:3], v127 offset:0
    v_smfmac_f32_16x16x64_bf16 v[72:75], v[28:31], a[64:71], v126
    buffer_load_dwordx4 v[96:99], v127, s[8:11], s72 offen sc1
    v_smfmac_f32_16x16x64_bf16 v[76:79], v[28:31], a[72:79], v126
    ds_read_b128 v[44:47], v129 offset:7168
    ds_read_b128 v[8:11], v127 offset:2048
    s_waitcnt lgkmcnt(4)
    v_smfmac_f32_16x16x64_bf16 v[56:59], v[24:27], v[32:39], v126
    ds_read_b128 v[12:15], v127 offset:3072
    v_smfmac_f32_16x16x64_bf16 v[60:63], v[24:27], a[80:87], v126
    ds_read_b128 v[32:35], v129 offset:14336
    ds_read_b128 v[36:39], v129 offset:15360
    s_waitcnt lgkmcnt(5)
    v_smfmac_f32_16x16x64_bf16 v[56:59], v[0:3], a[88:95], v126
    buffer_load_dwordx4 v[100:103], v129, s[8:11], s72 offen sc1
    s_waitcnt lgkmcnt(4)
    v_smfmac_f32_16x16x64_bf16 v[60:63], v[0:3], v[40:47], v126
    ds_read_b128 v[44:47], v129 offset:23552
    ds_read_b128 v[16:19], v127 offset:4096
    s_waitcnt lgkmcnt(5)
    v_smfmac_f32_16x16x64_bf16 v[56:59], v[8:11], a[96:103], v126
    buffer_load_dword v138, v139, s[8:11], s34 offen sc1
    v_smfmac_f32_16x16x64_bf16 v[60:63], v[8:11], a[104:111], v126
    ds_read_b128 v[20:23], v127 offset:5120
    s_waitcnt lgkmcnt(3)
    v_smfmac_f32_16x16x64_bf16 v[56:59], v[12:15], v[32:39], v126
    ds_read_b128 v[40:43], v129 offset:22528
    v_smfmac_f32_16x16x64_bf16 v[60:63], v[12:15], a[112:119], v126
    ds_read_b128 v[36:39], v128 offset:56320
    s_waitcnt lgkmcnt(3)
    v_smfmac_f32_16x16x64_bf16 v[56:59], v[16:19], a[120:127], v126
    ds_read_b128 v[32:35], v128 offset:55296
    v_smfmac_f32_16x16x64_bf16 v[60:63], v[16:19], a[128:135], v126
    buffer_load_dwordx4 v[48:51], v127, s[8:11], s34 offen sc1
    s_waitcnt lgkmcnt(2)
    v_smfmac_f32_16x16x64_bf16 v[56:59], v[20:23], v[40:47], v126
    ds_read_b128 v[40:43], v128 offset:30720
    v_smfmac_f32_16x16x64_bf16 v[60:63], v[20:23], a[136:143], v126
    v_smfmac_f32_16x16x64_bf16 v[64:67], v[24:27], a[144:151], v126
    ds_read_b128 v[44:47], v128 offset:31744
    v_add_f32 v56, v56, v58
    s_waitcnt lgkmcnt(2)
    v_smfmac_f32_16x16x64_bf16 v[68:71], v[24:27], v[32:39], v126
    buffer_load_dwordx4 v[52:55], v129, s[8:11], s34 offen sc1
    v_smfmac_f32_16x16x64_bf16 v[64:67], v[0:3], a[152:159], v126
    ds_read_b128 v[36:39], v128 offset:39936
    v_add_f32 v57, v57, v59
    v_cvt_pk_bf16_f32 v56, v56, v57
    v_smfmac_f32_16x16x64_bf16 v[68:71], v[0:3], a[160:167], v126
    ds_read_b128 v[32:35], v128 offset:38912
    v_add_f32 v60, v60, v62
    v_add_f32 v61, v61, v63
    v_cvt_pk_bf16_f32 v57, v60, v61
    s_waitcnt lgkmcnt(2)
    v_smfmac_f32_16x16x64_bf16 v[64:67], v[8:11], v[40:47], v126
    ds_write_b64 v143, v[56:57] offset:9728
    v_smfmac_f32_16x16x64_bf16 v[68:71], v[8:11], a[168:175], v126
    ds_read_b128 v[40:43], v128 offset:47104
    v_smfmac_f32_16x16x64_bf16 v[64:67], v[12:15], a[176:183], v126
    v_smfmac_f32_16x16x64_bf16 v[68:71], v[12:15], a[184:191], v126
    ds_read_b128 v[44:47], v128 offset:48128
    v_mov_b64 v[6:7], 0
    s_waitcnt lgkmcnt(3)
    v_smfmac_f32_16x16x64_bf16 v[64:67], v[16:19], v[32:39], v126
    s_waitcnt lgkmcnt(2)
    s_barrier
    v_smfmac_f32_16x16x64_bf16 v[68:71], v[16:19], a[192:199], v126
    ds_read_b64_tr_b16 v[56:57], v140 offset:8192
    ds_read_b64_tr_b16 v[58:59], v140 offset:8704
    v_smfmac_f32_16x16x64_bf16 v[64:67], v[20:23], a[200:207], v126
    ds_read_b64_tr_b16 v[60:61], v140 offset:9216
    ds_read_b64_tr_b16 v[62:63], v140 offset:9728
    s_waitcnt lgkmcnt(4)
    v_smfmac_f32_16x16x64_bf16 v[68:71], v[20:23], v[40:47], v126
    ds_read_b128 v[44:47], v128 offset:15360
    v_smfmac_f32_16x16x64_bf16 v[72:75], v[24:27], a[208:215], v126
    ds_read_b128 v[36:39], v127 offset:64512
    v_add_f32 v64, v64, v66
    ds_read_b128 v[40:43], v128 offset:14336
    s_waitcnt lgkmcnt(5)
    v_mfma_f32_16x16x32_bf16 v[106:109], v[80:83], v[56:59], 0
    v_add_f32 v69, v69, v71
    ds_read_b128 v[32:35], v127 offset:63488
    s_waitcnt lgkmcnt(4)
    v_mfma_f32_16x16x32_bf16 v[106:109], v[84:87], v[60:63], v[106:109]
    v_add_f32 v68, v68, v70
    v_add_f32 v65, v65, v67
    v_cvt_pk_bf16_f32 v64, v64, v65
    v_cvt_pk_bf16_f32 v65, v68, v69
    v_smfmac_f32_16x16x64_bf16 v[76:79], v[24:27], a[216:223], v126
    ds_write_b64 v143, v[64:65] offset:11776
    v_cndmask_b32 v106, v106, v109, s[24:25]
    v_cndmask_b32 v107, v107, v108, s[24:25]
    s_waitcnt lgkmcnt(1)
    v_smfmac_f32_16x16x64_bf16 v[72:75], v[0:3], v[32:39], v126
    ds_read_b128 v[36:39], v128 offset:23552
    v_add_f32_dpp v104, v107, v106 quad_perm:[2,3,0,1] row_mask:0xf bank_mask:0xf
    v_exp_f32 v141, v104
    v_smfmac_f32_16x16x64_bf16 v[76:79], v[0:3], a[224:231], v126
    ds_read_b128 v[32:35], v128 offset:22528
    v_cvt_pk_bf16_f32 v141, v141, v141
    v_smfmac_f32_16x16x64_bf16 v[72:75], v[8:11], a[232:239], v126
    ds_write_b16 v132, v141
    v_smfmac_f32_16x16x64_bf16 v[76:79], v[8:11], a[240:247], v126
    v_mov_b64 v[10:11], 0
    v_mov_b64 v[0:1], 0
    v_mov_b64 v[122:123], s[70:71]
    v_smfmac_f32_16x16x64_bf16 v[72:75], v[12:15], v[40:47], v126
    ds_read_b128 v[44:47], v127 offset:48128
    v_smfmac_f32_16x16x64_bf16 v[76:79], v[12:15], a[248:255], v126
    s_waitcnt lgkmcnt(1)
    s_barrier
    v_smfmac_f32_16x16x64_bf16 v[72:75], v[16:19], v[232:239], v126
    ds_read_b64_tr_b16 v[66:67], v140 offset:10752
    ds_read_b64_tr_b16 v[64:65], v140 offset:10240
    v_smfmac_f32_16x16x64_bf16 v[76:79], v[16:19], v[32:39], v126
    ds_read_b64_tr_b16 v[68:69], v140 offset:11264
    ds_read_b64_tr_b16 v[70:71], v140 offset:11776
    v_mov_b64 v[8:9], 0
    v_smfmac_f32_16x16x64_bf16 v[72:75], v[20:23], v[240:247], v126
    ds_read_b128 v[110:113], v133
    ds_read_b128 v[36:39], v127 offset:56320
    v_smfmac_f32_16x16x64_bf16 v[76:79], v[20:23], v[248:255], v126
    ds_read_b128 v[114:117], v134
    v_mov_b64 v[14:15], 0
    s_waitcnt lgkmcnt(5)
    v_mfma_f32_16x16x32_bf16 v[106:109], v[64:67], v[56:59], 0
    v_add_f32 v72, v72, v74
    ds_read_b128 v[32:35], v127 offset:55296
    s_waitcnt lgkmcnt(4)
    v_mfma_f32_16x16x32_bf16 v[106:109], v[68:71], v[60:63], v[106:109]
    ds_read_b128 v[40:43], v127 offset:47104
    s_waitcnt lgkmcnt(4)
    v_mfma_f32_16x16x32_bf16 v[64:67], v[122:125], v[110:113], 0
    v_add_f32 v77, v77, v79
    v_mfma_f32_16x16x32_bf16 v[118:121], v[88:91], v[110:113], 0
    v_cndmask_b32 v106, v106, v109, s[24:25]
    v_cndmask_b32 v107, v107, v108, s[24:25]
    s_waitcnt lgkmcnt(2)
    v_mfma_f32_16x16x32_bf16 v[118:121], v[92:95], v[114:117], v[118:121]
    v_add_f32_dpp v105, v107, v106 quad_perm:[2,3,0,1] row_mask:0xf bank_mask:0xf
    v_mul_f32 v105, s39, v105
    v_exp_f32 v107, v105
    v_mov_b64 v[2:3], 0
    v_add_f32 v76, v76, v78
    v_mov_b32_dpp v108, v107 quad_perm:[2,3,0,1] row_mask:0xf bank_mask:0xf
    v_cvt_pk_bf16_f32 v107, v107, v108
    v_cndmask_b32 v69, 0, v107, s[24:25]
    v_cndmask_b32 v68, v107, 0, s[24:25]
    v_add_f32 v73, v73, v75
    v_cvt_pk_bf16_f32 v72, v72, v73
    v_mfma_f32_16x16x16_bf16 v[64:67], v[122:123], v[68:69], v[64:67]
    v_cvt_pk_bf16_f32 v73, v77, v76
    s_nop 1
    v_mfma_f32_16x16x16_bf16 v[118:121], v[72:73], v[68:69], v[118:121]
    s_nop 3
    v_subrev_u32 v142, s44, v64
    v_cmp_le_u32 vcc, s45, v142
    v_rcp_f32_dpp v141, v64 quad_perm:[0,1,0,1] row_mask:0xf bank_mask:0xf
LF3_norm:
    s_nop 0
    v_mul_f32 v118, v118, v141
    v_mul_f32 v119, v119, v141
    v_mul_f32 v120, v120, v141
    v_mul_f32 v121, v121, v141
    v_cvt_pk_bf16_f32 v60, v118, v119
    v_cvt_pk_bf16_f32 v61, v120, v121
    ds_write_b64 v135, v[60:61] offset:5312
    s_and_b64 vcc, vcc, s[26:27]
    s_cbranch_scc1 LF3_fallback
    v_mov_b32_dpp v62, v60 quad_perm:[2,3,0,1] row_mask:0xf bank_mask:0xf
    v_mov_b32_dpp v63, v61 quad_perm:[2,3,0,1] row_mask:0xf bank_mask:0xf
    s_waitcnt lgkmcnt(1)
    s_nop 0
    v_smfmac_f32_16x16x64_bf16 v[0:3], v[60:63], v[40:47], v126
    ds_read_b128 v[40:43], v127 offset:22528
    v_mov_b64 v[12:13], 0
    v_smfmac_f32_16x16x64_bf16 v[4:7], v[60:63], v[144:151], v126
    v_smfmac_f32_16x16x64_bf16 v[8:11], v[60:63], v[152:159], v126
    s_waitcnt lgkmcnt(1)
    s_barrier
    ds_read_b128 v[106:109], v136 offset:5120
    v_smfmac_f32_16x16x64_bf16 v[12:15], v[60:63], v[32:39], v126
    ds_read_b128 v[110:113], v136 offset:5184
    ds_read_b128 v[16:19], v136 offset:5248
    ds_read_b128 v[44:47], v127 offset:23552
    ds_read_b128 v[36:39], v127 offset:31744
    ds_read_b128 v[32:35], v127 offset:30720
    s_waitcnt lgkmcnt(5)
    v_smfmac_f32_16x16x64_bf16 v[0:3], v[106:109], v[160:167], v126
    s_waitcnt lgkmcnt(4)
    v_smfmac_f32_16x16x64_bf16 v[0:3], v[110:113], v[168:175], v126
    s_waitcnt lgkmcnt(3)
    v_smfmac_f32_16x16x64_bf16 v[0:3], v[16:19], v[176:183], v126
    buffer_load_dword v137, v127, s[8:11], s31 offen sc1
    s_waitcnt lgkmcnt(2)
    v_smfmac_f32_16x16x64_bf16 v[4:7], v[106:109], v[40:47], v126
    ds_read_b128 v[44:47], v127 offset:39936
    v_smfmac_f32_16x16x64_bf16 v[4:7], v[110:113], v[184:191], v126
    v_cvt_pk_bf16_f32 v115, v1, v3
    v_cvt_pk_bf16_f32 v114, v0, v2
    v_smfmac_f32_16x16x64_bf16 v[4:7], v[16:19], v[192:199], v126
    ds_read_b128 v[40:43], v127 offset:38912
    v_and_or_b32 v114, v114, -2, s28
    s_waitcnt lgkmcnt(2)
    v_smfmac_f32_16x16x64_bf16 v[8:11], v[106:109], v[32:39], v126
    buffer_store_dwordx2 v[114:115], v130, s[8:11], 0 offen offset:0
    v_smfmac_f32_16x16x64_bf16 v[8:11], v[110:113], v[200:207], v126
    v_cvt_pk_bf16_f32 v116, v4, v6
    v_and_or_b32 v116, v116, -2, s28
    v_cvt_pk_bf16_f32 v117, v5, v7
    v_smfmac_f32_16x16x64_bf16 v[8:11], v[16:19], v[208:215], v126
    buffer_store_dwordx2 v[116:117], v130, s[8:11], 0 offen offset:2048
    v_smfmac_f32_16x16x64_bf16 v[12:15], v[106:109], v[216:223], v126
    s_waitcnt lgkmcnt(0)
    v_smfmac_f32_16x16x64_bf16 v[12:15], v[110:113], v[40:47], v126
    v_cvt_pk_bf16_f32 v119, v9, v11
    v_cvt_pk_bf16_f32 v118, v8, v10
    v_and_or_b32 v118, v118, -2, s28
    v_smfmac_f32_16x16x64_bf16 v[12:15], v[16:19], v[224:231], v126
    buffer_store_dwordx2 v[118:119], v130, s[8:11], s69 offen offset:0
    s_nop 6
    v_cvt_pk_bf16_f32 v120, v12, v14
    v_and_or_b32 v120, v120, -2, s28
    v_cvt_pk_bf16_f32 v121, v13, v15
    buffer_store_dwordx2 v[120:121], v130, s[8:11], s69 offen offset:2048
    s_waitcnt vmcnt(4)
    v_cmp_gt_u32 vcc, s43, v137
    ds_read_b128 v[122:125], v127 offset:13312
    s_waitcnt vmcnt(4)
    s_add_u32 s30, s30, 1048576
    s_add_u32 s68, s68, 1048576
    s_cbranch_vccnz LF3_lead
LF3_leadok:
    s_barrier
    s_add_u32 s33, s33, 1048576
    s_add_u32 s37, s37, 1048576
    s_add_u32 s32, s32, 1048576
    s_add_u32 s38, s38, 1
    s_xor_b32 s28, s28, 1
    v_mov_b64 v[88:89], v[96:97]
    v_mov_b64 v[90:91], v[98:99]
    v_mov_b64 v[92:93], v[100:101]
    v_mov_b64 v[94:95], v[102:103]
    v_mov_b64 v[80:81], v[48:49]
    v_mov_b64 v[82:83], v[50:51]
    v_mov_b64 v[84:85], v[52:53]
    v_mov_b64 v[86:87], v[54:55]
    v_mov_b64 v[56:57], 0
    v_mov_b64 v[58:59], 0
    v_mov_b64 v[60:61], 0
    v_mov_b64 v[62:63], 0
    v_mov_b64 v[64:65], 0
    v_mov_b64 v[66:67], 0
    v_mov_b64 v[68:69], 0
    v_mov_b64 v[70:71], 0
    v_mov_b64 v[72:73], 0
    v_mov_b64 v[74:75], 0
    v_mov_b64 v[76:77], 0
    v_mov_b64 v[78:79], 0
    s_add_u32 s34, s34, 1048576
    s_add_u32 s72, s72, 1048576
    ds_read_b128 v[32:35], v128 offset:6144
    ds_read_b128 v[36:39], v128 offset:7168
    ds_read_b128 v[40:43], v128 offset:63488
    ds_read_b128 v[44:47], v128 offset:64512
    s_add_u32 s43, s43, 1
    s_nop 5
    buffer_load_dwordx4 v[0:3], v127, s[8:11], s29 offen sc1
    buffer_load_dwordx4 v[4:7], v127, s[8:11], s29 offen offset:1024 sc1
    s_waitcnt lgkmcnt(0)
    s_branch LF3_pollP
LF3_done:
    buffer_store_dword v112, v131, s[8:11], s33 offen sc1
    s_waitcnt vmcnt(0)
    s_endpgm
LF3_retryE:
    buffer_load_dwordx4 v[4:7], v127, s[8:11], s30 offen sc1
    buffer_load_dwordx4 v[28:31], v127, s[8:11], s68 offen sc1
    s_sub_u32 s22, s22, 1
    s_cbranch_scc1 L_exit
    s_nop 3
    v_mov_b64 v[64:65], 0
    v_mov_b64 v[66:67], 0
    v_mov_b64 v[68:69], 0
    v_mov_b64 v[70:71], 0
    v_mov_b64 v[56:57], 0
    v_mov_b64 v[58:59], 0
    v_mov_b64 v[60:61], 0
    v_mov_b64 v[62:63], 0
    s_waitcnt vmcnt(1)
    s_branch LF3_bA
LF3_retryL:
    buffer_load_dwordx4 v[28:31], v127, s[8:11], s68 offen sc1
    s_sub_u32 s22, s22, 1
    s_cbranch_scc1 L_exit
    s_waitcnt vmcnt(0)
    v_cmp_eq_u32 vcc, -1, v28
    s_cbranch_vccnz LF3_retryL
    ds_write_b128 v127, v[28:31] offset:7168
    s_waitcnt lgkmcnt(0)
    s_branch LF3_Lok
    s_nop 0
LF3_retryP:
    buffer_load_dwordx4 v[0:3], v127, s[8:11], s29 offen sc1
    buffer_load_dwordx4 v[4:7], v127, s[8:11], s29 offen offset:1024 sc1
    s_sub_u32 s22, s22, 1
    s_cbranch_scc1 L_exit
    s_branch LF3_pollP
LF3_slowflag:
LF3_sf_spin:
    buffer_load_dword v138, off, s[8:11], s37 sc1
    s_sub_u32 s22, s22, 1
    s_cbranch_scc1 L_exit
    s_waitcnt vmcnt(0)
    v_readfirstlane_b32 s41, v138
    s_cmp_eq_u32 s41, -1
    s_cbranch_scc1 LF3_sf_spin
    s_branch LF3_flagok
    s_nop 1
.p2align 5
LF3_lead:
    s_waitcnt vmcnt(2)
    s_nop 12
    s_branch LF3_leadok
LF3_fallback:
    s_nop 7
    v_lshlrev_b32 v142, 1, v132
    v_subrev_u32 v142, 20480, v142
    ds_write_b32 v142, v104
    v_min_u32 v142, v133, v134
    v_lshlrev_b32 v142, 1, v142
    v_subrev_u32 v142, 20480, v142
    s_waitcnt lgkmcnt(0)
    s_barrier
    ds_read_b128 v[56:59], v142
    ds_read_b128 v[60:63], v142 offset:16
    s_waitcnt lgkmcnt(1)
    v_max3_f32 v141, v56, v57, v58
    s_waitcnt lgkmcnt(0)
    v_max3_f32 v141, v141, v59, v60
    v_max3_f32 v141, v141, v61, v62
    v_max3_f32 v141, v141, v63, v105
    s_nop 1
    v_max_f32_dpp v141, v141, v141 quad_perm:[2,3,0,1] row_mask:0xf bank_mask:0xf
    v_mov_b32 v142, v141
    s_nop 1
    v_permlane16_swap_b32 v141, v142
    v_max_f32 v141, v141, v142
    v_mov_b32 v142, v141
    s_nop 1
    v_permlane32_swap_b32 v141, v142
    v_max_f32 v141, v141, v142
    v_sub_f32 v56, v56, v141
    v_exp_f32 v56, v56
    v_sub_f32 v57, v57, v141
    v_exp_f32 v57, v57
    v_sub_f32 v58, v58, v141
    v_exp_f32 v58, v58
    v_sub_f32 v59, v59, v141
    v_exp_f32 v59, v59
    v_sub_f32 v60, v60, v141
    v_exp_f32 v60, v60
    v_sub_f32 v61, v61, v141
    v_exp_f32 v61, v61
    v_sub_f32 v62, v62, v141
    v_exp_f32 v62, v62
    v_sub_f32 v63, v63, v141
    v_exp_f32 v63, v63
    v_sub_f32 v107, v105, v141
    v_exp_f32 v107, v107
    s_nop 1
    v_mov_b32_dpp v108, v107 quad_perm:[2,3,0,1] row_mask:0xf bank_mask:0xf
    v_cvt_pk_bf16_f32 v107, v107, v108
    v_cndmask_b32 v68, v107, 0, s[24:25]
    v_cndmask_b32 v69, 0, v107, s[24:25]
    v_cvt_pk_bf16_f32 v142, v56, v57
    v_cndmask_b32 v110, v142, 0, s[24:25]
    v_cndmask_b32 v114, 0, v142, s[24:25]
    v_cvt_pk_bf16_f32 v142, v58, v59
    v_cndmask_b32 v111, v142, 0, s[24:25]
    v_cndmask_b32 v115, 0, v142, s[24:25]
    v_cvt_pk_bf16_f32 v142, v60, v61
    v_cndmask_b32 v112, v142, 0, s[24:25]
    v_cndmask_b32 v116, 0, v142, s[24:25]
    v_cvt_pk_bf16_f32 v142, v62, v63
    v_cndmask_b32 v113, v142, 0, s[24:25]
    v_cndmask_b32 v117, 0, v142, s[24:25]
    s_nop 0
    v_mfma_f32_16x16x32_bf16 v[118:121], v[88:91], v[110:113], 0
    v_mfma_f32_16x16x32_bf16 v[118:121], v[92:95], v[114:117], v[118:121]
    v_mfma_f32_16x16x32_bf16 v[64:67], v[122:125], v[110:113], 0
    s_nop 5
    v_mfma_f32_16x16x16_bf16 v[64:67], v[122:123], v[68:69], v[64:67]
    v_mfma_f32_16x16x16_bf16 v[118:121], v[72:73], v[68:69], v[118:121]
    s_nop 3
    v_rcp_f32_dpp v141, v64 quad_perm:[0,1,0,1] row_mask:0xf bank_mask:0xf
    s_mov_b64 vcc, 0
    s_nop 1
    s_branch LF3_norm
L_chain_slow3:
    s_add_u32 s34, s34, 1048576
    s_add_u32 s72, s72, 1048576
    s_add_u32 s37, s37, 1048576
    s_mov_b32 s43, 1
    s_mov_b32 s28, 1
    ds_read_b128 v[32:35], v128 offset:6144
    ds_read_b128 v[36:39], v128 offset:7168
    ds_read_b128 v[40:43], v128 offset:63488
    ds_read_b128 v[44:47], v128 offset:64512
    v_mov_b64 v[56:57], 0
    v_mov_b64 v[58:59], 0
    v_mov_b64 v[60:61], 0
    v_mov_b64 v[62:63], 0
    v_mov_b64 v[64:65], 0
    v_mov_b64 v[66:67], 0
    v_mov_b64 v[68:69], 0
    v_mov_b64 v[70:71], 0
    v_mov_b64 v[72:73], 0
    v_mov_b64 v[74:75], 0
    v_mov_b64 v[76:77], 0
    v_mov_b64 v[78:79], 0
    v_mov_b32 v142, s43
    s_waitcnt lgkmcnt(0)
    buffer_load_dwordx4 v[4:7], v127, s[8:11], s30 offen sc1
    buffer_load_dwordx4 v[28:31], v127, s[8:11], s68 offen sc1
    s_branch LS3_bAw
LS3_pollP:
    s_waitcnt vmcnt(1)
    v_mfma_f32_16x16x32_bf16 v[110:113], v[122:125], v[0:3], 0
    v_bitop3_b32 v141, v0, s28, 1 bitop3:0x28
    v_bitop3_b32 v141, v2, s28, v141 bitop3:0x28
    s_waitcnt vmcnt(0)
    v_mfma_f32_16x16x32_bf16 v[110:113], v[122:125], v[4:7], v[110:113]
    v_bitop3_b32 v141, v4, s28, v141 bitop3:0x28
    v_bitop3_b32 v141, v6, s28, v141 bitop3:0x28
    v_cmp_ne_u32 vcc, 1, v141
    s_nop 2
    s_cbranch_vccnz LS3_retryP
LS3_Pok:
    v_add_f32_dpp v110, v110, v110 row_ror:4 row_mask:0xf bank_mask:0xf
    v_add_f32_dpp v111, v111, v111 row_ror:4 row_mask:0xf bank_mask:0xf
    s_cmp_ge_u32 s38, 63
    v_add_f32_dpp v110, v110, v110 row_ror:8 row_mask:0xf bank_mask:0xf
    v_add_f32_dpp v111, v111, v111 row_ror:8 row_mask:0xf bank_mask:0xf
    v_cvt_pk_bf16_f32 v112, v110, v111
LS3_Mst:
    buffer_store_dword v112, v131, s[8:11], s32 offen sc1
    s_cbranch_scc1 LS3_done
    v_readlane_b32 s41, v138, 33
    s_cmp_eq_u32 s41, -1
    s_cbranch_scc1 LS3_slowflag
LS3_flagok:
    buffer_load_dwordx4 v[4:7], v127, s[8:11], s30 offen sc1
    s_waitcnt vmcnt(1)
    s_nop 2
    buffer_load_dwordx4 v[28:31], v127, s[8:11], s68 offen sc1
LS3_bAw:
    s_waitcnt vmcnt(1)
LS3_bA:
    v_max3_u32 v141, v4, v5, v6
    v_max_u32 v141, v141, v7
    v_cmp_eq_u32 vcc, -1, v141
    v_smfmac_f32_16x16x64_bf16 v[56:59], v[4:7], a[0:7], v126
    v_smfmac_f32_16x16x64_bf16 v[60:63], v[4:7], a[8:15], v126
    s_cbranch_vccnz LS3_retryE
    ds_write_b128 v127, v[4:7] offset:1024
    v_smfmac_f32_16x16x64_bf16 v[64:67], v[4:7], a[16:23], v126
    v_mov_b64 v[122:123], s[70:71]
    v_smfmac_f32_16x16x64_bf16 v[68:71], v[4:7], a[24:31], v126
    v_mov_b64 v[124:125], s[70:71]
    v_smfmac_f32_16x16x64_bf16 v[72:75], v[4:7], a[32:39], v126
    v_smfmac_f32_16x16x64_bf16 v[76:79], v[4:7], v[32:39], v126
    ds_read_b128 v[32:35], v129 offset:30720
    ds_read_b128 v[36:39], v129 offset:31744
    s_waitcnt vmcnt(0)
    v_max3_u32 v141, v28, v29, v30
    v_max_u32 v141, v141, v31
    v_cmp_eq_u32 vcc, -1, v141
    ds_write_b128 v127, v[28:31] offset:7168
    v_mov_b64 v[4:5], 0
    s_cbranch_vccnz LS3_retryL
LS3_Lok:
    v_smfmac_f32_16x16x64_bf16 v[56:59], v[28:31], a[40:47], v126
    v_mov_b64 v[6:7], 0
    v_smfmac_f32_16x16x64_bf16 v[60:63], v[28:31], a[48:55], v126
    v_smfmac_f32_16x16x64_bf16 v[64:67], v[28:31], v[40:47], v126
    s_waitcnt lgkmcnt(3)
    s_waitcnt lgkmcnt(0)
    s_barrier
    v_smfmac_f32_16x16x64_bf16 v[68:71], v[28:31], a[56:63], v126
    ds_read_b128 v[24:27], v127 offset:6144
    ds_read_b128 v[0:3], v127 offset:0
    v_smfmac_f32_16x16x64_bf16 v[72:75], v[28:31], a[64:71], v126
    ds_read_b128 v[40:43], v129 offset:6144
    ds_read_b128 v[44:47], v129 offset:7168
    v_smfmac_f32_16x16x64_bf16 v[76:79], v[28:31], a[72:79], v126
    buffer_load_dword v138, v139, s[8:11], s34 offen sc1
    ds_read_b128 v[8:11], v127 offset:2048
    ds_read_b128 v[12:15], v127 offset:3072
    s_waitcnt lgkmcnt(5)
    v_smfmac_f32_16x16x64_bf16 v[56:59], v[24:27], v[32:39], v126
    ds_read_b128 v[32:35], v129 offset:14336
    ds_read_b128 v[36:39], v129 offset:15360
    v_smfmac_f32_16x16x64_bf16 v[60:63], v[24:27], a[80:87], v126
    buffer_load_dwordx4 v[96:99], v127, s[8:11], s72 offen sc1
    s_waitcnt lgkmcnt(6)
    v_smfmac_f32_16x16x64_bf16 v[56:59], v[0:3], a[88:95], v126
    buffer_load_dwordx4 v[100:103], v129, s[8:11], s72 offen sc1
    s_waitcnt lgkmcnt(4)
    v_smfmac_f32_16x16x64_bf16 v[60:63], v[0:3], v[40:47], v126
    ds_read_b128 v[16:19], v127 offset:4096
    ds_read_b128 v[20:23], v127 offset:5120
    s_waitcnt lgkmcnt(5)
    v_smfmac_f32_16x16x64_bf16 v[56:59], v[8:11], a[96:103], v126
    ds_read_b128 v[40:43], v129 offset:22528
    ds_read_b128 v[44:47], v129 offset:23552
    v_smfmac_f32_16x16x64_bf16 v[60:63], v[8:11], a[104:111], v126
    buffer_load_dwordx4 v[48:51], v127, s[8:11], s34 offen sc1
    s_waitcnt lgkmcnt(4)
    v_smfmac_f32_16x16x64_bf16 v[56:59], v[12:15], v[32:39], v126
    ds_read_b128 v[32:35], v128 offset:55296
    ds_read_b128 v[36:39], v128 offset:56320
    v_smfmac_f32_16x16x64_bf16 v[60:63], v[12:15], a[112:119], v126
    s_waitcnt lgkmcnt(5)
    v_smfmac_f32_16x16x64_bf16 v[56:59], v[16:19], a[120:127], v126
    v_smfmac_f32_16x16x64_bf16 v[60:63], v[16:19], a[128:135], v126
    s_waitcnt lgkmcnt(2)
    v_smfmac_f32_16x16x64_bf16 v[56:59], v[20:23], v[40:47], v126
    ds_read_b128 v[40:43], v128 offset:30720
    ds_read_b128 v[44:47], v128 offset:31744
    v_smfmac_f32_16x16x64_bf16 v[60:63], v[20:23], a[136:143], v126
    buffer_load_dwordx4 v[52:55], v129, s[8:11], s34 offen sc1
    s_nop 2
    v_add_f32 v56, v56, v58
    v_add_f32 v57, v57, v59
    v_cvt_pk_bf16_f32 v56, v56, v57
    s_nop 0
    v_add_f32 v60, v60, v62
    v_add_f32 v61, v61, v63
    v_cvt_pk_bf16_f32 v57, v60, v61
    v_smfmac_f32_16x16x64_bf16 v[64:67], v[24:27], a[144:151], v126
    ds_write_b64 v143, v[56:57] offset:9728
    s_waitcnt lgkmcnt(3)
    v_smfmac_f32_16x16x64_bf16 v[68:71], v[24:27], v[32:39], v126
    ds_read_b128 v[32:35], v128 offset:38912
    ds_read_b128 v[36:39], v128 offset:39936
    v_smfmac_f32_16x16x64_bf16 v[64:67], v[0:3], a[152:159], v126
    v_smfmac_f32_16x16x64_bf16 v[68:71], v[0:3], a[160:167], v126
    s_waitcnt lgkmcnt(2)
    s_barrier
    v_smfmac_f32_16x16x64_bf16 v[64:67], v[8:11], v[40:47], v126
    ds_read_b64_tr_b16 v[56:57], v140 offset:8192
    ds_read_b64_tr_b16 v[58:59], v140 offset:8704
    v_smfmac_f32_16x16x64_bf16 v[68:71], v[8:11], a[168:175], v126
    ds_read_b64_tr_b16 v[60:61], v140 offset:9216
    ds_read_b64_tr_b16 v[62:63], v140 offset:9728
    v_smfmac_f32_16x16x64_bf16 v[64:67], v[12:15], a[176:183], v126
    ds_read_b128 v[40:43], v128 offset:47104
    ds_read_b128 v[44:47], v128 offset:48128
    v_smfmac_f32_16x16x64_bf16 v[68:71], v[12:15], a[184:191], v126
    s_waitcnt lgkmcnt(6)
    v_smfmac_f32_16x16x64_bf16 v[64:67], v[16:19], v[32:39], v126
    ds_read_b128 v[32:35], v127 offset:63488
    ds_read_b128 v[36:39], v127 offset:64512
    v_smfmac_f32_16x16x64_bf16 v[68:71], v[16:19], a[192:199], v126
    s_waitcnt lgkmcnt(6)
    v_mfma_f32_16x16x32_bf16 v[106:109], v[80:83], v[56:59], 0
    v_smfmac_f32_16x16x64_bf16 v[64:67], v[20:23], a[200:207], v126
    s_waitcnt lgkmcnt(4)
    v_mfma_f32_16x16x32_bf16 v[106:109], v[84:87], v[60:63], v[106:109]
    s_waitcnt lgkmcnt(2)
    v_smfmac_f32_16x16x64_bf16 v[68:71], v[20:23], v[40:47], v126
    ds_read_b128 v[40:43], v128 offset:14336
    v_add_f32 v64, v64, v66
    v_add_f32 v65, v65, v67
    v_cndmask_b32 v107, v107, v108, s[24:25]
    v_cndmask_b32 v106, v106, v109, s[24:25]
    v_cvt_pk_bf16_f32 v64, v64, v65
    v_smfmac_f32_16x16x64_bf16 v[72:75], v[24:27], a[208:215], v126
    ds_read_b128 v[44:47], v128 offset:15360
    v_add_f32_dpp v104, v107, v106 quad_perm:[2,3,0,1] row_mask:0xf bank_mask:0xf
    v_exp_f32 v141, v104
    v_add_f32 v68, v68, v70
    v_add_f32 v69, v69, v71
    v_cvt_pk_bf16_f32 v65, v68, v69
    v_smfmac_f32_16x16x64_bf16 v[76:79], v[24:27], a[216:223], v126
    ds_write_b64 v143, v[64:65] offset:11776
    v_cvt_pk_bf16_f32 v141, v141, v141
    s_waitcnt lgkmcnt(3)
    v_smfmac_f32_16x16x64_bf16 v[72:75], v[0:3], v[32:39], v126
    ds_write_b16 v132, v141
    v_smfmac_f32_16x16x64_bf16 v[76:79], v[0:3], a[224:231], v126
    ds_read_b128 v[32:35], v128 offset:22528
    ds_read_b128 v[36:39], v128 offset:23552
    v_smfmac_f32_16x16x64_bf16 v[72:75], v[8:11], a[232:239], v126
    v_mov_b64 v[0:1], 0
    v_smfmac_f32_16x16x64_bf16 v[76:79], v[8:11], a[240:247], v126
    s_waitcnt lgkmcnt(2)
    s_barrier
    v_smfmac_f32_16x16x64_bf16 v[72:75], v[12:15], v[40:47], v126
    ds_read_b64_tr_b16 v[64:65], v140 offset:10240
    ds_read_b64_tr_b16 v[66:67], v140 offset:10752
    v_smfmac_f32_16x16x64_bf16 v[76:79], v[12:15], a[248:255], v126
    ds_read_b64_tr_b16 v[68:69], v140 offset:11264
    ds_read_b64_tr_b16 v[70:71], v140 offset:11776
    v_smfmac_f32_16x16x64_bf16 v[72:75], v[16:19], v[232:239], v126
    ds_read_b128 v[110:113], v133
    ds_read_b128 v[114:117], v134
    s_waitcnt lgkmcnt(6)
    v_smfmac_f32_16x16x64_bf16 v[76:79], v[16:19], v[32:39], v126
    ds_read_b128 v[40:43], v127 offset:47104
    ds_read_b128 v[44:47], v127 offset:48128
    s_waitcnt lgkmcnt(6)
    v_mfma_f32_16x16x32_bf16 v[106:109], v[64:67], v[56:59], 0
    ds_read_b128 v[32:35], v127 offset:55296
    ds_read_b128 v[36:39], v127 offset:56320
    s_waitcnt lgkmcnt(6)
    v_mfma_f32_16x16x32_bf16 v[106:109], v[68:71], v[60:63], v[106:109]
    v_mov_b64 v[2:3], 0
    v_mov_b64 v[8:9], 0
    v_smfmac_f32_16x16x64_bf16 v[72:75], v[20:23], v[240:247], v126
    v_mov_b64 v[10:11], 0
    v_smfmac_f32_16x16x64_bf16 v[76:79], v[20:23], v[248:255], v126
    v_cndmask_b32 v107, v107, v108, s[24:25]
    v_cndmask_b32 v106, v106, v109, s[24:25]
    s_waitcnt lgkmcnt(5)
    v_mfma_f32_16x16x32_bf16 v[118:121], v[88:91], v[110:113], 0
    v_add_f32_dpp v105, v107, v106 quad_perm:[2,3,0,1] row_mask:0xf bank_mask:0xf
    v_mul_f32 v105, s39, v105
    v_exp_f32 v107, v105
    v_mfma_f32_16x16x32_bf16 v[64:67], v[122:125], v[110:113], 0
    v_mov_b32_dpp v108, v107 quad_perm:[2,3,0,1] row_mask:0xf bank_mask:0xf
    v_cvt_pk_bf16_f32 v107, v107, v108
    s_waitcnt lgkmcnt(4)
    v_mfma_f32_16x16x32_bf16 v[118:121], v[92:95], v[114:117], v[118:121]
    v_cndmask_b32 v68, v107, 0, s[24:25]
    v_cndmask_b32 v69, 0, v107, s[24:25]
    v_add_f32 v72, v72, v74
    v_add_f32 v73, v73, v75
    v_mfma_f32_16x16x16_bf16 v[64:67], v[122:123], v[68:69], v[64:67]
    v_add_f32 v76, v76, v78
    v_add_f32 v77, v77, v79
    v_cvt_pk_bf16_f32 v72, v72, v73
    v_cvt_pk_bf16_f32 v73, v77, v76
    v_mov_b64 v[12:13], 0
    v_mov_b64 v[14:15], 0
    v_mfma_f32_16x16x16_bf16 v[118:121], v[72:73], v[68:69], v[118:121]
    s_nop 0
    v_rcp_f32_dpp v141, v64 quad_perm:[0,1,0,1] row_mask:0xf bank_mask:0xf
    v_subrev_u32 v142, s44, v64
    v_cmp_le_u32 vcc, s45, v142
LS3_norm:
    s_nop 3
    v_mul_f32 v118, v118, v141
    v_mul_f32 v119, v119, v141
    v_mul_f32 v120, v120, v141
    v_mul_f32 v121, v121, v141
    v_cvt_pk_bf16_f32 v60, v118, v119
    v_cvt_pk_bf16_f32 v61, v120, v121
    ds_write_b64 v135, v[60:61] offset:5312
    s_and_b64 vcc, vcc, s[26:27]
    s_cbranch_scc1 LS3_fallback
    v_mov_b32_dpp v62, v60 quad_perm:[2,3,0,1] row_mask:0xf bank_mask:0xf
    v_mov_b32_dpp v63, v61 quad_perm:[2,3,0,1] row_mask:0xf bank_mask:0xf
    s_waitcnt lgkmcnt(3)
    s_nop 0
    v_smfmac_f32_16x16x64_bf16 v[0:3], v[60:63], v[40:47], v126
    ds_read_b128 v[40:43], v127 offset:22528
    ds_read_b128 v[44:47], v127 offset:23552
    v_smfmac_f32_16x16x64_bf16 v[4:7], v[60:63], v[144:151], v126
    s_waitcnt lgkmcnt(2)
    s_barrier
    v_smfmac_f32_16x16x64_bf16 v[8:11], v[60:63], v[152:159], v126
    ds_read_b128 v[106:109], v136 offset:5120
    ds_read_b128 v[110:113], v136 offset:5184
    v_smfmac_f32_16x16x64_bf16 v[12:15], v[60:63], v[32:39], v126
    ds_read_b128 v[16:19], v136 offset:5248
    ds_read_b128 v[32:35], v127 offset:30720
    ds_read_b128 v[36:39], v127 offset:31744
    s_waitcnt lgkmcnt(4)
    v_smfmac_f32_16x16x64_bf16 v[0:3], v[106:109], v[160:167], v126
    s_waitcnt lgkmcnt(3)
    v_smfmac_f32_16x16x64_bf16 v[0:3], v[110:113], v[168:175], v126
    s_waitcnt lgkmcnt(2)
    v_smfmac_f32_16x16x64_bf16 v[0:3], v[16:19], v[176:183], v126
    buffer_load_dword v137, v127, s[8:11], s31 offen sc1
    v_smfmac_f32_16x16x64_bf16 v[4:7], v[106:109], v[40:47], v126
    ds_read_b128 v[40:43], v127 offset:38912
    ds_read_b128 v[44:47], v127 offset:39936
    s_nop 1
    v_cvt_pk_bf16_f32 v114, v0, v2
    v_cvt_pk_bf16_f32 v115, v1, v3
    v_and_or_b32 v114, v114, -2, s28
    v_smfmac_f32_16x16x64_bf16 v[4:7], v[110:113], v[184:191], v126
    buffer_store_dwordx2 v[114:115], v130, s[8:11], 0 offen offset:0 sc1
    v_smfmac_f32_16x16x64_bf16 v[4:7], v[16:19], v[192:199], v126
    s_waitcnt lgkmcnt(2)
    v_smfmac_f32_16x16x64_bf16 v[8:11], v[106:109], v[32:39], v126
    v_smfmac_f32_16x16x64_bf16 v[8:11], v[110:113], v[200:207], v126
    v_cvt_pk_bf16_f32 v116, v4, v6
    v_cvt_pk_bf16_f32 v117, v5, v7
    v_and_or_b32 v116, v116, -2, s28
    v_smfmac_f32_16x16x64_bf16 v[8:11], v[16:19], v[208:215], v126
    buffer_store_dwordx2 v[116:117], v130, s[8:11], 0 offen offset:2048 sc1
    v_smfmac_f32_16x16x64_bf16 v[12:15], v[106:109], v[216:223], v126
    s_nop 3
    v_cvt_pk_bf16_f32 v118, v8, v10
    v_cvt_pk_bf16_f32 v119, v9, v11
    v_and_or_b32 v118, v118, -2, s28
    s_waitcnt lgkmcnt(0)
    v_smfmac_f32_16x16x64_bf16 v[12:15], v[110:113], v[40:47], v126
    buffer_store_dwordx2 v[118:119], v130, s[8:11], s69 offen offset:0 sc1
    v_smfmac_f32_16x16x64_bf16 v[12:15], v[16:19], v[224:231], v126
    s_nop 7
    v_cvt_pk_bf16_f32 v120, v12, v14
    v_cvt_pk_bf16_f32 v121, v13, v15
    v_and_or_b32 v120, v120, -2, s28
    buffer_store_dwordx2 v[120:121], v130, s[8:11], s69 offen offset:2048 sc1
    s_waitcnt vmcnt(4)
    v_cmp_gt_u32 vcc, s43, v137
    ds_read_b128 v[122:125], v127 offset:13312
    s_waitcnt vmcnt(4)
    s_add_u32 s30, s30, 1048576
    s_add_u32 s68, s68, 1048576
    s_cbranch_vccnz LS3_lead
LS3_leadok:
    s_barrier
    s_add_u32 s33, s33, 1048576
    s_add_u32 s37, s37, 1048576
    s_add_u32 s32, s32, 1048576
    s_add_u32 s38, s38, 1
    s_xor_b32 s28, s28, 1
    v_mov_b64 v[88:89], v[96:97]
    v_mov_b64 v[90:91], v[98:99]
    v_mov_b64 v[92:93], v[100:101]
    v_mov_b64 v[94:95], v[102:103]
    v_mov_b64 v[80:81], v[48:49]
    v_mov_b64 v[82:83], v[50:51]
    v_mov_b64 v[84:85], v[52:53]
    v_mov_b64 v[86:87], v[54:55]
    v_mov_b64 v[56:57], 0
    v_mov_b64 v[58:59], 0
    v_mov_b64 v[60:61], 0
    v_mov_b64 v[62:63], 0
    v_mov_b64 v[64:65], 0
    v_mov_b64 v[66:67], 0
    v_mov_b64 v[68:69], 0
    v_mov_b64 v[70:71], 0
    v_mov_b64 v[72:73], 0
    v_mov_b64 v[74:75], 0
    v_mov_b64 v[76:77], 0
    v_mov_b64 v[78:79], 0
    s_add_u32 s34, s34, 1048576
    s_add_u32 s72, s72, 1048576
    ds_read_b128 v[32:35], v128 offset:6144
    ds_read_b128 v[36:39], v128 offset:7168
    ds_read_b128 v[40:43], v128 offset:63488
    ds_read_b128 v[44:47], v128 offset:64512
    s_add_u32 s43, s43, 1
    s_nop 5
    buffer_load_dwordx4 v[0:3], v127, s[8:11], s29 offen sc1
    buffer_load_dwordx4 v[4:7], v127, s[8:11], s29 offen offset:1024 sc1
    s_waitcnt lgkmcnt(0)
    s_branch LS3_pollP
LS3_done:
    buffer_store_dword v112, v131, s[8:11], s33 offen sc1
    s_waitcnt vmcnt(0)
    s_endpgm
LS3_retryE:
    buffer_load_dwordx4 v[4:7], v127, s[8:11], s30 offen sc1
    buffer_load_dwordx4 v[28:31], v127, s[8:11], s68 offen sc1
    s_sub_u32 s22, s22, 1
    s_cbranch_scc1 L_exit
    s_nop 3
    v_mov_b64 v[56:57], 0
    v_mov_b64 v[58:59], 0
    v_mov_b64 v[60:61], 0
    v_mov_b64 v[62:63], 0
    s_waitcnt vmcnt(1)
    s_branch LS3_bA
LS3_retryL:
    buffer_load_dwordx4 v[28:31], v127, s[8:11], s68 offen sc1
    s_sub_u32 s22, s22, 1
    s_cbranch_scc1 L_exit
    s_waitcnt vmcnt(0)
    v_max3_u32 v141, v28, v29, v30
    v_max_u32 v141, v141, v31
    v_cmp_eq_u32 vcc, -1, v141
    s_cbranch_vccnz LS3_retryL
    ds_write_b128 v127, v[28:31] offset:7168
    s_waitcnt lgkmcnt(0)
    s_branch LS3_Lok
    s_nop 0
LS3_retryP:
    buffer_load_dwordx4 v[0:3], v127, s[8:11], s29 offen sc1
    buffer_load_dwordx4 v[4:7], v127, s[8:11], s29 offen offset:1024 sc1
    s_sub_u32 s22, s22, 1
    s_cbranch_scc1 L_exit
    s_branch LS3_pollP
LS3_slowflag:
LS3_sf_spin:
    buffer_load_dword v138, off, s[8:11], s37 sc1
    s_sub_u32 s22, s22, 1
    s_cbranch_scc1 L_exit
    s_waitcnt vmcnt(0)
    v_readfirstlane_b32 s41, v138
    s_cmp_eq_u32 s41, -1
    s_cbranch_scc1 LS3_sf_spin
    s_branch LS3_flagok
    s_nop 1
LS3_lead:
    s_waitcnt vmcnt(2)
    s_nop 12
    s_branch LS3_leadok
LS3_fallback:
    s_nop 7
    v_lshlrev_b32 v142, 1, v132
    v_subrev_u32 v142, 20480, v142
    ds_write_b32 v142, v104
    v_min_u32 v142, v133, v134
    v_lshlrev_b32 v142, 1, v142
    v_subrev_u32 v142, 20480, v142
    s_waitcnt lgkmcnt(0)
    s_barrier
    ds_read_b128 v[56:59], v142
    ds_read_b128 v[60:63], v142 offset:16
    s_waitcnt lgkmcnt(1)
    v_max3_f32 v141, v56, v57, v58
    s_waitcnt lgkmcnt(0)
    v_max3_f32 v141, v141, v59, v60
    v_max3_f32 v141, v141, v61, v62
    v_max3_f32 v141, v141, v63, v105
    s_nop 1
    v_max_f32_dpp v141, v141, v141 quad_perm:[2,3,0,1] row_mask:0xf bank_mask:0xf
    v_mov_b32 v142, v141
    s_nop 1
    v_permlane16_swap_b32 v141, v142
    v_max_f32 v141, v141, v142
    v_mov_b32 v142, v141
    s_nop 1
    v_permlane32_swap_b32 v141, v142
    v_max_f32 v141, v141, v142
    v_sub_f32 v56, v56, v141
    v_exp_f32 v56, v56
    v_sub_f32 v57, v57, v141
    v_exp_f32 v57, v57
    v_sub_f32 v58, v58, v141
    v_exp_f32 v58, v58
    v_sub_f32 v59, v59, v141
    v_exp_f32 v59, v59
    v_sub_f32 v60, v60, v141
    v_exp_f32 v60, v60
    v_sub_f32 v61, v61, v141
    v_exp_f32 v61, v61
    v_sub_f32 v62, v62, v141
    v_exp_f32 v62, v62
    v_sub_f32 v63, v63, v141
    v_exp_f32 v63, v63
    v_sub_f32 v107, v105, v141
    v_exp_f32 v107, v107
    s_nop 1
    v_mov_b32_dpp v108, v107 quad_perm:[2,3,0,1] row_mask:0xf bank_mask:0xf
    v_cvt_pk_bf16_f32 v107, v107, v108
    v_cndmask_b32 v68, v107, 0, s[24:25]
    v_cndmask_b32 v69, 0, v107, s[24:25]
    v_cvt_pk_bf16_f32 v142, v56, v57
    v_cndmask_b32 v110, v142, 0, s[24:25]
    v_cndmask_b32 v114, 0, v142, s[24:25]
    v_cvt_pk_bf16_f32 v142, v58, v59
    v_cndmask_b32 v111, v142, 0, s[24:25]
    v_cndmask_b32 v115, 0, v142, s[24:25]
    v_cvt_pk_bf16_f32 v142, v60, v61
    v_cndmask_b32 v112, v142, 0, s[24:25]
    v_cndmask_b32 v116, 0, v142, s[24:25]
    v_cvt_pk_bf16_f32 v142, v62, v63
    v_cndmask_b32 v113, v142, 0, s[24:25]
    v_cndmask_b32 v117, 0, v142, s[24:25]
    s_nop 0
    v_mfma_f32_16x16x32_bf16 v[118:121], v[88:91], v[110:113], 0
    v_mfma_f32_16x16x32_bf16 v[118:121], v[92:95], v[114:117], v[118:121]
    v_mfma_f32_16x16x32_bf16 v[64:67], v[122:125], v[110:113], 0
    s_nop 5
    v_mfma_f32_16x16x16_bf16 v[64:67], v[122:123], v[68:69], v[64:67]
    v_mfma_f32_16x16x16_bf16 v[118:121], v[72:73], v[68:69], v[118:121]
    s_nop 3
    v_rcp_f32_dpp v141, v64 quad_perm:[0,1,0,1] row_mask:0xf bank_mask:0xf
    s_mov_b64 vcc, 0
    s_nop 1
    s_branch LS3_norm
    s_endpgm
.section .rodata,"a"
.p2align 6
.amdhsa_kernel gated_mix__memory_aug_recurrent_mem_tr__ssm_conv_h3__prompt_kernel
  .amdhsa_next_free_vgpr 512
  .amdhsa_next_free_sgpr 102
  .amdhsa_accum_offset 256
  .amdhsa_group_segment_fixed_size 0
  .amdhsa_kernarg_size 136
  .amdhsa_user_sgpr_count 2
  .amdhsa_user_sgpr_kernarg_segment_ptr 1
  .amdhsa_system_sgpr_workgroup_id_x 1
.end_amdhsa_kernel
```
